```python
import torch

def _softmax(x, axis=-1):
    return torch.softmax(x, dim=axis)

def _gelu(x):
    return torch.nn.functional.gelu(x, approximate='tanh')

def _silu(x):
    return torch.nn.functional.silu(x)

def _sigmoid(x):
    return torch.sigmoid(x)

def _layernorm(x, axis=-1, eps=1e-05):
    m = x.mean(dim=axis, keepdim=True)
    v = x.var(dim=axis, keepdim=True, unbiased=False)
    return (x - m) / torch.sqrt(v + eps)

def _scatter_add(tgt, idx, src, axis=0):
    return tgt.clone().index_add_(axis, idx, src)

def _segment_sum(src, seg, n):
    out = torch.zeros((n,) + src.shape[1:], dtype=src.dtype)
    return out.index_add_(0, seg, src)

def _pad(x, pw):
    flat = tuple((v for pair in reversed(pw) for v in pair))
    return torch.nn.functional.pad(x, flat)
kernel_name = 'parallel_sum__memory_aug_recurrent_mem_tr__dense_activation_mish__prompt'

def setup_inputs():

    _w = lambda a: (lambda t: t.to(torch.bfloat16) if t.is_floating_point() else t)(torch.as_tensor(a))

    def _A_setup():
        B, S, Dm = (1, 2048, 1024)
        H, Dh = (32, 128)
        M, seg = (8, 32)
        seg = min(seg, S)
        S = S // seg * seg
        return {'x': _w((lambda *s: torch.randn(*s, dtype=torch.bfloat16) * 0.05)(B, S, Dm)), 'mem0': _w((lambda *s: torch.randn(*s, dtype=torch.bfloat16) * 0.2)(B, M, Dm)), 'Wq': _w((lambda *s: torch.randn(*s, dtype=torch.bfloat16) * 1.6)(Dm, H, Dh) * Dm ** (-0.5)), 'Wk': _w((lambda *s: torch.randn(*s, dtype=torch.bfloat16) * 1.6)(Dm, H, Dh) * Dm ** (-0.5)), 'Wv': _w((lambda *s: torch.randn(*s, dtype=torch.bfloat16) * 0.2)(Dm, H, Dh) * Dm ** (-0.5)), 'Wo': _w((lambda *s: torch.randn(*s, dtype=torch.bfloat16) * 0.2)(H, Dh, Dm) * (H * Dh) ** (-0.5)), 'seg_len': seg}
    _A_in = _A_setup()

    def _B_setup():
        B, S, D, F = (1, 2048, 1024, 3584)
        return {'x': _w((lambda *s: torch.randn(*s, dtype=torch.bfloat16) * 0.05)(B, S, D)), 'w1': _w((lambda *s: torch.randn(*s, dtype=torch.bfloat16) * 0.4)(D, F) * D ** (-0.5)), 'b1': _w((lambda *s: torch.randn(*s, dtype=torch.bfloat16) * 0.1)(F)), 'w2': _w((lambda *s: torch.randn(*s, dtype=torch.bfloat16) * 0.1)(F, D) * F ** (-0.5))}
    _B_in = _B_setup()
    return {'A_x': _A_in['x'], 'A_mem0': _A_in['mem0'], 'A_Wq': _A_in['Wq'], 'A_Wk': _A_in['Wk'], 'A_Wv': _A_in['Wv'], 'A_Wo': _A_in['Wo'], 'A_seg_len': _A_in['seg_len'], 'B_x': _B_in['x'], 'B_w1': _B_in['w1'], 'B_b1': _B_in['b1'], 'B_w2': _B_in['w2']}

def reference(A_x, A_mem0, A_Wq, A_Wk, A_Wv, A_Wo, A_seg_len, B_x, B_w1, B_b1, B_w2):

    def _A_ref(x, mem0, Wq, Wk, Wv, Wo, seg_len):
        B, S, Dm = x.shape
        H, Dh = (Wq.shape[1], Wq.shape[2])
        M = mem0.shape[1]
        scale = Dh ** (-0.5)
        n_seg = S // seg_len
        L = M + seg_len
        idx = torch.arange(L)
        mask = (idx[:, None] < M) | (idx[:, None] >= idx[None, :])
        mem = mem0
        outs = []
        for s in range(n_seg):
            xs = x[:, s * seg_len:(s + 1) * seg_len, :].clone()
            h = torch.concatenate([mem, xs], axis=1)
            q = torch.einsum('btd,dhe->bhte', h, Wq)
            k = torch.einsum('btd,dhe->bhte', h, Wk)
            v = torch.einsum('btd,dhe->bhte', h, Wv)
            scores = torch.einsum('bhqe,bhke->bhqk', q, k) * scale
            scores = torch.where(mask[None, None], scores, -1000000000.0)
            p = _softmax(scores, axis=-1)
            o = torch.einsum('bhqk,bhke->bhqe', p, v)
            o = torch.einsum('bhte,hed->btd', o, Wo)
            mem = o[:, :M, :].clone()
            outs.append(o[:, M:, :])
        return torch.concatenate(outs, axis=1)

    def _B_ref(x, w1, b1, w2):
        h = torch.einsum('bsd,df->bsf', x, w1) + b1
        sp = torch.log1p(torch.exp(-torch.abs(h))) + torch.where(h > 0, h, torch.zeros_like(h))
        act = h * torch.tanh(sp)
        return torch.einsum('bsf,fd->bsd', act, w2)
    x = A_x
    xn = _layernorm(x, axis=-1)
    return x + _A_ref(xn, A_mem0, A_Wq, A_Wk, A_Wv, A_Wo, A_seg_len) + _B_ref(xn, B_w1, B_b1, B_w2)
```

```asm
; @launch kernel=main_kernel grid=(256,1,1) block=(256,1,1) lds=147456
.amdgcn_target "amdgcn-amd-amdhsa--gfx950"
.text
.globl main_kernel
.p2align 8
.type main_kernel,@function
main_kernel:
    s_cmp_ge_u32 s2, 256
    s_cbranch_scc1 Lch_end
    s_getpc_b64 s[4:5]
Lcode0:
    s_and_b32 s5, s5, 0xffff
    s_mov_b32 s6, Lcode1-Lcode0
    s_mov_b32 s7, 0x20000
    v_lshlrev_b32 v192, 7, v0
    s_mov_b32 s3, 0x8000
    buffer_load_dword v193, v192, s[4:7], 0 offen
    buffer_load_dword v194, v192, s[4:7], s3 offen
    s_mov_b32 s3, 0x10000
    buffer_load_dword v195, v192, s[4:7], s3 offen
    s_getreg_b32 s3, hwreg(HW_REG_XCC_ID, 0, 3)
    s_sub_u32 s3, s3, s2
    s_and_b32 s3, s3, 7
    s_or_b32 s3, s3, 8
    s_cmp_lg_u32 s2, 0
    s_cbranch_scc1 Lrole
    s_load_dwordx2 s[4:5], s[0:1], 96
    v_mov_b32 v2, 0
    v_mov_b32 v3, s3
    s_mov_b32 s6, 256
    s_waitcnt lgkmcnt(0)
    s_mov_b64 exec, 1
    buffer_store_dword v3, v2, s[4:7], 0 offen offset:144 sc1
    s_mov_b64 exec, -1
Lrole:
    s_add_u32 s97, s2, s3
    s_and_b32 s97, s97, 7
    s_and_b32 s96, s2, 0xf8
    s_or_b32 s97, s97, s96
    s_and_b32 s20, s97, 3
    s_lshl_b32 s20, s20, 1
    s_lshr_b32 s21, s97, 7
    s_add_u32 s20, s20, s21
    s_bfe_u32 s21, s97, 0x40003
    s_bitcmp1_b32 s97, 2
    s_cbranch_scc1 Lworker
    s_load_dwordx2 s[4:5], s[0:1], 8
    s_load_dwordx8 s[64:71], s[0:1], 16
    s_load_dwordx4 s[52:55], s[0:1], 96
    v_lshrrev_b32 v2, 6, v0
    v_and_b32 v1, 63, v0
    s_nop 0
    v_readfirstlane_b32 s22, v2
    s_waitcnt lgkmcnt(0)
    s_mov_b32 s8, s54
    s_mov_b32 s9, s55
    s_mov_b32 s10, 0x10000000
    s_mov_b32 s11, 0x20000
    s_lshl_b32 s34, s20, 10
    s_lshr_b32 s35, s21, 1
    s_lshl_b32 s35, s35, 7
    s_add_u32 s86, s34, s35
    s_lshl_b32 s34, s22, 16
    s_add_u32 s84, s86, s34
    s_mov_b32 s86, s84
    s_and_b32 s34, s21, 1
    s_cselect_b64 s[64:65], s[66:67], s[64:65]
    s_nop 0
    s_lshl_b32 s34, s20, 20
    s_lshl_b32 s35, s21, 7
    s_add_u32 s85, s34, s35
    s_lshl_b32 s34, s22, 18
    s_add_u32 s85, s85, s34
    v_lshrrev_b32 v5, 3, v1
    v_and_b32 v6, 7, v1
    v_lshlrev_b32 v6, 4, v6
    v_lshl_add_u32 v104, v5, 13, v6
    v_lshl_add_u32 v105, v5, 11, v6
    v_bfe_u32 v6, v1, 2, 1
    s_and_b32 s34, s21, 1
    v_xor_b32 v6, s34, v6
    v_lshl_add_u32 v106, v6, 22, v104
    s_mov_b32 s16, s64
    s_mov_b32 s17, s65
    s_mov_b32 s18, 0x800000
    s_mov_b32 s19, 0x20000
    s_lshl_b32 s61, s21, 2
    s_add_u32 s61, s61, s22
    s_mul_i32 s60, s61, 768
    s_lshl_b32 s7, s20, 18
    s_add_u32 s7, s7, 90177536
    v_lshl_add_u32 v253, v1, 4, s60
    s_lshl_b32 s62, s20, 6
    s_add_u32 s61, s61, s62
    s_lshl_b32 s61, s61, 11
    s_add_u32 s61, s61, 88080384
    s_and_b32 s27, s21, 1
    s_mov_b32 s60, s7
    v_lshlrev_b32 v34, 4, v1
    v_mov_b32 v36, -1
    v_mov_b32 v37, -1
    v_mov_b32 v38, -1
    v_mov_b32 v39, -1
    buffer_store_dwordx4 v[36:39], v34, s[8:11], s61 offen offset:0 sc1
    buffer_store_dwordx4 v[36:39], v34, s[8:11], s61 offen offset:1024 sc1
    s_mov_b32 exec_hi, 0xffff
    buffer_store_dwordx4 v[36:39], v253, s[8:11], s60 offen sc1
    s_add_u32 s60, s60, 0x10000
    buffer_store_dwordx4 v[36:39], v253, s[8:11], s60 offen sc1
    s_add_u32 s60, s60, 0x10000
    buffer_store_dwordx4 v[36:39], v253, s[8:11], s60 offen sc1
    s_add_u32 s60, s60, 0x10000
    buffer_store_dwordx4 v[36:39], v253, s[8:11], s60 offen sc1
    s_add_u32 s60, s60, 0x10000
    s_mov_b32 exec_hi, -1
    s_mov_b32 s16, s68
    s_mov_b32 s17, s69
    s_mov_b32 s87, s86
    buffer_load_dwordx4 a[128:131], v106, s[16:19], s87 offen
    s_add_u32 s87, s87, 262144
    buffer_load_dwordx4 a[132:135], v106, s[16:19], s87 offen
    s_add_u32 s87, s87, 262144
    buffer_load_dwordx4 a[136:139], v106, s[16:19], s87 offen
    s_add_u32 s87, s87, 262144
    buffer_load_dwordx4 a[140:143], v106, s[16:19], s87 offen
    s_add_u32 s87, s87, 262144
    buffer_load_dwordx4 a[144:147], v106, s[16:19], s87 offen
    s_add_u32 s87, s87, 262144
    buffer_load_dwordx4 a[148:151], v106, s[16:19], s87 offen
    s_add_u32 s87, s87, 262144
    buffer_load_dwordx4 a[152:155], v106, s[16:19], s87 offen
    s_add_u32 s87, s87, 262144
    buffer_load_dwordx4 a[156:159], v106, s[16:19], s87 offen
    s_add_u32 s87, s87, 262144
    buffer_load_dwordx4 a[160:163], v106, s[16:19], s87 offen
    s_add_u32 s87, s87, 262144
    buffer_load_dwordx4 a[164:167], v106, s[16:19], s87 offen
    s_add_u32 s87, s87, 262144
    buffer_load_dwordx4 a[168:171], v106, s[16:19], s87 offen
    s_add_u32 s87, s87, 262144
    buffer_load_dwordx4 a[172:175], v106, s[16:19], s87 offen
    s_add_u32 s87, s87, 262144
    buffer_load_dwordx4 a[176:179], v106, s[16:19], s87 offen
    s_add_u32 s87, s87, 262144
    buffer_load_dwordx4 a[180:183], v106, s[16:19], s87 offen
    s_add_u32 s87, s87, 262144
    buffer_load_dwordx4 a[184:187], v106, s[16:19], s87 offen
    s_add_u32 s87, s87, 262144
    buffer_load_dwordx4 a[188:191], v106, s[16:19], s87 offen
    s_add_u32 s87, s87, 262144
    s_cmp_eq_u32 s27, 0
    s_cbranch_scc1 Lch_nq
    s_mov_b32 s16, s64
    s_mov_b32 s17, s65
    s_mov_b32 s87, s84
    buffer_load_dwordx4 a[0:3], v104, s[16:19], s87 offen
    s_add_u32 s87, s87, 262144
    buffer_load_dwordx4 a[4:7], v104, s[16:19], s87 offen
    s_add_u32 s87, s87, 262144
    buffer_load_dwordx4 a[8:11], v104, s[16:19], s87 offen
    s_add_u32 s87, s87, 262144
    buffer_load_dwordx4 a[12:15], v104, s[16:19], s87 offen
    s_add_u32 s87, s87, 262144
    buffer_load_dwordx4 a[16:19], v104, s[16:19], s87 offen
    s_add_u32 s87, s87, 262144
    buffer_load_dwordx4 a[20:23], v104, s[16:19], s87 offen
    s_add_u32 s87, s87, 262144
    buffer_load_dwordx4 a[24:27], v104, s[16:19], s87 offen
    s_add_u32 s87, s87, 262144
    buffer_load_dwordx4 a[28:31], v104, s[16:19], s87 offen
    s_add_u32 s87, s87, 262144
    buffer_load_dwordx4 a[32:35], v104, s[16:19], s87 offen
    s_add_u32 s87, s87, 262144
    buffer_load_dwordx4 a[36:39], v104, s[16:19], s87 offen
    s_add_u32 s87, s87, 262144
    buffer_load_dwordx4 a[40:43], v104, s[16:19], s87 offen
    s_add_u32 s87, s87, 262144
    buffer_load_dwordx4 a[44:47], v104, s[16:19], s87 offen
    s_add_u32 s87, s87, 262144
    buffer_load_dwordx4 a[48:51], v104, s[16:19], s87 offen
    s_add_u32 s87, s87, 262144
    buffer_load_dwordx4 a[52:55], v104, s[16:19], s87 offen
    s_add_u32 s87, s87, 262144
    buffer_load_dwordx4 a[56:59], v104, s[16:19], s87 offen
    s_add_u32 s87, s87, 262144
    buffer_load_dwordx4 a[60:63], v104, s[16:19], s87 offen
    s_add_u32 s87, s87, 262144
    buffer_load_dwordx4 a[64:67], v104, s[16:19], s87 offen
    s_add_u32 s87, s87, 262144
    buffer_load_dwordx4 a[68:71], v104, s[16:19], s87 offen
    s_add_u32 s87, s87, 262144
    buffer_load_dwordx4 a[72:75], v104, s[16:19], s87 offen
    s_add_u32 s87, s87, 262144
    buffer_load_dwordx4 a[76:79], v104, s[16:19], s87 offen
    s_add_u32 s87, s87, 262144
    buffer_load_dwordx4 a[80:83], v104, s[16:19], s87 offen
    s_add_u32 s87, s87, 262144
    buffer_load_dwordx4 a[84:87], v104, s[16:19], s87 offen
    s_add_u32 s87, s87, 262144
    buffer_load_dwordx4 a[88:91], v104, s[16:19], s87 offen
    s_add_u32 s87, s87, 262144
    buffer_load_dwordx4 a[92:95], v104, s[16:19], s87 offen
    s_add_u32 s87, s87, 262144
    buffer_load_dwordx4 a[96:99], v104, s[16:19], s87 offen
    s_add_u32 s87, s87, 262144
    buffer_load_dwordx4 a[100:103], v104, s[16:19], s87 offen
    s_add_u32 s87, s87, 262144
    buffer_load_dwordx4 a[104:107], v104, s[16:19], s87 offen
    s_add_u32 s87, s87, 262144
    buffer_load_dwordx4 a[108:111], v104, s[16:19], s87 offen
    s_add_u32 s87, s87, 262144
    buffer_load_dwordx4 a[112:115], v104, s[16:19], s87 offen
    s_add_u32 s87, s87, 262144
    buffer_load_dwordx4 a[116:119], v104, s[16:19], s87 offen
    s_add_u32 s87, s87, 262144
    buffer_load_dwordx4 a[120:123], v104, s[16:19], s87 offen
    s_add_u32 s87, s87, 262144
    buffer_load_dwordx4 a[124:127], v104, s[16:19], s87 offen
    s_add_u32 s87, s87, 262144
    s_branch Lch_nr
Lch_nq:
    s_mov_b32 s16, s64
    s_mov_b32 s17, s65
    s_mov_b32 s87, s84
    buffer_load_dwordx4 a[0:3], v104, s[16:19], s87 offen nt
    s_add_u32 s87, s87, 262144
    buffer_load_dwordx4 a[4:7], v104, s[16:19], s87 offen nt
    s_add_u32 s87, s87, 262144
    buffer_load_dwordx4 a[8:11], v104, s[16:19], s87 offen nt
    s_add_u32 s87, s87, 262144
    buffer_load_dwordx4 a[12:15], v104, s[16:19], s87 offen nt
    s_add_u32 s87, s87, 262144
    buffer_load_dwordx4 a[16:19], v104, s[16:19], s87 offen nt
    s_add_u32 s87, s87, 262144
    buffer_load_dwordx4 a[20:23], v104, s[16:19], s87 offen nt
    s_add_u32 s87, s87, 262144
    buffer_load_dwordx4 a[24:27], v104, s[16:19], s87 offen nt
    s_add_u32 s87, s87, 262144
    buffer_load_dwordx4 a[28:31], v104, s[16:19], s87 offen nt
    s_add_u32 s87, s87, 262144
    buffer_load_dwordx4 a[32:35], v104, s[16:19], s87 offen nt
    s_add_u32 s87, s87, 262144
    buffer_load_dwordx4 a[36:39], v104, s[16:19], s87 offen nt
    s_add_u32 s87, s87, 262144
    buffer_load_dwordx4 a[40:43], v104, s[16:19], s87 offen nt
    s_add_u32 s87, s87, 262144
    buffer_load_dwordx4 a[44:47], v104, s[16:19], s87 offen nt
    s_add_u32 s87, s87, 262144
    buffer_load_dwordx4 a[48:51], v104, s[16:19], s87 offen nt
    s_add_u32 s87, s87, 262144
    buffer_load_dwordx4 a[52:55], v104, s[16:19], s87 offen nt
    s_add_u32 s87, s87, 262144
    buffer_load_dwordx4 a[56:59], v104, s[16:19], s87 offen nt
    s_add_u32 s87, s87, 262144
    buffer_load_dwordx4 a[60:63], v104, s[16:19], s87 offen nt
    s_add_u32 s87, s87, 262144
    buffer_load_dwordx4 a[64:67], v104, s[16:19], s87 offen nt
    s_add_u32 s87, s87, 262144
    buffer_load_dwordx4 a[68:71], v104, s[16:19], s87 offen nt
    s_add_u32 s87, s87, 262144
    buffer_load_dwordx4 a[72:75], v104, s[16:19], s87 offen nt
    s_add_u32 s87, s87, 262144
    buffer_load_dwordx4 a[76:79], v104, s[16:19], s87 offen nt
    s_add_u32 s87, s87, 262144
    buffer_load_dwordx4 a[80:83], v104, s[16:19], s87 offen nt
    s_add_u32 s87, s87, 262144
    buffer_load_dwordx4 a[84:87], v104, s[16:19], s87 offen nt
    s_add_u32 s87, s87, 262144
    buffer_load_dwordx4 a[88:91], v104, s[16:19], s87 offen nt
    s_add_u32 s87, s87, 262144
    buffer_load_dwordx4 a[92:95], v104, s[16:19], s87 offen nt
    s_add_u32 s87, s87, 262144
    buffer_load_dwordx4 a[96:99], v104, s[16:19], s87 offen nt
    s_add_u32 s87, s87, 262144
    buffer_load_dwordx4 a[100:103], v104, s[16:19], s87 offen nt
    s_add_u32 s87, s87, 262144
    buffer_load_dwordx4 a[104:107], v104, s[16:19], s87 offen nt
    s_add_u32 s87, s87, 262144
    buffer_load_dwordx4 a[108:111], v104, s[16:19], s87 offen nt
    s_add_u32 s87, s87, 262144
    buffer_load_dwordx4 a[112:115], v104, s[16:19], s87 offen nt
    s_add_u32 s87, s87, 262144
    buffer_load_dwordx4 a[116:119], v104, s[16:19], s87 offen nt
    s_add_u32 s87, s87, 262144
    buffer_load_dwordx4 a[120:123], v104, s[16:19], s87 offen nt
    s_add_u32 s87, s87, 262144
    buffer_load_dwordx4 a[124:127], v104, s[16:19], s87 offen nt
    s_add_u32 s87, s87, 262144
Lch_nr:
    s_mov_b32 s72, s52
    s_mov_b32 s73, s53
    s_mov_b32 s74, 0x100
    s_mov_b32 s75, 0x20000
    v_mov_b32 v100, 0
    buffer_load_dword v107, v100, s[72:75], 0 offen offset:144 sc1
    s_mov_b32 s16, s70
    s_mov_b32 s17, s71
    s_mov_b32 s87, s85
    buffer_load_dwordx4 a[192:195], v105, s[16:19], s87 offen nt
    s_add_u32 s87, s87, 16384
    buffer_load_dwordx4 a[196:199], v105, s[16:19], s87 offen nt
    s_add_u32 s87, s87, 16384
    buffer_load_dwordx4 a[200:203], v105, s[16:19], s87 offen nt
    s_add_u32 s87, s87, 16384
    buffer_load_dwordx4 a[204:207], v105, s[16:19], s87 offen nt
    s_add_u32 s87, s87, 16384
    buffer_load_dwordx4 a[208:211], v105, s[16:19], s87 offen nt
    s_add_u32 s87, s87, 16384
    buffer_load_dwordx4 a[212:215], v105, s[16:19], s87 offen nt
    s_add_u32 s87, s87, 16384
    buffer_load_dwordx4 a[216:219], v105, s[16:19], s87 offen nt
    s_add_u32 s87, s87, 16384
    buffer_load_dwordx4 a[220:223], v105, s[16:19], s87 offen nt
    s_add_u32 s87, s87, 16384
    buffer_load_dwordx4 a[224:227], v105, s[16:19], s87 offen nt
    s_add_u32 s87, s87, 16384
    buffer_load_dwordx4 a[228:231], v105, s[16:19], s87 offen nt
    s_add_u32 s87, s87, 16384
    buffer_load_dwordx4 a[232:235], v105, s[16:19], s87 offen nt
    s_add_u32 s87, s87, 16384
    buffer_load_dwordx4 a[236:239], v105, s[16:19], s87 offen nt
    s_add_u32 s87, s87, 16384
    buffer_load_dwordx4 a[240:243], v105, s[16:19], s87 offen nt
    s_add_u32 s87, s87, 16384
    buffer_load_dwordx4 a[244:247], v105, s[16:19], s87 offen nt
    s_add_u32 s87, s87, 16384
    buffer_load_dwordx4 a[248:251], v105, s[16:19], s87 offen nt
    s_add_u32 s87, s87, 16384
    buffer_load_dwordx4 a[252:255], v105, s[16:19], s87 offen nt
    s_add_u32 s87, s87, 16384
    buffer_load_dword v101, v100, s[72:75], 0 offen offset:128 sc1
    v_and_b32 v2, 15, v1
    v_lshrrev_b32 v3, 4, v1
    v_and_b32 v4, 7, v1
    s_lshl_b32 s34, s22, 10
    v_lshl_add_u32 v88, v1, 4, s34
    v_and_b32 v5, 32, v1
    v_xor_b32 v88, v88, v5
    v_xor_b32 v89, 64, v88
    v_add_u32 v90, 0x10000, v88
    v_add_u32 v91, 0x10000, v89
    s_lshl_b32 s34, s22, 14
    s_add_u32 s34, s34, 65536
    v_lshl_add_u32 v92, v1, 4, s34
    v_and_b32 v5, 16, v1
    v_lshlrev_b32 v5, 1, v5
    v_xor_b32 v92, v92, v5
    v_xor_b32 v93, 64, v92
    v_lshrrev_b32 v6, 2, v2
    v_lshl_add_u32 v6, v3, 3, v6
    v_lshlrev_b32 v6, 7, v6
    v_and_b32 v7, 3, v2
    v_lshl_add_u32 v6, v7, 3, v6
    v_bfe_u32 v8, v2, 3, 1
    v_and_b32 v9, 1, v3
    v_lshl_add_u32 v5, v9, 1, v8
    v_lshl_add_u32 v6, v5, 5, v6
    v_add_u32 v6, s34, v6
    v_xor_b32 v96, 0, v6
    v_xor_b32 v97, 32, v6
    v_xor_b32 v98, 64, v6
    v_xor_b32 v99, 96, v6
    v_lshlrev_b32 v6, 5, v8
    v_bfe_u32 v5, v2, 2, 1
    v_add_u32 v6, v6, v5
    v_lshl_add_u32 v6, v3, 2, v6
    v_lshlrev_b32 v6, 7, v6
    v_lshl_add_u32 v6, v7, 3, v6
    v_lshl_add_u32 v5, v8, 1, v9
    v_xor_b32 v5, s22, v5
    v_lshl_add_u32 v95, v5, 5, v6
    s_lshl_b32 s44, s27, 1
    s_xor_b32 s44, s44, s22
    s_lshl_b32 s57, s44, 15
    v_add_u32 v84, s57, v95
    v_xor_b32 v85, 0x8000, v84
    v_xor_b32 v86, 0x10000, v84
    v_xor_b32 v87, 0x18000, v84
    s_and_b32 s57, s57, 0x8000
    v_add_u32 v94, s57, v95
    v_xor_b32 v95, 0x8000, v94
    s_getreg_b32 s63, hwreg(HW_REG_XCC_ID, 0, 3)
    s_mul_i32 s62, s63, s63
    s_lshl_b32 s62, s62, 12
    s_lshl_b32 s63, s63, 5
    s_add_u32 s63, s63, s62
    s_add_u32 s63, s63, 1
    s_lshl_b32 s34, s44, 12
    v_lshl_add_u32 v10, v1, 4, s34
    s_and_b32 s35, s22, 1
    v_xor_b32 v12, 0x1000, v10
    v_xor_b32 v13, 0x2000, v10
    v_xor_b32 v120, 0x3000, v10
    s_lshr_b32 s56, s21, 2
    s_lshl_b32 s56, s56, 13
    s_bfe_u32 s57, s21, 0x10001
    s_lshl_b32 s57, s57, 11
    s_add_u32 s41, s56, s57
    v_and_b32 v5, 1, v3
    v_lshlrev_b32 v5, 3, v5
    v_lshl_add_u32 v5, v4, 4, v5
    v_lshrrev_b32 v6, 1, v3
    v_lshl_add_u32 v5, v6, 8, v5
    s_lshl_b32 s57, s22, 9
    s_lshl_b32 s58, s27, 7
    s_add_u32 s57, s57, s58
    s_add_u32 s57, s57, s41
    v_add_u32 v14, s57, v5
    v_add_u32 v15, 4096, v14
    s_lshr_b32 s58, s22, 1
    s_lshl_b32 s58, s58, 7
    v_xor_b32 v15, s58, v15
    v_and_b32 v7, 1, v3
    v_cmp_eq_u32 vcc, 1, v7
    v_subrev_u32 v7, 8, v15
    s_nop 0
    v_cndmask_b32 v32, v14, v7, vcc
    s_or_b32 s40, s21, s22
    s_lshl_b32 s58, s22, 13
    v_lshl_add_u32 v16, v1, 4, s58
    v_add_u32 v17, 4096, v16
    s_lshl_b32 s58, s20, 2
    s_add_u32 s58, s58, s22
    s_lshl_b32 s58, s58, 13
    v_lshlrev_b32 v7, 9, v3
    v_lshl_add_u32 v7, v2, 4, v7
    v_add_u32 v18, s58, v7
    v_add_u32 v19, 4096, v18
    s_lshl_b32 s58, s22, 11
    s_add_u32 s58, s58, 20480
    v_lshlrev_b32 v7, 7, v3
    v_lshl_add_u32 v7, v4, 4, v7
    v_lshrrev_b32 v8, 3, v2
    v_lshl_add_u32 v7, v8, 10, v7
    v_add_u32 v20, s58, v7
    s_lshl_b32 s58, s22, 9
    s_add_u32 s58, s58, 20480
    v_lshrrev_b32 v7, 5, v1
    v_lshlrev_b32 v7, 8, v7
    v_bfe_u32 v8, v1, 1, 1
    v_lshl_add_u32 v7, v8, 7, v7
    v_bfe_u32 v8, v1, 2, 3
    v_lshl_add_u32 v7, v8, 4, v7
    v_and_b32 v8, 1, v1
    v_lshl_add_u32 v7, v8, 3, v7
    v_add_u32 v21, s58, v7
    v_lshlrev_b32 v24, 2, v1
    s_lshl_b32 s58, s21, 10
    s_lshl_b32 s59, s35, 9
    s_add_u32 s58, s58, s59
    s_lshr_b32 s59, s22, 1
    s_lshl_b32 s59, s59, 7
    s_add_u32 s58, s58, s59
    v_lshrrev_b32 v7, 3, v2
    v_lshlrev_b32 v7, 8, v7
    v_lshl_add_u32 v7, v4, 4, v7
    v_and_b32 v8, 1, v3
    v_lshl_add_u32 v7, v8, 3, v7
    v_add_u32 v25, s58, v7
    v_lshlrev_b32 v35, 4, v1
    v_and_b32 v7, 1, v2
    v_lshlrev_b32 v7, 4, v7
    v_mov_b32 v8, 0x3f80
    v_lshlrev_b32 v7, v7, v8
    v_lshrrev_b32 v8, 1, v2
    v_cmp_eq_u32 vcc, 0, v8
    s_nop 1
    v_cndmask_b32 v36, 0, v7, vcc
    v_cmp_eq_u32 vcc, 1, v8
    s_nop 1
    v_cndmask_b32 v37, 0, v7, vcc
    v_cmp_eq_u32 vcc, 2, v8
    s_nop 1
    v_cndmask_b32 v38, 0, v7, vcc
    v_cmp_eq_u32 vcc, 3, v8
    s_nop 1
    v_cndmask_b32 v39, 0, v7, vcc
    s_mov_b32 s38, 0x00ff00ff
    s_mov_b32 s39, 0x00ff00ff
    s_mov_b32 s36, 0x3e0293ee
    s_mov_b32 s37, 0xffff0000
    v_mov_b32 v7, 0xff800000
    v_cmp_gt_u32 vcc, 32, v1
    s_nop 1
    v_cndmask_b32 v40, 0, v7, vcc
    v_cndmask_b32 v41, 0, v7, vcc
    v_cndmask_b32 v42, 0, v7, vcc
    v_cndmask_b32 v43, 0, v7, vcc
    s_mul_i32 s27, s20, 2883584
    s_add_u32 s27, s27, 92274688
    s_lshl_b32 s6, s21, 16
    s_lshl_b32 s34, s22, 11
    s_add_u32 s6, s6, s34
    s_add_u32 s6, s6, 88080384
    s_mov_b32 s29, 20971520
    s_mov_b32 s30, 37748736
    s_mov_b32 s23, 0
    s_lshl_b32 s56, s21, 2
    s_add_u32 s56, s56, s22
    s_lshl_b32 s57, s56, 9
    s_lshl_b32 s58, s20, 15
    s_add_u32 s57, s57, s58
    s_add_u32 s57, s57, 21495808
    v_and_b32 v7, 3, v1
    v_lshl_add_u32 v7, v7, 7, s57
    v_add_u32 v8, 16777216, v7
    v_cmp_gt_u32 vcc, 4, v1
    v_mov_b32 v22, 0x40000
    s_nop 0
    v_cndmask_b32 v26, v8, v7, vcc
    s_lshl_b32 s43, s20, 9
    s_add_u32 s43, s43, 120061952
    s_add_u32 s58, s43, 12
    s_mov_b32 s59, 4
    v_writelane_b32 v26, s58, 8
    v_writelane_b32 v22, s59, 8
    s_mov_b32 s12, s4
    s_mov_b32 s13, s5
    s_mov_b32 s14, 0x4000
    s_mov_b32 s15, 0x20000
    v_lshlrev_b32 v7, 11, v4
    v_lshrrev_b32 v8, 3, v2
    v_lshl_add_u32 v7, v8, 6, v7
    v_lshl_add_u32 v7, v3, 4, v7
    s_lshl_b32 s58, s44, 9
    buffer_load_dwordx4 v[64:67], v7, s[12:15], s58 offen offset:0
    buffer_load_dwordx4 v[68:71], v7, s[12:15], s58 offen offset:128
    buffer_load_dwordx4 v[72:75], v7, s[12:15], s58 offen offset:256
    buffer_load_dwordx4 v[76:79], v7, s[12:15], s58 offen offset:384
    s_mov_b32 s58, 0x11111111
    s_mov_b32 s59, 0x11111111
    s_lshl_b32 s34, s22, 2
    s_add_u32 s34, s34, 16384
    v_lshl_add_u32 v33, v2, 4, s34
    v_mov_b32 v7, 0x7f800000
    v_cndmask_b32 v121, v7, 0, s[38:39]
    v_bfe_u32 v252, v1, 2, 3
    v_lshlrev_b32 v252, 4, v252
    v_add_u32 v252, 16384, v252
    v_mov_b32 v7, 0x4444
    v_mov_b32 v8, 0xeeee
    v_cndmask_b32 v11, v8, v7, s[38:39]
    v_and_b32 v7, 1, v3
    v_lshlrev_b32 v7, 2, v7
    v_sub_u32 v7, v2, v7
    v_and_b32 v8, 1, v2
    v_lshlrev_b32 v8, 4, v8
    v_mov_b32 v9, 0x3f80
    v_lshlrev_b32 v8, v8, v9
    v_ashrrev_i32 v7, 1, v7
    v_cmp_eq_u32 vcc, 0, v7
    s_nop 1
    v_cndmask_b32 v250, 0, v8, vcc
    v_cmp_eq_u32 vcc, 1, v7
    s_nop 1
    v_cndmask_b32 v251, 0, v8, vcc
    v_mov_b32 v4, 0x3f803f80
    v_mov_b32 v5, 0x3f803f80
    v_mov_b32 v6, 0x3f803f80
    v_mov_b32 v7, 0x3f803f80
    v_mov_b32 v8, 0x3f003f00
    v_mov_b32 v9, 0x3f003f00
    s_waitcnt vmcnt(21)
    v_readfirstlane_b32 s96, v107
    s_cmp_eq_u32 s96, s3
    s_cbranch_scc1 Lvr_c
    s_mov_b32 s94, 144
    s_mov_b32 s95, 0
    v_mov_b32 v196, 0
Lwf_rotc:
    buffer_load_dword v197, v196, s[72:75], s94 offen sc1
    s_waitcnt vmcnt(0)
    v_readfirstlane_b32 s96, v197
    s_and_b32 s96, s96, 15
    s_cmp_ge_u32 s96, 8
    s_cbranch_scc1 Lwd_rotc
    s_sleep 4
    s_add_u32 s95, s95, 1
    s_cmp_lt_u32 s95, 2000000
    s_cbranch_scc1 Lwf_rotc
    s_branch Lch_fail
Lwd_rotc:
    s_cmp_eq_u32 s96, s3
    s_cbranch_scc1 Lvr_c
    s_mov_b32 s3, s96
    s_branch Lrole
Lvr_c:
    ds_write_b128 v88, a[0:3] offset:0
    ds_write_b128 v89, a[4:7] offset:4096
    ds_write_b128 v88, a[8:11] offset:8192
    ds_write_b128 v89, a[12:15] offset:12288
    ds_write_b128 v88, a[16:19] offset:16384
    ds_write_b128 v89, a[20:23] offset:20480
    ds_write_b128 v88, a[24:27] offset:24576
    ds_write_b128 v89, a[28:31] offset:28672
    s_waitcnt lgkmcnt(6)
    ds_write_b128 v88, a[32:35] offset:32768
    ds_write_b128 v89, a[36:39] offset:36864
    ds_write_b128 v88, a[40:43] offset:40960
    ds_write_b128 v89, a[44:47] offset:45056
    ds_write_b128 v88, a[48:51] offset:49152
    ds_write_b128 v89, a[52:55] offset:53248
    ds_write_b128 v88, a[56:59] offset:57344
    ds_write_b128 v89, a[60:63] offset:61440
    s_waitcnt lgkmcnt(6)
    ds_write_b128 v90, a[64:67] offset:0
    ds_write_b128 v91, a[68:71] offset:4096
    ds_write_b128 v90, a[72:75] offset:8192
    ds_write_b128 v91, a[76:79] offset:12288
    ds_write_b128 v90, a[80:83] offset:16384
    ds_write_b128 v91, a[84:87] offset:20480
    ds_write_b128 v90, a[88:91] offset:24576
    ds_write_b128 v91, a[92:95] offset:28672
    s_waitcnt lgkmcnt(6)
    ds_write_b128 v90, a[96:99] offset:32768
    ds_write_b128 v91, a[100:103] offset:36864
    ds_write_b128 v90, a[104:107] offset:40960
    ds_write_b128 v91, a[108:111] offset:45056
    ds_write_b128 v90, a[112:115] offset:49152
    ds_write_b128 v91, a[116:119] offset:53248
    ds_write_b128 v90, a[120:123] offset:57344
    ds_write_b128 v91, a[124:127] offset:61440
    s_waitcnt lgkmcnt(0)
    s_barrier
    ds_read_b64_tr_b16 a[0:1], v84 offset:0
    ds_read_b64_tr_b16 a[2:3], v84 offset:256
    ds_read_b64_tr_b16 a[4:5], v84 offset:2048
    ds_read_b64_tr_b16 a[6:7], v84 offset:2304
    ds_read_b64_tr_b16 a[8:9], v84 offset:8192
    ds_read_b64_tr_b16 a[10:11], v84 offset:8448
    ds_read_b64_tr_b16 a[12:13], v84 offset:10240
    ds_read_b64_tr_b16 a[14:15], v84 offset:10496
    s_waitcnt lgkmcnt(6)
    ds_read_b64_tr_b16 a[16:17], v84 offset:16384
    ds_read_b64_tr_b16 a[18:19], v84 offset:16640
    ds_read_b64_tr_b16 a[20:21], v84 offset:18432
    ds_read_b64_tr_b16 a[22:23], v84 offset:18688
    ds_read_b64_tr_b16 a[24:25], v84 offset:24576
    ds_read_b64_tr_b16 a[26:27], v84 offset:24832
    ds_read_b64_tr_b16 a[28:29], v84 offset:26624
    ds_read_b64_tr_b16 a[30:31], v84 offset:26880
    s_waitcnt lgkmcnt(6)
    ds_read_b64_tr_b16 a[32:33], v85 offset:0
    ds_read_b64_tr_b16 a[34:35], v85 offset:256
    ds_read_b64_tr_b16 a[36:37], v85 offset:2048
    ds_read_b64_tr_b16 a[38:39], v85 offset:2304
    ds_read_b64_tr_b16 a[40:41], v85 offset:8192
    ds_read_b64_tr_b16 a[42:43], v85 offset:8448
    ds_read_b64_tr_b16 a[44:45], v85 offset:10240
    ds_read_b64_tr_b16 a[46:47], v85 offset:10496
    s_waitcnt lgkmcnt(6)
    ds_read_b64_tr_b16 a[48:49], v85 offset:16384
    ds_read_b64_tr_b16 a[50:51], v85 offset:16640
    ds_read_b64_tr_b16 a[52:53], v85 offset:18432
    ds_read_b64_tr_b16 a[54:55], v85 offset:18688
    ds_read_b64_tr_b16 a[56:57], v85 offset:24576
    ds_read_b64_tr_b16 a[58:59], v85 offset:24832
    ds_read_b64_tr_b16 a[60:61], v85 offset:26624
    ds_read_b64_tr_b16 a[62:63], v85 offset:26880
    s_waitcnt lgkmcnt(6)
    ds_read_b64_tr_b16 a[64:65], v86 offset:0
    ds_read_b64_tr_b16 a[66:67], v86 offset:256
    ds_read_b64_tr_b16 a[68:69], v86 offset:2048
    ds_read_b64_tr_b16 a[70:71], v86 offset:2304
    ds_read_b64_tr_b16 a[72:73], v86 offset:8192
    ds_read_b64_tr_b16 a[74:75], v86 offset:8448
    ds_read_b64_tr_b16 a[76:77], v86 offset:10240
    ds_read_b64_tr_b16 a[78:79], v86 offset:10496
    s_waitcnt lgkmcnt(6)
    ds_read_b64_tr_b16 a[80:81], v86 offset:16384
    ds_read_b64_tr_b16 a[82:83], v86 offset:16640
    ds_read_b64_tr_b16 a[84:85], v86 offset:18432
    ds_read_b64_tr_b16 a[86:87], v86 offset:18688
    ds_read_b64_tr_b16 a[88:89], v86 offset:24576
    ds_read_b64_tr_b16 a[90:91], v86 offset:24832
    ds_read_b64_tr_b16 a[92:93], v86 offset:26624
    ds_read_b64_tr_b16 a[94:95], v86 offset:26880
    s_waitcnt lgkmcnt(6)
    ds_read_b64_tr_b16 a[96:97], v87 offset:0
    ds_read_b64_tr_b16 a[98:99], v87 offset:256
    ds_read_b64_tr_b16 a[100:101], v87 offset:2048
    ds_read_b64_tr_b16 a[102:103], v87 offset:2304
    ds_read_b64_tr_b16 a[104:105], v87 offset:8192
    ds_read_b64_tr_b16 a[106:107], v87 offset:8448
    ds_read_b64_tr_b16 a[108:109], v87 offset:10240
    ds_read_b64_tr_b16 a[110:111], v87 offset:10496
    s_waitcnt lgkmcnt(6)
    ds_read_b64_tr_b16 a[112:113], v87 offset:16384
    ds_read_b64_tr_b16 a[114:115], v87 offset:16640
    ds_read_b64_tr_b16 a[116:117], v87 offset:18432
    ds_read_b64_tr_b16 a[118:119], v87 offset:18688
    ds_read_b64_tr_b16 a[120:121], v87 offset:24576
    ds_read_b64_tr_b16 a[122:123], v87 offset:24832
    ds_read_b64_tr_b16 a[124:125], v87 offset:26624
    ds_read_b64_tr_b16 a[126:127], v87 offset:26880
    s_waitcnt lgkmcnt(0)
    s_waitcnt vmcnt(0)
    v_readfirstlane_b32 s56, v101
    s_cmp_eq_u32 s56, 16
    s_cbranch_scc1 Lwd_go
    s_mov_b32 s57, 128
    s_mov_b32 s31, 0
    v_mov_b32 v2, 0
Lwf_go:
    buffer_load_dword v3, v2, s[72:75], s57 offen sc1
    s_waitcnt vmcnt(0)
    v_readfirstlane_b32 s34, v3
    s_and_b32 s34, s34, 255
    s_cmp_eq_u32 s34, 16
    s_cbranch_scc1 Lwd_go
    s_sleep 4
    s_add_u32 s31, s31, 1
    s_cmp_lt_u32 s31, 2000000
    s_cbranch_scc1 Lwf_go
    s_branch Lch_fail
Lwd_go:
    s_barrier
    s_cmp_lg_u32 s22, 0
    s_cbranch_scc1 Lch_sg
    s_lshl_b32 s56, s20, 7
    s_add_u32 s56, s56, 120075264
    v_mov_b32 v101, s63
    s_mov_b64 exec, 1
    buffer_atomic_add v101, v100, s[8:11], s56 offen sc1
    s_mov_b64 exec, -1
Lch_sg:
    s_mov_b32 s56, 120076288
    v_mov_b32 v101, 1
    s_cmp_lg_u32 s22, 1
    s_cbranch_scc1 Lch_nk
    s_mov_b64 exec, 1
    buffer_atomic_add v101, v100, s[8:11], s56 offen offset:128 sc0 sc1
    s_mov_b64 exec, -1
Lch_nk:
    ds_write_b128 v88, a[128:131] offset:0
    ds_write_b128 v89, a[132:135] offset:4096
    ds_write_b128 v88, a[136:139] offset:8192
    ds_write_b128 v89, a[140:143] offset:12288
    ds_write_b128 v88, a[144:147] offset:16384
    ds_write_b128 v89, a[148:151] offset:20480
    ds_write_b128 v88, a[152:155] offset:24576
    ds_write_b128 v89, a[156:159] offset:28672
    s_waitcnt lgkmcnt(6)
    ds_write_b128 v88, a[160:163] offset:32768
    ds_write_b128 v89, a[164:167] offset:36864
    ds_write_b128 v88, a[168:171] offset:40960
    ds_write_b128 v89, a[172:175] offset:45056
    ds_write_b128 v88, a[176:179] offset:49152
    ds_write_b128 v89, a[180:183] offset:53248
    ds_write_b128 v88, a[184:187] offset:57344
    ds_write_b128 v89, a[188:191] offset:61440
    s_waitcnt lgkmcnt(6)
    ds_write_b128 v92, a[192:195] offset:0
    ds_write_b128 v93, a[196:199] offset:1024
    ds_write_b128 v92, a[200:203] offset:2048
    ds_write_b128 v93, a[204:207] offset:3072
    ds_write_b128 v92, a[208:211] offset:4096
    ds_write_b128 v93, a[212:215] offset:5120
    ds_write_b128 v92, a[216:219] offset:6144
    ds_write_b128 v93, a[220:223] offset:7168
    s_waitcnt lgkmcnt(6)
    ds_write_b128 v92, a[224:227] offset:8192
    ds_write_b128 v93, a[228:231] offset:9216
    ds_write_b128 v92, a[232:235] offset:10240
    ds_write_b128 v93, a[236:239] offset:11264
    ds_write_b128 v92, a[240:243] offset:12288
    ds_write_b128 v93, a[244:247] offset:13312
    ds_write_b128 v92, a[248:251] offset:14336
    ds_write_b128 v93, a[252:255] offset:15360
    s_waitcnt lgkmcnt(0)
    s_barrier
    ds_read_b64_tr_b16 a[128:129], v94 offset:0
    ds_read_b64_tr_b16 a[130:131], v94 offset:256
    ds_read_b64_tr_b16 a[132:133], v94 offset:2048
    ds_read_b64_tr_b16 a[134:135], v94 offset:2304
    ds_read_b64_tr_b16 a[136:137], v94 offset:8192
    ds_read_b64_tr_b16 a[138:139], v94 offset:8448
    ds_read_b64_tr_b16 a[140:141], v94 offset:10240
    ds_read_b64_tr_b16 a[142:143], v94 offset:10496
    s_waitcnt lgkmcnt(6)
    ds_read_b64_tr_b16 a[144:145], v94 offset:16384
    ds_read_b64_tr_b16 a[146:147], v94 offset:16640
    ds_read_b64_tr_b16 a[148:149], v94 offset:18432
    ds_read_b64_tr_b16 a[150:151], v94 offset:18688
    ds_read_b64_tr_b16 a[152:153], v94 offset:24576
    ds_read_b64_tr_b16 a[154:155], v94 offset:24832
    ds_read_b64_tr_b16 a[156:157], v94 offset:26624
    ds_read_b64_tr_b16 a[158:159], v94 offset:26880
    s_waitcnt lgkmcnt(6)
    ds_read_b64_tr_b16 a[160:161], v95 offset:0
    ds_read_b64_tr_b16 a[162:163], v95 offset:256
    ds_read_b64_tr_b16 a[164:165], v95 offset:2048
    ds_read_b64_tr_b16 a[166:167], v95 offset:2304
    ds_read_b64_tr_b16 a[168:169], v95 offset:8192
    ds_read_b64_tr_b16 a[170:171], v95 offset:8448
    ds_read_b64_tr_b16 a[172:173], v95 offset:10240
    ds_read_b64_tr_b16 a[174:175], v95 offset:10496
    s_waitcnt lgkmcnt(6)
    ds_read_b64_tr_b16 a[176:177], v95 offset:16384
    ds_read_b64_tr_b16 a[178:179], v95 offset:16640
    ds_read_b64_tr_b16 a[180:181], v95 offset:18432
    ds_read_b64_tr_b16 a[182:183], v95 offset:18688
    ds_read_b64_tr_b16 a[184:185], v95 offset:24576
    ds_read_b64_tr_b16 a[186:187], v95 offset:24832
    ds_read_b64_tr_b16 a[188:189], v95 offset:26624
    ds_read_b64_tr_b16 a[190:191], v95 offset:26880
    s_waitcnt lgkmcnt(6)
    ds_read_b64_tr_b16 a[192:193], v96 offset:0
    ds_read_b64_tr_b16 a[194:195], v96 offset:512
    ds_read_b64_tr_b16 a[196:197], v96 offset:4096
    ds_read_b64_tr_b16 a[198:199], v96 offset:4608
    ds_read_b64_tr_b16 a[200:201], v96 offset:8192
    ds_read_b64_tr_b16 a[202:203], v96 offset:8704
    ds_read_b64_tr_b16 a[204:205], v96 offset:12288
    ds_read_b64_tr_b16 a[206:207], v96 offset:12800
    s_waitcnt lgkmcnt(6)
    ds_read_b64_tr_b16 a[208:209], v97 offset:0
    ds_read_b64_tr_b16 a[210:211], v97 offset:512
    ds_read_b64_tr_b16 a[212:213], v97 offset:4096
    ds_read_b64_tr_b16 a[214:215], v97 offset:4608
    ds_read_b64_tr_b16 a[216:217], v97 offset:8192
    ds_read_b64_tr_b16 a[218:219], v97 offset:8704
    ds_read_b64_tr_b16 a[220:221], v97 offset:12288
    ds_read_b64_tr_b16 a[222:223], v97 offset:12800
    s_waitcnt lgkmcnt(6)
    ds_read_b64_tr_b16 a[224:225], v98 offset:0
    ds_read_b64_tr_b16 a[226:227], v98 offset:512
    ds_read_b64_tr_b16 a[228:229], v98 offset:4096
    ds_read_b64_tr_b16 a[230:231], v98 offset:4608
    ds_read_b64_tr_b16 a[232:233], v98 offset:8192
    ds_read_b64_tr_b16 a[234:235], v98 offset:8704
    ds_read_b64_tr_b16 a[236:237], v98 offset:12288
    ds_read_b64_tr_b16 a[238:239], v98 offset:12800
    s_waitcnt lgkmcnt(6)
    ds_read_b64_tr_b16 a[240:241], v99 offset:0
    ds_read_b64_tr_b16 a[242:243], v99 offset:512
    ds_read_b64_tr_b16 a[244:245], v99 offset:4096
    ds_read_b64_tr_b16 a[246:247], v99 offset:4608
    ds_read_b64_tr_b16 a[248:249], v99 offset:8192
    ds_read_b64_tr_b16 a[250:251], v99 offset:8704
    ds_read_b64_tr_b16 a[252:253], v99 offset:12288
    ds_read_b64_tr_b16 a[254:255], v99 offset:12800
    s_waitcnt lgkmcnt(0)
    s_barrier
    s_waitcnt vmcnt(0)
    v_readfirstlane_b32 s57, v101
    s_cmp_lg_u32 s57, 0
    s_cbranch_scc1 Lch_cal
    s_and_b32 s80, s61, 0xffffc000
    s_mov_b32 s82, -1
    s_mov_b32 s83, -1
    s_add_u32 s81, s80, 8192
    s_mov_b64 exec, 1
    s_memtime s[76:77]
    s_waitcnt lgkmcnt(0)
    buffer_load_dword v101, v100, s[8:11], s80 offen offset:0 sc1
    s_waitcnt vmcnt(0)
    s_memtime s[78:79]
    s_waitcnt lgkmcnt(0)
    s_sub_u32 s78, s78, s76
    s_min_u32 s82, s82, s78
    s_memtime s[76:77]
    s_waitcnt lgkmcnt(0)
    buffer_load_dword v101, v100, s[8:11], s81 offen offset:0 sc1
    s_waitcnt vmcnt(0)
    s_memtime s[78:79]
    s_waitcnt lgkmcnt(0)
    s_sub_u32 s78, s78, s76
    s_min_u32 s83, s83, s78
    s_memtime s[76:77]
    s_waitcnt lgkmcnt(0)
    buffer_load_dword v101, v100, s[8:11], s80 offen offset:512 sc1
    s_waitcnt vmcnt(0)
    s_memtime s[78:79]
    s_waitcnt lgkmcnt(0)
    s_sub_u32 s78, s78, s76
    s_min_u32 s82, s82, s78
    s_memtime s[76:77]
    s_waitcnt lgkmcnt(0)
    buffer_load_dword v101, v100, s[8:11], s81 offen offset:512 sc1
    s_waitcnt vmcnt(0)
    s_memtime s[78:79]
    s_waitcnt lgkmcnt(0)
    s_sub_u32 s78, s78, s76
    s_min_u32 s83, s83, s78
    s_memtime s[76:77]
    s_waitcnt lgkmcnt(0)
    buffer_load_dword v101, v100, s[8:11], s80 offen offset:1024 sc1
    s_waitcnt vmcnt(0)
    s_memtime s[78:79]
    s_waitcnt lgkmcnt(0)
    s_sub_u32 s78, s78, s76
    s_min_u32 s82, s82, s78
    s_memtime s[76:77]
    s_waitcnt lgkmcnt(0)
    buffer_load_dword v101, v100, s[8:11], s81 offen offset:1024 sc1
    s_waitcnt vmcnt(0)
    s_memtime s[78:79]
    s_waitcnt lgkmcnt(0)
    s_sub_u32 s78, s78, s76
    s_min_u32 s83, s83, s78
    s_memtime s[76:77]
    s_waitcnt lgkmcnt(0)
    buffer_load_dword v101, v100, s[8:11], s80 offen offset:1536 sc1
    s_waitcnt vmcnt(0)
    s_memtime s[78:79]
    s_waitcnt lgkmcnt(0)
    s_sub_u32 s78, s78, s76
    s_min_u32 s82, s82, s78
    s_memtime s[76:77]
    s_waitcnt lgkmcnt(0)
    buffer_load_dword v101, v100, s[8:11], s81 offen offset:1536 sc1
    s_waitcnt vmcnt(0)
    s_memtime s[78:79]
    s_waitcnt lgkmcnt(0)
    s_sub_u32 s78, s78, s76
    s_min_u32 s83, s83, s78
    s_memtime s[76:77]
    s_waitcnt lgkmcnt(0)
    buffer_load_dword v101, v100, s[8:11], s80 offen offset:2048 sc1
    s_waitcnt vmcnt(0)
    s_memtime s[78:79]
    s_waitcnt lgkmcnt(0)
    s_sub_u32 s78, s78, s76
    s_min_u32 s82, s82, s78
    s_memtime s[76:77]
    s_waitcnt lgkmcnt(0)
    buffer_load_dword v101, v100, s[8:11], s81 offen offset:2048 sc1
    s_waitcnt vmcnt(0)
    s_memtime s[78:79]
    s_waitcnt lgkmcnt(0)
    s_sub_u32 s78, s78, s76
    s_min_u32 s83, s83, s78
    s_memtime s[76:77]
    s_waitcnt lgkmcnt(0)
    buffer_load_dword v101, v100, s[8:11], s80 offen offset:2560 sc1
    s_waitcnt vmcnt(0)
    s_memtime s[78:79]
    s_waitcnt lgkmcnt(0)
    s_sub_u32 s78, s78, s76
    s_min_u32 s82, s82, s78
    s_memtime s[76:77]
    s_waitcnt lgkmcnt(0)
    buffer_load_dword v101, v100, s[8:11], s81 offen offset:2560 sc1
    s_waitcnt vmcnt(0)
    s_memtime s[78:79]
    s_waitcnt lgkmcnt(0)
    s_sub_u32 s78, s78, s76
    s_min_u32 s83, s83, s78
    s_cmp_gt_u32 s82, s83
    s_cselect_b32 s57, 48, 16
    v_mov_b32 v101, s57
    buffer_store_dword v101, v100, s[8:11], s56 offen sc1
    s_mov_b64 exec, -1
Lch_cal:
    v_lshlrev_b32 v100, 7, v1
    s_sub_u32 s56, s43, 120061952
    v_add_u32 v100, 13312, v100
    v_mov_b32 v102, 31
    v_mov_b32 v103, 16
    s_mov_b32 s57, 0xff0f
    s_mov_b32 s60, 0x1008
    v_writelane_b32 v100, s56, 9
    v_writelane_b32 v102, s57, 9
    v_writelane_b32 v103, s60, 9
    s_mov_b32 s31, 0
    s_mov_b32 s33, 120061952
    s_mov_b32 s60, s7
    buffer_load_dword v112, v253, s[8:11], s60 offen sc1
    s_add_u32 s60, s60, 0x10000
    buffer_load_dword v113, v253, s[8:11], s60 offen sc1
    s_add_u32 s60, s60, 0x10000
    buffer_load_dword v114, v253, s[8:11], s60 offen sc1
    s_add_u32 s60, s60, 0x10000
    buffer_load_dword v115, v253, s[8:11], s60 offen sc1
    s_add_u32 s60, s60, 0x10000
    s_mov_b64 exec, 0x3ff
Lch_w0:
    buffer_load_dword v101, v100, s[8:11], s33 offen sc1
    s_waitcnt vmcnt(0)
    v_and_b32 v104, v102, v101
    v_cmp_ne_u32 vcc, v103, v104
    s_cbranch_vccz Lch_w1
    s_sleep 3
    s_add_u32 s31, s31, 1
    s_cmp_lt_u32 s31, 2000000
    s_cbranch_scc1 Lch_w0
    s_mov_b64 exec, -1
    s_branch Lch_fail
Lch_w1:
    v_readlane_b32 s62, v101, s20
    v_readlane_b32 s56, v101, 8
    s_lshl_b32 s63, s63, 4
    s_mov_b64 exec, -1
    s_xor_b32 s41, s63, s62
    s_and_b32 s56, s56, 32
    s_lshl_b32 s56, s56, 8
    s_add_u32 s6, s6, s56
    s_and_b32 s34, s23, 3
    s_lshl_b32 s35, s34, 16
    s_add_u32 s26, s7, s35
    s_add_u32 s24, s26, 32768
    s_xor_b32 s25, s26, 0x20000
    s_and_b32 s34, s23, 3
    s_lshl_b32 s34, s34, 14
    s_add_u32 s28, s6, s34
    buffer_load_dwordx4 v[160:163], v18, s[8:11], s30 offen offset:0 sc1
    buffer_load_dwordx4 v[176:179], v18, s[8:11], s30 offen offset:256 sc1
    buffer_load_dwordx4 v[164:167], v18, s[8:11], s30 offen offset:2048 sc1
    buffer_load_dwordx4 v[180:183], v18, s[8:11], s30 offen offset:2304 sc1
    buffer_load_dwordx4 v[168:171], v19, s[8:11], s30 offen offset:0 sc1
    buffer_load_dwordx4 v[184:187], v19, s[8:11], s30 offen offset:256 sc1
    buffer_load_dwordx4 v[172:175], v19, s[8:11], s30 offen offset:2048 sc1
    buffer_load_dwordx4 v[188:191], v19, s[8:11], s30 offen offset:2304 sc1
    buffer_load_dwordx4 v[128:131], v18, s[8:11], s29 offen offset:0 sc1
    buffer_load_dwordx4 v[144:147], v18, s[8:11], s29 offen offset:256 sc1
    buffer_load_dwordx4 v[132:135], v18, s[8:11], s29 offen offset:2048 sc1
    buffer_load_dwordx4 v[148:151], v18, s[8:11], s29 offen offset:2304 sc1
    buffer_load_dwordx4 v[136:139], v19, s[8:11], s29 offen offset:0 sc1
    buffer_load_dwordx4 v[152:155], v19, s[8:11], s29 offen offset:256 sc1
    buffer_load_dwordx4 v[140:143], v19, s[8:11], s29 offen offset:2048 sc1
    buffer_load_dwordx4 v[156:159], v19, s[8:11], s29 offen offset:2304 sc1
    v_subrev_u32 v2, 0x40000, v26
    s_mov_b64 exec, 0xff
    buffer_load_dword v23, v2, s[8:11], 0 offen sc1
    s_mov_b64 exec, -1
    s_waitcnt vmcnt(9)
    v_mfma_f32_16x16x32_bf16 v[216:219], v[160:163], a[192:195], 0
    v_mfma_f32_16x16x32_bf16 v[220:223], v[176:179], a[192:195], 0
    v_mfma_f32_16x16x32_bf16 v[224:227], v[160:163], a[208:211], 0
    v_mfma_f32_16x16x32_bf16 v[228:231], v[176:179], a[208:211], 0
    v_mfma_f32_16x16x32_bf16 v[232:235], v[160:163], a[224:227], 0
    v_mfma_f32_16x16x32_bf16 v[236:239], v[176:179], a[224:227], 0
    v_mfma_f32_16x16x32_bf16 v[240:243], v[160:163], a[240:243], 0
    v_mfma_f32_16x16x32_bf16 v[244:247], v[176:179], a[240:243], 0
    v_mfma_f32_16x16x32_bf16 v[216:219], v[164:167], a[196:199], v[216:219]
    v_mfma_f32_16x16x32_bf16 v[220:223], v[180:183], a[196:199], v[220:223]
    v_mfma_f32_16x16x32_bf16 v[224:227], v[164:167], a[212:215], v[224:227]
    v_mfma_f32_16x16x32_bf16 v[228:231], v[180:183], a[212:215], v[228:231]
    v_mfma_f32_16x16x32_bf16 v[232:235], v[164:167], a[228:231], v[232:235]
    v_mfma_f32_16x16x32_bf16 v[236:239], v[180:183], a[228:231], v[236:239]
    v_mfma_f32_16x16x32_bf16 v[240:243], v[164:167], a[244:247], v[240:243]
    v_mfma_f32_16x16x32_bf16 v[244:247], v[180:183], a[244:247], v[244:247]
    v_mfma_f32_16x16x32_bf16 v[216:219], v[168:171], a[200:203], v[216:219]
    v_mfma_f32_16x16x32_bf16 v[220:223], v[184:187], a[200:203], v[220:223]
    v_mfma_f32_16x16x32_bf16 v[224:227], v[168:171], a[216:219], v[224:227]
    v_mfma_f32_16x16x32_bf16 v[228:231], v[184:187], a[216:219], v[228:231]
    v_mfma_f32_16x16x32_bf16 v[232:235], v[168:171], a[232:235], v[232:235]
    v_mfma_f32_16x16x32_bf16 v[236:239], v[184:187], a[232:235], v[236:239]
    v_mfma_f32_16x16x32_bf16 v[240:243], v[168:171], a[248:251], v[240:243]
    v_mfma_f32_16x16x32_bf16 v[244:247], v[184:187], a[248:251], v[244:247]
    v_mfma_f32_16x16x32_bf16 v[216:219], v[172:175], a[204:207], v[216:219]
    v_mfma_f32_16x16x32_bf16 v[220:223], v[188:191], a[204:207], v[220:223]
    v_mfma_f32_16x16x32_bf16 v[224:227], v[172:175], a[220:223], v[224:227]
    v_mfma_f32_16x16x32_bf16 v[228:231], v[188:191], a[220:223], v[228:231]
    v_mfma_f32_16x16x32_bf16 v[232:235], v[172:175], a[236:239], v[232:235]
    v_mfma_f32_16x16x32_bf16 v[236:239], v[188:191], a[236:239], v[236:239]
    v_mfma_f32_16x16x32_bf16 v[240:243], v[172:175], a[252:255], v[240:243]
    v_mfma_f32_16x16x32_bf16 v[244:247], v[188:191], a[252:255], v[244:247]
    s_nop 4
    v_cvt_pk_bf16_f32 v192, v216, v217
    v_cvt_pk_bf16_f32 v193, v218, v219
    v_cvt_pk_bf16_f32 v194, v220, v221
    v_cvt_pk_bf16_f32 v195, v222, v223
    v_cvt_pk_bf16_f32 v196, v224, v225
    v_cvt_pk_bf16_f32 v197, v226, v227
    v_cvt_pk_bf16_f32 v198, v228, v229
    v_cvt_pk_bf16_f32 v199, v230, v231
    v_cvt_pk_bf16_f32 v200, v232, v233
    v_cvt_pk_bf16_f32 v201, v234, v235
    v_cvt_pk_bf16_f32 v202, v236, v237
    v_cvt_pk_bf16_f32 v203, v238, v239
    v_cvt_pk_bf16_f32 v204, v240, v241
    v_cvt_pk_bf16_f32 v205, v242, v243
    v_cvt_pk_bf16_f32 v206, v244, v245
    v_cvt_pk_bf16_f32 v207, v246, v247
    s_add_u32 s30, s30, 0x40000
    v_mov_b32 v232, v64
    v_mov_b32 v233, v65
    v_mov_b32 v234, v66
    v_mov_b32 v235, v67
    v_mov_b32 v236, v68
    v_mov_b32 v237, v69
    v_mov_b32 v238, v70
    v_mov_b32 v239, v71
    v_mov_b32 v240, v72
    v_mov_b32 v241, v73
    v_mov_b32 v242, v74
    v_mov_b32 v243, v75
    v_mov_b32 v244, v76
    v_mov_b32 v245, v77
    v_mov_b32 v246, v78
    v_mov_b32 v247, v79
    v_mov_b32 v216, 0
    v_mov_b32 v224, 0
    v_mov_b32 v217, 0
    v_mov_b32 v225, 0
    v_mov_b32 v218, 0
    v_mov_b32 v226, 0
    v_mov_b32 v219, 0
    v_mov_b32 v227, 0
    s_nop 1
    ds_write_b128 v10, v[232:235] offset:0
    ds_write_b128 v10, v[236:239] offset:1024
    ds_write_b128 v10, v[240:243] offset:2048
    ds_write_b128 v10, v[244:247] offset:3072
    s_cmp_eq_u32 s41, 0
    s_cbranch_scc1 Lok_i1
    s_branch Lok_i1_s
Lch_step:
    s_waitcnt vmcnt(0)
    buffer_load_dwordx4 v[232:235], v10, s[8:11], s24 offen offset:0 sc1
    buffer_load_dwordx4 v[236:239], v10, s[8:11], s24 offen offset:1024 sc1
    buffer_load_dwordx4 v[240:243], v10, s[8:11], s24 offen offset:2048 sc1
    buffer_load_dwordx4 v[244:247], v10, s[8:11], s24 offen offset:3072 sc1
    v_readlane_b32 s34, v23, 8
    s_and_b32 s34, s34, 0xff0f
    s_cmp_lg_u32 s34, 0x1008
    s_cbranch_scc1 Lch_kvw
Lch_kvok:
    v_mov_b32 v216, 0
    v_mov_b32 v224, 0
    v_mov_b32 v217, 0
    v_mov_b32 v225, 0
    v_mov_b32 v218, 0
    v_mov_b32 v226, 0
    v_mov_b32 v219, 0
    v_mov_b32 v227, 0
    s_mov_b32 s31, 0
    s_waitcnt vmcnt(3)
    v_max3_u32 v34, v232, v233, v234
    v_max_u32 v34, v34, v235
    v_cmp_eq_u32 vcc, -1, v34
    s_cbranch_vccnz Lq0_i1
Lg0_i1:
    ds_write_b128 v10, v[232:235] offset:0
    s_waitcnt vmcnt(2)
    v_max3_u32 v34, v236, v237, v238
    v_max_u32 v34, v34, v239
    v_cmp_eq_u32 vcc, -1, v34
    s_cbranch_vccnz Lq1_i1
Lg1_i1:
    ds_write_b128 v10, v[236:239] offset:1024
    s_waitcnt vmcnt(1)
    v_max3_u32 v34, v240, v241, v242
    v_max_u32 v34, v34, v243
    v_cmp_eq_u32 vcc, -1, v34
    s_cbranch_vccnz Lq2_i1
Lg2_i1:
    ds_write_b128 v10, v[240:243] offset:2048
    s_waitcnt vmcnt(0)
    v_max3_u32 v34, v244, v245, v246
    v_max_u32 v34, v34, v247
    v_cmp_eq_u32 vcc, -1, v34
    s_cbranch_vccnz Lq3_i1
Lg3_i1:
    ds_write_b128 v10, v[244:247] offset:3072
Lok_i1:
    buffer_load_dwordx4 v[136:139], v19, s[8:11], s29 offen offset:0 sc1
    buffer_load_dwordx4 v[152:155], v19, s[8:11], s29 offen offset:256 sc1
    buffer_load_dwordx4 v[140:143], v19, s[8:11], s29 offen offset:2048 sc1
    buffer_load_dwordx4 v[156:159], v19, s[8:11], s29 offen offset:2304 sc1
    s_waitcnt lgkmcnt(0)
    s_barrier
    ds_read_b128 v[64:67], v12 offset:0
    ds_read_b128 v[68:71], v12 offset:1024
    ds_read_b128 v[72:75], v12 offset:2048
    ds_read_b128 v[76:79], v12 offset:3072
    v_smfmac_f32_16x16x64_bf16 v[216:219], v[232:235], a[128:135], v11
    ds_read_b128 v[80:83], v13 offset:0
    v_smfmac_f32_16x16x64_bf16 v[216:219], v[236:239], a[136:143], v11
    ds_read_b128 v[84:87], v13 offset:1024
    v_smfmac_f32_16x16x64_bf16 v[216:219], v[240:243], a[144:151], v11
    ds_read_b128 v[88:91], v13 offset:2048
    v_smfmac_f32_16x16x64_bf16 v[216:219], v[244:247], a[152:159], v11
    ds_read_b128 v[92:95], v13 offset:3072
    v_smfmac_f32_16x16x64_bf16 v[224:227], v[232:235], a[0:7], v11
    ds_read_b128 v[96:99], v120 offset:0
    v_smfmac_f32_16x16x64_bf16 v[224:227], v[236:239], a[8:15], v11
    ds_read_b128 v[100:103], v120 offset:1024
    v_smfmac_f32_16x16x64_bf16 v[224:227], v[240:243], a[16:23], v11
    ds_read_b128 v[104:107], v120 offset:2048
    v_smfmac_f32_16x16x64_bf16 v[224:227], v[244:247], a[24:31], v11
    ds_read_b128 v[108:111], v120 offset:3072
    s_waitcnt lgkmcnt(11)
    v_smfmac_f32_16x16x64_bf16 v[216:219], v[64:67], a[160:167], v11
    s_waitcnt lgkmcnt(10)
    v_smfmac_f32_16x16x64_bf16 v[216:219], v[68:71], a[168:175], v11
    s_waitcnt lgkmcnt(9)
    v_smfmac_f32_16x16x64_bf16 v[216:219], v[72:75], a[176:183], v11
    s_waitcnt lgkmcnt(8)
    v_smfmac_f32_16x16x64_bf16 v[216:219], v[76:79], a[184:191], v11
    v_smfmac_f32_16x16x64_bf16 v[224:227], v[64:67], a[32:39], v11
    v_smfmac_f32_16x16x64_bf16 v[224:227], v[68:71], a[40:47], v11
    v_smfmac_f32_16x16x64_bf16 v[224:227], v[72:75], a[48:55], v11
    s_nop 4
    v_cvt_pk_bf16_f32 v30, v216, v217
    v_cvt_pk_bf16_f32 v31, v218, v219
    v_smfmac_f32_16x16x64_bf16 v[224:227], v[76:79], a[56:63], v11
    s_waitcnt lgkmcnt(7)
    v_mfma_f32_16x16x16_bf16 v[220:223], v[30:31], v[250:251], 0
    v_smfmac_f32_16x16x64_bf16 v[224:227], v[80:83], a[64:71], v11
    s_waitcnt lgkmcnt(6)
    v_smfmac_f32_16x16x64_bf16 v[224:227], v[84:87], a[72:79], v11
    s_nop 4
    v_cvt_pk_bf16_f32 v30, v220, v221
    v_cvt_pk_bf16_f32 v31, v222, v223
    v_min_u32 v30, -2, v30
    v_min_u32 v31, -2, v31
    s_mov_b64 exec, s[38:39]
    buffer_store_dwordx2 v[30:31], v15, s[8:11], s26 offen
    s_mov_b64 exec, -1
    s_waitcnt lgkmcnt(5)
    v_smfmac_f32_16x16x64_bf16 v[224:227], v[88:91], a[80:87], v11
    s_waitcnt lgkmcnt(4)
    v_smfmac_f32_16x16x64_bf16 v[224:227], v[92:95], a[88:95], v11
    s_waitcnt lgkmcnt(3)
    v_smfmac_f32_16x16x64_bf16 v[224:227], v[96:99], a[96:103], v11
    s_waitcnt lgkmcnt(2)
    v_smfmac_f32_16x16x64_bf16 v[224:227], v[100:103], a[104:111], v11
    s_waitcnt lgkmcnt(1)
    v_smfmac_f32_16x16x64_bf16 v[224:227], v[104:107], a[112:119], v11
    s_waitcnt lgkmcnt(0)
    v_smfmac_f32_16x16x64_bf16 v[224:227], v[108:111], a[120:127], v11
    s_nop 7
    v_cvt_pk_bf16_f32 v28, v224, v225
    v_cvt_pk_bf16_f32 v29, v226, v227
    s_nop 1
    v_mfma_f32_16x16x16_bf16 v[228:231], v[28:29], v[250:251], 0
    s_nop 7
    v_cvt_pk_bf16_f32 v28, v228, v229
    v_cvt_pk_bf16_f32 v29, v230, v231
    v_min_u32 v28, -2, v28
    v_min_u32 v29, -2, v29
    s_mov_b64 exec, s[38:39]
    buffer_store_dwordx2 v[28:29], v14, s[8:11], s26 offen
    s_mov_b64 exec, -1
    s_or_b32 s34, s23, 8
    s_cmp_eq_u32 s34, 63
    s_cbranch_scc1 Lch_e
Lch_er:
    buffer_load_dwordx4 v[232:235], v17, s[8:11], s26 offen offset:0 sc1
    buffer_load_dwordx4 v[236:239], v17, s[8:11], s26 offen offset:1024 sc1
    buffer_load_dwordx4 v[240:243], v17, s[8:11], s26 offen offset:2048 sc1
    buffer_load_dwordx4 v[244:247], v17, s[8:11], s26 offen offset:3072 sc1
    s_mov_b32 s31, 0
    s_waitcnt vmcnt(3)
    v_max3_u32 v34, v232, v233, v234
    v_max_u32 v34, v34, v235
    s_waitcnt vmcnt(2)
    v_max3_u32 v34, v236, v237, v34
    v_max3_u32 v34, v238, v239, v34
    s_waitcnt vmcnt(1)
    v_max3_u32 v34, v240, v241, v34
    v_max3_u32 v34, v242, v243, v34
    s_waitcnt vmcnt(0)
    v_max3_u32 v34, v244, v245, v34
    v_max3_u32 v34, v246, v247, v34
    v_cmp_eq_u32 vcc, -1, v34
    s_cbranch_vccnz Ls_iv
    s_waitcnt vmcnt(0)
Lw_iv:
    buffer_load_dwordx4 v[64:67], v16, s[8:11], s26 offen offset:0 sc1
    buffer_load_dwordx4 v[68:71], v16, s[8:11], s26 offen offset:1024 sc1
    buffer_load_dwordx4 v[72:75], v16, s[8:11], s26 offen offset:2048 sc1
    buffer_load_dwordx4 v[76:79], v16, s[8:11], s26 offen offset:3072 sc1
    v_mfma_f32_16x16x32_bf16 v[216:219], v[232:235], a[192:195], 0
    v_mfma_f32_16x16x32_bf16 v[220:223], v[232:235], a[208:211], 0
    v_mfma_f32_16x16x32_bf16 v[224:227], v[232:235], a[224:227], 0
    v_mfma_f32_16x16x32_bf16 v[228:231], v[232:235], a[240:243], 0
    v_mfma_f32_16x16x32_bf16 v[216:219], v[236:239], a[196:199], v[216:219]
    v_mfma_f32_16x16x32_bf16 v[220:223], v[236:239], a[212:215], v[220:223]
    v_mfma_f32_16x16x32_bf16 v[224:227], v[236:239], a[228:231], v[224:227]
    v_mfma_f32_16x16x32_bf16 v[228:231], v[236:239], a[244:247], v[228:231]
    v_mfma_f32_16x16x32_bf16 v[216:219], v[240:243], a[200:203], v[216:219]
    v_mfma_f32_16x16x32_bf16 v[220:223], v[240:243], a[216:219], v[220:223]
    v_mfma_f32_16x16x32_bf16 v[224:227], v[240:243], a[232:235], v[224:227]
    v_mfma_f32_16x16x32_bf16 v[228:231], v[240:243], a[248:251], v[228:231]
    v_mfma_f32_16x16x32_bf16 v[216:219], v[244:247], a[204:207], v[216:219]
    v_mfma_f32_16x16x32_bf16 v[220:223], v[244:247], a[220:223], v[220:223]
    v_mfma_f32_16x16x32_bf16 v[224:227], v[244:247], a[236:239], v[224:227]
    v_mfma_f32_16x16x32_bf16 v[228:231], v[244:247], a[252:255], v[228:231]
    s_nop 4
Lok_iv:
    v_cvt_pk_bf16_f32 v208, v216, v217
    v_cvt_pk_bf16_f32 v209, v218, v219
    v_cvt_pk_bf16_f32 v210, v220, v221
    v_cvt_pk_bf16_f32 v211, v222, v223
    v_cvt_pk_bf16_f32 v212, v224, v225
    v_cvt_pk_bf16_f32 v213, v226, v227
    v_cvt_pk_bf16_f32 v214, v228, v229
    v_cvt_pk_bf16_f32 v215, v230, v231
    buffer_load_dwordx4 v[160:163], v18, s[8:11], s30 offen offset:0 sc1
    buffer_load_dwordx4 v[176:179], v18, s[8:11], s30 offen offset:256 sc1
    buffer_load_dwordx4 v[164:167], v18, s[8:11], s30 offen offset:2048 sc1
    buffer_load_dwordx4 v[180:183], v18, s[8:11], s30 offen offset:2304 sc1
    s_mov_b32 s31, 0
    s_waitcnt vmcnt(7)
    v_max3_u32 v34, v64, v65, v66
    v_max_u32 v34, v34, v67
    s_waitcnt vmcnt(6)
    v_max3_u32 v34, v68, v69, v34
    v_max3_u32 v34, v70, v71, v34
    s_waitcnt vmcnt(5)
    v_max3_u32 v34, v72, v73, v34
    v_max3_u32 v34, v74, v75, v34
    s_waitcnt vmcnt(4)
    v_max3_u32 v34, v76, v77, v34
    v_max3_u32 v34, v78, v79, v34
    v_cmp_eq_u32 vcc, -1, v34
    s_cbranch_vccnz Ls_i2
Lw_i2:
    v_mfma_f32_16x16x32_bf16 v[56:59], v[128:131], v[64:67], 0
    v_mfma_f32_16x16x32_bf16 v[60:63], v[144:147], v[64:67], 0
    v_mfma_f32_16x16x32_bf16 v[52:55], v[64:67], v[64:67], v[40:43]
    buffer_load_dwordx4 v[168:171], v19, s[8:11], s30 offen offset:0 sc1
    v_mfma_f32_16x16x32_bf16 v[56:59], v[132:135], v[68:71], v[56:59]
    v_mfma_f32_16x16x32_bf16 v[60:63], v[148:151], v[68:71], v[60:63]
    v_mfma_f32_16x16x32_bf16 v[52:55], v[68:71], v[68:71], v[52:55]
    buffer_load_dwordx4 v[184:187], v19, s[8:11], s30 offen offset:256 sc1
    v_mfma_f32_16x16x32_bf16 v[56:59], v[136:139], v[72:75], v[56:59]
    v_mfma_f32_16x16x32_bf16 v[60:63], v[152:155], v[72:75], v[60:63]
    v_mfma_f32_16x16x32_bf16 v[52:55], v[72:75], v[72:75], v[52:55]
    buffer_load_dwordx4 v[172:175], v19, s[8:11], s30 offen offset:2048 sc1
    v_mfma_f32_16x16x32_bf16 v[56:59], v[140:143], v[76:79], v[56:59]
    v_mfma_f32_16x16x32_bf16 v[60:63], v[156:159], v[76:79], v[60:63]
    v_mfma_f32_16x16x32_bf16 v[52:55], v[76:79], v[76:79], v[52:55]
    buffer_load_dwordx4 v[188:191], v19, s[8:11], s30 offen offset:2304 sc1
Lok_i2:
    s_lshl_b32 s34, s20, 8
    s_add_u32 s42, s28, s34
    s_add_u32 s29, s29, 0x40000
    s_add_u32 s30, s30, 0x40000
    s_mov_b64 exec, 0x1ff
    buffer_load_dword v23, v26, s[8:11], 0 offen sc1
    s_mov_b64 exec, -1
    v_add_u32 v26, v26, v22
    v_max3_f32 v2, v56, v57, v58
    v_max3_f32 v3, v59, v60, v61
    v_max3_f32 v2, v62, v63, v2
    v_max3_f32 v3, v52, v53, v3
    v_max3_f32 v2, v54, v55, v2
    v_max_f32 v27, v2, v3
    v_max_f32 v3, v2, v3
    s_nop 0
    s_nop 0
    v_permlane16_swap_b32 v27, v3
    v_max_f32 v2, v27, v3
    v_max_f32 v3, v27, v3
    s_nop 0
    s_nop 0
    v_permlane32_swap_b32 v2, v3
    v_max_f32 v2, v2, v3
    v_fma_f32 v2, v2, s36, v121
    v_pk_fma_f32 v[52:53], v[52:53], s[36:37], v[2:3] op_sel_hi:[1,0,0] neg_lo:[0,0,1] neg_hi:[0,0,1]
    v_pk_fma_f32 v[54:55], v[54:55], s[36:37], v[2:3] op_sel_hi:[1,0,0] neg_lo:[0,0,1] neg_hi:[0,0,1]
    v_pk_fma_f32 v[56:57], v[56:57], s[36:37], v[2:3] op_sel_hi:[1,0,0] neg_lo:[0,0,1] neg_hi:[0,0,1]
    v_pk_fma_f32 v[58:59], v[58:59], s[36:37], v[2:3] op_sel_hi:[1,0,0] neg_lo:[0,0,1] neg_hi:[0,0,1]
    v_pk_fma_f32 v[60:61], v[60:61], s[36:37], v[2:3] op_sel_hi:[1,0,0] neg_lo:[0,0,1] neg_hi:[0,0,1]
    v_pk_fma_f32 v[62:63], v[62:63], s[36:37], v[2:3] op_sel_hi:[1,0,0] neg_lo:[0,0,1] neg_hi:[0,0,1]
    v_exp_f32 v52, v52
    v_exp_f32 v53, v53
    v_exp_f32 v54, v54
    v_exp_f32 v55, v55
    v_exp_f32 v56, v56
    v_exp_f32 v57, v57
    v_cvt_pk_bf16_f32 v46, v52, v53
    v_cvt_pk_bf16_f32 v44, v52, v53
    v_cvt_pk_bf16_f32 v47, v54, v55
    v_cvt_pk_bf16_f32 v45, v54, v55
    v_exp_f32 v58, v58
    v_exp_f32 v59, v59
    v_permlane32_swap_b32 v46, v44
    v_permlane32_swap_b32 v47, v45
    v_exp_f32 v60, v60
    v_exp_f32 v61, v61
    v_mfma_f32_16x16x16_bf16 v[96:99], v[8:9], v[44:45], 0
    v_mov_b32_dpp v122, v44 row_shr:8 row_mask:0xf bank_mask:0xf bound_ctrl:0
    v_mov_b32_dpp v123, v45 row_shr:8 row_mask:0xf bank_mask:0xf bound_ctrl:0
    v_mfma_f32_16x16x16_bf16 v[80:83], v[208:209], v[44:45], 0
    v_exp_f32 v62, v62
    v_mfma_f32_16x16x16_bf16 v[84:87], v[210:211], v[44:45], 0
    v_exp_f32 v63, v63
    v_cvt_pk_bf16_f32 v48, v56, v57
    v_cvt_pk_bf16_f32 v49, v58, v59
    v_mfma_f32_16x16x16_bf16 v[80:83], v[212:213], v[122:123], v[80:83]
    v_cvt_pk_bf16_f32 v50, v60, v61
    v_cvt_pk_bf16_f32 v51, v62, v63
    v_mfma_f32_16x16x16_bf16 v[84:87], v[214:215], v[122:123], v[84:87]
    v_mov_b32_dpp v124, v48 row_shr:8 row_mask:0xf bank_mask:0xf bound_ctrl:0
    v_mov_b32_dpp v125, v49 row_shr:8 row_mask:0xf bank_mask:0xf bound_ctrl:0
    v_mfma_f32_16x16x32_bf16 v[96:99], v[4:7], v[48:51], v[96:99]
    v_mov_b32_dpp v126, v50 row_shr:8 row_mask:0xf bank_mask:0xf bound_ctrl:0
    v_mov_b32_dpp v127, v51 row_shr:8 row_mask:0xf bank_mask:0xf bound_ctrl:0
    v_mfma_f32_16x16x32_bf16 v[80:83], v[192:195], v[48:51], v[80:83]
    v_mfma_f32_16x16x32_bf16 v[84:87], v[196:199], v[48:51], v[84:87]
    v_mfma_f32_16x16x32_bf16 v[80:83], v[200:203], v[124:127], v[80:83]
    v_mfma_f32_16x16x32_bf16 v[84:87], v[204:207], v[124:127], v[84:87]
    s_nop 1
    v_rcp_f32 v2, v96
    s_nop 2
    ds_write_b32 v33, v2
    ds_write_b128 v20, v[80:83] offset:0
    ds_write_b128 v20, v[84:87] offset:512
    buffer_load_dwordx4 v[128:131], v18, s[8:11], s29 offen offset:0 sc1
    buffer_load_dwordx4 v[144:147], v18, s[8:11], s29 offen offset:256 sc1
    buffer_load_dwordx4 v[132:135], v18, s[8:11], s29 offen offset:2048 sc1
    buffer_load_dwordx4 v[148:151], v18, s[8:11], s29 offen offset:2304 sc1
    s_waitcnt lgkmcnt(0)
    s_barrier
    ds_read_b128 v[92:95], v252
    ds_read_b64 v[80:81], v21 offset:0
    ds_read_b64 v[82:83], v21 offset:2048
    ds_read_b64 v[84:85], v21 offset:4096
    ds_read_b64 v[86:87], v21 offset:6144
    s_waitcnt lgkmcnt(3)
    v_mul_f32 v80, v80, v92
    v_mul_f32 v81, v81, v92
    s_waitcnt lgkmcnt(2)
    v_fmac_f32 v80, v82, v93
    v_fmac_f32 v81, v83, v93
    s_waitcnt lgkmcnt(1)
    v_fmac_f32 v80, v84, v94
    v_fmac_f32 v81, v85, v94
    s_waitcnt lgkmcnt(0)
    v_fmac_f32 v80, v86, v95
    v_fmac_f32 v81, v87, v95
    v_cvt_pk_bf16_f32 v88, v80, v81
    v_min_u32 v88, -2, v88
    buffer_store_dword v88, v24, s[8:11], s42 offen sc1
    s_waitcnt vmcnt(6)
    v_mov_b32 v208, -1
    v_mov_b32 v209, -1
    v_mov_b32 v210, -1
    v_mov_b32 v211, -1
    s_xor_b32 s32, s42, 0x8000
    s_mov_b32 exec_hi, 0xffff
    buffer_store_dwordx4 v[208:211], v253, s[8:11], s25 offen
    s_mov_b32 exec_hi, -1
    v_permlane16_swap_b32 v28, v30
    v_permlane16_swap_b32 v29, v31
    s_mov_b64 exec, s[38:39]
    buffer_store_dwordx4 v[28:31], v32, s[8:11], s27 offen sc1
    s_mov_b64 exec, -1
    s_mov_b64 exec, 0xffff
    buffer_store_dwordx4 v[208:211], v35, s[8:11], s32 offen sc1
    s_mov_b64 exec, -1
    s_cmp_lg_u32 s40, 0
    s_cbranch_scc1 Lch_np
    s_lshl_b32 s34, s20, 7
    s_add_u32 s34, s34, 120074240
    v_mov_b32 v2, s23
    s_mov_b64 exec, 1
    buffer_store_dword v2, v35, s[8:11], s34 offen sc1
Lch_np:
    s_mov_b64 exec, -1
    v_mfma_f32_16x16x32_bf16 v[216:219], v[160:163], a[192:195], 0
    v_mfma_f32_16x16x32_bf16 v[220:223], v[176:179], a[192:195], 0
    v_mfma_f32_16x16x32_bf16 v[224:227], v[160:163], a[208:211], 0
    v_mfma_f32_16x16x32_bf16 v[228:231], v[176:179], a[208:211], 0
    v_mfma_f32_16x16x32_bf16 v[232:235], v[160:163], a[224:227], 0
    v_mfma_f32_16x16x32_bf16 v[236:239], v[176:179], a[224:227], 0
    v_mfma_f32_16x16x32_bf16 v[240:243], v[160:163], a[240:243], 0
    v_mfma_f32_16x16x32_bf16 v[244:247], v[176:179], a[240:243], 0
    v_mfma_f32_16x16x32_bf16 v[216:219], v[164:167], a[196:199], v[216:219]
    v_mfma_f32_16x16x32_bf16 v[220:223], v[180:183], a[196:199], v[220:223]
    v_mfma_f32_16x16x32_bf16 v[224:227], v[164:167], a[212:215], v[224:227]
    v_mfma_f32_16x16x32_bf16 v[228:231], v[180:183], a[212:215], v[228:231]
    v_mfma_f32_16x16x32_bf16 v[232:235], v[164:167], a[228:231], v[232:235]
    v_mfma_f32_16x16x32_bf16 v[236:239], v[180:183], a[228:231], v[236:239]
    v_mfma_f32_16x16x32_bf16 v[240:243], v[164:167], a[244:247], v[240:243]
    v_mfma_f32_16x16x32_bf16 v[244:247], v[180:183], a[244:247], v[244:247]
    v_mfma_f32_16x16x32_bf16 v[216:219], v[168:171], a[200:203], v[216:219]
    v_mfma_f32_16x16x32_bf16 v[220:223], v[184:187], a[200:203], v[220:223]
    v_mfma_f32_16x16x32_bf16 v[224:227], v[168:171], a[216:219], v[224:227]
    v_mfma_f32_16x16x32_bf16 v[228:231], v[184:187], a[216:219], v[228:231]
    v_mfma_f32_16x16x32_bf16 v[232:235], v[168:171], a[232:235], v[232:235]
    buffer_load_dwordx4 v[112:115], v35, s[8:11], s28 offen offset:0 sc1
    buffer_load_dwordx4 v[116:119], v35, s[8:11], s28 offen offset:1024 sc1
    v_mfma_f32_16x16x32_bf16 v[236:239], v[184:187], a[232:235], v[236:239]
    v_mfma_f32_16x16x32_bf16 v[240:243], v[168:171], a[248:251], v[240:243]
    v_mfma_f32_16x16x32_bf16 v[244:247], v[184:187], a[248:251], v[244:247]
    v_mfma_f32_16x16x32_bf16 v[216:219], v[172:175], a[204:207], v[216:219]
    v_mfma_f32_16x16x32_bf16 v[220:223], v[188:191], a[204:207], v[220:223]
    v_mfma_f32_16x16x32_bf16 v[224:227], v[172:175], a[220:223], v[224:227]
    v_mfma_f32_16x16x32_bf16 v[228:231], v[188:191], a[220:223], v[228:231]
    v_mfma_f32_16x16x32_bf16 v[232:235], v[172:175], a[236:239], v[232:235]
    v_mfma_f32_16x16x32_bf16 v[236:239], v[188:191], a[236:239], v[236:239]
    v_mfma_f32_16x16x32_bf16 v[240:243], v[172:175], a[252:255], v[240:243]
    v_mfma_f32_16x16x32_bf16 v[244:247], v[188:191], a[252:255], v[244:247]
    s_nop 4
    v_cvt_pk_bf16_f32 v192, v216, v217
    v_cvt_pk_bf16_f32 v193, v218, v219
    v_cvt_pk_bf16_f32 v194, v220, v221
    v_cvt_pk_bf16_f32 v195, v222, v223
    v_cvt_pk_bf16_f32 v196, v224, v225
    v_cvt_pk_bf16_f32 v197, v226, v227
    v_cvt_pk_bf16_f32 v198, v228, v229
    v_cvt_pk_bf16_f32 v199, v230, v231
    v_cvt_pk_bf16_f32 v200, v232, v233
    v_cvt_pk_bf16_f32 v201, v234, v235
    v_cvt_pk_bf16_f32 v202, v236, v237
    v_cvt_pk_bf16_f32 v203, v238, v239
    v_cvt_pk_bf16_f32 v204, v240, v241
    v_cvt_pk_bf16_f32 v205, v242, v243
    v_cvt_pk_bf16_f32 v206, v244, v245
    v_cvt_pk_bf16_f32 v207, v246, v247
    s_add_u32 s27, s27, 32768
    s_add_u32 s23, s23, 1
    s_and_b32 s34, s23, 3
    s_lshl_b32 s35, s34, 16
    s_add_u32 s26, s7, s35
    s_add_u32 s24, s26, 32768
    s_xor_b32 s25, s26, 0x20000
    s_mov_b32 s31, 0
    s_waitcnt vmcnt(1)
    v_max3_u32 v34, v112, v113, v114
    v_max_u32 v34, v34, v115
    s_waitcnt vmcnt(0)
    v_max3_u32 v34, v116, v117, v34
    v_max3_u32 v34, v118, v119, v34
    v_cmp_eq_u32 vcc, -1, v34
    s_cbranch_vccnz Ls_x1
Lw_x1:
    v_mfma_f32_16x16x32_bf16 v[52:55], v[36:39], v[112:115], 0
    v_mfma_f32_16x16x32_bf16 v[52:55], v[36:39], v[116:119], v[52:55]
    s_nop 4
Lok_x1:
    s_and_b32 s34, s23, 3
    s_lshl_b32 s34, s34, 14
    s_add_u32 s28, s6, s34
    v_cvt_pk_bf16_f32 v248, v52, v53
    v_cvt_pk_bf16_f32 v249, v54, v55
    v_min_u32 v248, -2, v248
    v_min_u32 v249, -2, v249
    s_mov_b32 exec_hi, 0
    buffer_store_dwordx2 v[248:249], v25, s[8:11], s24 offen
    s_mov_b32 exec_hi, -1
    s_branch Lch_step
Lch_kvw:
    s_cmp_gt_u32 s23, 61
    s_cbranch_scc1 Lch_kvok
    s_lshl_b32 s33, s23, 2
    s_add_u32 s33, s33, s43
    s_add_u32 s33, s33, 8
    s_mov_b32 s31, 0
    v_mov_b32 v2, 0
Lwf_chk:
    buffer_load_dword v3, v2, s[8:11], s33 offen sc1
    s_waitcnt vmcnt(0)
    v_readfirstlane_b32 s34, v3
    s_and_b32 s34, s34, 65295
    s_cmp_eq_u32 s34, 4104
    s_cbranch_scc1 Lwd_chk
    s_sleep 4
    s_add_u32 s31, s31, 1
    s_cmp_lt_u32 s31, 2000000
    s_cbranch_scc1 Lwf_chk
    s_branch Lch_fail
Lwd_chk:
    s_branch Lch_kvok
Lq0_i1:
    buffer_load_dwordx4 v[232:235], v10, s[8:11], s24 offen offset:0 sc1
    buffer_load_dwordx4 v[236:239], v10, s[8:11], s24 offen offset:1024 sc1
    buffer_load_dwordx4 v[240:243], v10, s[8:11], s24 offen offset:2048 sc1
    buffer_load_dwordx4 v[244:247], v10, s[8:11], s24 offen offset:3072 sc1
    s_sleep 3
Lx0_i1:
    buffer_load_dwordx4 v[232:235], v10, s[8:11], s24 offen offset:0 sc1
    buffer_load_dwordx4 v[236:239], v10, s[8:11], s24 offen offset:1024 sc1
    buffer_load_dwordx4 v[240:243], v10, s[8:11], s24 offen offset:2048 sc1
    buffer_load_dwordx4 v[244:247], v10, s[8:11], s24 offen offset:3072 sc1
    s_add_u32 s31, s31, 1
    s_cmp_ge_u32 s31, 4000000
    s_cbranch_scc1 Lch_fail
    s_waitcnt vmcnt(7)
    v_max3_u32 v34, v232, v233, v234
    v_max_u32 v34, v34, v235
    v_cmp_eq_u32 vcc, -1, v34
    s_cbranch_vccnz Lx0_i1
    ds_write_b128 v10, v[232:235] offset:0
    s_waitcnt vmcnt(6)
    v_max3_u32 v34, v236, v237, v238
    v_max_u32 v34, v34, v239
    v_cmp_eq_u32 vcc, -1, v34
    s_cbranch_vccnz Lx1_i1
    ds_write_b128 v10, v[236:239] offset:1024
    s_waitcnt vmcnt(5)
    v_max3_u32 v34, v240, v241, v242
    v_max_u32 v34, v34, v243
    v_cmp_eq_u32 vcc, -1, v34
    s_cbranch_vccnz Lx2_i1
    ds_write_b128 v10, v[240:243] offset:2048
    s_waitcnt vmcnt(4)
    v_max3_u32 v34, v244, v245, v246
    v_max_u32 v34, v34, v247
    v_cmp_eq_u32 vcc, -1, v34
    s_cbranch_vccnz Lx3_i1
    ds_write_b128 v10, v[244:247] offset:3072
    s_branch Lok_i1
Lq1_i1:
    buffer_load_dwordx4 v[236:239], v10, s[8:11], s24 offen offset:1024 sc1
    buffer_load_dwordx4 v[240:243], v10, s[8:11], s24 offen offset:2048 sc1
    buffer_load_dwordx4 v[244:247], v10, s[8:11], s24 offen offset:3072 sc1
    s_sleep 3
Lx1_i1:
    buffer_load_dwordx4 v[236:239], v10, s[8:11], s24 offen offset:1024 sc1
    buffer_load_dwordx4 v[240:243], v10, s[8:11], s24 offen offset:2048 sc1
    buffer_load_dwordx4 v[244:247], v10, s[8:11], s24 offen offset:3072 sc1
    s_add_u32 s31, s31, 1
    s_cmp_ge_u32 s31, 4000000
    s_cbranch_scc1 Lch_fail
    s_waitcnt vmcnt(5)
    v_max3_u32 v34, v236, v237, v238
    v_max_u32 v34, v34, v239
    v_cmp_eq_u32 vcc, -1, v34
    s_cbranch_vccnz Lx1_i1
    ds_write_b128 v10, v[236:239] offset:1024
    s_waitcnt vmcnt(4)
    v_max3_u32 v34, v240, v241, v242
    v_max_u32 v34, v34, v243
    v_cmp_eq_u32 vcc, -1, v34
    s_cbranch_vccnz Lx2_i1
    ds_write_b128 v10, v[240:243] offset:2048
    s_waitcnt vmcnt(3)
    v_max3_u32 v34, v244, v245, v246
    v_max_u32 v34, v34, v247
    v_cmp_eq_u32 vcc, -1, v34
    s_cbranch_vccnz Lx3_i1
    ds_write_b128 v10, v[244:247] offset:3072
    s_branch Lok_i1
Lq2_i1:
    buffer_load_dwordx4 v[240:243], v10, s[8:11], s24 offen offset:2048 sc1
    buffer_load_dwordx4 v[244:247], v10, s[8:11], s24 offen offset:3072 sc1
    s_sleep 3
Lx2_i1:
    buffer_load_dwordx4 v[240:243], v10, s[8:11], s24 offen offset:2048 sc1
    buffer_load_dwordx4 v[244:247], v10, s[8:11], s24 offen offset:3072 sc1
    s_add_u32 s31, s31, 1
    s_cmp_ge_u32 s31, 4000000
    s_cbranch_scc1 Lch_fail
    s_waitcnt vmcnt(3)
    v_max3_u32 v34, v240, v241, v242
    v_max_u32 v34, v34, v243
    v_cmp_eq_u32 vcc, -1, v34
    s_cbranch_vccnz Lx2_i1
    ds_write_b128 v10, v[240:243] offset:2048
    s_waitcnt vmcnt(2)
    v_max3_u32 v34, v244, v245, v246
    v_max_u32 v34, v34, v247
    v_cmp_eq_u32 vcc, -1, v34
    s_cbranch_vccnz Lx3_i1
    ds_write_b128 v10, v[244:247] offset:3072
    s_branch Lok_i1
Lq3_i1:
    buffer_load_dwordx4 v[244:247], v10, s[8:11], s24 offen offset:3072 sc1
    s_sleep 3
Lx3_i1:
    buffer_load_dwordx4 v[244:247], v10, s[8:11], s24 offen offset:3072 sc1
    s_add_u32 s31, s31, 1
    s_cmp_ge_u32 s31, 4000000
    s_cbranch_scc1 Lch_fail
    s_waitcnt vmcnt(1)
    v_max3_u32 v34, v244, v245, v246
    v_max_u32 v34, v34, v247
    v_cmp_eq_u32 vcc, -1, v34
    s_cbranch_vccnz Lx3_i1
    s_branch Lg3_i1
Lch_e:
    s_cmp_eq_u32 s23, 63
    s_cbranch_scc1 Lch_last
    v_permlane16_swap_b32 v28, v30
    v_permlane16_swap_b32 v29, v31
    s_mov_b64 exec, s[38:39]
    buffer_store_dwordx4 v[28:31], v32, s[8:11], s27 offen sc1
    s_mov_b64 exec, -1
    s_nop 1
    v_permlane16_swap_b32 v28, v30
    v_permlane16_swap_b32 v29, v31
    s_branch Lch_er
Ls_iv:
    buffer_load_dwordx4 v[232:235], v17, s[8:11], s26 offen offset:0 sc1
    buffer_load_dwordx4 v[236:239], v17, s[8:11], s26 offen offset:1024 sc1
    buffer_load_dwordx4 v[240:243], v17, s[8:11], s26 offen offset:2048 sc1
    buffer_load_dwordx4 v[244:247], v17, s[8:11], s26 offen offset:3072 sc1
    s_add_u32 s31, s31, 1
    s_cmp_ge_u32 s31, 4000000
    s_cbranch_scc1 Lch_fail
    s_waitcnt vmcnt(3)
    v_max3_u32 v34, v232, v233, v234
    v_max_u32 v34, v34, v235
    s_waitcnt vmcnt(2)
    v_max3_u32 v34, v236, v237, v34
    v_max3_u32 v34, v238, v239, v34
    s_waitcnt vmcnt(1)
    v_max3_u32 v34, v240, v241, v34
    v_max3_u32 v34, v242, v243, v34
    s_waitcnt vmcnt(0)
    v_max3_u32 v34, v244, v245, v34
    v_max3_u32 v34, v246, v247, v34
    v_cmp_eq_u32 vcc, -1, v34
    s_cbranch_vccnz Ls_iv
    s_branch Lw_iv
Ls_i2:
    buffer_load_dwordx4 v[64:67], v16, s[8:11], s26 offen offset:0 sc1
    buffer_load_dwordx4 v[68:71], v16, s[8:11], s26 offen offset:1024 sc1
    buffer_load_dwordx4 v[72:75], v16, s[8:11], s26 offen offset:2048 sc1
    buffer_load_dwordx4 v[76:79], v16, s[8:11], s26 offen offset:3072 sc1
    s_add_u32 s31, s31, 1
    s_cmp_ge_u32 s31, 4000000
    s_cbranch_scc1 Lch_fail
    s_waitcnt vmcnt(3)
    v_max3_u32 v34, v64, v65, v66
    v_max_u32 v34, v34, v67
    s_waitcnt vmcnt(2)
    v_max3_u32 v34, v68, v69, v34
    v_max3_u32 v34, v70, v71, v34
    s_waitcnt vmcnt(1)
    v_max3_u32 v34, v72, v73, v34
    v_max3_u32 v34, v74, v75, v34
    s_waitcnt vmcnt(0)
    v_max3_u32 v34, v76, v77, v34
    v_max3_u32 v34, v78, v79, v34
    v_cmp_eq_u32 vcc, -1, v34
    s_cbranch_vccnz Ls_i2
    s_branch Lw_i2
Ls_x1:
    buffer_load_dwordx4 v[112:115], v35, s[8:11], s28 offen offset:0 sc1
    buffer_load_dwordx4 v[116:119], v35, s[8:11], s28 offen offset:1024 sc1
    s_add_u32 s31, s31, 1
    s_cmp_ge_u32 s31, 4000000
    s_cbranch_scc1 Lch_fail
    s_waitcnt vmcnt(1)
    v_max3_u32 v34, v112, v113, v114
    v_max_u32 v34, v34, v115
    s_waitcnt vmcnt(0)
    v_max3_u32 v34, v116, v117, v34
    v_max3_u32 v34, v118, v119, v34
    v_cmp_eq_u32 vcc, -1, v34
    s_cbranch_vccnz Ls_x1
    s_branch Lw_x1
Lch_step_s:
    s_waitcnt vmcnt(0)
    buffer_load_dwordx4 v[232:235], v10, s[8:11], s24 offen offset:0 sc1
    buffer_load_dwordx4 v[236:239], v10, s[8:11], s24 offen offset:1024 sc1
    buffer_load_dwordx4 v[240:243], v10, s[8:11], s24 offen offset:2048 sc1
    buffer_load_dwordx4 v[244:247], v10, s[8:11], s24 offen offset:3072 sc1
    v_readlane_b32 s34, v23, 8
    s_and_b32 s34, s34, 0xff0f
    s_cmp_lg_u32 s34, 0x1008
    s_cbranch_scc1 Lch_kvw_s
Lch_kvok_s:
    v_mov_b32 v216, 0
    v_mov_b32 v224, 0
    v_mov_b32 v217, 0
    v_mov_b32 v225, 0
    v_mov_b32 v218, 0
    v_mov_b32 v226, 0
    v_mov_b32 v219, 0
    v_mov_b32 v227, 0
    s_mov_b32 s31, 0
    s_waitcnt vmcnt(3)
    v_max3_u32 v34, v232, v233, v234
    v_max_u32 v34, v34, v235
    v_cmp_eq_u32 vcc, -1, v34
    s_cbranch_vccnz Lq0_i1_s
Lg0_i1_s:
    ds_write_b128 v10, v[232:235] offset:0
    s_waitcnt vmcnt(2)
    v_max3_u32 v34, v236, v237, v238
    v_max_u32 v34, v34, v239
    v_cmp_eq_u32 vcc, -1, v34
    s_cbranch_vccnz Lq1_i1_s
Lg1_i1_s:
    ds_write_b128 v10, v[236:239] offset:1024
    s_waitcnt vmcnt(1)
    v_max3_u32 v34, v240, v241, v242
    v_max_u32 v34, v34, v243
    v_cmp_eq_u32 vcc, -1, v34
    s_cbranch_vccnz Lq2_i1_s
Lg2_i1_s:
    ds_write_b128 v10, v[240:243] offset:2048
    s_waitcnt vmcnt(0)
    v_max3_u32 v34, v244, v245, v246
    v_max_u32 v34, v34, v247
    v_cmp_eq_u32 vcc, -1, v34
    s_cbranch_vccnz Lq3_i1_s
Lg3_i1_s:
    ds_write_b128 v10, v[244:247] offset:3072
Lok_i1_s:
    buffer_load_dwordx4 v[136:139], v19, s[8:11], s29 offen offset:0 sc1
    buffer_load_dwordx4 v[152:155], v19, s[8:11], s29 offen offset:256 sc1
    buffer_load_dwordx4 v[140:143], v19, s[8:11], s29 offen offset:2048 sc1
    buffer_load_dwordx4 v[156:159], v19, s[8:11], s29 offen offset:2304 sc1
    s_waitcnt lgkmcnt(0)
    s_barrier
    ds_read_b128 v[64:67], v12 offset:0
    ds_read_b128 v[68:71], v12 offset:1024
    ds_read_b128 v[72:75], v12 offset:2048
    ds_read_b128 v[76:79], v12 offset:3072
    v_smfmac_f32_16x16x64_bf16 v[216:219], v[232:235], a[128:135], v11
    ds_read_b128 v[80:83], v13 offset:0
    v_smfmac_f32_16x16x64_bf16 v[216:219], v[236:239], a[136:143], v11
    ds_read_b128 v[84:87], v13 offset:1024
    v_smfmac_f32_16x16x64_bf16 v[216:219], v[240:243], a[144:151], v11
    ds_read_b128 v[88:91], v13 offset:2048
    v_smfmac_f32_16x16x64_bf16 v[216:219], v[244:247], a[152:159], v11
    ds_read_b128 v[92:95], v13 offset:3072
    v_smfmac_f32_16x16x64_bf16 v[224:227], v[232:235], a[0:7], v11
    ds_read_b128 v[96:99], v120 offset:0
    v_smfmac_f32_16x16x64_bf16 v[224:227], v[236:239], a[8:15], v11
    ds_read_b128 v[100:103], v120 offset:1024
    v_smfmac_f32_16x16x64_bf16 v[224:227], v[240:243], a[16:23], v11
    ds_read_b128 v[104:107], v120 offset:2048
    v_smfmac_f32_16x16x64_bf16 v[224:227], v[244:247], a[24:31], v11
    ds_read_b128 v[108:111], v120 offset:3072
    s_waitcnt lgkmcnt(11)
    v_smfmac_f32_16x16x64_bf16 v[216:219], v[64:67], a[160:167], v11
    s_waitcnt lgkmcnt(10)
    v_smfmac_f32_16x16x64_bf16 v[216:219], v[68:71], a[168:175], v11
    s_waitcnt lgkmcnt(9)
    v_smfmac_f32_16x16x64_bf16 v[216:219], v[72:75], a[176:183], v11
    s_waitcnt lgkmcnt(8)
    v_smfmac_f32_16x16x64_bf16 v[216:219], v[76:79], a[184:191], v11
    v_smfmac_f32_16x16x64_bf16 v[224:227], v[64:67], a[32:39], v11
    v_smfmac_f32_16x16x64_bf16 v[224:227], v[68:71], a[40:47], v11
    v_smfmac_f32_16x16x64_bf16 v[224:227], v[72:75], a[48:55], v11
    s_nop 4
    v_cvt_pk_bf16_f32 v30, v216, v217
    v_cvt_pk_bf16_f32 v31, v218, v219
    v_smfmac_f32_16x16x64_bf16 v[224:227], v[76:79], a[56:63], v11
    s_waitcnt lgkmcnt(7)
    v_mfma_f32_16x16x16_bf16 v[220:223], v[30:31], v[250:251], 0
    v_smfmac_f32_16x16x64_bf16 v[224:227], v[80:83], a[64:71], v11
    s_waitcnt lgkmcnt(6)
    v_smfmac_f32_16x16x64_bf16 v[224:227], v[84:87], a[72:79], v11
    s_nop 4
    v_cvt_pk_bf16_f32 v30, v220, v221
    v_cvt_pk_bf16_f32 v31, v222, v223
    v_min_u32 v30, -2, v30
    v_min_u32 v31, -2, v31
    s_mov_b64 exec, s[38:39]
    buffer_store_dwordx2 v[30:31], v15, s[8:11], s26 offen sc1
    s_mov_b64 exec, -1
    s_waitcnt lgkmcnt(5)
    v_smfmac_f32_16x16x64_bf16 v[224:227], v[88:91], a[80:87], v11
    s_waitcnt lgkmcnt(4)
    v_smfmac_f32_16x16x64_bf16 v[224:227], v[92:95], a[88:95], v11
    s_waitcnt lgkmcnt(3)
    v_smfmac_f32_16x16x64_bf16 v[224:227], v[96:99], a[96:103], v11
    s_waitcnt lgkmcnt(2)
    v_smfmac_f32_16x16x64_bf16 v[224:227], v[100:103], a[104:111], v11
    s_waitcnt lgkmcnt(1)
    v_smfmac_f32_16x16x64_bf16 v[224:227], v[104:107], a[112:119], v11
    s_waitcnt lgkmcnt(0)
    v_smfmac_f32_16x16x64_bf16 v[224:227], v[108:111], a[120:127], v11
    s_nop 7
    v_cvt_pk_bf16_f32 v28, v224, v225
    v_cvt_pk_bf16_f32 v29, v226, v227
    s_nop 1
    v_mfma_f32_16x16x16_bf16 v[228:231], v[28:29], v[250:251], 0
    s_nop 7
    v_cvt_pk_bf16_f32 v28, v228, v229
    v_cvt_pk_bf16_f32 v29, v230, v231
    v_min_u32 v28, -2, v28
    v_min_u32 v29, -2, v29
    s_mov_b64 exec, s[38:39]
    buffer_store_dwordx2 v[28:29], v14, s[8:11], s26 offen sc1
    s_mov_b64 exec, -1
    s_or_b32 s34, s23, 8
    s_cmp_eq_u32 s34, 63
    s_cbranch_scc1 Lch_e_s
Lch_er_s:
    buffer_load_dwordx4 v[232:235], v17, s[8:11], s26 offen offset:0 sc1
    buffer_load_dwordx4 v[236:239], v17, s[8:11], s26 offen offset:1024 sc1
    buffer_load_dwordx4 v[240:243], v17, s[8:11], s26 offen offset:2048 sc1
    buffer_load_dwordx4 v[244:247], v17, s[8:11], s26 offen offset:3072 sc1
    s_mov_b32 s31, 0
    s_waitcnt vmcnt(3)
    v_max3_u32 v34, v232, v233, v234
    v_max_u32 v34, v34, v235
    s_waitcnt vmcnt(2)
    v_max3_u32 v34, v236, v237, v34
    v_max3_u32 v34, v238, v239, v34
    s_waitcnt vmcnt(1)
    v_max3_u32 v34, v240, v241, v34
    v_max3_u32 v34, v242, v243, v34
    s_waitcnt vmcnt(0)
    v_max3_u32 v34, v244, v245, v34
    v_max3_u32 v34, v246, v247, v34
    v_cmp_eq_u32 vcc, -1, v34
    s_cbranch_vccnz Ls_iv_s
    s_waitcnt vmcnt(0)
Lw_iv_s:
    buffer_load_dwordx4 v[64:67], v16, s[8:11], s26 offen offset:0 sc1
    buffer_load_dwordx4 v[68:71], v16, s[8:11], s26 offen offset:1024 sc1
    buffer_load_dwordx4 v[72:75], v16, s[8:11], s26 offen offset:2048 sc1
    buffer_load_dwordx4 v[76:79], v16, s[8:11], s26 offen offset:3072 sc1
    v_mfma_f32_16x16x32_bf16 v[216:219], v[232:235], a[192:195], 0
    v_mfma_f32_16x16x32_bf16 v[220:223], v[232:235], a[208:211], 0
    v_mfma_f32_16x16x32_bf16 v[224:227], v[232:235], a[224:227], 0
    v_mfma_f32_16x16x32_bf16 v[228:231], v[232:235], a[240:243], 0
    v_mfma_f32_16x16x32_bf16 v[216:219], v[236:239], a[196:199], v[216:219]
    v_mfma_f32_16x16x32_bf16 v[220:223], v[236:239], a[212:215], v[220:223]
    v_mfma_f32_16x16x32_bf16 v[224:227], v[236:239], a[228:231], v[224:227]
    v_mfma_f32_16x16x32_bf16 v[228:231], v[236:239], a[244:247], v[228:231]
    v_mfma_f32_16x16x32_bf16 v[216:219], v[240:243], a[200:203], v[216:219]
    v_mfma_f32_16x16x32_bf16 v[220:223], v[240:243], a[216:219], v[220:223]
    v_mfma_f32_16x16x32_bf16 v[224:227], v[240:243], a[232:235], v[224:227]
    v_mfma_f32_16x16x32_bf16 v[228:231], v[240:243], a[248:251], v[228:231]
    v_mfma_f32_16x16x32_bf16 v[216:219], v[244:247], a[204:207], v[216:219]
    v_mfma_f32_16x16x32_bf16 v[220:223], v[244:247], a[220:223], v[220:223]
    v_mfma_f32_16x16x32_bf16 v[224:227], v[244:247], a[236:239], v[224:227]
    v_mfma_f32_16x16x32_bf16 v[228:231], v[244:247], a[252:255], v[228:231]
    s_nop 4
Lok_iv_s:
    v_cvt_pk_bf16_f32 v208, v216, v217
    v_cvt_pk_bf16_f32 v209, v218, v219
    v_cvt_pk_bf16_f32 v210, v220, v221
    v_cvt_pk_bf16_f32 v211, v222, v223
    v_cvt_pk_bf16_f32 v212, v224, v225
    v_cvt_pk_bf16_f32 v213, v226, v227
    v_cvt_pk_bf16_f32 v214, v228, v229
    v_cvt_pk_bf16_f32 v215, v230, v231
    buffer_load_dwordx4 v[160:163], v18, s[8:11], s30 offen offset:0 sc1
    buffer_load_dwordx4 v[176:179], v18, s[8:11], s30 offen offset:256 sc1
    buffer_load_dwordx4 v[164:167], v18, s[8:11], s30 offen offset:2048 sc1
    buffer_load_dwordx4 v[180:183], v18, s[8:11], s30 offen offset:2304 sc1
    s_mov_b32 s31, 0
    s_waitcnt vmcnt(7)
    v_max3_u32 v34, v64, v65, v66
    v_max_u32 v34, v34, v67
    s_waitcnt vmcnt(6)
    v_max3_u32 v34, v68, v69, v34
    v_max3_u32 v34, v70, v71, v34
    s_waitcnt vmcnt(5)
    v_max3_u32 v34, v72, v73, v34
    v_max3_u32 v34, v74, v75, v34
    s_waitcnt vmcnt(4)
    v_max3_u32 v34, v76, v77, v34
    v_max3_u32 v34, v78, v79, v34
    v_cmp_eq_u32 vcc, -1, v34
    s_cbranch_vccnz Ls_i2_s
Lw_i2_s:
    v_mfma_f32_16x16x32_bf16 v[56:59], v[128:131], v[64:67], 0
    v_mfma_f32_16x16x32_bf16 v[60:63], v[144:147], v[64:67], 0
    v_mfma_f32_16x16x32_bf16 v[52:55], v[64:67], v[64:67], v[40:43]
    buffer_load_dwordx4 v[168:171], v19, s[8:11], s30 offen offset:0 sc1
    v_mfma_f32_16x16x32_bf16 v[56:59], v[132:135], v[68:71], v[56:59]
    v_mfma_f32_16x16x32_bf16 v[60:63], v[148:151], v[68:71], v[60:63]
    v_mfma_f32_16x16x32_bf16 v[52:55], v[68:71], v[68:71], v[52:55]
    buffer_load_dwordx4 v[184:187], v19, s[8:11], s30 offen offset:256 sc1
    v_mfma_f32_16x16x32_bf16 v[56:59], v[136:139], v[72:75], v[56:59]
    v_mfma_f32_16x16x32_bf16 v[60:63], v[152:155], v[72:75], v[60:63]
    v_mfma_f32_16x16x32_bf16 v[52:55], v[72:75], v[72:75], v[52:55]
    buffer_load_dwordx4 v[172:175], v19, s[8:11], s30 offen offset:2048 sc1
    v_mfma_f32_16x16x32_bf16 v[56:59], v[140:143], v[76:79], v[56:59]
    v_mfma_f32_16x16x32_bf16 v[60:63], v[156:159], v[76:79], v[60:63]
    v_mfma_f32_16x16x32_bf16 v[52:55], v[76:79], v[76:79], v[52:55]
    buffer_load_dwordx4 v[188:191], v19, s[8:11], s30 offen offset:2304 sc1
Lok_i2_s:
    s_lshl_b32 s34, s20, 8
    s_add_u32 s42, s28, s34
    s_add_u32 s29, s29, 0x40000
    s_add_u32 s30, s30, 0x40000
    s_mov_b64 exec, 0x1ff
    buffer_load_dword v23, v26, s[8:11], 0 offen sc1
    s_mov_b64 exec, -1
    v_add_u32 v26, v26, v22
    v_max3_f32 v2, v56, v57, v58
    v_max3_f32 v3, v59, v60, v61
    v_max3_f32 v2, v62, v63, v2
    v_max3_f32 v3, v52, v53, v3
    v_max3_f32 v2, v54, v55, v2
    v_max_f32 v27, v2, v3
    v_max_f32 v3, v2, v3
    s_nop 0
    s_nop 0
    v_permlane16_swap_b32 v27, v3
    v_max_f32 v2, v27, v3
    v_max_f32 v3, v27, v3
    s_nop 0
    s_nop 0
    v_permlane32_swap_b32 v2, v3
    v_max_f32 v2, v2, v3
    v_fma_f32 v2, v2, s36, v121
    v_pk_fma_f32 v[52:53], v[52:53], s[36:37], v[2:3] op_sel_hi:[1,0,0] neg_lo:[0,0,1] neg_hi:[0,0,1]
    v_pk_fma_f32 v[54:55], v[54:55], s[36:37], v[2:3] op_sel_hi:[1,0,0] neg_lo:[0,0,1] neg_hi:[0,0,1]
    v_pk_fma_f32 v[56:57], v[56:57], s[36:37], v[2:3] op_sel_hi:[1,0,0] neg_lo:[0,0,1] neg_hi:[0,0,1]
    v_pk_fma_f32 v[58:59], v[58:59], s[36:37], v[2:3] op_sel_hi:[1,0,0] neg_lo:[0,0,1] neg_hi:[0,0,1]
    v_pk_fma_f32 v[60:61], v[60:61], s[36:37], v[2:3] op_sel_hi:[1,0,0] neg_lo:[0,0,1] neg_hi:[0,0,1]
    v_pk_fma_f32 v[62:63], v[62:63], s[36:37], v[2:3] op_sel_hi:[1,0,0] neg_lo:[0,0,1] neg_hi:[0,0,1]
    v_exp_f32 v52, v52
    v_exp_f32 v53, v53
    v_exp_f32 v54, v54
    v_exp_f32 v55, v55
    v_exp_f32 v56, v56
    v_exp_f32 v57, v57
    v_cvt_pk_bf16_f32 v46, v52, v53
    v_cvt_pk_bf16_f32 v44, v52, v53
    v_cvt_pk_bf16_f32 v47, v54, v55
    v_cvt_pk_bf16_f32 v45, v54, v55
    v_exp_f32 v58, v58
    v_exp_f32 v59, v59
    v_permlane32_swap_b32 v46, v44
    v_permlane32_swap_b32 v47, v45
    v_exp_f32 v60, v60
    v_exp_f32 v61, v61
    v_mfma_f32_16x16x16_bf16 v[96:99], v[8:9], v[44:45], 0
    v_mov_b32_dpp v122, v44 row_shr:8 row_mask:0xf bank_mask:0xf bound_ctrl:0
    v_mov_b32_dpp v123, v45 row_shr:8 row_mask:0xf bank_mask:0xf bound_ctrl:0
    v_mfma_f32_16x16x16_bf16 v[80:83], v[208:209], v[44:45], 0
    v_exp_f32 v62, v62
    v_mfma_f32_16x16x16_bf16 v[84:87], v[210:211], v[44:45], 0
    v_exp_f32 v63, v63
    v_cvt_pk_bf16_f32 v48, v56, v57
    v_cvt_pk_bf16_f32 v49, v58, v59
    v_mfma_f32_16x16x16_bf16 v[80:83], v[212:213], v[122:123], v[80:83]
    v_cvt_pk_bf16_f32 v50, v60, v61
    v_cvt_pk_bf16_f32 v51, v62, v63
    v_mfma_f32_16x16x16_bf16 v[84:87], v[214:215], v[122:123], v[84:87]
    v_mov_b32_dpp v124, v48 row_shr:8 row_mask:0xf bank_mask:0xf bound_ctrl:0
    v_mov_b32_dpp v125, v49 row_shr:8 row_mask:0xf bank_mask:0xf bound_ctrl:0
    v_mfma_f32_16x16x32_bf16 v[96:99], v[4:7], v[48:51], v[96:99]
    v_mov_b32_dpp v126, v50 row_shr:8 row_mask:0xf bank_mask:0xf bound_ctrl:0
    v_mov_b32_dpp v127, v51 row_shr:8 row_mask:0xf bank_mask:0xf bound_ctrl:0
    v_mfma_f32_16x16x32_bf16 v[80:83], v[192:195], v[48:51], v[80:83]
    v_mfma_f32_16x16x32_bf16 v[84:87], v[196:199], v[48:51], v[84:87]
    v_mfma_f32_16x16x32_bf16 v[80:83], v[200:203], v[124:127], v[80:83]
    v_mfma_f32_16x16x32_bf16 v[84:87], v[204:207], v[124:127], v[84:87]
    s_nop 1
    v_rcp_f32 v2, v96
    s_nop 2
    ds_write_b32 v33, v2
    ds_write_b128 v20, v[80:83] offset:0
    ds_write_b128 v20, v[84:87] offset:512
    buffer_load_dwordx4 v[128:131], v18, s[8:11], s29 offen offset:0 sc1
    buffer_load_dwordx4 v[144:147], v18, s[8:11], s29 offen offset:256 sc1
    buffer_load_dwordx4 v[132:135], v18, s[8:11], s29 offen offset:2048 sc1
    buffer_load_dwordx4 v[148:151], v18, s[8:11], s29 offen offset:2304 sc1
    s_waitcnt lgkmcnt(0)
    s_barrier
    ds_read_b128 v[92:95], v252
    ds_read_b64 v[80:81], v21 offset:0
    ds_read_b64 v[82:83], v21 offset:2048
    ds_read_b64 v[84:85], v21 offset:4096
    ds_read_b64 v[86:87], v21 offset:6144
    s_waitcnt lgkmcnt(3)
    v_mul_f32 v80, v80, v92
    v_mul_f32 v81, v81, v92
    s_waitcnt lgkmcnt(2)
    v_fmac_f32 v80, v82, v93
    v_fmac_f32 v81, v83, v93
    s_waitcnt lgkmcnt(1)
    v_fmac_f32 v80, v84, v94
    v_fmac_f32 v81, v85, v94
    s_waitcnt lgkmcnt(0)
    v_fmac_f32 v80, v86, v95
    v_fmac_f32 v81, v87, v95
    v_cvt_pk_bf16_f32 v88, v80, v81
    v_min_u32 v88, -2, v88
    buffer_store_dword v88, v24, s[8:11], s42 offen sc1
    s_waitcnt vmcnt(6)
    v_mov_b32 v208, -1
    v_mov_b32 v209, -1
    v_mov_b32 v210, -1
    v_mov_b32 v211, -1
    s_xor_b32 s32, s42, 0x8000
    s_mov_b32 exec_hi, 0xffff
    buffer_store_dwordx4 v[208:211], v253, s[8:11], s25 offen sc1
    s_mov_b32 exec_hi, -1
    v_permlane16_swap_b32 v28, v30
    v_permlane16_swap_b32 v29, v31
    s_mov_b64 exec, s[38:39]
    buffer_store_dwordx4 v[28:31], v32, s[8:11], s27 offen sc1
    s_mov_b64 exec, -1
    s_mov_b64 exec, 0xffff
    buffer_store_dwordx4 v[208:211], v35, s[8:11], s32 offen sc1
    s_mov_b64 exec, -1
    s_cmp_lg_u32 s40, 0
    s_cbranch_scc1 Lch_np_s
    s_lshl_b32 s34, s20, 7
    s_add_u32 s34, s34, 120074240
    v_mov_b32 v2, s23
    s_mov_b64 exec, 1
    buffer_store_dword v2, v35, s[8:11], s34 offen sc1
Lch_np_s:
    s_mov_b64 exec, -1
    v_mfma_f32_16x16x32_bf16 v[216:219], v[160:163], a[192:195], 0
    v_mfma_f32_16x16x32_bf16 v[220:223], v[176:179], a[192:195], 0
    v_mfma_f32_16x16x32_bf16 v[224:227], v[160:163], a[208:211], 0
    v_mfma_f32_16x16x32_bf16 v[228:231], v[176:179], a[208:211], 0
    v_mfma_f32_16x16x32_bf16 v[232:235], v[160:163], a[224:227], 0
    v_mfma_f32_16x16x32_bf16 v[236:239], v[176:179], a[224:227], 0
    v_mfma_f32_16x16x32_bf16 v[240:243], v[160:163], a[240:243], 0
    v_mfma_f32_16x16x32_bf16 v[244:247], v[176:179], a[240:243], 0
    v_mfma_f32_16x16x32_bf16 v[216:219], v[164:167], a[196:199], v[216:219]
    v_mfma_f32_16x16x32_bf16 v[220:223], v[180:183], a[196:199], v[220:223]
    v_mfma_f32_16x16x32_bf16 v[224:227], v[164:167], a[212:215], v[224:227]
    v_mfma_f32_16x16x32_bf16 v[228:231], v[180:183], a[212:215], v[228:231]
    v_mfma_f32_16x16x32_bf16 v[232:235], v[164:167], a[228:231], v[232:235]
    v_mfma_f32_16x16x32_bf16 v[236:239], v[180:183], a[228:231], v[236:239]
    v_mfma_f32_16x16x32_bf16 v[240:243], v[164:167], a[244:247], v[240:243]
    v_mfma_f32_16x16x32_bf16 v[244:247], v[180:183], a[244:247], v[244:247]
    v_mfma_f32_16x16x32_bf16 v[216:219], v[168:171], a[200:203], v[216:219]
    v_mfma_f32_16x16x32_bf16 v[220:223], v[184:187], a[200:203], v[220:223]
    v_mfma_f32_16x16x32_bf16 v[224:227], v[168:171], a[216:219], v[224:227]
    v_mfma_f32_16x16x32_bf16 v[228:231], v[184:187], a[216:219], v[228:231]
    v_mfma_f32_16x16x32_bf16 v[232:235], v[168:171], a[232:235], v[232:235]
    buffer_load_dwordx4 v[112:115], v35, s[8:11], s28 offen offset:0 sc1
    buffer_load_dwordx4 v[116:119], v35, s[8:11], s28 offen offset:1024 sc1
    v_mfma_f32_16x16x32_bf16 v[236:239], v[184:187], a[232:235], v[236:239]
    v_mfma_f32_16x16x32_bf16 v[240:243], v[168:171], a[248:251], v[240:243]
    v_mfma_f32_16x16x32_bf16 v[244:247], v[184:187], a[248:251], v[244:247]
    v_mfma_f32_16x16x32_bf16 v[216:219], v[172:175], a[204:207], v[216:219]
    v_mfma_f32_16x16x32_bf16 v[220:223], v[188:191], a[204:207], v[220:223]
    v_mfma_f32_16x16x32_bf16 v[224:227], v[172:175], a[220:223], v[224:227]
    v_mfma_f32_16x16x32_bf16 v[228:231], v[188:191], a[220:223], v[228:231]
    v_mfma_f32_16x16x32_bf16 v[232:235], v[172:175], a[236:239], v[232:235]
    v_mfma_f32_16x16x32_bf16 v[236:239], v[188:191], a[236:239], v[236:239]
    v_mfma_f32_16x16x32_bf16 v[240:243], v[172:175], a[252:255], v[240:243]
    v_mfma_f32_16x16x32_bf16 v[244:247], v[188:191], a[252:255], v[244:247]
    s_nop 4
    v_cvt_pk_bf16_f32 v192, v216, v217
    v_cvt_pk_bf16_f32 v193, v218, v219
    v_cvt_pk_bf16_f32 v194, v220, v221
    v_cvt_pk_bf16_f32 v195, v222, v223
    v_cvt_pk_bf16_f32 v196, v224, v225
    v_cvt_pk_bf16_f32 v197, v226, v227
    v_cvt_pk_bf16_f32 v198, v228, v229
    v_cvt_pk_bf16_f32 v199, v230, v231
    v_cvt_pk_bf16_f32 v200, v232, v233
    v_cvt_pk_bf16_f32 v201, v234, v235
    v_cvt_pk_bf16_f32 v202, v236, v237
    v_cvt_pk_bf16_f32 v203, v238, v239
    v_cvt_pk_bf16_f32 v204, v240, v241
    v_cvt_pk_bf16_f32 v205, v242, v243
    v_cvt_pk_bf16_f32 v206, v244, v245
    v_cvt_pk_bf16_f32 v207, v246, v247
    s_add_u32 s27, s27, 32768
    s_add_u32 s23, s23, 1
    s_and_b32 s34, s23, 3
    s_lshl_b32 s35, s34, 16
    s_add_u32 s26, s7, s35
    s_add_u32 s24, s26, 32768
    s_xor_b32 s25, s26, 0x20000
    s_mov_b32 s31, 0
    s_waitcnt vmcnt(1)
    v_max3_u32 v34, v112, v113, v114
    v_max_u32 v34, v34, v115
    s_waitcnt vmcnt(0)
    v_max3_u32 v34, v116, v117, v34
    v_max3_u32 v34, v118, v119, v34
    v_cmp_eq_u32 vcc, -1, v34
    s_cbranch_vccnz Ls_x1_s
Lw_x1_s:
    v_mfma_f32_16x16x32_bf16 v[52:55], v[36:39], v[112:115], 0
    v_mfma_f32_16x16x32_bf16 v[52:55], v[36:39], v[116:119], v[52:55]
    s_nop 4
Lok_x1_s:
    s_and_b32 s34, s23, 3
    s_lshl_b32 s34, s34, 14
    s_add_u32 s28, s6, s34
    v_cvt_pk_bf16_f32 v248, v52, v53
    v_cvt_pk_bf16_f32 v249, v54, v55
    v_min_u32 v248, -2, v248
    v_min_u32 v249, -2, v249
    s_mov_b32 exec_hi, 0
    buffer_store_dwordx2 v[248:249], v25, s[8:11], s24 offen sc1
    s_mov_b32 exec_hi, -1
    s_branch Lch_step_s
Lch_kvw_s:
    s_cmp_gt_u32 s23, 61
    s_cbranch_scc1 Lch_kvok_s
    s_lshl_b32 s33, s23, 2
    s_add_u32 s33, s33, s43
    s_add_u32 s33, s33, 8
    s_mov_b32 s31, 0
    v_mov_b32 v2, 0
Lwf_chk_s:
    buffer_load_dword v3, v2, s[8:11], s33 offen sc1
    s_waitcnt vmcnt(0)
    v_readfirstlane_b32 s34, v3
    s_and_b32 s34, s34, 65295
    s_cmp_eq_u32 s34, 4104
    s_cbranch_scc1 Lwd_chk_s
    s_sleep 4
    s_add_u32 s31, s31, 1
    s_cmp_lt_u32 s31, 2000000
    s_cbranch_scc1 Lwf_chk_s
    s_branch Lch_fail
Lwd_chk_s:
    s_branch Lch_kvok_s
Lq0_i1_s:
    buffer_load_dwordx4 v[232:235], v10, s[8:11], s24 offen offset:0 sc1
    buffer_load_dwordx4 v[236:239], v10, s[8:11], s24 offen offset:1024 sc1
    buffer_load_dwordx4 v[240:243], v10, s[8:11], s24 offen offset:2048 sc1
    buffer_load_dwordx4 v[244:247], v10, s[8:11], s24 offen offset:3072 sc1
    s_sleep 3
Lx0_i1_s:
    buffer_load_dwordx4 v[232:235], v10, s[8:11], s24 offen offset:0 sc1
    buffer_load_dwordx4 v[236:239], v10, s[8:11], s24 offen offset:1024 sc1
    buffer_load_dwordx4 v[240:243], v10, s[8:11], s24 offen offset:2048 sc1
    buffer_load_dwordx4 v[244:247], v10, s[8:11], s24 offen offset:3072 sc1
    s_add_u32 s31, s31, 1
    s_cmp_ge_u32 s31, 4000000
    s_cbranch_scc1 Lch_fail
    s_waitcnt vmcnt(7)
    v_max3_u32 v34, v232, v233, v234
    v_max_u32 v34, v34, v235
    v_cmp_eq_u32 vcc, -1, v34
    s_cbranch_vccnz Lx0_i1_s
    ds_write_b128 v10, v[232:235] offset:0
    s_waitcnt vmcnt(6)
    v_max3_u32 v34, v236, v237, v238
    v_max_u32 v34, v34, v239
    v_cmp_eq_u32 vcc, -1, v34
    s_cbranch_vccnz Lx1_i1_s
    ds_write_b128 v10, v[236:239] offset:1024
    s_waitcnt vmcnt(5)
    v_max3_u32 v34, v240, v241, v242
    v_max_u32 v34, v34, v243
    v_cmp_eq_u32 vcc, -1, v34
    s_cbranch_vccnz Lx2_i1_s
    ds_write_b128 v10, v[240:243] offset:2048
    s_waitcnt vmcnt(4)
    v_max3_u32 v34, v244, v245, v246
    v_max_u32 v34, v34, v247
    v_cmp_eq_u32 vcc, -1, v34
    s_cbranch_vccnz Lx3_i1_s
    ds_write_b128 v10, v[244:247] offset:3072
    s_branch Lok_i1_s
Lq1_i1_s:
    buffer_load_dwordx4 v[236:239], v10, s[8:11], s24 offen offset:1024 sc1
    buffer_load_dwordx4 v[240:243], v10, s[8:11], s24 offen offset:2048 sc1
    buffer_load_dwordx4 v[244:247], v10, s[8:11], s24 offen offset:3072 sc1
    s_sleep 3
Lx1_i1_s:
    buffer_load_dwordx4 v[236:239], v10, s[8:11], s24 offen offset:1024 sc1
    buffer_load_dwordx4 v[240:243], v10, s[8:11], s24 offen offset:2048 sc1
    buffer_load_dwordx4 v[244:247], v10, s[8:11], s24 offen offset:3072 sc1
    s_add_u32 s31, s31, 1
    s_cmp_ge_u32 s31, 4000000
    s_cbranch_scc1 Lch_fail
    s_waitcnt vmcnt(5)
    v_max3_u32 v34, v236, v237, v238
    v_max_u32 v34, v34, v239
    v_cmp_eq_u32 vcc, -1, v34
    s_cbranch_vccnz Lx1_i1_s
    ds_write_b128 v10, v[236:239] offset:1024
    s_waitcnt vmcnt(4)
    v_max3_u32 v34, v240, v241, v242
    v_max_u32 v34, v34, v243
    v_cmp_eq_u32 vcc, -1, v34
    s_cbranch_vccnz Lx2_i1_s
    ds_write_b128 v10, v[240:243] offset:2048
    s_waitcnt vmcnt(3)
    v_max3_u32 v34, v244, v245, v246
    v_max_u32 v34, v34, v247
    v_cmp_eq_u32 vcc, -1, v34
    s_cbranch_vccnz Lx3_i1_s
    ds_write_b128 v10, v[244:247] offset:3072
    s_branch Lok_i1_s
Lq2_i1_s:
    buffer_load_dwordx4 v[240:243], v10, s[8:11], s24 offen offset:2048 sc1
    buffer_load_dwordx4 v[244:247], v10, s[8:11], s24 offen offset:3072 sc1
    s_sleep 3
Lx2_i1_s:
    buffer_load_dwordx4 v[240:243], v10, s[8:11], s24 offen offset:2048 sc1
    buffer_load_dwordx4 v[244:247], v10, s[8:11], s24 offen offset:3072 sc1
    s_add_u32 s31, s31, 1
    s_cmp_ge_u32 s31, 4000000
    s_cbranch_scc1 Lch_fail
    s_waitcnt vmcnt(3)
    v_max3_u32 v34, v240, v241, v242
    v_max_u32 v34, v34, v243
    v_cmp_eq_u32 vcc, -1, v34
    s_cbranch_vccnz Lx2_i1_s
    ds_write_b128 v10, v[240:243] offset:2048
    s_waitcnt vmcnt(2)
    v_max3_u32 v34, v244, v245, v246
    v_max_u32 v34, v34, v247
    v_cmp_eq_u32 vcc, -1, v34
    s_cbranch_vccnz Lx3_i1_s
    ds_write_b128 v10, v[244:247] offset:3072
    s_branch Lok_i1_s
Lq3_i1_s:
    buffer_load_dwordx4 v[244:247], v10, s[8:11], s24 offen offset:3072 sc1
    s_sleep 3
Lx3_i1_s:
    buffer_load_dwordx4 v[244:247], v10, s[8:11], s24 offen offset:3072 sc1
    s_add_u32 s31, s31, 1
    s_cmp_ge_u32 s31, 4000000
    s_cbranch_scc1 Lch_fail
    s_waitcnt vmcnt(1)
    v_max3_u32 v34, v244, v245, v246
    v_max_u32 v34, v34, v247
    v_cmp_eq_u32 vcc, -1, v34
    s_cbranch_vccnz Lx3_i1_s
    s_branch Lg3_i1_s
Lch_e_s:
    s_cmp_eq_u32 s23, 63
    s_cbranch_scc1 Lch_last
    v_permlane16_swap_b32 v28, v30
    v_permlane16_swap_b32 v29, v31
    s_mov_b64 exec, s[38:39]
    buffer_store_dwordx4 v[28:31], v32, s[8:11], s27 offen sc1
    s_mov_b64 exec, -1
    s_nop 1
    v_permlane16_swap_b32 v28, v30
    v_permlane16_swap_b32 v29, v31
    s_branch Lch_er_s
Ls_iv_s:
    buffer_load_dwordx4 v[232:235], v17, s[8:11], s26 offen offset:0 sc1
    buffer_load_dwordx4 v[236:239], v17, s[8:11], s26 offen offset:1024 sc1
    buffer_load_dwordx4 v[240:243], v17, s[8:11], s26 offen offset:2048 sc1
    buffer_load_dwordx4 v[244:247], v17, s[8:11], s26 offen offset:3072 sc1
    s_add_u32 s31, s31, 1
    s_cmp_ge_u32 s31, 4000000
    s_cbranch_scc1 Lch_fail
    s_waitcnt vmcnt(3)
    v_max3_u32 v34, v232, v233, v234
    v_max_u32 v34, v34, v235
    s_waitcnt vmcnt(2)
    v_max3_u32 v34, v236, v237, v34
    v_max3_u32 v34, v238, v239, v34
    s_waitcnt vmcnt(1)
    v_max3_u32 v34, v240, v241, v34
    v_max3_u32 v34, v242, v243, v34
    s_waitcnt vmcnt(0)
    v_max3_u32 v34, v244, v245, v34
    v_max3_u32 v34, v246, v247, v34
    v_cmp_eq_u32 vcc, -1, v34
    s_cbranch_vccnz Ls_iv_s
    s_branch Lw_iv_s
Ls_i2_s:
    buffer_load_dwordx4 v[64:67], v16, s[8:11], s26 offen offset:0 sc1
    buffer_load_dwordx4 v[68:71], v16, s[8:11], s26 offen offset:1024 sc1
    buffer_load_dwordx4 v[72:75], v16, s[8:11], s26 offen offset:2048 sc1
    buffer_load_dwordx4 v[76:79], v16, s[8:11], s26 offen offset:3072 sc1
    s_add_u32 s31, s31, 1
    s_cmp_ge_u32 s31, 4000000
    s_cbranch_scc1 Lch_fail
    s_waitcnt vmcnt(3)
    v_max3_u32 v34, v64, v65, v66
    v_max_u32 v34, v34, v67
    s_waitcnt vmcnt(2)
    v_max3_u32 v34, v68, v69, v34
    v_max3_u32 v34, v70, v71, v34
    s_waitcnt vmcnt(1)
    v_max3_u32 v34, v72, v73, v34
    v_max3_u32 v34, v74, v75, v34
    s_waitcnt vmcnt(0)
    v_max3_u32 v34, v76, v77, v34
    v_max3_u32 v34, v78, v79, v34
    v_cmp_eq_u32 vcc, -1, v34
    s_cbranch_vccnz Ls_i2_s
    s_branch Lw_i2_s
Ls_x1_s:
    buffer_load_dwordx4 v[112:115], v35, s[8:11], s28 offen offset:0 sc1
    buffer_load_dwordx4 v[116:119], v35, s[8:11], s28 offen offset:1024 sc1
    s_add_u32 s31, s31, 1
    s_cmp_ge_u32 s31, 4000000
    s_cbranch_scc1 Lch_fail
    s_waitcnt vmcnt(1)
    v_max3_u32 v34, v112, v113, v114
    v_max_u32 v34, v34, v115
    s_waitcnt vmcnt(0)
    v_max3_u32 v34, v116, v117, v34
    v_max3_u32 v34, v118, v119, v34
    v_cmp_eq_u32 vcc, -1, v34
    s_cbranch_vccnz Ls_x1_s
    s_branch Lw_x1_s
Lch_last:
    s_nop 1
    v_permlane16_swap_b32 v28, v30
    v_permlane16_swap_b32 v29, v31
    s_mov_b64 exec, s[38:39]
    buffer_store_dwordx4 v[28:31], v32, s[8:11], s27 offen sc1
    s_mov_b64 exec, -1
    s_mul_i32 s29, s20, 2850816
    s_add_u32 s29, s29, 94896128
    s_lshl_b32 s34, s21, 2
    s_add_u32 s34, s34, s22
    s_lshl_b32 s42, s34, 10
    s_add_u32 s42, s42, 94371840
    s_lshl_b32 s34, s20, 16
    s_add_u32 s30, s42, s34
    s_mov_b32 s23, 0
    s_lshl_b32 s34, s22, 13
    v_add_u32 v20, s34, v35
    s_lshl_b32 s34, s22, 11
    v_add_u32 v21, s34, v35
    buffer_load_dwordx4 v[128:131], v18, s[8:11], s29 offen offset:0 sc1
    buffer_load_dwordx4 v[144:147], v18, s[8:11], s29 offen offset:256 sc1
    buffer_load_dwordx4 v[132:135], v18, s[8:11], s29 offen offset:2048 sc1
    buffer_load_dwordx4 v[148:151], v18, s[8:11], s29 offen offset:2304 sc1
    buffer_load_dwordx4 v[136:139], v19, s[8:11], s29 offen offset:0 sc1
    buffer_load_dwordx4 v[152:155], v19, s[8:11], s29 offen offset:256 sc1
    buffer_load_dwordx4 v[140:143], v19, s[8:11], s29 offen offset:2048 sc1
    buffer_load_dwordx4 v[156:159], v19, s[8:11], s29 offen offset:2304 sc1
    s_lshl_b32 s34, s21, 2
    s_add_u32 s34, s34, s22
    s_mul_i32 s34, s34, 2560
    s_mul_i32 s35, s20, 2883584
    s_add_u32 s34, s34, s35
    s_add_u32 s34, s34, 94896128
    v_lshlrev_b32 v2, 7, v1
    s_mov_b64 exec, 0xfffff
    buffer_load_dword v3, v2, s[8:11], s34 offen sc1
    s_mov_b64 exec, -1
    s_lshl_b32 s32, s22, 16
    s_lshl_b32 s34, s21, 10
    s_add_u32 s32, s32, s34
    s_add_u32 s32, s32, s7
    s_add_u32 s32, s32, 49152
    s_mov_b32 s33, 120071936
    s_mov_b32 s31, 0
    v_mov_b32 v2, 0
Lwf_base:
    buffer_load_dword v3, v2, s[8:11], s33 offen sc1
    s_waitcnt vmcnt(0)
    v_readfirstlane_b32 s34, v3
    s_and_b32 s34, s34, 255
    s_cmp_eq_u32 s34, 16
    s_cbranch_scc1 Lwd_base
    s_sleep 4
    s_add_u32 s31, s31, 1
    s_cmp_lt_u32 s31, 2000000
    s_cbranch_scc1 Lwf_base
    s_branch Lch_fail
Lwd_base:
    v_and_b32 v27, 31, v1
    v_lshlrev_b32 v27, 11, v27
    v_lshrrev_b32 v3, 5, v1
    v_lshl_add_u32 v27, v3, 4, v27
    s_lshl_b32 s26, s20, 16
    s_lshl_b32 s34, s21, 7
    s_add_u32 s26, s26, s34
    s_lshl_b32 s34, s22, 5
    s_add_u32 s26, s26, s34
    s_add_u32 s33, s26, 115343360
    buffer_load_dwordx4 v[192:195], v27, s[8:11], s33 offen sc1
    s_lshr_b32 s33, s21, 1
    s_lshl_b32 s33, s33, 4
    s_bfe_u32 s34, s20, 0x10001
    s_sub_u32 s33, s33, s34
    s_add_u32 s33, s33, 15
    s_lshl_b32 s33, s33, 2
    s_lshr_b32 s34, s20, 2
    s_lshl_b32 s34, s34, 1
    s_add_u32 s33, s33, s34
    s_and_b32 s34, s21, 1
    s_add_u32 s33, s33, s34
    s_lshl_b32 s33, s33, 13
    s_and_b32 s34, s20, 1
    s_lshl_b32 s34, s34, 12
    s_add_u32 s33, s33, s34
    s_lshr_b32 s34, s22, 1
    s_lshl_b32 s34, s34, 10
    s_add_u32 s33, s33, s34
    s_and_b32 s34, s22, 1
    s_lshl_b32 s34, s34, 3
    s_add_u32 s33, s33, s34
    s_add_u32 s33, s33, 115867648
    v_bfe_u32 v2, v1, 4, 1
    v_lshlrev_b32 v2, 11, v2
    v_lshl_add_u32 v2, v3, 9, v2
    v_and_b32 v3, 15, v1
    v_lshl_add_u32 v2, v3, 4, v2
    buffer_load_dwordx2 v[196:197], v2, s[8:11], s33 offen sc1
    buffer_load_dwordx2 v[198:199], v2, s[8:11], s33 offen offset:256 sc1
    s_barrier
Lch_tail:
    s_add_u32 s24, s29, 32768
    buffer_load_dwordx4 v[160:163], v18, s[8:11], s24 offen offset:0 sc1
    ds_read_b128 v[64:67], v21 offset:32768
    ds_read_b128 v[68:71], v21 offset:33792
    buffer_load_dwordx4 v[176:179], v18, s[8:11], s24 offen offset:256 sc1
    ds_read_b128 v[72:75], v21 offset:40960
    ds_read_b128 v[76:79], v21 offset:41984
    buffer_load_dwordx4 v[164:167], v18, s[8:11], s24 offen offset:2048 sc1
    ds_read_b128 v[80:83], v21 offset:49152
    ds_read_b128 v[84:87], v21 offset:50176
    buffer_load_dwordx4 v[180:183], v18, s[8:11], s24 offen offset:2304 sc1
    ds_read_b128 v[88:91], v21 offset:57344
    ds_read_b128 v[92:95], v21 offset:58368
    s_mov_b32 s31, 0
Lt_o0:
    v_max_u32 v34, v128, v129
    v_max3_u32 v34, v130, v131, v34
    v_max3_u32 v34, v132, v133, v34
    v_max3_u32 v34, v134, v135, v34
    v_max3_u32 v34, v136, v137, v34
    v_max3_u32 v34, v138, v139, v34
    v_max3_u32 v34, v140, v141, v34
    v_max3_u32 v34, v142, v143, v34
    v_max3_u32 v34, v144, v145, v34
    v_max3_u32 v34, v146, v147, v34
    v_max3_u32 v34, v148, v149, v34
    v_max3_u32 v34, v150, v151, v34
    v_max3_u32 v34, v152, v153, v34
    v_max3_u32 v34, v154, v155, v34
    v_max3_u32 v34, v156, v157, v34
    v_max3_u32 v34, v158, v159, v34
    v_cmp_eq_u32 vcc, -1, v34
    s_cbranch_vccz Lu_o0
Lv_o0:
    s_add_u32 s31, s31, 1
    s_cmp_ge_u32 s31, 4000000
    s_cbranch_scc1 Lch_fail
    s_mov_b64 exec, 1
    buffer_load_dword v34, v19, s[8:11], s29 offen offset:4092 sc1
    s_waitcnt vmcnt(0)
    v_cmp_eq_u32 vcc, -1, v34
    s_mov_b64 exec, -1
    s_cbranch_vccnz Lv_o0
    buffer_load_dwordx4 v[128:131], v18, s[8:11], s29 offen offset:0 sc1
    buffer_load_dwordx4 v[144:147], v18, s[8:11], s29 offen offset:256 sc1
    buffer_load_dwordx4 v[132:135], v18, s[8:11], s29 offen offset:2048 sc1
    buffer_load_dwordx4 v[148:151], v18, s[8:11], s29 offen offset:2304 sc1
    buffer_load_dwordx4 v[136:139], v19, s[8:11], s29 offen offset:0 sc1
    buffer_load_dwordx4 v[152:155], v19, s[8:11], s29 offen offset:256 sc1
    buffer_load_dwordx4 v[140:143], v19, s[8:11], s29 offen offset:2048 sc1
    buffer_load_dwordx4 v[156:159], v19, s[8:11], s29 offen offset:2304 sc1
    s_waitcnt vmcnt(0)
    s_branch Lt_o0
Lu_o0:
    s_mov_b32 s29, s24
    v_mfma_f32_16x16x32_bf16 v[216:219], a[192:195], v[128:131], 0
    buffer_load_dwordx4 v[168:171], v19, s[8:11], s24 offen offset:0 sc1
    s_waitcnt lgkmcnt(0)
    v_add_f32 v64, v64, v72
    v_mfma_f32_16x16x32_bf16 v[220:223], a[192:195], v[144:147], 0
    v_add_f32 v65, v65, v73
    v_add_f32 v66, v66, v74
    v_mfma_f32_16x16x32_bf16 v[216:219], a[196:199], v[132:135], v[216:219]
    buffer_load_dwordx4 v[184:187], v19, s[8:11], s24 offen offset:256 sc1
    v_add_f32 v67, v67, v75
    v_add_f32 v68, v68, v76
    v_mfma_f32_16x16x32_bf16 v[220:223], a[196:199], v[148:151], v[220:223]
    v_add_f32 v69, v69, v77
    v_add_f32 v70, v70, v78
    v_mfma_f32_16x16x32_bf16 v[216:219], a[200:203], v[136:139], v[216:219]
    buffer_load_dwordx4 v[172:175], v19, s[8:11], s24 offen offset:2048 sc1
    v_add_f32 v71, v71, v79
    v_add_f32 v64, v64, v80
    v_mfma_f32_16x16x32_bf16 v[220:223], a[200:203], v[152:155], v[220:223]
    v_add_f32 v65, v65, v81
    v_add_f32 v66, v66, v82
    v_mfma_f32_16x16x32_bf16 v[216:219], a[204:207], v[140:143], v[216:219]
    buffer_load_dwordx4 v[188:191], v19, s[8:11], s24 offen offset:2304 sc1
    v_add_f32 v67, v67, v83
    v_add_f32 v68, v68, v84
    v_mfma_f32_16x16x32_bf16 v[220:223], a[204:207], v[156:159], v[220:223]
    v_add_f32 v69, v69, v85
    v_add_f32 v70, v70, v86
    v_mfma_f32_16x16x32_bf16 v[224:227], a[208:211], v[128:131], 0
    v_add_f32 v71, v71, v87
    v_add_f32 v64, v64, v88
    v_mfma_f32_16x16x32_bf16 v[228:231], a[208:211], v[144:147], 0
    v_add_f32 v65, v65, v89
    v_add_f32 v66, v66, v90
    v_mfma_f32_16x16x32_bf16 v[224:227], a[212:215], v[132:135], v[224:227]
    v_add_f32 v67, v67, v91
    v_add_f32 v68, v68, v92
    v_mfma_f32_16x16x32_bf16 v[228:231], a[212:215], v[148:151], v[228:231]
    v_add_f32 v69, v69, v93
    v_add_f32 v70, v70, v94
    v_mfma_f32_16x16x32_bf16 v[224:227], a[216:219], v[136:139], v[224:227]
    v_add_f32 v71, v71, v95
    v_cvt_pk_bf16_f32 v96, v64, v65
    v_mfma_f32_16x16x32_bf16 v[228:231], a[216:219], v[152:155], v[228:231]
    v_cvt_pk_bf16_f32 v97, v66, v67
    v_cvt_pk_bf16_f32 v98, v68, v69
    v_mfma_f32_16x16x32_bf16 v[224:227], a[220:223], v[140:143], v[224:227]
    ds_write_b128 v20, v[216:219] offset:0
    v_mfma_f32_16x16x32_bf16 v[228:231], a[220:223], v[156:159], v[228:231]
    ds_write_b128 v20, v[220:223] offset:1024
    v_mfma_f32_16x16x32_bf16 v[232:235], a[224:227], v[128:131], 0
    v_cvt_pk_bf16_f32 v99, v70, v71
    v_min_u32 v96, -2, v96
    v_mfma_f32_16x16x32_bf16 v[236:239], a[224:227], v[144:147], 0
    v_min_u32 v97, -2, v97
    v_min_u32 v98, -2, v98
    v_mfma_f32_16x16x32_bf16 v[232:235], a[228:231], v[132:135], v[232:235]
    v_min_u32 v99, -2, v99
    s_nop 0
    v_permlane16_swap_b32 v96, v98
    v_permlane16_swap_b32 v97, v99
    v_mfma_f32_16x16x32_bf16 v[236:239], a[228:231], v[148:151], v[236:239]
    buffer_store_dwordx4 v[96:99], v35, s[8:11], s32 offen sc1
    s_mov_b32 s32, s30
    s_add_u32 s30, s30, 2883584
    v_mfma_f32_16x16x32_bf16 v[232:235], a[232:235], v[136:139], v[232:235]
    v_mfma_f32_16x16x32_bf16 v[236:239], a[232:235], v[152:155], v[236:239]
    v_mfma_f32_16x16x32_bf16 v[232:235], a[236:239], v[140:143], v[232:235]
    ds_write_b128 v20, v[224:227] offset:2048
    v_mfma_f32_16x16x32_bf16 v[236:239], a[236:239], v[156:159], v[236:239]
    ds_write_b128 v20, v[228:231] offset:3072
    v_mfma_f32_16x16x32_bf16 v[240:243], a[240:243], v[128:131], 0
    v_mfma_f32_16x16x32_bf16 v[244:247], a[240:243], v[144:147], 0
    v_mfma_f32_16x16x32_bf16 v[240:243], a[244:247], v[132:135], v[240:243]
    v_mfma_f32_16x16x32_bf16 v[244:247], a[244:247], v[148:151], v[244:247]
    v_mfma_f32_16x16x32_bf16 v[240:243], a[248:251], v[136:139], v[240:243]
    v_mfma_f32_16x16x32_bf16 v[244:247], a[248:251], v[152:155], v[244:247]
    v_mfma_f32_16x16x32_bf16 v[240:243], a[252:255], v[140:143], v[240:243]
    ds_write_b128 v20, v[232:235] offset:4096
    v_mfma_f32_16x16x32_bf16 v[244:247], a[252:255], v[156:159], v[244:247]
    ds_write_b128 v20, v[236:239] offset:5120
    s_nop 6
    ds_write_b128 v20, v[240:243] offset:6144
    ds_write_b128 v20, v[244:247] offset:7168
    s_waitcnt vmcnt(1) lgkmcnt(0)
    s_barrier
    s_add_u32 s24, s29, 32768
    buffer_load_dwordx4 v[128:131], v18, s[8:11], s24 offen offset:0 sc1
    ds_read_b128 v[64:67], v21 offset:0
    ds_read_b128 v[68:71], v21 offset:1024
    buffer_load_dwordx4 v[144:147], v18, s[8:11], s24 offen offset:256 sc1
    ds_read_b128 v[72:75], v21 offset:8192
    ds_read_b128 v[76:79], v21 offset:9216
    buffer_load_dwordx4 v[132:135], v18, s[8:11], s24 offen offset:2048 sc1
    ds_read_b128 v[80:83], v21 offset:16384
    ds_read_b128 v[84:87], v21 offset:17408
    buffer_load_dwordx4 v[148:151], v18, s[8:11], s24 offen offset:2304 sc1
    ds_read_b128 v[88:91], v21 offset:24576
    ds_read_b128 v[92:95], v21 offset:25600
    s_mov_b32 s31, 0
Lt_o1:
    v_max_u32 v34, v160, v161
    v_max3_u32 v34, v162, v163, v34
    v_max3_u32 v34, v164, v165, v34
    v_max3_u32 v34, v166, v167, v34
    v_max3_u32 v34, v168, v169, v34
    v_max3_u32 v34, v170, v171, v34
    v_max3_u32 v34, v172, v173, v34
    v_max3_u32 v34, v174, v175, v34
    v_max3_u32 v34, v176, v177, v34
    v_max3_u32 v34, v178, v179, v34
    v_max3_u32 v34, v180, v181, v34
    v_max3_u32 v34, v182, v183, v34
    v_max3_u32 v34, v184, v185, v34
    v_max3_u32 v34, v186, v187, v34
    v_max3_u32 v34, v188, v189, v34
    v_max3_u32 v34, v190, v191, v34
    v_cmp_eq_u32 vcc, -1, v34
    s_cbranch_vccz Lu_o1
Lv_o1:
    s_add_u32 s31, s31, 1
    s_cmp_ge_u32 s31, 4000000
    s_cbranch_scc1 Lch_fail
    s_mov_b64 exec, 1
    buffer_load_dword v34, v19, s[8:11], s29 offen offset:4092 sc1
    s_waitcnt vmcnt(0)
    v_cmp_eq_u32 vcc, -1, v34
    s_mov_b64 exec, -1
    s_cbranch_vccnz Lv_o1
    buffer_load_dwordx4 v[160:163], v18, s[8:11], s29 offen offset:0 sc1
    buffer_load_dwordx4 v[176:179], v18, s[8:11], s29 offen offset:256 sc1
    buffer_load_dwordx4 v[164:167], v18, s[8:11], s29 offen offset:2048 sc1
    buffer_load_dwordx4 v[180:183], v18, s[8:11], s29 offen offset:2304 sc1
    buffer_load_dwordx4 v[168:171], v19, s[8:11], s29 offen offset:0 sc1
    buffer_load_dwordx4 v[184:187], v19, s[8:11], s29 offen offset:256 sc1
    buffer_load_dwordx4 v[172:175], v19, s[8:11], s29 offen offset:2048 sc1
    buffer_load_dwordx4 v[188:191], v19, s[8:11], s29 offen offset:2304 sc1
    s_waitcnt vmcnt(0)
    s_branch Lt_o1
Lu_o1:
    s_mov_b32 s29, s24
    v_mfma_f32_16x16x32_bf16 v[216:219], a[192:195], v[160:163], 0
    buffer_load_dwordx4 v[136:139], v19, s[8:11], s24 offen offset:0 sc1
    s_waitcnt lgkmcnt(0)
    v_add_f32 v64, v64, v72
    v_mfma_f32_16x16x32_bf16 v[220:223], a[192:195], v[176:179], 0
    v_add_f32 v65, v65, v73
    v_add_f32 v66, v66, v74
    v_mfma_f32_16x16x32_bf16 v[216:219], a[196:199], v[164:167], v[216:219]
    buffer_load_dwordx4 v[152:155], v19, s[8:11], s24 offen offset:256 sc1
    v_add_f32 v67, v67, v75
    v_add_f32 v68, v68, v76
    v_mfma_f32_16x16x32_bf16 v[220:223], a[196:199], v[180:183], v[220:223]
    v_add_f32 v69, v69, v77
    v_add_f32 v70, v70, v78
    v_mfma_f32_16x16x32_bf16 v[216:219], a[200:203], v[168:171], v[216:219]
    buffer_load_dwordx4 v[140:143], v19, s[8:11], s24 offen offset:2048 sc1
    v_add_f32 v71, v71, v79
    v_add_f32 v64, v64, v80
    v_mfma_f32_16x16x32_bf16 v[220:223], a[200:203], v[184:187], v[220:223]
    v_add_f32 v65, v65, v81
    v_add_f32 v66, v66, v82
    v_mfma_f32_16x16x32_bf16 v[216:219], a[204:207], v[172:175], v[216:219]
    buffer_load_dwordx4 v[156:159], v19, s[8:11], s24 offen offset:2304 sc1
    v_add_f32 v67, v67, v83
    v_add_f32 v68, v68, v84
    v_mfma_f32_16x16x32_bf16 v[220:223], a[204:207], v[188:191], v[220:223]
    v_add_f32 v69, v69, v85
    v_add_f32 v70, v70, v86
    v_mfma_f32_16x16x32_bf16 v[224:227], a[208:211], v[160:163], 0
    v_add_f32 v71, v71, v87
    v_add_f32 v64, v64, v88
    v_mfma_f32_16x16x32_bf16 v[228:231], a[208:211], v[176:179], 0
    v_add_f32 v65, v65, v89
    v_add_f32 v66, v66, v90
    v_mfma_f32_16x16x32_bf16 v[224:227], a[212:215], v[164:167], v[224:227]
    v_add_f32 v67, v67, v91
    v_add_f32 v68, v68, v92
    v_mfma_f32_16x16x32_bf16 v[228:231], a[212:215], v[180:183], v[228:231]
    v_add_f32 v69, v69, v93
    v_add_f32 v70, v70, v94
    v_mfma_f32_16x16x32_bf16 v[224:227], a[216:219], v[168:171], v[224:227]
    v_add_f32 v71, v71, v95
    v_cvt_pk_bf16_f32 v96, v64, v65
    v_mfma_f32_16x16x32_bf16 v[228:231], a[216:219], v[184:187], v[228:231]
    v_cvt_pk_bf16_f32 v97, v66, v67
    v_cvt_pk_bf16_f32 v98, v68, v69
    v_mfma_f32_16x16x32_bf16 v[224:227], a[220:223], v[172:175], v[224:227]
    ds_write_b128 v20, v[216:219] offset:32768
    v_mfma_f32_16x16x32_bf16 v[228:231], a[220:223], v[188:191], v[228:231]
    ds_write_b128 v20, v[220:223] offset:33792
    v_mfma_f32_16x16x32_bf16 v[232:235], a[224:227], v[160:163], 0
    v_cvt_pk_bf16_f32 v99, v70, v71
    v_min_u32 v96, -2, v96
    v_mfma_f32_16x16x32_bf16 v[236:239], a[224:227], v[176:179], 0
    v_min_u32 v97, -2, v97
    v_min_u32 v98, -2, v98
    v_mfma_f32_16x16x32_bf16 v[232:235], a[228:231], v[164:167], v[232:235]
    v_min_u32 v99, -2, v99
    s_nop 0
    v_permlane16_swap_b32 v96, v98
    v_permlane16_swap_b32 v97, v99
    v_mfma_f32_16x16x32_bf16 v[236:239], a[228:231], v[180:183], v[236:239]
    buffer_store_dwordx4 v[96:99], v35, s[8:11], s32 offen sc1
    s_mov_b32 s32, s30
    s_add_u32 s30, s30, 2883584
    v_mfma_f32_16x16x32_bf16 v[232:235], a[232:235], v[168:171], v[232:235]
    v_mfma_f32_16x16x32_bf16 v[236:239], a[232:235], v[184:187], v[236:239]
    v_mfma_f32_16x16x32_bf16 v[232:235], a[236:239], v[172:175], v[232:235]
    ds_write_b128 v20, v[224:227] offset:34816
    v_mfma_f32_16x16x32_bf16 v[236:239], a[236:239], v[188:191], v[236:239]
    ds_write_b128 v20, v[228:231] offset:35840
    v_mfma_f32_16x16x32_bf16 v[240:243], a[240:243], v[160:163], 0
    v_mfma_f32_16x16x32_bf16 v[244:247], a[240:243], v[176:179], 0
    v_mfma_f32_16x16x32_bf16 v[240:243], a[244:247], v[164:167], v[240:243]
    v_mfma_f32_16x16x32_bf16 v[244:247], a[244:247], v[180:183], v[244:247]
    v_mfma_f32_16x16x32_bf16 v[240:243], a[248:251], v[168:171], v[240:243]
    v_mfma_f32_16x16x32_bf16 v[244:247], a[248:251], v[184:187], v[244:247]
    v_mfma_f32_16x16x32_bf16 v[240:243], a[252:255], v[172:175], v[240:243]
    ds_write_b128 v20, v[232:235] offset:36864
    v_mfma_f32_16x16x32_bf16 v[244:247], a[252:255], v[188:191], v[244:247]
    ds_write_b128 v20, v[236:239] offset:37888
    s_nop 6
    ds_write_b128 v20, v[240:243] offset:38912
    ds_write_b128 v20, v[244:247] offset:39936
    s_waitcnt vmcnt(1) lgkmcnt(0)
    s_barrier
    s_add_u32 s23, s23, 1
    s_cmp_lt_u32 s23, 4
    s_cbranch_scc1 Lch_tail
    ds_read_b128 v[64:67], v21 offset:32768
    ds_read_b128 v[68:71], v21 offset:33792
    ds_read_b128 v[72:75], v21 offset:40960
    ds_read_b128 v[76:79], v21 offset:41984
    ds_read_b128 v[80:83], v21 offset:49152
    ds_read_b128 v[84:87], v21 offset:50176
    ds_read_b128 v[88:91], v21 offset:57344
    ds_read_b128 v[92:95], v21 offset:58368
    s_waitcnt lgkmcnt(0)
    v_add_f32 v64, v64, v72
    v_add_f32 v65, v65, v73
    v_add_f32 v66, v66, v74
    v_add_f32 v67, v67, v75
    v_add_f32 v68, v68, v76
    v_add_f32 v69, v69, v77
    v_add_f32 v70, v70, v78
    v_add_f32 v71, v71, v79
    v_add_f32 v64, v64, v80
    v_add_f32 v65, v65, v81
    v_add_f32 v66, v66, v82
    v_add_f32 v67, v67, v83
    v_add_f32 v68, v68, v84
    v_add_f32 v69, v69, v85
    v_add_f32 v70, v70, v86
    v_add_f32 v71, v71, v87
    v_add_f32 v64, v64, v88
    v_add_f32 v65, v65, v89
    v_add_f32 v66, v66, v90
    v_add_f32 v67, v67, v91
    v_add_f32 v68, v68, v92
    v_add_f32 v69, v69, v93
    v_add_f32 v70, v70, v94
    v_add_f32 v71, v71, v95
    v_cvt_pk_bf16_f32 v96, v64, v65
    v_cvt_pk_bf16_f32 v97, v66, v67
    v_cvt_pk_bf16_f32 v98, v68, v69
    v_cvt_pk_bf16_f32 v99, v70, v71
    v_min_u32 v96, -2, v96
    v_min_u32 v97, -2, v97
    v_min_u32 v98, -2, v98
    v_min_u32 v99, -2, v99
    s_nop 0
    v_permlane16_swap_b32 v96, v98
    v_permlane16_swap_b32 v97, v99
    buffer_store_dwordx4 v[96:99], v35, s[8:11], s32 offen sc1
    s_mov_b32 s32, s30
    s_add_u32 s30, s30, 2883584
    s_mul_i32 s30, s20, 2883584
    s_add_u32 s30, s30, s42
    v_add_u32 v3, 4096, v35
    s_load_dwordx2 s[4:5], s[0:1], 88
    s_add_u32 s64, s30, 0
    s_add_u32 s65, s30, 65536
    s_add_u32 s66, s30, 131072
    s_add_u32 s67, s30, 196608
    s_add_u32 s68, s30, 262144
    s_add_u32 s69, s30, 327680
    s_add_u32 s70, s30, 393216
    s_add_u32 s71, s30, 458752
    buffer_load_dwordx4 v[128:131], v35, s[8:11], s64 offen sc1
    buffer_load_dwordx4 v[132:135], v35, s[8:11], s65 offen sc1
    buffer_load_dwordx4 v[136:139], v35, s[8:11], s66 offen sc1
    buffer_load_dwordx4 v[140:143], v35, s[8:11], s67 offen sc1
    buffer_load_dwordx4 v[144:147], v35, s[8:11], s68 offen sc1
    buffer_load_dwordx4 v[148:151], v35, s[8:11], s69 offen sc1
    buffer_load_dwordx4 v[152:155], v35, s[8:11], s70 offen sc1
    buffer_load_dwordx4 v[156:159], v35, s[8:11], s71 offen sc1
    s_waitcnt vmcnt(0) lgkmcnt(0)
    s_mov_b32 s31, 0
Lt_p:
    v_max_u32 v34, v128, v129
    v_max3_u32 v34, v130, v131, v34
    v_max3_u32 v34, v132, v133, v34
    v_max3_u32 v34, v134, v135, v34
    v_max3_u32 v34, v136, v137, v34
    v_max3_u32 v34, v138, v139, v34
    v_max3_u32 v34, v140, v141, v34
    v_max3_u32 v34, v142, v143, v34
    v_max3_u32 v34, v144, v145, v34
    v_max3_u32 v34, v146, v147, v34
    v_max3_u32 v34, v148, v149, v34
    v_max3_u32 v34, v150, v151, v34
    v_max3_u32 v34, v152, v153, v34
    v_max3_u32 v34, v154, v155, v34
    v_max3_u32 v34, v156, v157, v34
    v_max3_u32 v34, v158, v159, v34
    v_cmp_eq_u32 vcc, -1, v34
    s_cbranch_vccz Lu_p
Lv_p:
    s_add_u32 s31, s31, 1
    s_cmp_ge_u32 s31, 4000000
    s_cbranch_scc1 Lch_fail
    buffer_load_dwordx4 v[128:131], v35, s[8:11], s64 offen sc1
    buffer_load_dwordx4 v[132:135], v35, s[8:11], s65 offen sc1
    buffer_load_dwordx4 v[136:139], v35, s[8:11], s66 offen sc1
    buffer_load_dwordx4 v[140:143], v35, s[8:11], s67 offen sc1
    buffer_load_dwordx4 v[144:147], v35, s[8:11], s68 offen sc1
    buffer_load_dwordx4 v[148:151], v35, s[8:11], s69 offen sc1
    buffer_load_dwordx4 v[152:155], v35, s[8:11], s70 offen sc1
    buffer_load_dwordx4 v[156:159], v35, s[8:11], s71 offen sc1
    s_waitcnt vmcnt(0)
    s_branch Lt_p
Lu_p:
    s_mov_b32 s12, s4
    s_mov_b32 s13, s5
    s_mov_b32 s14, 0x400000
    s_mov_b32 s15, 0x20000
    v_lshlrev_b32 v72, 16, v128
    v_and_b32 v73, s37, v128
    v_lshlrev_b32 v74, 16, v129
    v_and_b32 v75, s37, v129
    v_lshlrev_b32 v76, 16, v130
    v_and_b32 v77, s37, v130
    v_lshlrev_b32 v78, 16, v131
    v_and_b32 v79, s37, v131
    v_lshlrev_b32 v80, 16, v132
    v_and_b32 v81, s37, v132
    v_pk_add_f32 v[72:73], v[72:73], v[80:81]
    v_lshlrev_b32 v80, 16, v133
    v_and_b32 v81, s37, v133
    v_pk_add_f32 v[74:75], v[74:75], v[80:81]
    v_lshlrev_b32 v80, 16, v134
    v_and_b32 v81, s37, v134
    v_pk_add_f32 v[76:77], v[76:77], v[80:81]
    v_lshlrev_b32 v80, 16, v135
    v_and_b32 v81, s37, v135
    v_pk_add_f32 v[78:79], v[78:79], v[80:81]
    v_lshlrev_b32 v80, 16, v136
    v_and_b32 v81, s37, v136
    v_pk_add_f32 v[72:73], v[72:73], v[80:81]
    v_lshlrev_b32 v80, 16, v137
    v_and_b32 v81, s37, v137
    v_pk_add_f32 v[74:75], v[74:75], v[80:81]
    v_lshlrev_b32 v80, 16, v138
    v_and_b32 v81, s37, v138
    v_pk_add_f32 v[76:77], v[76:77], v[80:81]
    v_lshlrev_b32 v80, 16, v139
    v_and_b32 v81, s37, v139
    v_pk_add_f32 v[78:79], v[78:79], v[80:81]
    v_lshlrev_b32 v80, 16, v140
    v_and_b32 v81, s37, v140
    v_pk_add_f32 v[72:73], v[72:73], v[80:81]
    v_lshlrev_b32 v80, 16, v141
    v_and_b32 v81, s37, v141
    v_pk_add_f32 v[74:75], v[74:75], v[80:81]
    v_lshlrev_b32 v80, 16, v142
    v_and_b32 v81, s37, v142
    v_pk_add_f32 v[76:77], v[76:77], v[80:81]
    v_lshlrev_b32 v80, 16, v143
    v_and_b32 v81, s37, v143
    v_pk_add_f32 v[78:79], v[78:79], v[80:81]
    v_lshlrev_b32 v80, 16, v144
    v_and_b32 v81, s37, v144
    v_pk_add_f32 v[72:73], v[72:73], v[80:81]
    v_lshlrev_b32 v80, 16, v145
    v_and_b32 v81, s37, v145
    v_pk_add_f32 v[74:75], v[74:75], v[80:81]
    v_lshlrev_b32 v80, 16, v146
    v_and_b32 v81, s37, v146
    v_pk_add_f32 v[76:77], v[76:77], v[80:81]
    v_lshlrev_b32 v80, 16, v147
    v_and_b32 v81, s37, v147
    v_pk_add_f32 v[78:79], v[78:79], v[80:81]
    v_lshlrev_b32 v80, 16, v148
    v_and_b32 v81, s37, v148
    v_pk_add_f32 v[72:73], v[72:73], v[80:81]
    v_lshlrev_b32 v80, 16, v149
    v_and_b32 v81, s37, v149
    v_pk_add_f32 v[74:75], v[74:75], v[80:81]
    v_lshlrev_b32 v80, 16, v150
    v_and_b32 v81, s37, v150
    v_pk_add_f32 v[76:77], v[76:77], v[80:81]
    v_lshlrev_b32 v80, 16, v151
    v_and_b32 v81, s37, v151
    v_pk_add_f32 v[78:79], v[78:79], v[80:81]
    v_lshlrev_b32 v80, 16, v152
    v_and_b32 v81, s37, v152
    v_pk_add_f32 v[72:73], v[72:73], v[80:81]
    v_lshlrev_b32 v80, 16, v153
    v_and_b32 v81, s37, v153
    v_pk_add_f32 v[74:75], v[74:75], v[80:81]
    v_lshlrev_b32 v80, 16, v154
    v_and_b32 v81, s37, v154
    v_pk_add_f32 v[76:77], v[76:77], v[80:81]
    v_lshlrev_b32 v80, 16, v155
    v_and_b32 v81, s37, v155
    v_pk_add_f32 v[78:79], v[78:79], v[80:81]
    v_lshlrev_b32 v80, 16, v156
    v_and_b32 v81, s37, v156
    v_pk_add_f32 v[72:73], v[72:73], v[80:81]
    v_lshlrev_b32 v80, 16, v157
    v_and_b32 v81, s37, v157
    v_pk_add_f32 v[74:75], v[74:75], v[80:81]
    v_lshlrev_b32 v80, 16, v158
    v_and_b32 v81, s37, v158
    v_pk_add_f32 v[76:77], v[76:77], v[80:81]
    v_lshlrev_b32 v80, 16, v159
    v_and_b32 v81, s37, v159
    v_pk_add_f32 v[78:79], v[78:79], v[80:81]
    v_lshlrev_b32 v80, 16, v192
    v_and_b32 v81, s37, v192
    v_pk_add_f32 v[72:73], v[72:73], v[80:81]
    v_lshlrev_b32 v80, 16, v193
    v_and_b32 v81, s37, v193
    v_pk_add_f32 v[74:75], v[74:75], v[80:81]
    v_lshlrev_b32 v80, 16, v194
    v_and_b32 v81, s37, v194
    v_pk_add_f32 v[76:77], v[76:77], v[80:81]
    v_lshlrev_b32 v80, 16, v195
    v_and_b32 v81, s37, v195
    v_pk_add_f32 v[78:79], v[78:79], v[80:81]
    v_lshlrev_b32 v80, 16, v196
    v_and_b32 v81, s37, v196
    v_pk_add_f32 v[72:73], v[72:73], v[80:81]
    v_lshlrev_b32 v80, 16, v197
    v_and_b32 v81, s37, v197
    v_pk_add_f32 v[74:75], v[74:75], v[80:81]
    v_lshlrev_b32 v80, 16, v198
    v_and_b32 v81, s37, v198
    v_pk_add_f32 v[76:77], v[76:77], v[80:81]
    v_lshlrev_b32 v80, 16, v199
    v_and_b32 v81, s37, v199
    v_pk_add_f32 v[78:79], v[78:79], v[80:81]
    v_cvt_pk_bf16_f32 v68, v72, v73
    v_cvt_pk_bf16_f32 v69, v74, v75
    v_cvt_pk_bf16_f32 v70, v76, v77
    v_cvt_pk_bf16_f32 v71, v78, v79
    s_add_u32 s26, s26, 3670016
    buffer_store_dwordx4 v[68:71], v27, s[12:15], s26 offen
    s_branch Lch_end
Lch_fail:
    s_mov_b32 s12, s52
    s_mov_b32 s13, s53
    s_mov_b32 s14, 0x100
    s_mov_b32 s15, 0x20000
    v_mov_b32 v2, 252
    v_mov_b32 v3, 0xdead
    s_mov_b64 exec, 1
    buffer_store_dword v3, v2, s[12:15], 0 offen
Lch_end:
    s_endpgm
Lworker:
    s_load_dwordx2 s[60:61], s[0:1], 0
    s_load_dwordx8 s[64:71], s[0:1], 16
    s_load_dwordx8 s[72:79], s[0:1], 64
    s_load_dwordx4 s[84:87], s[0:1], 96
    v_lshrrev_b32 v2, 6, v0
    v_and_b32 v1, 63, v0
    s_nop 0
    v_readfirstlane_b32 s46, v2
    s_waitcnt lgkmcnt(0)
    s_mov_b32 s8, s86
    s_mov_b32 s9, s87
    s_mov_b32 s10, 0x10000000
    s_mov_b32 s11, 0x20000
    s_lshl_b32 s28, s20, 4
    s_add_u32 s28, s28, s21
    s_lshl_b32 s28, s28, 2
    s_add_u32 s28, s28, s46
    s_mov_b32 s16, s60
    s_mov_b32 s17, s61
    s_mov_b32 s18, 0x400000
    s_mov_b32 s19, 0x20000
    s_mov_b32 s12, s84
    s_mov_b32 s13, s85
    s_mov_b32 s14, 0x100
    s_mov_b32 s15, 0x20000
    v_and_b32 v3, 3, v1
    v_lshrrev_b32 v4, 2, v1
    s_lshl_b32 s24, s28, 13
    v_lshlrev_b32 v5, 11, v3
    v_lshl_add_u32 v5, v4, 4, v5
    buffer_load_dwordx4 v[64:67], v5, s[16:19], s24 offen offset:0
    buffer_load_dwordx4 v[68:71], v5, s[16:19], s24 offen offset:256
    buffer_load_dwordx4 v[72:75], v5, s[16:19], s24 offen offset:512
    buffer_load_dwordx4 v[76:79], v5, s[16:19], s24 offen offset:768
    buffer_load_dwordx4 v[80:83], v5, s[16:19], s24 offen offset:1024
    buffer_load_dwordx4 v[84:87], v5, s[16:19], s24 offen offset:1280
    buffer_load_dwordx4 v[88:91], v5, s[16:19], s24 offen offset:1536
    buffer_load_dwordx4 v[92:95], v5, s[16:19], s24 offen offset:1792
    s_lshr_b32 s25, s28, 3
    s_lshl_b32 s25, s25, 16
    s_and_b32 s26, s28, 7
    s_lshl_b32 s26, s26, 6
    s_add_u32 s25, s25, s26
    s_add_u32 s25, s25, 0
    v_lshlrev_b32 v6, 9, v4
    v_lshl_add_u32 v6, v3, 4, v6
    s_mov_b32 s27, 0xffff0000
    v_mov_b32 v8, 0
    v_mov_b32 v9, 0
    s_waitcnt vmcnt(7)
    v_lshlrev_b32 v96, 16, v64
    v_and_b32 v97, s27, v64
    v_pk_add_f32 v[8:9], v[8:9], v[96:97]
    v_lshlrev_b32 v98, 16, v65
    v_and_b32 v99, s27, v65
    v_pk_add_f32 v[8:9], v[8:9], v[98:99]
    v_lshlrev_b32 v100, 16, v66
    v_and_b32 v101, s27, v66
    v_pk_add_f32 v[8:9], v[8:9], v[100:101]
    v_lshlrev_b32 v102, 16, v67
    v_and_b32 v103, s27, v67
    v_pk_add_f32 v[8:9], v[8:9], v[102:103]
    s_waitcnt vmcnt(6)
    v_lshlrev_b32 v104, 16, v68
    v_and_b32 v105, s27, v68
    v_pk_add_f32 v[8:9], v[8:9], v[104:105]
    v_lshlrev_b32 v106, 16, v69
    v_and_b32 v107, s27, v69
    v_pk_add_f32 v[8:9], v[8:9], v[106:107]
    v_lshlrev_b32 v108, 16, v70
    v_and_b32 v109, s27, v70
    v_pk_add_f32 v[8:9], v[8:9], v[108:109]
    v_lshlrev_b32 v110, 16, v71
    v_and_b32 v111, s27, v71
    v_pk_add_f32 v[8:9], v[8:9], v[110:111]
    s_waitcnt vmcnt(5)
    v_lshlrev_b32 v112, 16, v72
    v_and_b32 v113, s27, v72
    v_pk_add_f32 v[8:9], v[8:9], v[112:113]
    v_lshlrev_b32 v114, 16, v73
    v_and_b32 v115, s27, v73
    v_pk_add_f32 v[8:9], v[8:9], v[114:115]
    v_lshlrev_b32 v116, 16, v74
    v_and_b32 v117, s27, v74
    v_pk_add_f32 v[8:9], v[8:9], v[116:117]
    v_lshlrev_b32 v118, 16, v75
    v_and_b32 v119, s27, v75
    v_pk_add_f32 v[8:9], v[8:9], v[118:119]
    s_waitcnt vmcnt(4)
    v_lshlrev_b32 v120, 16, v76
    v_and_b32 v121, s27, v76
    v_pk_add_f32 v[8:9], v[8:9], v[120:121]
    v_lshlrev_b32 v122, 16, v77
    v_and_b32 v123, s27, v77
    v_pk_add_f32 v[8:9], v[8:9], v[122:123]
    v_lshlrev_b32 v124, 16, v78
    v_and_b32 v125, s27, v78
    v_pk_add_f32 v[8:9], v[8:9], v[124:125]
    v_lshlrev_b32 v126, 16, v79
    v_and_b32 v127, s27, v79
    v_pk_add_f32 v[8:9], v[8:9], v[126:127]
    s_waitcnt vmcnt(3)
    v_lshlrev_b32 v128, 16, v80
    v_and_b32 v129, s27, v80
    v_pk_add_f32 v[8:9], v[8:9], v[128:129]
    v_lshlrev_b32 v130, 16, v81
    v_and_b32 v131, s27, v81
    v_pk_add_f32 v[8:9], v[8:9], v[130:131]
    v_lshlrev_b32 v132, 16, v82
    v_and_b32 v133, s27, v82
    v_pk_add_f32 v[8:9], v[8:9], v[132:133]
    v_lshlrev_b32 v134, 16, v83
    v_and_b32 v135, s27, v83
    v_pk_add_f32 v[8:9], v[8:9], v[134:135]
    s_waitcnt vmcnt(2)
    v_lshlrev_b32 v136, 16, v84
    v_and_b32 v137, s27, v84
    v_pk_add_f32 v[8:9], v[8:9], v[136:137]
    v_lshlrev_b32 v138, 16, v85
    v_and_b32 v139, s27, v85
    v_pk_add_f32 v[8:9], v[8:9], v[138:139]
    v_lshlrev_b32 v140, 16, v86
    v_and_b32 v141, s27, v86
    v_pk_add_f32 v[8:9], v[8:9], v[140:141]
    v_lshlrev_b32 v142, 16, v87
    v_and_b32 v143, s27, v87
    v_pk_add_f32 v[8:9], v[8:9], v[142:143]
    s_waitcnt vmcnt(1)
    v_lshlrev_b32 v144, 16, v88
    v_and_b32 v145, s27, v88
    v_pk_add_f32 v[8:9], v[8:9], v[144:145]
    v_lshlrev_b32 v146, 16, v89
    v_and_b32 v147, s27, v89
    v_pk_add_f32 v[8:9], v[8:9], v[146:147]
    v_lshlrev_b32 v148, 16, v90
    v_and_b32 v149, s27, v90
    v_pk_add_f32 v[8:9], v[8:9], v[148:149]
    v_lshlrev_b32 v150, 16, v91
    v_and_b32 v151, s27, v91
    v_pk_add_f32 v[8:9], v[8:9], v[150:151]
    s_waitcnt vmcnt(0)
    v_lshlrev_b32 v152, 16, v92
    v_and_b32 v153, s27, v92
    v_pk_add_f32 v[8:9], v[8:9], v[152:153]
    v_lshlrev_b32 v154, 16, v93
    v_and_b32 v155, s27, v93
    v_pk_add_f32 v[8:9], v[8:9], v[154:155]
    v_lshlrev_b32 v156, 16, v94
    v_and_b32 v157, s27, v94
    v_pk_add_f32 v[8:9], v[8:9], v[156:157]
    v_lshlrev_b32 v158, 16, v95
    v_and_b32 v159, s27, v95
    v_pk_add_f32 v[8:9], v[8:9], v[158:159]
    v_mov_b32 v7, 0
    buffer_load_dword v2, v7, s[12:15], 0 offen offset:144 sc1
    v_add_f32 v8, v8, v9
    s_nop 1
    v_add_f32_dpp v8, v8, v8 row_ror:4 row_mask:0xf bank_mask:0xf
    s_nop 1
    v_add_f32_dpp v8, v8, v8 row_ror:8 row_mask:0xf bank_mask:0xf
    v_mov_b32 v10, v8
    s_nop 1
    v_permlane16_swap_b32 v8, v10
    v_add_f32 v8, v8, v10
    v_mov_b32 v10, v8
    s_nop 1
    v_permlane32_swap_b32 v8, v10
    v_add_f32 v8, v8, v10
    v_mul_f32 v8, 0xba800000, v8
    v_mov_b32 v14, 0
    v_mov_b32 v15, 0
    v_mov_b32 v9, v8
    v_pk_add_f32 v[12:13], v[96:97], v[8:9]
    v_pk_fma_f32 v[14:15], v[12:13], v[12:13], v[14:15]
    v_pk_add_f32 v[12:13], v[98:99], v[8:9]
    v_pk_fma_f32 v[14:15], v[12:13], v[12:13], v[14:15]
    v_pk_add_f32 v[12:13], v[100:101], v[8:9]
    v_pk_fma_f32 v[14:15], v[12:13], v[12:13], v[14:15]
    v_pk_add_f32 v[12:13], v[102:103], v[8:9]
    v_pk_fma_f32 v[14:15], v[12:13], v[12:13], v[14:15]
    v_pk_add_f32 v[12:13], v[104:105], v[8:9]
    v_pk_fma_f32 v[14:15], v[12:13], v[12:13], v[14:15]
    v_pk_add_f32 v[12:13], v[106:107], v[8:9]
    v_pk_fma_f32 v[14:15], v[12:13], v[12:13], v[14:15]
    v_pk_add_f32 v[12:13], v[108:109], v[8:9]
    v_pk_fma_f32 v[14:15], v[12:13], v[12:13], v[14:15]
    v_pk_add_f32 v[12:13], v[110:111], v[8:9]
    v_pk_fma_f32 v[14:15], v[12:13], v[12:13], v[14:15]
    v_pk_add_f32 v[12:13], v[112:113], v[8:9]
    v_pk_fma_f32 v[14:15], v[12:13], v[12:13], v[14:15]
    v_pk_add_f32 v[12:13], v[114:115], v[8:9]
    v_pk_fma_f32 v[14:15], v[12:13], v[12:13], v[14:15]
    v_pk_add_f32 v[12:13], v[116:117], v[8:9]
    v_pk_fma_f32 v[14:15], v[12:13], v[12:13], v[14:15]
    v_pk_add_f32 v[12:13], v[118:119], v[8:9]
    v_pk_fma_f32 v[14:15], v[12:13], v[12:13], v[14:15]
    v_pk_add_f32 v[12:13], v[120:121], v[8:9]
    v_pk_fma_f32 v[14:15], v[12:13], v[12:13], v[14:15]
    v_pk_add_f32 v[12:13], v[122:123], v[8:9]
    v_pk_fma_f32 v[14:15], v[12:13], v[12:13], v[14:15]
    v_pk_add_f32 v[12:13], v[124:125], v[8:9]
    v_pk_fma_f32 v[14:15], v[12:13], v[12:13], v[14:15]
    v_pk_add_f32 v[12:13], v[126:127], v[8:9]
    v_pk_fma_f32 v[14:15], v[12:13], v[12:13], v[14:15]
    v_pk_add_f32 v[12:13], v[128:129], v[8:9]
    v_pk_fma_f32 v[14:15], v[12:13], v[12:13], v[14:15]
    v_pk_add_f32 v[12:13], v[130:131], v[8:9]
    v_pk_fma_f32 v[14:15], v[12:13], v[12:13], v[14:15]
    v_pk_add_f32 v[12:13], v[132:133], v[8:9]
    v_pk_fma_f32 v[14:15], v[12:13], v[12:13], v[14:15]
    v_pk_add_f32 v[12:13], v[134:135], v[8:9]
    v_pk_fma_f32 v[14:15], v[12:13], v[12:13], v[14:15]
    v_pk_add_f32 v[12:13], v[136:137], v[8:9]
    v_pk_fma_f32 v[14:15], v[12:13], v[12:13], v[14:15]
    v_pk_add_f32 v[12:13], v[138:139], v[8:9]
    v_pk_fma_f32 v[14:15], v[12:13], v[12:13], v[14:15]
    v_pk_add_f32 v[12:13], v[140:141], v[8:9]
    v_pk_fma_f32 v[14:15], v[12:13], v[12:13], v[14:15]
    v_pk_add_f32 v[12:13], v[142:143], v[8:9]
    v_pk_fma_f32 v[14:15], v[12:13], v[12:13], v[14:15]
    v_pk_add_f32 v[12:13], v[144:145], v[8:9]
    v_pk_fma_f32 v[14:15], v[12:13], v[12:13], v[14:15]
    v_pk_add_f32 v[12:13], v[146:147], v[8:9]
    v_pk_fma_f32 v[14:15], v[12:13], v[12:13], v[14:15]
    v_pk_add_f32 v[12:13], v[148:149], v[8:9]
    v_pk_fma_f32 v[14:15], v[12:13], v[12:13], v[14:15]
    v_pk_add_f32 v[12:13], v[150:151], v[8:9]
    v_pk_fma_f32 v[14:15], v[12:13], v[12:13], v[14:15]
    v_pk_add_f32 v[12:13], v[152:153], v[8:9]
    v_pk_fma_f32 v[14:15], v[12:13], v[12:13], v[14:15]
    v_pk_add_f32 v[12:13], v[154:155], v[8:9]
    v_pk_fma_f32 v[14:15], v[12:13], v[12:13], v[14:15]
    v_pk_add_f32 v[12:13], v[156:157], v[8:9]
    v_pk_fma_f32 v[14:15], v[12:13], v[12:13], v[14:15]
    v_pk_add_f32 v[12:13], v[158:159], v[8:9]
    v_pk_fma_f32 v[14:15], v[12:13], v[12:13], v[14:15]
    v_add_f32 v9, v14, v15
    s_nop 1
    v_add_f32_dpp v9, v9, v9 row_ror:4 row_mask:0xf bank_mask:0xf
    s_nop 1
    v_add_f32_dpp v9, v9, v9 row_ror:8 row_mask:0xf bank_mask:0xf
    v_mov_b32 v10, v9
    s_nop 1
    v_permlane16_swap_b32 v9, v10
    v_add_f32 v9, v9, v10
    v_mov_b32 v10, v9
    s_nop 1
    v_permlane32_swap_b32 v9, v10
    v_add_f32 v9, v9, v10
    v_mul_f32 v9, 0x3a800000, v9
    v_cvt_pk_bf16_f32 v12, v8, v9
    v_lshlrev_b32 v8, 16, v12
    v_and_b32 v9, s27, v12
    v_add_f32 v9, 0x3727c5ac, v9
    v_cvt_pk_bf16_f32 v9, v9, v9
    v_and_b32 v9, s27, v9
    v_sqrt_f32 v9, v9
    s_nop 0
    v_cvt_pk_bf16_f32 v9, v9, v9
    v_and_b32 v9, s27, v9
    v_rcp_f32 v10, v9
    s_nop 0
    v_fma_f32 v12, -v9, v10, 1.0
    v_fma_f32 v10, v12, v10, v10
    v_mov_b32 v9, v8
    v_mov_b32 v11, v10
    v_pk_add_f32 v[96:97], v[96:97], v[8:9]
    v_cvt_pk_bf16_f32 v64, v96, v97
    v_lshlrev_b32 v96, 16, v64
    v_and_b32 v97, s27, v64
    v_pk_mul_f32 v[96:97], v[96:97], v[10:11]
    v_cvt_pk_bf16_f32 v64, v96, v97
    v_pk_add_f32 v[98:99], v[98:99], v[8:9]
    v_cvt_pk_bf16_f32 v65, v98, v99
    v_lshlrev_b32 v98, 16, v65
    v_and_b32 v99, s27, v65
    v_pk_mul_f32 v[98:99], v[98:99], v[10:11]
    v_cvt_pk_bf16_f32 v65, v98, v99
    v_pk_add_f32 v[100:101], v[100:101], v[8:9]
    v_cvt_pk_bf16_f32 v66, v100, v101
    v_lshlrev_b32 v100, 16, v66
    v_and_b32 v101, s27, v66
    v_pk_mul_f32 v[100:101], v[100:101], v[10:11]
    v_cvt_pk_bf16_f32 v66, v100, v101
    v_pk_add_f32 v[102:103], v[102:103], v[8:9]
    v_cvt_pk_bf16_f32 v67, v102, v103
    v_lshlrev_b32 v102, 16, v67
    v_and_b32 v103, s27, v67
    v_pk_mul_f32 v[102:103], v[102:103], v[10:11]
    v_cvt_pk_bf16_f32 v67, v102, v103
    s_waitcnt vmcnt(0)
    v_readfirstlane_b32 s96, v2
    s_cmp_eq_u32 s96, s3
    s_cbranch_scc1 Lvr_w
    s_mov_b32 s94, 144
    s_mov_b32 s95, 0
    v_mov_b32 v196, 0
Lwf_rotw:
    buffer_load_dword v197, v196, s[12:15], s94 offen sc1
    s_waitcnt vmcnt(0)
    v_readfirstlane_b32 s96, v197
    s_and_b32 s96, s96, 15
    s_cmp_ge_u32 s96, 8
    s_cbranch_scc1 Lwd_rotw
    s_sleep 4
    s_add_u32 s95, s95, 1
    s_cmp_lt_u32 s95, 2000000
    s_cbranch_scc1 Lwf_rotw
    s_branch Lw_fail
Lwd_rotw:
    s_cmp_eq_u32 s96, s3
    s_cbranch_scc1 Lvr_w
    s_mov_b32 s3, s96
    s_branch Lrole
Lvr_w:
    buffer_store_dwordx4 v[64:67], v6, s[8:11], s25 offen sc1
    s_add_u32 s25, s25, 8192
    v_pk_add_f32 v[104:105], v[104:105], v[8:9]
    v_cvt_pk_bf16_f32 v68, v104, v105
    v_lshlrev_b32 v104, 16, v68
    v_and_b32 v105, s27, v68
    v_pk_mul_f32 v[104:105], v[104:105], v[10:11]
    v_cvt_pk_bf16_f32 v68, v104, v105
    v_pk_add_f32 v[106:107], v[106:107], v[8:9]
    v_cvt_pk_bf16_f32 v69, v106, v107
    v_lshlrev_b32 v106, 16, v69
    v_and_b32 v107, s27, v69
    v_pk_mul_f32 v[106:107], v[106:107], v[10:11]
    v_cvt_pk_bf16_f32 v69, v106, v107
    v_pk_add_f32 v[108:109], v[108:109], v[8:9]
    v_cvt_pk_bf16_f32 v70, v108, v109
    v_lshlrev_b32 v108, 16, v70
    v_and_b32 v109, s27, v70
    v_pk_mul_f32 v[108:109], v[108:109], v[10:11]
    v_cvt_pk_bf16_f32 v70, v108, v109
    v_pk_add_f32 v[110:111], v[110:111], v[8:9]
    v_cvt_pk_bf16_f32 v71, v110, v111
    v_lshlrev_b32 v110, 16, v71
    v_and_b32 v111, s27, v71
    v_pk_mul_f32 v[110:111], v[110:111], v[10:11]
    v_cvt_pk_bf16_f32 v71, v110, v111
    buffer_store_dwordx4 v[68:71], v6, s[8:11], s25 offen sc1
    s_add_u32 s25, s25, 8192
    v_pk_add_f32 v[112:113], v[112:113], v[8:9]
    v_cvt_pk_bf16_f32 v72, v112, v113
    v_lshlrev_b32 v112, 16, v72
    v_and_b32 v113, s27, v72
    v_pk_mul_f32 v[112:113], v[112:113], v[10:11]
    v_cvt_pk_bf16_f32 v72, v112, v113
    v_pk_add_f32 v[114:115], v[114:115], v[8:9]
    v_cvt_pk_bf16_f32 v73, v114, v115
    v_lshlrev_b32 v114, 16, v73
    v_and_b32 v115, s27, v73
    v_pk_mul_f32 v[114:115], v[114:115], v[10:11]
    v_cvt_pk_bf16_f32 v73, v114, v115
    v_pk_add_f32 v[116:117], v[116:117], v[8:9]
    v_cvt_pk_bf16_f32 v74, v116, v117
    v_lshlrev_b32 v116, 16, v74
    v_and_b32 v117, s27, v74
    v_pk_mul_f32 v[116:117], v[116:117], v[10:11]
    v_cvt_pk_bf16_f32 v74, v116, v117
    v_pk_add_f32 v[118:119], v[118:119], v[8:9]
    v_cvt_pk_bf16_f32 v75, v118, v119
    v_lshlrev_b32 v118, 16, v75
    v_and_b32 v119, s27, v75
    v_pk_mul_f32 v[118:119], v[118:119], v[10:11]
    v_cvt_pk_bf16_f32 v75, v118, v119
    buffer_store_dwordx4 v[72:75], v6, s[8:11], s25 offen sc1
    s_add_u32 s25, s25, 8192
    v_pk_add_f32 v[120:121], v[120:121], v[8:9]
    v_cvt_pk_bf16_f32 v76, v120, v121
    v_lshlrev_b32 v120, 16, v76
    v_and_b32 v121, s27, v76
    v_pk_mul_f32 v[120:121], v[120:121], v[10:11]
    v_cvt_pk_bf16_f32 v76, v120, v121
    v_pk_add_f32 v[122:123], v[122:123], v[8:9]
    v_cvt_pk_bf16_f32 v77, v122, v123
    v_lshlrev_b32 v122, 16, v77
    v_and_b32 v123, s27, v77
    v_pk_mul_f32 v[122:123], v[122:123], v[10:11]
    v_cvt_pk_bf16_f32 v77, v122, v123
    v_pk_add_f32 v[124:125], v[124:125], v[8:9]
    v_cvt_pk_bf16_f32 v78, v124, v125
    v_lshlrev_b32 v124, 16, v78
    v_and_b32 v125, s27, v78
    v_pk_mul_f32 v[124:125], v[124:125], v[10:11]
    v_cvt_pk_bf16_f32 v78, v124, v125
    v_pk_add_f32 v[126:127], v[126:127], v[8:9]
    v_cvt_pk_bf16_f32 v79, v126, v127
    v_lshlrev_b32 v126, 16, v79
    v_and_b32 v127, s27, v79
    v_pk_mul_f32 v[126:127], v[126:127], v[10:11]
    v_cvt_pk_bf16_f32 v79, v126, v127
    buffer_store_dwordx4 v[76:79], v6, s[8:11], s25 offen sc1
    s_add_u32 s25, s25, 8192
    v_pk_add_f32 v[128:129], v[128:129], v[8:9]
    v_cvt_pk_bf16_f32 v80, v128, v129
    v_lshlrev_b32 v128, 16, v80
    v_and_b32 v129, s27, v80
    v_pk_mul_f32 v[128:129], v[128:129], v[10:11]
    v_cvt_pk_bf16_f32 v80, v128, v129
    v_pk_add_f32 v[130:131], v[130:131], v[8:9]
    v_cvt_pk_bf16_f32 v81, v130, v131
    v_lshlrev_b32 v130, 16, v81
    v_and_b32 v131, s27, v81
    v_pk_mul_f32 v[130:131], v[130:131], v[10:11]
    v_cvt_pk_bf16_f32 v81, v130, v131
    v_pk_add_f32 v[132:133], v[132:133], v[8:9]
    v_cvt_pk_bf16_f32 v82, v132, v133
    v_lshlrev_b32 v132, 16, v82
    v_and_b32 v133, s27, v82
    v_pk_mul_f32 v[132:133], v[132:133], v[10:11]
    v_cvt_pk_bf16_f32 v82, v132, v133
    v_pk_add_f32 v[134:135], v[134:135], v[8:9]
    v_cvt_pk_bf16_f32 v83, v134, v135
    v_lshlrev_b32 v134, 16, v83
    v_and_b32 v135, s27, v83
    v_pk_mul_f32 v[134:135], v[134:135], v[10:11]
    v_cvt_pk_bf16_f32 v83, v134, v135
    buffer_store_dwordx4 v[80:83], v6, s[8:11], s25 offen sc1
    s_add_u32 s25, s25, 8192
    v_pk_add_f32 v[136:137], v[136:137], v[8:9]
    v_cvt_pk_bf16_f32 v84, v136, v137
    v_lshlrev_b32 v136, 16, v84
    v_and_b32 v137, s27, v84
    v_pk_mul_f32 v[136:137], v[136:137], v[10:11]
    v_cvt_pk_bf16_f32 v84, v136, v137
    v_pk_add_f32 v[138:139], v[138:139], v[8:9]
    v_cvt_pk_bf16_f32 v85, v138, v139
    v_lshlrev_b32 v138, 16, v85
    v_and_b32 v139, s27, v85
    v_pk_mul_f32 v[138:139], v[138:139], v[10:11]
    v_cvt_pk_bf16_f32 v85, v138, v139
    v_pk_add_f32 v[140:141], v[140:141], v[8:9]
    v_cvt_pk_bf16_f32 v86, v140, v141
    v_lshlrev_b32 v140, 16, v86
    v_and_b32 v141, s27, v86
    v_pk_mul_f32 v[140:141], v[140:141], v[10:11]
    v_cvt_pk_bf16_f32 v86, v140, v141
    v_pk_add_f32 v[142:143], v[142:143], v[8:9]
    v_cvt_pk_bf16_f32 v87, v142, v143
    v_lshlrev_b32 v142, 16, v87
    v_and_b32 v143, s27, v87
    v_pk_mul_f32 v[142:143], v[142:143], v[10:11]
    v_cvt_pk_bf16_f32 v87, v142, v143
    buffer_store_dwordx4 v[84:87], v6, s[8:11], s25 offen sc1
    s_add_u32 s25, s25, 8192
    v_pk_add_f32 v[144:145], v[144:145], v[8:9]
    v_cvt_pk_bf16_f32 v88, v144, v145
    v_lshlrev_b32 v144, 16, v88
    v_and_b32 v145, s27, v88
    v_pk_mul_f32 v[144:145], v[144:145], v[10:11]
    v_cvt_pk_bf16_f32 v88, v144, v145
    v_pk_add_f32 v[146:147], v[146:147], v[8:9]
    v_cvt_pk_bf16_f32 v89, v146, v147
    v_lshlrev_b32 v146, 16, v89
    v_and_b32 v147, s27, v89
    v_pk_mul_f32 v[146:147], v[146:147], v[10:11]
    v_cvt_pk_bf16_f32 v89, v146, v147
    v_pk_add_f32 v[148:149], v[148:149], v[8:9]
    v_cvt_pk_bf16_f32 v90, v148, v149
    v_lshlrev_b32 v148, 16, v90
    v_and_b32 v149, s27, v90
    v_pk_mul_f32 v[148:149], v[148:149], v[10:11]
    v_cvt_pk_bf16_f32 v90, v148, v149
    v_pk_add_f32 v[150:151], v[150:151], v[8:9]
    v_cvt_pk_bf16_f32 v91, v150, v151
    v_lshlrev_b32 v150, 16, v91
    v_and_b32 v151, s27, v91
    v_pk_mul_f32 v[150:151], v[150:151], v[10:11]
    v_cvt_pk_bf16_f32 v91, v150, v151
    buffer_store_dwordx4 v[88:91], v6, s[8:11], s25 offen sc1
    s_add_u32 s25, s25, 8192
    v_pk_add_f32 v[152:153], v[152:153], v[8:9]
    v_cvt_pk_bf16_f32 v92, v152, v153
    v_lshlrev_b32 v152, 16, v92
    v_and_b32 v153, s27, v92
    v_pk_mul_f32 v[152:153], v[152:153], v[10:11]
    v_cvt_pk_bf16_f32 v92, v152, v153
    v_pk_add_f32 v[154:155], v[154:155], v[8:9]
    v_cvt_pk_bf16_f32 v93, v154, v155
    v_lshlrev_b32 v154, 16, v93
    v_and_b32 v155, s27, v93
    v_pk_mul_f32 v[154:155], v[154:155], v[10:11]
    v_cvt_pk_bf16_f32 v93, v154, v155
    v_pk_add_f32 v[156:157], v[156:157], v[8:9]
    v_cvt_pk_bf16_f32 v94, v156, v157
    v_lshlrev_b32 v156, 16, v94
    v_and_b32 v157, s27, v94
    v_pk_mul_f32 v[156:157], v[156:157], v[10:11]
    v_cvt_pk_bf16_f32 v94, v156, v157
    v_pk_add_f32 v[158:159], v[158:159], v[8:9]
    v_cvt_pk_bf16_f32 v95, v158, v159
    v_lshlrev_b32 v158, 16, v95
    v_and_b32 v159, s27, v95
    v_pk_mul_f32 v[158:159], v[158:159], v[10:11]
    v_cvt_pk_bf16_f32 v95, v158, v159
    buffer_store_dwordx4 v[92:95], v6, s[8:11], s25 offen sc1
    s_add_u32 s25, s25, 8192
    s_lshr_b32 s49, s46, 1
    s_lshl_b32 s49, s49, 13
    v_lshrrev_b32 v2, 4, v1
    v_and_b32 v3, 15, v1
    v_lshlrev_b32 v4, 9, v2
    v_lshl_add_u32 v4, v3, 4, v4
    v_add_u32 v16, s49, v4
    v_add_u32 v17, 0x10000, v16
    v_lshrrev_b32 v4, 2, v3
    v_lshl_add_u32 v5, v2, 3, v4
    v_lshlrev_b32 v5, 9, v5
    v_and_b32 v6, 3, v3
    v_lshl_add_u32 v5, v6, 3, v5
    v_and_b32 v6, 1, v2
    v_lshl_add_u32 v4, v6, 2, v4
    v_lshl_add_u32 v5, v4, 5, v5
    s_and_b32 s49, s46, 1
    s_lshl_b32 s49, s49, 8
    s_add_u32 s49, s49, 16384
    v_add_u32 v5, s49, v5
    v_xor_b32 v32, 0, v5
    v_add_u32 v40, 0x10000, v32
    v_xor_b32 v33, 32, v5
    v_add_u32 v41, 0x10000, v33
    v_xor_b32 v34, 64, v5
    v_add_u32 v42, 0x10000, v34
    v_xor_b32 v35, 96, v5
    v_add_u32 v43, 0x10000, v35
    v_xor_b32 v36, 128, v5
    v_add_u32 v44, 0x10000, v36
    v_xor_b32 v37, 160, v5
    v_add_u32 v45, 0x10000, v37
    v_xor_b32 v38, 192, v5
    v_add_u32 v46, 0x10000, v38
    v_xor_b32 v39, 224, v5
    v_add_u32 v47, 0x10000, v39
    s_lshl_b32 s49, s46, 17
    v_lshl_add_u32 v18, v1, 4, s49
    v_add_u32 v19, 63488, v18
    s_lshl_b32 s47, s46, 12
    s_add_u32 s48, s47, 16384
    v_lshlrev_b32 v24, 4, v1
    v_add_u32 v25, 4096, v24
    v_mov_b32 v28, -1
    v_mov_b32 v29, -1
    v_mov_b32 v30, -1
    v_mov_b32 v31, -1
    s_cmp_ge_u32 s28, 16
    s_cbranch_scc1 Lw_nz
    s_lshl_b32 s24, s28, 10
    s_add_u32 s24, s24, 120061952
    s_cmp_lt_u32 s28, 4
    s_cselect_b32 s25, 0x1000, 0
    v_mov_b32 v5, s25
    v_and_b32 v4, 31, v1
    v_cmp_gt_u32 vcc, 12, v4
    s_nop 1
    v_cndmask_b32 v4, 0, v5, vcc
    v_mov_b32 v5, v4
    v_mov_b32 v6, v4
    v_mov_b32 v7, v4
    buffer_store_dwordx4 v[4:7], v24, s[8:11], s24 offen sc1
Lw_nz:
    s_waitcnt vmcnt(0)
    s_barrier
    s_cmp_lg_u32 s46, 0
    s_cbranch_scc1 Lw_ls
    s_lshl_b32 s24, s20, 2
    v_mov_b32 v2, 0
    v_mov_b32 v3, 1
    v_mov_b32 v4, 16
    s_mov_b64 exec, 1
    buffer_atomic_add v3, v2, s[12:15], s24 offen sc0 sc1
    s_waitcnt vmcnt(0)
    v_readfirstlane_b32 s25, v3
    s_cmp_lg_u32 s25, 15
    s_cbranch_scc1 Lw_ls
    s_cmp_gt_u32 s20, 1
    s_cbranch_scc1 Lw_l2
    s_lshl_b32 s25, s20, 3
    buffer_store_dword v4, v2, s[12:15], s25 offen offset:128 sc1
Lw_l2:
    v_mov_b32 v3, 1
    buffer_atomic_add v3, v2, s[12:15], 0 offen offset:32 sc0 sc1
    s_waitcnt vmcnt(0)
    v_readfirstlane_b32 s25, v3
    s_cmp_lg_u32 s25, 7
    s_cbranch_scc1 Lw_ls
    buffer_store_dword v4, v2, s[12:15], 0 offen offset:132 sc1
Lw_ls:
    s_mov_b64 exec, -1
    s_and_b32 s36, s21, 1
    s_lshr_b32 s37, s21, 3
    s_add_u32 s37, s37, 1
    s_bfe_u32 s38, s21, 0x20001
    s_lshl_b32 s24, s20, 2
    s_add_u32 s38, s38, s24
    s_cmp_lg_u32 s46, 0
    s_cbranch_scc1 Lld_w
    v_lshlrev_b32 v2, 2, v1
    s_mov_b32 s24, 0
    s_mov_b32 exec_lo, 0
    s_mov_b32 exec_hi, 1
Lln_w:
    buffer_load_dword v3, v2, s[12:15], 0 offen sc1
    s_waitcnt vmcnt(0)
    v_cmp_ne_u32 vcc, 16, v3
    s_cbranch_vccz Lld_w
    s_sleep 3
    s_add_u32 s24, s24, 1
    s_cmp_lt_u32 s24, 2000000
    s_cbranch_scc1 Lln_w
    s_mov_b64 exec, -1
    s_branch Lw_fail
Lld_w:
    s_mov_b64 exec, -1
    s_barrier
    s_mov_b32 s4, s84
    s_mov_b32 s5, s85
    s_mov_b32 s6, 0x100
    s_mov_b32 s7, 0x20000
    s_call_b64 s[62:63], Lw_spro
    s_call_b64 s[62:63], Lw_srun
    s_add_u32 s39, s36, 1
    s_mov_b32 s83, 2
    s_call_b64 s[62:63], Lw_upro
    s_waitcnt vmcnt(12)
    s_barrier
    s_cmp_lg_u32 s46, 0
    s_cbranch_scc1 Lw_s1a
    v_lshlrev_b32 v2, 2, v1
    v_mov_b32 v3, s93
    s_mov_b64 exec, s[94:95]
    buffer_atomic_add v3, v2, s[8:11], s92 offen sc1
    s_mov_b64 exec, -1
Lw_s1a:
    s_mov_b32 s83, 4
    s_call_b64 s[62:63], Lw_mdma
    v_accvgpr_write_b32 a0, 0
    v_accvgpr_write_b32 a1, 0
    v_accvgpr_write_b32 a2, 0
    v_accvgpr_write_b32 a3, 0
    v_accvgpr_write_b32 a4, 0
    v_accvgpr_write_b32 a5, 0
    v_accvgpr_write_b32 a6, 0
    v_accvgpr_write_b32 a7, 0
    v_accvgpr_write_b32 a8, 0
    v_accvgpr_write_b32 a9, 0
    v_accvgpr_write_b32 a10, 0
    v_accvgpr_write_b32 a11, 0
    v_accvgpr_write_b32 a12, 0
    v_accvgpr_write_b32 a13, 0
    v_accvgpr_write_b32 a14, 0
    v_accvgpr_write_b32 a15, 0
    v_accvgpr_write_b32 a16, 0
    v_accvgpr_write_b32 a17, 0
    v_accvgpr_write_b32 a18, 0
    v_accvgpr_write_b32 a19, 0
    v_accvgpr_write_b32 a20, 0
    v_accvgpr_write_b32 a21, 0
    v_accvgpr_write_b32 a22, 0
    v_accvgpr_write_b32 a23, 0
    v_accvgpr_write_b32 a24, 0
    v_accvgpr_write_b32 a25, 0
    v_accvgpr_write_b32 a26, 0
    v_accvgpr_write_b32 a27, 0
    v_accvgpr_write_b32 a28, 0
    v_accvgpr_write_b32 a29, 0
    v_accvgpr_write_b32 a30, 0
    v_accvgpr_write_b32 a31, 0
    v_accvgpr_write_b32 a32, 0
    v_accvgpr_write_b32 a33, 0
    v_accvgpr_write_b32 a34, 0
    v_accvgpr_write_b32 a35, 0
    v_accvgpr_write_b32 a36, 0
    v_accvgpr_write_b32 a37, 0
    v_accvgpr_write_b32 a38, 0
    v_accvgpr_write_b32 a39, 0
    v_accvgpr_write_b32 a40, 0
    v_accvgpr_write_b32 a41, 0
    v_accvgpr_write_b32 a42, 0
    v_accvgpr_write_b32 a43, 0
    v_accvgpr_write_b32 a44, 0
    v_accvgpr_write_b32 a45, 0
    v_accvgpr_write_b32 a46, 0
    v_accvgpr_write_b32 a47, 0
    v_accvgpr_write_b32 a48, 0
    v_accvgpr_write_b32 a49, 0
    v_accvgpr_write_b32 a50, 0
    v_accvgpr_write_b32 a51, 0
    v_accvgpr_write_b32 a52, 0
    v_accvgpr_write_b32 a53, 0
    v_accvgpr_write_b32 a54, 0
    v_accvgpr_write_b32 a55, 0
    v_accvgpr_write_b32 a56, 0
    v_accvgpr_write_b32 a57, 0
    v_accvgpr_write_b32 a58, 0
    v_accvgpr_write_b32 a59, 0
    v_accvgpr_write_b32 a60, 0
    v_accvgpr_write_b32 a61, 0
    v_accvgpr_write_b32 a62, 0
    v_accvgpr_write_b32 a63, 0
    v_accvgpr_write_b32 a64, 0
    v_accvgpr_write_b32 a65, 0
    v_accvgpr_write_b32 a66, 0
    v_accvgpr_write_b32 a67, 0
    v_accvgpr_write_b32 a68, 0
    v_accvgpr_write_b32 a69, 0
    v_accvgpr_write_b32 a70, 0
    v_accvgpr_write_b32 a71, 0
    v_accvgpr_write_b32 a72, 0
    v_accvgpr_write_b32 a73, 0
    v_accvgpr_write_b32 a74, 0
    v_accvgpr_write_b32 a75, 0
    v_accvgpr_write_b32 a76, 0
    v_accvgpr_write_b32 a77, 0
    v_accvgpr_write_b32 a78, 0
    v_accvgpr_write_b32 a79, 0
    v_accvgpr_write_b32 a80, 0
    v_accvgpr_write_b32 a81, 0
    v_accvgpr_write_b32 a82, 0
    v_accvgpr_write_b32 a83, 0
    v_accvgpr_write_b32 a84, 0
    v_accvgpr_write_b32 a85, 0
    v_accvgpr_write_b32 a86, 0
    v_accvgpr_write_b32 a87, 0
    v_accvgpr_write_b32 a88, 0
    v_accvgpr_write_b32 a89, 0
    v_accvgpr_write_b32 a90, 0
    v_accvgpr_write_b32 a91, 0
    v_accvgpr_write_b32 a92, 0
    v_accvgpr_write_b32 a93, 0
    v_accvgpr_write_b32 a94, 0
    v_accvgpr_write_b32 a95, 0
    v_accvgpr_write_b32 a96, 0
    v_accvgpr_write_b32 a97, 0
    v_accvgpr_write_b32 a98, 0
    v_accvgpr_write_b32 a99, 0
    v_accvgpr_write_b32 a100, 0
    v_accvgpr_write_b32 a101, 0
    v_accvgpr_write_b32 a102, 0
    v_accvgpr_write_b32 a103, 0
    v_accvgpr_write_b32 a104, 0
    v_accvgpr_write_b32 a105, 0
    v_accvgpr_write_b32 a106, 0
    v_accvgpr_write_b32 a107, 0
    v_accvgpr_write_b32 a108, 0
    v_accvgpr_write_b32 a109, 0
    v_accvgpr_write_b32 a110, 0
    v_accvgpr_write_b32 a111, 0
    v_accvgpr_write_b32 a112, 0
    v_accvgpr_write_b32 a113, 0
    v_accvgpr_write_b32 a114, 0
    v_accvgpr_write_b32 a115, 0
    v_accvgpr_write_b32 a116, 0
    v_accvgpr_write_b32 a117, 0
    v_accvgpr_write_b32 a118, 0
    v_accvgpr_write_b32 a119, 0
    v_accvgpr_write_b32 a120, 0
    v_accvgpr_write_b32 a121, 0
    v_accvgpr_write_b32 a122, 0
    v_accvgpr_write_b32 a123, 0
    v_accvgpr_write_b32 a124, 0
    v_accvgpr_write_b32 a125, 0
    v_accvgpr_write_b32 a126, 0
    v_accvgpr_write_b32 a127, 0
    s_call_b64 s[62:63], Lw_urun
    s_lshr_b32 s49, s46, 1
    s_lshl_b32 s49, s49, 13
    v_lshrrev_b32 v2, 4, v1
    v_and_b32 v3, 15, v1
    v_lshlrev_b32 v4, 9, v2
    v_lshl_add_u32 v4, v3, 4, v4
    v_add_u32 v16, s49, v4
    v_add_u32 v17, 0x10000, v16
    v_lshrrev_b32 v4, 2, v3
    v_lshl_add_u32 v5, v2, 3, v4
    v_lshlrev_b32 v5, 9, v5
    v_and_b32 v6, 3, v3
    v_lshl_add_u32 v5, v6, 3, v5
    v_and_b32 v6, 1, v2
    v_lshl_add_u32 v4, v6, 2, v4
    v_lshl_add_u32 v5, v4, 5, v5
    s_and_b32 s49, s46, 1
    s_lshl_b32 s49, s49, 8
    s_add_u32 s49, s49, 16384
    v_add_u32 v5, s49, v5
    v_xor_b32 v32, 0, v5
    v_add_u32 v40, 0x10000, v32
    v_xor_b32 v33, 32, v5
    v_add_u32 v41, 0x10000, v33
    v_xor_b32 v34, 64, v5
    v_add_u32 v42, 0x10000, v34
    v_xor_b32 v35, 96, v5
    v_add_u32 v43, 0x10000, v35
    v_xor_b32 v36, 128, v5
    v_add_u32 v44, 0x10000, v36
    v_xor_b32 v37, 160, v5
    v_add_u32 v45, 0x10000, v37
    v_xor_b32 v38, 192, v5
    v_add_u32 v46, 0x10000, v38
    v_xor_b32 v39, 224, v5
    v_add_u32 v47, 0x10000, v39
    s_lshl_b32 s49, s46, 17
    v_lshl_add_u32 v18, v1, 4, s49
    v_add_u32 v19, 63488, v18
    s_lshl_b32 s47, s46, 12
    s_add_u32 s48, s47, 16384
    v_lshlrev_b32 v24, 4, v1
    v_add_u32 v25, 4096, v24
    v_mov_b32 v28, -1
    v_mov_b32 v29, -1
    v_mov_b32 v30, -1
    v_mov_b32 v31, -1
    s_mov_b32 s16, s74
    s_mov_b32 s17, s75
    s_mov_b32 s18, 0x1c00
    s_mov_b32 s19, 0x20000
    s_mov_b32 s82, 0
    s_mov_b32 s35, 1
    s_waitcnt vmcnt(0)
    s_barrier
    s_cmp_lg_u32 s46, 0
    s_cbranch_scc1 Lw_s1b
    v_lshlrev_b32 v2, 2, v1
    v_mov_b32 v3, s93
    s_mov_b64 exec, s[94:95]
    buffer_atomic_add v3, v2, s[8:11], s92 offen sc1
    s_mov_b64 exec, -1
Lw_s1b:
    s_lshl_b32 s26, s82, 4
    s_add_u32 s26, s26, s21
    s_cmp_ge_u32 s26, 48
    s_cbranch_scc1 Lw_fail
    s_cmp_ge_u32 s26, 32
    s_cbranch_scc1 Lj2_a
    s_cmp_lt_u32 s26, 16
    s_cbranch_scc1 Ljk_a
    s_cmp_lt_u32 s26, 30
    s_cbranch_scc1 Ljf_a
    s_sub_u32 s26, s26, 14
Ljk_a:
    s_lshr_b32 s22, s26, 2
    s_add_u32 s22, s22, 3
    s_bfe_u32 s23, s26, 0x10001
    s_add_u32 s23, s23, 1
    s_branch Lnt_a
Lj2_a:
    s_and_b32 s24, s21, 12
    s_lshr_b32 s25, s20, 1
    s_add_u32 s24, s24, s25
    s_and_b32 s25, s21, 3
    s_lshl_b32 s25, s25, 1
    s_and_b32 s20, s20, 1
    s_add_u32 s20, s20, s25
    s_mov_b32 s21, s24
    s_lshl_b32 s28, s20, 4
    s_add_u32 s28, s28, s21
    s_lshl_b32 s28, s28, 2
    s_add_u32 s28, s28, s46
    s_mov_b32 s26, s21
    s_lshr_b32 s22, s26, 1
    s_mov_b32 s23, 0
    s_and_b32 s24, s46, 1
    s_lshl_b32 s24, s24, 2
    s_lshr_b32 s25, s46, 1
    s_add_u32 s24, s24, s25
    s_lshl_b32 s24, s24, 16
    v_lshl_add_u32 v18, v1, 4, s24
    v_add_u32 v19, 129024, v18
Lnt_a:
    s_and_b32 s30, s26, 1
    s_lshl_b32 s24, s20, 1
    s_add_u32 s30, s30, s24
    s_branch Lgo_a
Ljf_a:
    s_mul_i32 s24, s20, 14
    s_add_u32 s24, s24, s26
    s_sub_u32 s24, s24, 16
    s_lshr_b32 s30, s24, 3
    s_and_b32 s22, s24, 7
    s_mov_b32 s23, 3
Lgo_a:
    s_mov_b64 s[24:25], s[64:65]
    s_cmp_eq_u32 s23, 1
    s_cselect_b64 s[24:25], s[66:67], s[24:25]
    s_cmp_eq_u32 s23, 2
    s_cselect_b64 s[24:25], s[68:69], s[24:25]
    s_cmp_eq_u32 s23, 3
    s_cselect_b64 s[24:25], s[72:73], s[24:25]
    s_mov_b32 s43, 8192
    s_cselect_b32 s43, 7168, s43
    s_mov_b32 s12, s24
    s_mov_b32 s13, s25
    s_lshl_b32 s14, s43, 10
    s_mov_b32 s15, 0x20000
    s_lshl_b32 s41, s30, 9
    s_lshl_b32 s40, s22, 19
    s_add_u32 s40, s40, 0
    s_lshl_b32 s45, s43, 5
    s_lshl_b32 s49, s46, 3
    v_lshrrev_b32 v2, 5, v1
    v_add_u32 v2, s49, v2
    v_and_b32 v3, 31, v1
    s_and_b32 s50, s46, 1
    s_lshl_b32 s50, s50, 3
    v_xor_b32 v3, s50, v3
    v_add_u32 v4, 0, v2
    v_and_b32 v5, 3, v4
    v_lshlrev_b32 v5, 1, v5
    v_xor_b32 v5, v5, v3
    v_mul_lo_u32 v4, v4, s43
    v_lshl_add_u32 v4, v5, 4, v4
    v_subrev_u32 v20, 0, v4
    v_add_u32 v4, 2, v2
    v_and_b32 v5, 3, v4
    v_lshlrev_b32 v5, 1, v5
    v_xor_b32 v5, v5, v3
    v_mul_lo_u32 v4, v4, s43
    v_lshl_add_u32 v4, v5, 4, v4
    v_subrev_u32 v21, 1024, v4
    v_add_u32 v4, 4, v2
    v_and_b32 v5, 3, v4
    v_lshlrev_b32 v5, 1, v5
    v_xor_b32 v5, v5, v3
    v_mul_lo_u32 v4, v4, s43
    v_lshl_add_u32 v4, v5, 4, v4
    v_subrev_u32 v22, 2048, v4
    v_add_u32 v4, 6, v2
    v_and_b32 v5, 3, v4
    v_lshlrev_b32 v5, 1, v5
    v_xor_b32 v5, v5, v3
    v_mul_lo_u32 v4, v4, s43
    v_lshl_add_u32 v4, v5, 4, v4
    v_subrev_u32 v23, 3072, v4
    s_add_u32 m0, s47, 0
    s_nop 0
    buffer_load_dwordx4 v18, s[8:11], s40 offen offset:0 sc1 lds
    buffer_load_dwordx4 v18, s[8:11], s40 offen offset:1024 sc1 lds
    buffer_load_dwordx4 v19, s[8:11], s40 offen offset:2048 sc1 lds
    buffer_load_dwordx4 v19, s[8:11], s40 offen offset:3072 sc1 lds
    s_add_u32 s40, s40, 2048
    s_add_u32 m0, s48, 0
    s_nop 0
    buffer_load_dwordx4 v20, s[12:15], s41 offen offset:0 lds
    buffer_load_dwordx4 v21, s[12:15], s41 offen offset:1024 lds
    buffer_load_dwordx4 v22, s[12:15], s41 offen offset:2048 lds
    buffer_load_dwordx4 v23, s[12:15], s41 offen offset:3072 lds
    s_add_u32 s41, s41, s45
    s_add_u32 m0, s47, 32768
    s_nop 0
    buffer_load_dwordx4 v18, s[8:11], s40 offen offset:0 sc1 lds
    buffer_load_dwordx4 v18, s[8:11], s40 offen offset:1024 sc1 lds
    buffer_load_dwordx4 v19, s[8:11], s40 offen offset:2048 sc1 lds
    buffer_load_dwordx4 v19, s[8:11], s40 offen offset:3072 sc1 lds
    s_add_u32 s40, s40, 2048
    s_add_u32 m0, s48, 32768
    s_nop 0
    buffer_load_dwordx4 v20, s[12:15], s41 offen offset:0 lds
    buffer_load_dwordx4 v21, s[12:15], s41 offen offset:1024 lds
    buffer_load_dwordx4 v22, s[12:15], s41 offen offset:2048 lds
    buffer_load_dwordx4 v23, s[12:15], s41 offen offset:3072 lds
    s_add_u32 s41, s41, s45
    s_add_u32 m0, s47, 65536
    s_nop 0
    buffer_load_dwordx4 v18, s[8:11], s40 offen offset:0 sc1 lds
    buffer_load_dwordx4 v18, s[8:11], s40 offen offset:1024 sc1 lds
    buffer_load_dwordx4 v19, s[8:11], s40 offen offset:2048 sc1 lds
    buffer_load_dwordx4 v19, s[8:11], s40 offen offset:3072 sc1 lds
    s_add_u32 s40, s40, 2048
    s_add_u32 m0, s48, 65536
    s_nop 0
    buffer_load_dwordx4 v20, s[12:15], s41 offen offset:0 lds
    buffer_load_dwordx4 v21, s[12:15], s41 offen offset:1024 lds
    buffer_load_dwordx4 v22, s[12:15], s41 offen offset:2048 lds
    buffer_load_dwordx4 v23, s[12:15], s41 offen offset:3072 lds
    s_add_u32 s41, s41, s45
    s_add_u32 m0, s47, 98304
    s_nop 0
    buffer_load_dwordx4 v18, s[8:11], s40 offen offset:0 sc1 lds
    buffer_load_dwordx4 v18, s[8:11], s40 offen offset:1024 sc1 lds
    buffer_load_dwordx4 v19, s[8:11], s40 offen offset:2048 sc1 lds
    buffer_load_dwordx4 v19, s[8:11], s40 offen offset:3072 sc1 lds
    s_add_u32 s40, s40, 2048
    s_add_u32 m0, s48, 98304
    s_nop 0
    buffer_load_dwordx4 v20, s[12:15], s41 offen offset:0 lds
    buffer_load_dwordx4 v21, s[12:15], s41 offen offset:1024 lds
    buffer_load_dwordx4 v22, s[12:15], s41 offen offset:2048 lds
    buffer_load_dwordx4 v23, s[12:15], s41 offen offset:3072 lds
    s_add_u32 s41, s41, s45
    s_waitcnt vmcnt(0)
    s_mov_b32 s4, s72
    s_mov_b32 s5, s73
    s_mov_b32 s6, 0x700000
    s_mov_b32 s7, 0x20000
    v_lshlrev_b32 v9, 7, v1
    s_mul_i32 s29, s28, 5120
    s_lshl_b32 s92, s20, 9
    s_add_u32 s92, s92, 120062144
    s_mov_b64 s[94:95], 0xffff
    s_and_b32 s93, s21, 1
    s_lshl_b32 s93, s93, 9
    s_cbranch_scc0 Lw_job
    s_mul_i32 s24, s20, 2883584
    s_lshr_b32 s25, s21, 1
    s_lshl_b32 s25, s25, 2
    s_add_u32 s25, s25, s46
    s_mul_i32 s25, s25, 40960
    s_add_u32 s24, s24, s25
    s_add_u32 s24, s24, 93847552
    s_mov_b32 s25, 10
Lw_fl:
    buffer_store_dwordx4 v[28:31], v24, s[8:11], s24 offen offset:0 sc1
    buffer_store_dwordx4 v[28:31], v24, s[8:11], s24 offen offset:1024 sc1
    buffer_store_dwordx4 v[28:31], v24, s[8:11], s24 offen offset:2048 sc1
    buffer_store_dwordx4 v[28:31], v24, s[8:11], s24 offen offset:3072 sc1
    s_add_u32 s24, s24, 4096
    s_sub_u32 s25, s25, 1
    s_cbranch_scc0 Lw_fk
Lw_fk:
    s_cmp_lg_u32 s25, 0
    s_cbranch_scc1 Lw_fl
Lw_job:
    s_barrier
    ds_read_b128 v[96:99], v16 offset:0
    ds_read_b64_tr_b16 v[64:65], v32 offset:0
    ds_read_b64_tr_b16 v[66:67], v32 offset:2048
    ds_read_b128 v[100:103], v16 offset:256
    ds_read_b64_tr_b16 v[68:69], v33 offset:0
    ds_read_b64_tr_b16 v[70:71], v33 offset:2048
    ds_read_b128 v[104:107], v16 offset:2048
    ds_read_b64_tr_b16 v[72:73], v34 offset:0
    ds_read_b64_tr_b16 v[74:75], v34 offset:2048
    ds_read_b128 v[108:111], v16 offset:2304
    ds_read_b64_tr_b16 v[76:77], v35 offset:0
    ds_read_b64_tr_b16 v[78:79], v35 offset:2048
    ds_read_b128 v[112:115], v16 offset:4096
    s_waitcnt lgkmcnt(4)
    ds_read_b64_tr_b16 v[80:81], v36 offset:0
    ds_read_b64_tr_b16 v[82:83], v36 offset:2048
    ds_read_b128 v[116:119], v16 offset:4352
    ds_read_b64_tr_b16 v[84:85], v37 offset:0
    ds_read_b64_tr_b16 v[86:87], v37 offset:2048
    ds_read_b128 v[120:123], v16 offset:6144
    ds_read_b64_tr_b16 v[88:89], v38 offset:0
    ds_read_b64_tr_b16 v[90:91], v38 offset:2048
    ds_read_b128 v[124:127], v16 offset:6400
    ds_read_b64_tr_b16 v[92:93], v39 offset:0
    ds_read_b64_tr_b16 v[94:95], v39 offset:2048
    s_waitcnt lgkmcnt(0)
    s_barrier
    v_mfma_f32_16x16x32_bf16 a[0:3], v[64:67], v[96:99], 0
    ds_read_b128 v[160:163], v16 offset:32768
    v_mfma_f32_16x16x32_bf16 a[4:7], v[64:67], v[100:103], 0
    v_mfma_f32_16x16x32_bf16 a[8:11], v[64:67], v[104:107], 0
    ds_read_b64_tr_b16 v[128:129], v32 offset:32768
    s_add_u32 m0, s47, 0
    v_mfma_f32_16x16x32_bf16 a[12:15], v[64:67], v[108:111], 0
    buffer_load_dwordx4 v18, s[8:11], s40 offen offset:0 sc1 lds
    v_mfma_f32_16x16x32_bf16 a[16:19], v[64:67], v[112:115], 0
    ds_read_b64_tr_b16 v[130:131], v32 offset:34816
    v_mfma_f32_16x16x32_bf16 a[20:23], v[64:67], v[116:119], 0
    v_mfma_f32_16x16x32_bf16 a[24:27], v[64:67], v[120:123], 0
    ds_read_b128 v[164:167], v16 offset:33024
    v_mfma_f32_16x16x32_bf16 a[28:31], v[64:67], v[124:127], 0
    v_mfma_f32_16x16x32_bf16 a[32:35], v[68:71], v[96:99], 0
    ds_read_b64_tr_b16 v[132:133], v33 offset:32768
    v_mfma_f32_16x16x32_bf16 a[36:39], v[68:71], v[100:103], 0
    v_mfma_f32_16x16x32_bf16 a[40:43], v[68:71], v[104:107], 0
    buffer_load_dwordx4 v18, s[8:11], s40 offen offset:1024 sc1 lds
    v_mfma_f32_16x16x32_bf16 a[44:47], v[68:71], v[108:111], 0
    v_mfma_f32_16x16x32_bf16 a[48:51], v[68:71], v[112:115], 0
    ds_read_b64_tr_b16 v[134:135], v33 offset:34816
    v_mfma_f32_16x16x32_bf16 a[52:55], v[68:71], v[116:119], 0
    v_mfma_f32_16x16x32_bf16 a[56:59], v[68:71], v[120:123], 0
    ds_read_b128 v[168:171], v16 offset:34816
    v_mfma_f32_16x16x32_bf16 a[60:63], v[68:71], v[124:127], 0
    v_mfma_f32_16x16x32_bf16 a[64:67], v[72:75], v[96:99], 0
    ds_read_b64_tr_b16 v[136:137], v34 offset:32768
    v_mfma_f32_16x16x32_bf16 a[68:71], v[72:75], v[100:103], 0
    buffer_load_dwordx4 v19, s[8:11], s40 offen offset:2048 sc1 lds
    v_mfma_f32_16x16x32_bf16 a[72:75], v[72:75], v[104:107], 0
    ds_read_b64_tr_b16 v[138:139], v34 offset:34816
    v_mfma_f32_16x16x32_bf16 a[76:79], v[72:75], v[108:111], 0
    v_mfma_f32_16x16x32_bf16 a[80:83], v[72:75], v[112:115], 0
    ds_read_b128 v[172:175], v16 offset:35072
    v_mfma_f32_16x16x32_bf16 a[84:87], v[72:75], v[116:119], 0
    v_mfma_f32_16x16x32_bf16 a[88:91], v[72:75], v[120:123], 0
    ds_read_b64_tr_b16 v[140:141], v35 offset:32768
    v_mfma_f32_16x16x32_bf16 a[92:95], v[72:75], v[124:127], 0
    v_mfma_f32_16x16x32_bf16 a[96:99], v[76:79], v[96:99], 0
    buffer_load_dwordx4 v19, s[8:11], s40 offen offset:3072 sc1 lds
    s_add_u32 s40, s40, 2048
    v_mfma_f32_16x16x32_bf16 a[100:103], v[76:79], v[100:103], 0
    v_mfma_f32_16x16x32_bf16 a[104:107], v[76:79], v[104:107], 0
    ds_read_b64_tr_b16 v[142:143], v35 offset:34816
    v_mfma_f32_16x16x32_bf16 a[108:111], v[76:79], v[108:111], 0
    v_mfma_f32_16x16x32_bf16 a[112:115], v[76:79], v[112:115], 0
    ds_read_b128 v[176:179], v16 offset:36864
    s_waitcnt lgkmcnt(8)
    v_mfma_f32_16x16x32_bf16 a[116:119], v[76:79], v[116:119], 0
    v_mfma_f32_16x16x32_bf16 a[120:123], v[76:79], v[120:123], 0
    ds_read_b64_tr_b16 v[144:145], v36 offset:32768
    s_add_u32 m0, s48, 0
    v_mfma_f32_16x16x32_bf16 a[124:127], v[76:79], v[124:127], 0
    buffer_load_dwordx4 v20, s[12:15], s41 offen offset:0 lds
    v_mfma_f32_16x16x32_bf16 a[128:131], v[80:83], v[96:99], 0
    ds_read_b64_tr_b16 v[146:147], v36 offset:34816
    v_mfma_f32_16x16x32_bf16 a[132:135], v[80:83], v[100:103], 0
    v_mfma_f32_16x16x32_bf16 a[136:139], v[80:83], v[104:107], 0
    ds_read_b128 v[180:183], v16 offset:37120
    v_mfma_f32_16x16x32_bf16 a[140:143], v[80:83], v[108:111], 0
    v_mfma_f32_16x16x32_bf16 a[144:147], v[80:83], v[112:115], 0
    ds_read_b64_tr_b16 v[148:149], v37 offset:32768
    v_mfma_f32_16x16x32_bf16 a[148:151], v[80:83], v[116:119], 0
    v_mfma_f32_16x16x32_bf16 a[152:155], v[80:83], v[120:123], 0
    buffer_load_dwordx4 v21, s[12:15], s41 offen offset:1024 lds
    v_mfma_f32_16x16x32_bf16 a[156:159], v[80:83], v[124:127], 0
    v_mfma_f32_16x16x32_bf16 a[160:163], v[84:87], v[96:99], 0
    ds_read_b64_tr_b16 v[150:151], v37 offset:34816
    v_mfma_f32_16x16x32_bf16 a[164:167], v[84:87], v[100:103], 0
    v_mfma_f32_16x16x32_bf16 a[168:171], v[84:87], v[104:107], 0
    ds_read_b128 v[184:187], v16 offset:38912
    v_mfma_f32_16x16x32_bf16 a[172:175], v[84:87], v[108:111], 0
    v_mfma_f32_16x16x32_bf16 a[176:179], v[84:87], v[112:115], 0
    ds_read_b64_tr_b16 v[152:153], v38 offset:32768
    v_mfma_f32_16x16x32_bf16 a[180:183], v[84:87], v[116:119], 0
    buffer_load_dwordx4 v22, s[12:15], s41 offen offset:2048 lds
    v_mfma_f32_16x16x32_bf16 a[184:187], v[84:87], v[120:123], 0
    ds_read_b64_tr_b16 v[154:155], v38 offset:34816
    v_mfma_f32_16x16x32_bf16 a[188:191], v[84:87], v[124:127], 0
    v_mfma_f32_16x16x32_bf16 a[192:195], v[88:91], v[96:99], 0
    ds_read_b128 v[188:191], v16 offset:39168
    v_mfma_f32_16x16x32_bf16 a[196:199], v[88:91], v[100:103], 0
    v_mfma_f32_16x16x32_bf16 a[200:203], v[88:91], v[104:107], 0
    ds_read_b64_tr_b16 v[156:157], v39 offset:32768
    v_mfma_f32_16x16x32_bf16 a[204:207], v[88:91], v[108:111], 0
    v_mfma_f32_16x16x32_bf16 a[208:211], v[88:91], v[112:115], 0
    buffer_load_dwordx4 v23, s[12:15], s41 offen offset:3072 lds
    s_add_u32 s41, s41, s45
    v_mfma_f32_16x16x32_bf16 a[212:215], v[88:91], v[116:119], 0
    v_mfma_f32_16x16x32_bf16 a[216:219], v[88:91], v[120:123], 0
    ds_read_b64_tr_b16 v[158:159], v39 offset:34816
    v_mfma_f32_16x16x32_bf16 a[220:223], v[88:91], v[124:127], 0
    v_mfma_f32_16x16x32_bf16 a[224:227], v[92:95], v[96:99], 0
    v_mfma_f32_16x16x32_bf16 a[228:231], v[92:95], v[100:103], 0
    v_mfma_f32_16x16x32_bf16 a[232:235], v[92:95], v[104:107], 0
    v_mfma_f32_16x16x32_bf16 a[236:239], v[92:95], v[108:111], 0
    v_mfma_f32_16x16x32_bf16 a[240:243], v[92:95], v[112:115], 0
    v_mfma_f32_16x16x32_bf16 a[244:247], v[92:95], v[116:119], 0
    v_mfma_f32_16x16x32_bf16 a[248:251], v[92:95], v[120:123], 0
    v_mfma_f32_16x16x32_bf16 a[252:255], v[92:95], v[124:127], 0
    s_waitcnt lgkmcnt(0)
    s_barrier
    v_mfma_f32_16x16x32_bf16 a[0:3], v[128:131], v[160:163], a[0:3]
    ds_read_b128 v[96:99], v17 offset:0
    v_mfma_f32_16x16x32_bf16 a[4:7], v[128:131], v[164:167], a[4:7]
    v_mfma_f32_16x16x32_bf16 a[8:11], v[128:131], v[168:171], a[8:11]
    ds_read_b64_tr_b16 v[64:65], v40 offset:0
    s_add_u32 m0, s47, 32768
    v_mfma_f32_16x16x32_bf16 a[12:15], v[128:131], v[172:175], a[12:15]
    buffer_load_dwordx4 v18, s[8:11], s40 offen offset:0 sc1 lds
    v_mfma_f32_16x16x32_bf16 a[16:19], v[128:131], v[176:179], a[16:19]
    ds_read_b64_tr_b16 v[66:67], v40 offset:2048
    v_mfma_f32_16x16x32_bf16 a[20:23], v[128:131], v[180:183], a[20:23]
    v_mfma_f32_16x16x32_bf16 a[24:27], v[128:131], v[184:187], a[24:27]
    ds_read_b128 v[100:103], v17 offset:256
    v_mfma_f32_16x16x32_bf16 a[28:31], v[128:131], v[188:191], a[28:31]
    v_mfma_f32_16x16x32_bf16 a[32:35], v[132:135], v[160:163], a[32:35]
    ds_read_b64_tr_b16 v[68:69], v41 offset:0
    v_mfma_f32_16x16x32_bf16 a[36:39], v[132:135], v[164:167], a[36:39]
    v_mfma_f32_16x16x32_bf16 a[40:43], v[132:135], v[168:171], a[40:43]
    buffer_load_dwordx4 v18, s[8:11], s40 offen offset:1024 sc1 lds
    v_mfma_f32_16x16x32_bf16 a[44:47], v[132:135], v[172:175], a[44:47]
    v_mfma_f32_16x16x32_bf16 a[48:51], v[132:135], v[176:179], a[48:51]
    ds_read_b64_tr_b16 v[70:71], v41 offset:2048
    v_mfma_f32_16x16x32_bf16 a[52:55], v[132:135], v[180:183], a[52:55]
    v_mfma_f32_16x16x32_bf16 a[56:59], v[132:135], v[184:187], a[56:59]
    ds_read_b128 v[104:107], v17 offset:2048
    v_mfma_f32_16x16x32_bf16 a[60:63], v[132:135], v[188:191], a[60:63]
    v_mfma_f32_16x16x32_bf16 a[64:67], v[136:139], v[160:163], a[64:67]
    ds_read_b64_tr_b16 v[72:73], v42 offset:0
    v_mfma_f32_16x16x32_bf16 a[68:71], v[136:139], v[164:167], a[68:71]
    buffer_load_dwordx4 v19, s[8:11], s40 offen offset:2048 sc1 lds
    v_mfma_f32_16x16x32_bf16 a[72:75], v[136:139], v[168:171], a[72:75]
    ds_read_b64_tr_b16 v[74:75], v42 offset:2048
    v_mfma_f32_16x16x32_bf16 a[76:79], v[136:139], v[172:175], a[76:79]
    v_mfma_f32_16x16x32_bf16 a[80:83], v[136:139], v[176:179], a[80:83]
    ds_read_b128 v[108:111], v17 offset:2304
    v_mfma_f32_16x16x32_bf16 a[84:87], v[136:139], v[180:183], a[84:87]
    v_mfma_f32_16x16x32_bf16 a[88:91], v[136:139], v[184:187], a[88:91]
    ds_read_b64_tr_b16 v[76:77], v43 offset:0
    v_mfma_f32_16x16x32_bf16 a[92:95], v[136:139], v[188:191], a[92:95]
    v_mfma_f32_16x16x32_bf16 a[96:99], v[140:143], v[160:163], a[96:99]
    buffer_load_dwordx4 v19, s[8:11], s40 offen offset:3072 sc1 lds
    s_add_u32 s40, s40, 2048
    v_mfma_f32_16x16x32_bf16 a[100:103], v[140:143], v[164:167], a[100:103]
    v_mfma_f32_16x16x32_bf16 a[104:107], v[140:143], v[168:171], a[104:107]
    ds_read_b64_tr_b16 v[78:79], v43 offset:2048
    v_mfma_f32_16x16x32_bf16 a[108:111], v[140:143], v[172:175], a[108:111]
    v_mfma_f32_16x16x32_bf16 a[112:115], v[140:143], v[176:179], a[112:115]
    ds_read_b128 v[112:115], v17 offset:4096
    s_waitcnt lgkmcnt(8)
    v_mfma_f32_16x16x32_bf16 a[116:119], v[140:143], v[180:183], a[116:119]
    v_mfma_f32_16x16x32_bf16 a[120:123], v[140:143], v[184:187], a[120:123]
    ds_read_b64_tr_b16 v[80:81], v44 offset:0
    s_add_u32 m0, s48, 32768
    v_mfma_f32_16x16x32_bf16 a[124:127], v[140:143], v[188:191], a[124:127]
    buffer_load_dwordx4 v20, s[12:15], s41 offen offset:0 lds
    v_mfma_f32_16x16x32_bf16 a[128:131], v[144:147], v[160:163], a[128:131]
    ds_read_b64_tr_b16 v[82:83], v44 offset:2048
    v_mfma_f32_16x16x32_bf16 a[132:135], v[144:147], v[164:167], a[132:135]
    v_mfma_f32_16x16x32_bf16 a[136:139], v[144:147], v[168:171], a[136:139]
    ds_read_b128 v[116:119], v17 offset:4352
    v_mfma_f32_16x16x32_bf16 a[140:143], v[144:147], v[172:175], a[140:143]
    v_mfma_f32_16x16x32_bf16 a[144:147], v[144:147], v[176:179], a[144:147]
    ds_read_b64_tr_b16 v[84:85], v45 offset:0
    v_mfma_f32_16x16x32_bf16 a[148:151], v[144:147], v[180:183], a[148:151]
    v_mfma_f32_16x16x32_bf16 a[152:155], v[144:147], v[184:187], a[152:155]
    buffer_load_dwordx4 v21, s[12:15], s41 offen offset:1024 lds
    v_mfma_f32_16x16x32_bf16 a[156:159], v[144:147], v[188:191], a[156:159]
    v_mfma_f32_16x16x32_bf16 a[160:163], v[148:151], v[160:163], a[160:163]
    ds_read_b64_tr_b16 v[86:87], v45 offset:2048
    v_mfma_f32_16x16x32_bf16 a[164:167], v[148:151], v[164:167], a[164:167]
    v_mfma_f32_16x16x32_bf16 a[168:171], v[148:151], v[168:171], a[168:171]
    ds_read_b128 v[120:123], v17 offset:6144
    v_mfma_f32_16x16x32_bf16 a[172:175], v[148:151], v[172:175], a[172:175]
    v_mfma_f32_16x16x32_bf16 a[176:179], v[148:151], v[176:179], a[176:179]
    ds_read_b64_tr_b16 v[88:89], v46 offset:0
    v_mfma_f32_16x16x32_bf16 a[180:183], v[148:151], v[180:183], a[180:183]
    buffer_load_dwordx4 v22, s[12:15], s41 offen offset:2048 lds
    v_mfma_f32_16x16x32_bf16 a[184:187], v[148:151], v[184:187], a[184:187]
    ds_read_b64_tr_b16 v[90:91], v46 offset:2048
    v_mfma_f32_16x16x32_bf16 a[188:191], v[148:151], v[188:191], a[188:191]
    v_mfma_f32_16x16x32_bf16 a[192:195], v[152:155], v[160:163], a[192:195]
    ds_read_b128 v[124:127], v17 offset:6400
    v_mfma_f32_16x16x32_bf16 a[196:199], v[152:155], v[164:167], a[196:199]
    v_mfma_f32_16x16x32_bf16 a[200:203], v[152:155], v[168:171], a[200:203]
    ds_read_b64_tr_b16 v[92:93], v47 offset:0
    v_mfma_f32_16x16x32_bf16 a[204:207], v[152:155], v[172:175], a[204:207]
    v_mfma_f32_16x16x32_bf16 a[208:211], v[152:155], v[176:179], a[208:211]
    buffer_load_dwordx4 v23, s[12:15], s41 offen offset:3072 lds
    s_add_u32 s41, s41, s45
    v_mfma_f32_16x16x32_bf16 a[212:215], v[152:155], v[180:183], a[212:215]
    v_mfma_f32_16x16x32_bf16 a[216:219], v[152:155], v[184:187], a[216:219]
    ds_read_b64_tr_b16 v[94:95], v47 offset:2048
    v_mfma_f32_16x16x32_bf16 a[220:223], v[152:155], v[188:191], a[220:223]
    v_mfma_f32_16x16x32_bf16 a[224:227], v[156:159], v[160:163], a[224:227]
    v_mfma_f32_16x16x32_bf16 a[228:231], v[156:159], v[164:167], a[228:231]
    v_mfma_f32_16x16x32_bf16 a[232:235], v[156:159], v[168:171], a[232:235]
    v_mfma_f32_16x16x32_bf16 a[236:239], v[156:159], v[172:175], a[236:239]
    v_mfma_f32_16x16x32_bf16 a[240:243], v[156:159], v[176:179], a[240:243]
    v_mfma_f32_16x16x32_bf16 a[244:247], v[156:159], v[180:183], a[244:247]
    v_mfma_f32_16x16x32_bf16 a[248:251], v[156:159], v[184:187], a[248:251]
    v_mfma_f32_16x16x32_bf16 a[252:255], v[156:159], v[188:191], a[252:255]
    s_waitcnt lgkmcnt(0)
    s_barrier
    v_mfma_f32_16x16x32_bf16 a[0:3], v[64:67], v[96:99], a[0:3]
    ds_read_b128 v[160:163], v17 offset:32768
    v_mfma_f32_16x16x32_bf16 a[4:7], v[64:67], v[100:103], a[4:7]
    v_mfma_f32_16x16x32_bf16 a[8:11], v[64:67], v[104:107], a[8:11]
    ds_read_b64_tr_b16 v[128:129], v40 offset:32768
    s_add_u32 m0, s47, 65536
    v_mfma_f32_16x16x32_bf16 a[12:15], v[64:67], v[108:111], a[12:15]
    buffer_load_dwordx4 v18, s[8:11], s40 offen offset:0 sc1 lds
    v_mfma_f32_16x16x32_bf16 a[16:19], v[64:67], v[112:115], a[16:19]
    ds_read_b64_tr_b16 v[130:131], v40 offset:34816
    v_mfma_f32_16x16x32_bf16 a[20:23], v[64:67], v[116:119], a[20:23]
    v_mfma_f32_16x16x32_bf16 a[24:27], v[64:67], v[120:123], a[24:27]
    ds_read_b128 v[164:167], v17 offset:33024
    v_mfma_f32_16x16x32_bf16 a[28:31], v[64:67], v[124:127], a[28:31]
    v_mfma_f32_16x16x32_bf16 a[32:35], v[68:71], v[96:99], a[32:35]
    ds_read_b64_tr_b16 v[132:133], v41 offset:32768
    v_mfma_f32_16x16x32_bf16 a[36:39], v[68:71], v[100:103], a[36:39]
    v_mfma_f32_16x16x32_bf16 a[40:43], v[68:71], v[104:107], a[40:43]
    buffer_load_dwordx4 v18, s[8:11], s40 offen offset:1024 sc1 lds
    v_mfma_f32_16x16x32_bf16 a[44:47], v[68:71], v[108:111], a[44:47]
    v_mfma_f32_16x16x32_bf16 a[48:51], v[68:71], v[112:115], a[48:51]
    ds_read_b64_tr_b16 v[134:135], v41 offset:34816
    v_mfma_f32_16x16x32_bf16 a[52:55], v[68:71], v[116:119], a[52:55]
    v_mfma_f32_16x16x32_bf16 a[56:59], v[68:71], v[120:123], a[56:59]
    ds_read_b128 v[168:171], v17 offset:34816
    v_mfma_f32_16x16x32_bf16 a[60:63], v[68:71], v[124:127], a[60:63]
    v_mfma_f32_16x16x32_bf16 a[64:67], v[72:75], v[96:99], a[64:67]
    ds_read_b64_tr_b16 v[136:137], v42 offset:32768
    v_mfma_f32_16x16x32_bf16 a[68:71], v[72:75], v[100:103], a[68:71]
    buffer_load_dwordx4 v19, s[8:11], s40 offen offset:2048 sc1 lds
    v_mfma_f32_16x16x32_bf16 a[72:75], v[72:75], v[104:107], a[72:75]
    ds_read_b64_tr_b16 v[138:139], v42 offset:34816
    v_mfma_f32_16x16x32_bf16 a[76:79], v[72:75], v[108:111], a[76:79]
    v_mfma_f32_16x16x32_bf16 a[80:83], v[72:75], v[112:115], a[80:83]
    ds_read_b128 v[172:175], v17 offset:35072
    v_mfma_f32_16x16x32_bf16 a[84:87], v[72:75], v[116:119], a[84:87]
    v_mfma_f32_16x16x32_bf16 a[88:91], v[72:75], v[120:123], a[88:91]
    ds_read_b64_tr_b16 v[140:141], v43 offset:32768
    v_mfma_f32_16x16x32_bf16 a[92:95], v[72:75], v[124:127], a[92:95]
    v_mfma_f32_16x16x32_bf16 a[96:99], v[76:79], v[96:99], a[96:99]
    buffer_load_dwordx4 v19, s[8:11], s40 offen offset:3072 sc1 lds
    s_add_u32 s40, s40, 2048
    v_mfma_f32_16x16x32_bf16 a[100:103], v[76:79], v[100:103], a[100:103]
    v_mfma_f32_16x16x32_bf16 a[104:107], v[76:79], v[104:107], a[104:107]
    ds_read_b64_tr_b16 v[142:143], v43 offset:34816
    v_mfma_f32_16x16x32_bf16 a[108:111], v[76:79], v[108:111], a[108:111]
    v_mfma_f32_16x16x32_bf16 a[112:115], v[76:79], v[112:115], a[112:115]
    ds_read_b128 v[176:179], v17 offset:36864
    s_waitcnt lgkmcnt(8)
    v_mfma_f32_16x16x32_bf16 a[116:119], v[76:79], v[116:119], a[116:119]
    v_mfma_f32_16x16x32_bf16 a[120:123], v[76:79], v[120:123], a[120:123]
    ds_read_b64_tr_b16 v[144:145], v44 offset:32768
    s_add_u32 m0, s48, 65536
    v_mfma_f32_16x16x32_bf16 a[124:127], v[76:79], v[124:127], a[124:127]
    buffer_load_dwordx4 v20, s[12:15], s41 offen offset:0 lds
    v_mfma_f32_16x16x32_bf16 a[128:131], v[80:83], v[96:99], a[128:131]
    ds_read_b64_tr_b16 v[146:147], v44 offset:34816
    v_mfma_f32_16x16x32_bf16 a[132:135], v[80:83], v[100:103], a[132:135]
    v_mfma_f32_16x16x32_bf16 a[136:139], v[80:83], v[104:107], a[136:139]
    ds_read_b128 v[180:183], v17 offset:37120
    v_mfma_f32_16x16x32_bf16 a[140:143], v[80:83], v[108:111], a[140:143]
    v_mfma_f32_16x16x32_bf16 a[144:147], v[80:83], v[112:115], a[144:147]
    ds_read_b64_tr_b16 v[148:149], v45 offset:32768
    v_mfma_f32_16x16x32_bf16 a[148:151], v[80:83], v[116:119], a[148:151]
    v_mfma_f32_16x16x32_bf16 a[152:155], v[80:83], v[120:123], a[152:155]
    buffer_load_dwordx4 v21, s[12:15], s41 offen offset:1024 lds
    v_mfma_f32_16x16x32_bf16 a[156:159], v[80:83], v[124:127], a[156:159]
    v_mfma_f32_16x16x32_bf16 a[160:163], v[84:87], v[96:99], a[160:163]
    ds_read_b64_tr_b16 v[150:151], v45 offset:34816
    v_mfma_f32_16x16x32_bf16 a[164:167], v[84:87], v[100:103], a[164:167]
    v_mfma_f32_16x16x32_bf16 a[168:171], v[84:87], v[104:107], a[168:171]
    ds_read_b128 v[184:187], v17 offset:38912
    v_mfma_f32_16x16x32_bf16 a[172:175], v[84:87], v[108:111], a[172:175]
    v_mfma_f32_16x16x32_bf16 a[176:179], v[84:87], v[112:115], a[176:179]
    ds_read_b64_tr_b16 v[152:153], v46 offset:32768
    v_mfma_f32_16x16x32_bf16 a[180:183], v[84:87], v[116:119], a[180:183]
    buffer_load_dwordx4 v22, s[12:15], s41 offen offset:2048 lds
    v_mfma_f32_16x16x32_bf16 a[184:187], v[84:87], v[120:123], a[184:187]
    ds_read_b64_tr_b16 v[154:155], v46 offset:34816
    v_mfma_f32_16x16x32_bf16 a[188:191], v[84:87], v[124:127], a[188:191]
    v_mfma_f32_16x16x32_bf16 a[192:195], v[88:91], v[96:99], a[192:195]
    ds_read_b128 v[188:191], v17 offset:39168
    v_mfma_f32_16x16x32_bf16 a[196:199], v[88:91], v[100:103], a[196:199]
    v_mfma_f32_16x16x32_bf16 a[200:203], v[88:91], v[104:107], a[200:203]
    ds_read_b64_tr_b16 v[156:157], v47 offset:32768
    v_mfma_f32_16x16x32_bf16 a[204:207], v[88:91], v[108:111], a[204:207]
    v_mfma_f32_16x16x32_bf16 a[208:211], v[88:91], v[112:115], a[208:211]
    buffer_load_dwordx4 v23, s[12:15], s41 offen offset:3072 lds
    s_add_u32 s41, s41, s45
    v_mfma_f32_16x16x32_bf16 a[212:215], v[88:91], v[116:119], a[212:215]
    v_mfma_f32_16x16x32_bf16 a[216:219], v[88:91], v[120:123], a[216:219]
    ds_read_b64_tr_b16 v[158:159], v47 offset:34816
    v_mfma_f32_16x16x32_bf16 a[220:223], v[88:91], v[124:127], a[220:223]
    v_mfma_f32_16x16x32_bf16 a[224:227], v[92:95], v[96:99], a[224:227]
    v_mfma_f32_16x16x32_bf16 a[228:231], v[92:95], v[100:103], a[228:231]
    v_mfma_f32_16x16x32_bf16 a[232:235], v[92:95], v[104:107], a[232:235]
    v_mfma_f32_16x16x32_bf16 a[236:239], v[92:95], v[108:111], a[236:239]
    v_mfma_f32_16x16x32_bf16 a[240:243], v[92:95], v[112:115], a[240:243]
    v_mfma_f32_16x16x32_bf16 a[244:247], v[92:95], v[116:119], a[244:247]
    v_mfma_f32_16x16x32_bf16 a[248:251], v[92:95], v[120:123], a[248:251]
    v_mfma_f32_16x16x32_bf16 a[252:255], v[92:95], v[124:127], a[252:255]
    s_waitcnt vmcnt(16) lgkmcnt(0)
    s_barrier
    s_cmp_lg_u32 s46, 0
    s_cbranch_scc1 Lw_nohook
    v_lshlrev_b32 v2, 2, v1
    v_mov_b32 v3, s93
    s_mov_b64 exec, s[94:95]
    buffer_atomic_add v3, v2, s[8:11], s92 offen sc1
    s_mov_b64 exec, -1
Lw_nohook:
    v_mfma_f32_16x16x32_bf16 a[0:3], v[128:131], v[160:163], a[0:3]
    ds_read_b128 v[96:99], v16 offset:0
    v_mfma_f32_16x16x32_bf16 a[4:7], v[128:131], v[164:167], a[4:7]
    v_mfma_f32_16x16x32_bf16 a[8:11], v[128:131], v[168:171], a[8:11]
    ds_read_b64_tr_b16 v[64:65], v32 offset:0
    s_add_u32 m0, s47, 98304
    v_mfma_f32_16x16x32_bf16 a[12:15], v[128:131], v[172:175], a[12:15]
    buffer_load_dwordx4 v18, s[8:11], s40 offen offset:0 sc1 lds
    v_mfma_f32_16x16x32_bf16 a[16:19], v[128:131], v[176:179], a[16:19]
    ds_read_b64_tr_b16 v[66:67], v32 offset:2048
    v_mfma_f32_16x16x32_bf16 a[20:23], v[128:131], v[180:183], a[20:23]
    v_mfma_f32_16x16x32_bf16 a[24:27], v[128:131], v[184:187], a[24:27]
    ds_read_b128 v[100:103], v16 offset:256
    v_mfma_f32_16x16x32_bf16 a[28:31], v[128:131], v[188:191], a[28:31]
    v_mfma_f32_16x16x32_bf16 a[32:35], v[132:135], v[160:163], a[32:35]
    ds_read_b64_tr_b16 v[68:69], v33 offset:0
    v_mfma_f32_16x16x32_bf16 a[36:39], v[132:135], v[164:167], a[36:39]
    v_mfma_f32_16x16x32_bf16 a[40:43], v[132:135], v[168:171], a[40:43]
    buffer_load_dwordx4 v18, s[8:11], s40 offen offset:1024 sc1 lds
    v_mfma_f32_16x16x32_bf16 a[44:47], v[132:135], v[172:175], a[44:47]
    v_mfma_f32_16x16x32_bf16 a[48:51], v[132:135], v[176:179], a[48:51]
    ds_read_b64_tr_b16 v[70:71], v33 offset:2048
    v_mfma_f32_16x16x32_bf16 a[52:55], v[132:135], v[180:183], a[52:55]
    v_mfma_f32_16x16x32_bf16 a[56:59], v[132:135], v[184:187], a[56:59]
    ds_read_b128 v[104:107], v16 offset:2048
    v_mfma_f32_16x16x32_bf16 a[60:63], v[132:135], v[188:191], a[60:63]
    v_mfma_f32_16x16x32_bf16 a[64:67], v[136:139], v[160:163], a[64:67]
    ds_read_b64_tr_b16 v[72:73], v34 offset:0
    v_mfma_f32_16x16x32_bf16 a[68:71], v[136:139], v[164:167], a[68:71]
    buffer_load_dwordx4 v19, s[8:11], s40 offen offset:2048 sc1 lds
    v_mfma_f32_16x16x32_bf16 a[72:75], v[136:139], v[168:171], a[72:75]
    ds_read_b64_tr_b16 v[74:75], v34 offset:2048
    v_mfma_f32_16x16x32_bf16 a[76:79], v[136:139], v[172:175], a[76:79]
    v_mfma_f32_16x16x32_bf16 a[80:83], v[136:139], v[176:179], a[80:83]
    ds_read_b128 v[108:111], v16 offset:2304
    v_mfma_f32_16x16x32_bf16 a[84:87], v[136:139], v[180:183], a[84:87]
    v_mfma_f32_16x16x32_bf16 a[88:91], v[136:139], v[184:187], a[88:91]
    ds_read_b64_tr_b16 v[76:77], v35 offset:0
    v_mfma_f32_16x16x32_bf16 a[92:95], v[136:139], v[188:191], a[92:95]
    v_mfma_f32_16x16x32_bf16 a[96:99], v[140:143], v[160:163], a[96:99]
    buffer_load_dwordx4 v19, s[8:11], s40 offen offset:3072 sc1 lds
    s_add_u32 s40, s40, 2048
    v_mfma_f32_16x16x32_bf16 a[100:103], v[140:143], v[164:167], a[100:103]
    v_mfma_f32_16x16x32_bf16 a[104:107], v[140:143], v[168:171], a[104:107]
    ds_read_b64_tr_b16 v[78:79], v35 offset:2048
    v_mfma_f32_16x16x32_bf16 a[108:111], v[140:143], v[172:175], a[108:111]
    v_mfma_f32_16x16x32_bf16 a[112:115], v[140:143], v[176:179], a[112:115]
    ds_read_b128 v[112:115], v16 offset:4096
    s_waitcnt lgkmcnt(8)
    v_mfma_f32_16x16x32_bf16 a[116:119], v[140:143], v[180:183], a[116:119]
    v_mfma_f32_16x16x32_bf16 a[120:123], v[140:143], v[184:187], a[120:123]
    ds_read_b64_tr_b16 v[80:81], v36 offset:0
    s_add_u32 m0, s48, 98304
    v_mfma_f32_16x16x32_bf16 a[124:127], v[140:143], v[188:191], a[124:127]
    buffer_load_dwordx4 v20, s[12:15], s41 offen offset:0 lds
    v_mfma_f32_16x16x32_bf16 a[128:131], v[144:147], v[160:163], a[128:131]
    ds_read_b64_tr_b16 v[82:83], v36 offset:2048
    v_mfma_f32_16x16x32_bf16 a[132:135], v[144:147], v[164:167], a[132:135]
    v_mfma_f32_16x16x32_bf16 a[136:139], v[144:147], v[168:171], a[136:139]
    ds_read_b128 v[116:119], v16 offset:4352
    v_mfma_f32_16x16x32_bf16 a[140:143], v[144:147], v[172:175], a[140:143]
    v_mfma_f32_16x16x32_bf16 a[144:147], v[144:147], v[176:179], a[144:147]
    ds_read_b64_tr_b16 v[84:85], v37 offset:0
    v_mfma_f32_16x16x32_bf16 a[148:151], v[144:147], v[180:183], a[148:151]
    v_mfma_f32_16x16x32_bf16 a[152:155], v[144:147], v[184:187], a[152:155]
    buffer_load_dwordx4 v21, s[12:15], s41 offen offset:1024 lds
    v_mfma_f32_16x16x32_bf16 a[156:159], v[144:147], v[188:191], a[156:159]
    v_mfma_f32_16x16x32_bf16 a[160:163], v[148:151], v[160:163], a[160:163]
    ds_read_b64_tr_b16 v[86:87], v37 offset:2048
    v_mfma_f32_16x16x32_bf16 a[164:167], v[148:151], v[164:167], a[164:167]
    v_mfma_f32_16x16x32_bf16 a[168:171], v[148:151], v[168:171], a[168:171]
    ds_read_b128 v[120:123], v16 offset:6144
    v_mfma_f32_16x16x32_bf16 a[172:175], v[148:151], v[172:175], a[172:175]
    v_mfma_f32_16x16x32_bf16 a[176:179], v[148:151], v[176:179], a[176:179]
    ds_read_b64_tr_b16 v[88:89], v38 offset:0
    v_mfma_f32_16x16x32_bf16 a[180:183], v[148:151], v[180:183], a[180:183]
    buffer_load_dwordx4 v22, s[12:15], s41 offen offset:2048 lds
    v_mfma_f32_16x16x32_bf16 a[184:187], v[148:151], v[184:187], a[184:187]
    ds_read_b64_tr_b16 v[90:91], v38 offset:2048
    v_mfma_f32_16x16x32_bf16 a[188:191], v[148:151], v[188:191], a[188:191]
    v_mfma_f32_16x16x32_bf16 a[192:195], v[152:155], v[160:163], a[192:195]
    ds_read_b128 v[124:127], v16 offset:6400
    v_mfma_f32_16x16x32_bf16 a[196:199], v[152:155], v[164:167], a[196:199]
    v_mfma_f32_16x16x32_bf16 a[200:203], v[152:155], v[168:171], a[200:203]
    ds_read_b64_tr_b16 v[92:93], v39 offset:0
    v_mfma_f32_16x16x32_bf16 a[204:207], v[152:155], v[172:175], a[204:207]
    v_mfma_f32_16x16x32_bf16 a[208:211], v[152:155], v[176:179], a[208:211]
    buffer_load_dwordx4 v23, s[12:15], s41 offen offset:3072 lds
    s_add_u32 s41, s41, s45
    v_mfma_f32_16x16x32_bf16 a[212:215], v[152:155], v[180:183], a[212:215]
    v_mfma_f32_16x16x32_bf16 a[216:219], v[152:155], v[184:187], a[216:219]
    ds_read_b64_tr_b16 v[94:95], v39 offset:2048
    v_mfma_f32_16x16x32_bf16 a[220:223], v[152:155], v[188:191], a[220:223]
    v_mfma_f32_16x16x32_bf16 a[224:227], v[156:159], v[160:163], a[224:227]
    v_mfma_f32_16x16x32_bf16 a[228:231], v[156:159], v[164:167], a[228:231]
    v_mfma_f32_16x16x32_bf16 a[232:235], v[156:159], v[168:171], a[232:235]
    v_mfma_f32_16x16x32_bf16 a[236:239], v[156:159], v[172:175], a[236:239]
    v_mfma_f32_16x16x32_bf16 a[240:243], v[156:159], v[176:179], a[240:243]
    v_mfma_f32_16x16x32_bf16 a[244:247], v[156:159], v[180:183], a[244:247]
    v_mfma_f32_16x16x32_bf16 a[248:251], v[156:159], v[184:187], a[248:251]
    v_mfma_f32_16x16x32_bf16 a[252:255], v[156:159], v[188:191], a[252:255]
    s_mov_b32 s44, 6
Lg_loop_w:
    s_waitcnt vmcnt(16) lgkmcnt(0)
    s_barrier
    s_sub_u32 s29, s44, 1
    s_lshl_b32 s29, s29, 9
    s_add_u32 s29, s29, s28
    s_mul_i32 s29, s29, 2816
    s_mov_b64 exec, 0x3fffff
    s_cmp_eq_u32 s82, 0
    s_cbranch_scc1 Lw_t2
    s_cmp_eq_u32 s82, 1
    s_cselect_b32 s4, s64, s70
    s_cselect_b32 s5, s65, s71
    s_mov_b32 s6, 0x800000
    buffer_load_dword v7, v9, s[4:7], s29 offen
Lw_t2:
    s_cmp_gt_u32 s82, 1
    s_cbranch_scc1 Lw_notouch
    s_cmp_eq_u32 s82, 0
    s_cselect_b32 s4, s72, s76
    s_cselect_b32 s5, s73, s77
    s_mov_b32 s6, 7340032
    buffer_load_dword v8, v9, s[4:7], s29 offen
Lw_notouch:
    s_mov_b64 exec, -1
    v_mfma_f32_16x16x32_bf16 a[0:3], v[64:67], v[96:99], a[0:3]
    ds_read_b128 v[160:163], v16 offset:32768
    v_mfma_f32_16x16x32_bf16 a[4:7], v[64:67], v[100:103], a[4:7]
    v_mfma_f32_16x16x32_bf16 a[8:11], v[64:67], v[104:107], a[8:11]
    ds_read_b64_tr_b16 v[128:129], v32 offset:32768
    s_add_u32 m0, s47, 0
    v_mfma_f32_16x16x32_bf16 a[12:15], v[64:67], v[108:111], a[12:15]
    buffer_load_dwordx4 v18, s[8:11], s40 offen offset:0 sc1 lds
    v_mfma_f32_16x16x32_bf16 a[16:19], v[64:67], v[112:115], a[16:19]
    ds_read_b64_tr_b16 v[130:131], v32 offset:34816
    v_mfma_f32_16x16x32_bf16 a[20:23], v[64:67], v[116:119], a[20:23]
    v_mfma_f32_16x16x32_bf16 a[24:27], v[64:67], v[120:123], a[24:27]
    ds_read_b128 v[164:167], v16 offset:33024
    v_mfma_f32_16x16x32_bf16 a[28:31], v[64:67], v[124:127], a[28:31]
    v_mfma_f32_16x16x32_bf16 a[32:35], v[68:71], v[96:99], a[32:35]
    ds_read_b64_tr_b16 v[132:133], v33 offset:32768
    v_mfma_f32_16x16x32_bf16 a[36:39], v[68:71], v[100:103], a[36:39]
    v_mfma_f32_16x16x32_bf16 a[40:43], v[68:71], v[104:107], a[40:43]
    buffer_load_dwordx4 v18, s[8:11], s40 offen offset:1024 sc1 lds
    v_mfma_f32_16x16x32_bf16 a[44:47], v[68:71], v[108:111], a[44:47]
    v_mfma_f32_16x16x32_bf16 a[48:51], v[68:71], v[112:115], a[48:51]
    ds_read_b64_tr_b16 v[134:135], v33 offset:34816
    v_mfma_f32_16x16x32_bf16 a[52:55], v[68:71], v[116:119], a[52:55]
    v_mfma_f32_16x16x32_bf16 a[56:59], v[68:71], v[120:123], a[56:59]
    ds_read_b128 v[168:171], v16 offset:34816
    v_mfma_f32_16x16x32_bf16 a[60:63], v[68:71], v[124:127], a[60:63]
    v_mfma_f32_16x16x32_bf16 a[64:67], v[72:75], v[96:99], a[64:67]
    ds_read_b64_tr_b16 v[136:137], v34 offset:32768
    v_mfma_f32_16x16x32_bf16 a[68:71], v[72:75], v[100:103], a[68:71]
    buffer_load_dwordx4 v19, s[8:11], s40 offen offset:2048 sc1 lds
    v_mfma_f32_16x16x32_bf16 a[72:75], v[72:75], v[104:107], a[72:75]
    ds_read_b64_tr_b16 v[138:139], v34 offset:34816
    v_mfma_f32_16x16x32_bf16 a[76:79], v[72:75], v[108:111], a[76:79]
    v_mfma_f32_16x16x32_bf16 a[80:83], v[72:75], v[112:115], a[80:83]
    ds_read_b128 v[172:175], v16 offset:35072
    v_mfma_f32_16x16x32_bf16 a[84:87], v[72:75], v[116:119], a[84:87]
    v_mfma_f32_16x16x32_bf16 a[88:91], v[72:75], v[120:123], a[88:91]
    ds_read_b64_tr_b16 v[140:141], v35 offset:32768
    v_mfma_f32_16x16x32_bf16 a[92:95], v[72:75], v[124:127], a[92:95]
    v_mfma_f32_16x16x32_bf16 a[96:99], v[76:79], v[96:99], a[96:99]
    buffer_load_dwordx4 v19, s[8:11], s40 offen offset:3072 sc1 lds
    s_add_u32 s40, s40, 2048
    v_mfma_f32_16x16x32_bf16 a[100:103], v[76:79], v[100:103], a[100:103]
    v_mfma_f32_16x16x32_bf16 a[104:107], v[76:79], v[104:107], a[104:107]
    ds_read_b64_tr_b16 v[142:143], v35 offset:34816
    v_mfma_f32_16x16x32_bf16 a[108:111], v[76:79], v[108:111], a[108:111]
    v_mfma_f32_16x16x32_bf16 a[112:115], v[76:79], v[112:115], a[112:115]
    ds_read_b128 v[176:179], v16 offset:36864
    s_waitcnt lgkmcnt(8)
    v_mfma_f32_16x16x32_bf16 a[116:119], v[76:79], v[116:119], a[116:119]
    v_mfma_f32_16x16x32_bf16 a[120:123], v[76:79], v[120:123], a[120:123]
    ds_read_b64_tr_b16 v[144:145], v36 offset:32768
    s_add_u32 m0, s48, 0
    v_mfma_f32_16x16x32_bf16 a[124:127], v[76:79], v[124:127], a[124:127]
    buffer_load_dwordx4 v20, s[12:15], s41 offen offset:0 lds
    v_mfma_f32_16x16x32_bf16 a[128:131], v[80:83], v[96:99], a[128:131]
    ds_read_b64_tr_b16 v[146:147], v36 offset:34816
    v_mfma_f32_16x16x32_bf16 a[132:135], v[80:83], v[100:103], a[132:135]
    v_mfma_f32_16x16x32_bf16 a[136:139], v[80:83], v[104:107], a[136:139]
    ds_read_b128 v[180:183], v16 offset:37120
    v_mfma_f32_16x16x32_bf16 a[140:143], v[80:83], v[108:111], a[140:143]
    v_mfma_f32_16x16x32_bf16 a[144:147], v[80:83], v[112:115], a[144:147]
    ds_read_b64_tr_b16 v[148:149], v37 offset:32768
    v_mfma_f32_16x16x32_bf16 a[148:151], v[80:83], v[116:119], a[148:151]
    v_mfma_f32_16x16x32_bf16 a[152:155], v[80:83], v[120:123], a[152:155]
    buffer_load_dwordx4 v21, s[12:15], s41 offen offset:1024 lds
    v_mfma_f32_16x16x32_bf16 a[156:159], v[80:83], v[124:127], a[156:159]
    v_mfma_f32_16x16x32_bf16 a[160:163], v[84:87], v[96:99], a[160:163]
    ds_read_b64_tr_b16 v[150:151], v37 offset:34816
    v_mfma_f32_16x16x32_bf16 a[164:167], v[84:87], v[100:103], a[164:167]
    v_mfma_f32_16x16x32_bf16 a[168:171], v[84:87], v[104:107], a[168:171]
    ds_read_b128 v[184:187], v16 offset:38912
    v_mfma_f32_16x16x32_bf16 a[172:175], v[84:87], v[108:111], a[172:175]
    v_mfma_f32_16x16x32_bf16 a[176:179], v[84:87], v[112:115], a[176:179]
    ds_read_b64_tr_b16 v[152:153], v38 offset:32768
    v_mfma_f32_16x16x32_bf16 a[180:183], v[84:87], v[116:119], a[180:183]
    buffer_load_dwordx4 v22, s[12:15], s41 offen offset:2048 lds
    v_mfma_f32_16x16x32_bf16 a[184:187], v[84:87], v[120:123], a[184:187]
    ds_read_b64_tr_b16 v[154:155], v38 offset:34816
    v_mfma_f32_16x16x32_bf16 a[188:191], v[84:87], v[124:127], a[188:191]
    v_mfma_f32_16x16x32_bf16 a[192:195], v[88:91], v[96:99], a[192:195]
    ds_read_b128 v[188:191], v16 offset:39168
    v_mfma_f32_16x16x32_bf16 a[196:199], v[88:91], v[100:103], a[196:199]
    v_mfma_f32_16x16x32_bf16 a[200:203], v[88:91], v[104:107], a[200:203]
    ds_read_b64_tr_b16 v[156:157], v39 offset:32768
    v_mfma_f32_16x16x32_bf16 a[204:207], v[88:91], v[108:111], a[204:207]
    v_mfma_f32_16x16x32_bf16 a[208:211], v[88:91], v[112:115], a[208:211]
    buffer_load_dwordx4 v23, s[12:15], s41 offen offset:3072 lds
    s_add_u32 s41, s41, s45
    v_mfma_f32_16x16x32_bf16 a[212:215], v[88:91], v[116:119], a[212:215]
    v_mfma_f32_16x16x32_bf16 a[216:219], v[88:91], v[120:123], a[216:219]
    ds_read_b64_tr_b16 v[158:159], v39 offset:34816
    v_mfma_f32_16x16x32_bf16 a[220:223], v[88:91], v[124:127], a[220:223]
    v_mfma_f32_16x16x32_bf16 a[224:227], v[92:95], v[96:99], a[224:227]
    v_mfma_f32_16x16x32_bf16 a[228:231], v[92:95], v[100:103], a[228:231]
    v_mfma_f32_16x16x32_bf16 a[232:235], v[92:95], v[104:107], a[232:235]
    v_mfma_f32_16x16x32_bf16 a[236:239], v[92:95], v[108:111], a[236:239]
    v_mfma_f32_16x16x32_bf16 a[240:243], v[92:95], v[112:115], a[240:243]
    v_mfma_f32_16x16x32_bf16 a[244:247], v[92:95], v[116:119], a[244:247]
    v_mfma_f32_16x16x32_bf16 a[248:251], v[92:95], v[120:123], a[248:251]
    v_mfma_f32_16x16x32_bf16 a[252:255], v[92:95], v[124:127], a[252:255]
    s_waitcnt vmcnt(16) lgkmcnt(0)
    s_barrier
    v_mfma_f32_16x16x32_bf16 a[0:3], v[128:131], v[160:163], a[0:3]
    ds_read_b128 v[96:99], v17 offset:0
    v_mfma_f32_16x16x32_bf16 a[4:7], v[128:131], v[164:167], a[4:7]
    v_mfma_f32_16x16x32_bf16 a[8:11], v[128:131], v[168:171], a[8:11]
    ds_read_b64_tr_b16 v[64:65], v40 offset:0
    s_add_u32 m0, s47, 32768
    v_mfma_f32_16x16x32_bf16 a[12:15], v[128:131], v[172:175], a[12:15]
    buffer_load_dwordx4 v18, s[8:11], s40 offen offset:0 sc1 lds
    v_mfma_f32_16x16x32_bf16 a[16:19], v[128:131], v[176:179], a[16:19]
    ds_read_b64_tr_b16 v[66:67], v40 offset:2048
    v_mfma_f32_16x16x32_bf16 a[20:23], v[128:131], v[180:183], a[20:23]
    v_mfma_f32_16x16x32_bf16 a[24:27], v[128:131], v[184:187], a[24:27]
    ds_read_b128 v[100:103], v17 offset:256
    v_mfma_f32_16x16x32_bf16 a[28:31], v[128:131], v[188:191], a[28:31]
    v_mfma_f32_16x16x32_bf16 a[32:35], v[132:135], v[160:163], a[32:35]
    ds_read_b64_tr_b16 v[68:69], v41 offset:0
    v_mfma_f32_16x16x32_bf16 a[36:39], v[132:135], v[164:167], a[36:39]
    v_mfma_f32_16x16x32_bf16 a[40:43], v[132:135], v[168:171], a[40:43]
    buffer_load_dwordx4 v18, s[8:11], s40 offen offset:1024 sc1 lds
    v_mfma_f32_16x16x32_bf16 a[44:47], v[132:135], v[172:175], a[44:47]
    v_mfma_f32_16x16x32_bf16 a[48:51], v[132:135], v[176:179], a[48:51]
    ds_read_b64_tr_b16 v[70:71], v41 offset:2048
    v_mfma_f32_16x16x32_bf16 a[52:55], v[132:135], v[180:183], a[52:55]
    v_mfma_f32_16x16x32_bf16 a[56:59], v[132:135], v[184:187], a[56:59]
    ds_read_b128 v[104:107], v17 offset:2048
    v_mfma_f32_16x16x32_bf16 a[60:63], v[132:135], v[188:191], a[60:63]
    v_mfma_f32_16x16x32_bf16 a[64:67], v[136:139], v[160:163], a[64:67]
    ds_read_b64_tr_b16 v[72:73], v42 offset:0
    v_mfma_f32_16x16x32_bf16 a[68:71], v[136:139], v[164:167], a[68:71]
    buffer_load_dwordx4 v19, s[8:11], s40 offen offset:2048 sc1 lds
    v_mfma_f32_16x16x32_bf16 a[72:75], v[136:139], v[168:171], a[72:75]
    ds_read_b64_tr_b16 v[74:75], v42 offset:2048
    v_mfma_f32_16x16x32_bf16 a[76:79], v[136:139], v[172:175], a[76:79]
    v_mfma_f32_16x16x32_bf16 a[80:83], v[136:139], v[176:179], a[80:83]
    ds_read_b128 v[108:111], v17 offset:2304
    v_mfma_f32_16x16x32_bf16 a[84:87], v[136:139], v[180:183], a[84:87]
    v_mfma_f32_16x16x32_bf16 a[88:91], v[136:139], v[184:187], a[88:91]
    ds_read_b64_tr_b16 v[76:77], v43 offset:0
    v_mfma_f32_16x16x32_bf16 a[92:95], v[136:139], v[188:191], a[92:95]
    v_mfma_f32_16x16x32_bf16 a[96:99], v[140:143], v[160:163], a[96:99]
    buffer_load_dwordx4 v19, s[8:11], s40 offen offset:3072 sc1 lds
    s_add_u32 s40, s40, 2048
    v_mfma_f32_16x16x32_bf16 a[100:103], v[140:143], v[164:167], a[100:103]
    v_mfma_f32_16x16x32_bf16 a[104:107], v[140:143], v[168:171], a[104:107]
    ds_read_b64_tr_b16 v[78:79], v43 offset:2048
    v_mfma_f32_16x16x32_bf16 a[108:111], v[140:143], v[172:175], a[108:111]
    v_mfma_f32_16x16x32_bf16 a[112:115], v[140:143], v[176:179], a[112:115]
    ds_read_b128 v[112:115], v17 offset:4096
    s_waitcnt lgkmcnt(8)
    v_mfma_f32_16x16x32_bf16 a[116:119], v[140:143], v[180:183], a[116:119]
    v_mfma_f32_16x16x32_bf16 a[120:123], v[140:143], v[184:187], a[120:123]
    ds_read_b64_tr_b16 v[80:81], v44 offset:0
    s_add_u32 m0, s48, 32768
    v_mfma_f32_16x16x32_bf16 a[124:127], v[140:143], v[188:191], a[124:127]
    buffer_load_dwordx4 v20, s[12:15], s41 offen offset:0 lds
    v_mfma_f32_16x16x32_bf16 a[128:131], v[144:147], v[160:163], a[128:131]
    ds_read_b64_tr_b16 v[82:83], v44 offset:2048
    v_mfma_f32_16x16x32_bf16 a[132:135], v[144:147], v[164:167], a[132:135]
    v_mfma_f32_16x16x32_bf16 a[136:139], v[144:147], v[168:171], a[136:139]
    ds_read_b128 v[116:119], v17 offset:4352
    v_mfma_f32_16x16x32_bf16 a[140:143], v[144:147], v[172:175], a[140:143]
    v_mfma_f32_16x16x32_bf16 a[144:147], v[144:147], v[176:179], a[144:147]
    ds_read_b64_tr_b16 v[84:85], v45 offset:0
    v_mfma_f32_16x16x32_bf16 a[148:151], v[144:147], v[180:183], a[148:151]
    v_mfma_f32_16x16x32_bf16 a[152:155], v[144:147], v[184:187], a[152:155]
    buffer_load_dwordx4 v21, s[12:15], s41 offen offset:1024 lds
    v_mfma_f32_16x16x32_bf16 a[156:159], v[144:147], v[188:191], a[156:159]
    v_mfma_f32_16x16x32_bf16 a[160:163], v[148:151], v[160:163], a[160:163]
    ds_read_b64_tr_b16 v[86:87], v45 offset:2048
    v_mfma_f32_16x16x32_bf16 a[164:167], v[148:151], v[164:167], a[164:167]
    v_mfma_f32_16x16x32_bf16 a[168:171], v[148:151], v[168:171], a[168:171]
    ds_read_b128 v[120:123], v17 offset:6144
    v_mfma_f32_16x16x32_bf16 a[172:175], v[148:151], v[172:175], a[172:175]
    v_mfma_f32_16x16x32_bf16 a[176:179], v[148:151], v[176:179], a[176:179]
    ds_read_b64_tr_b16 v[88:89], v46 offset:0
    v_mfma_f32_16x16x32_bf16 a[180:183], v[148:151], v[180:183], a[180:183]
    buffer_load_dwordx4 v22, s[12:15], s41 offen offset:2048 lds
    v_mfma_f32_16x16x32_bf16 a[184:187], v[148:151], v[184:187], a[184:187]
    ds_read_b64_tr_b16 v[90:91], v46 offset:2048
    v_mfma_f32_16x16x32_bf16 a[188:191], v[148:151], v[188:191], a[188:191]
    v_mfma_f32_16x16x32_bf16 a[192:195], v[152:155], v[160:163], a[192:195]
    ds_read_b128 v[124:127], v17 offset:6400
    v_mfma_f32_16x16x32_bf16 a[196:199], v[152:155], v[164:167], a[196:199]
    v_mfma_f32_16x16x32_bf16 a[200:203], v[152:155], v[168:171], a[200:203]
    ds_read_b64_tr_b16 v[92:93], v47 offset:0
    v_mfma_f32_16x16x32_bf16 a[204:207], v[152:155], v[172:175], a[204:207]
    v_mfma_f32_16x16x32_bf16 a[208:211], v[152:155], v[176:179], a[208:211]
    buffer_load_dwordx4 v23, s[12:15], s41 offen offset:3072 lds
    s_add_u32 s41, s41, s45
    v_mfma_f32_16x16x32_bf16 a[212:215], v[152:155], v[180:183], a[212:215]
    v_mfma_f32_16x16x32_bf16 a[216:219], v[152:155], v[184:187], a[216:219]
    ds_read_b64_tr_b16 v[94:95], v47 offset:2048
    v_mfma_f32_16x16x32_bf16 a[220:223], v[152:155], v[188:191], a[220:223]
    v_mfma_f32_16x16x32_bf16 a[224:227], v[156:159], v[160:163], a[224:227]
    v_mfma_f32_16x16x32_bf16 a[228:231], v[156:159], v[164:167], a[228:231]
    v_mfma_f32_16x16x32_bf16 a[232:235], v[156:159], v[168:171], a[232:235]
    v_mfma_f32_16x16x32_bf16 a[236:239], v[156:159], v[172:175], a[236:239]
    v_mfma_f32_16x16x32_bf16 a[240:243], v[156:159], v[176:179], a[240:243]
    v_mfma_f32_16x16x32_bf16 a[244:247], v[156:159], v[180:183], a[244:247]
    v_mfma_f32_16x16x32_bf16 a[248:251], v[156:159], v[184:187], a[248:251]
    v_mfma_f32_16x16x32_bf16 a[252:255], v[156:159], v[188:191], a[252:255]
    s_waitcnt vmcnt(16) lgkmcnt(0)
    s_barrier
    v_mfma_f32_16x16x32_bf16 a[0:3], v[64:67], v[96:99], a[0:3]
    ds_read_b128 v[160:163], v17 offset:32768
    v_mfma_f32_16x16x32_bf16 a[4:7], v[64:67], v[100:103], a[4:7]
    v_mfma_f32_16x16x32_bf16 a[8:11], v[64:67], v[104:107], a[8:11]
    ds_read_b64_tr_b16 v[128:129], v40 offset:32768
    s_add_u32 m0, s47, 65536
    v_mfma_f32_16x16x32_bf16 a[12:15], v[64:67], v[108:111], a[12:15]
    buffer_load_dwordx4 v18, s[8:11], s40 offen offset:0 sc1 lds
    v_mfma_f32_16x16x32_bf16 a[16:19], v[64:67], v[112:115], a[16:19]
    ds_read_b64_tr_b16 v[130:131], v40 offset:34816
    v_mfma_f32_16x16x32_bf16 a[20:23], v[64:67], v[116:119], a[20:23]
    v_mfma_f32_16x16x32_bf16 a[24:27], v[64:67], v[120:123], a[24:27]
    ds_read_b128 v[164:167], v17 offset:33024
    v_mfma_f32_16x16x32_bf16 a[28:31], v[64:67], v[124:127], a[28:31]
    v_mfma_f32_16x16x32_bf16 a[32:35], v[68:71], v[96:99], a[32:35]
    ds_read_b64_tr_b16 v[132:133], v41 offset:32768
    v_mfma_f32_16x16x32_bf16 a[36:39], v[68:71], v[100:103], a[36:39]
    v_mfma_f32_16x16x32_bf16 a[40:43], v[68:71], v[104:107], a[40:43]
    buffer_load_dwordx4 v18, s[8:11], s40 offen offset:1024 sc1 lds
    v_mfma_f32_16x16x32_bf16 a[44:47], v[68:71], v[108:111], a[44:47]
    v_mfma_f32_16x16x32_bf16 a[48:51], v[68:71], v[112:115], a[48:51]
    ds_read_b64_tr_b16 v[134:135], v41 offset:34816
    v_mfma_f32_16x16x32_bf16 a[52:55], v[68:71], v[116:119], a[52:55]
    v_mfma_f32_16x16x32_bf16 a[56:59], v[68:71], v[120:123], a[56:59]
    ds_read_b128 v[168:171], v17 offset:34816
    v_mfma_f32_16x16x32_bf16 a[60:63], v[68:71], v[124:127], a[60:63]
    v_mfma_f32_16x16x32_bf16 a[64:67], v[72:75], v[96:99], a[64:67]
    ds_read_b64_tr_b16 v[136:137], v42 offset:32768
    v_mfma_f32_16x16x32_bf16 a[68:71], v[72:75], v[100:103], a[68:71]
    buffer_load_dwordx4 v19, s[8:11], s40 offen offset:2048 sc1 lds
    v_mfma_f32_16x16x32_bf16 a[72:75], v[72:75], v[104:107], a[72:75]
    ds_read_b64_tr_b16 v[138:139], v42 offset:34816
    v_mfma_f32_16x16x32_bf16 a[76:79], v[72:75], v[108:111], a[76:79]
    v_mfma_f32_16x16x32_bf16 a[80:83], v[72:75], v[112:115], a[80:83]
    ds_read_b128 v[172:175], v17 offset:35072
    v_mfma_f32_16x16x32_bf16 a[84:87], v[72:75], v[116:119], a[84:87]
    v_mfma_f32_16x16x32_bf16 a[88:91], v[72:75], v[120:123], a[88:91]
    ds_read_b64_tr_b16 v[140:141], v43 offset:32768
    v_mfma_f32_16x16x32_bf16 a[92:95], v[72:75], v[124:127], a[92:95]
    v_mfma_f32_16x16x32_bf16 a[96:99], v[76:79], v[96:99], a[96:99]
    buffer_load_dwordx4 v19, s[8:11], s40 offen offset:3072 sc1 lds
    s_add_u32 s40, s40, 2048
    v_mfma_f32_16x16x32_bf16 a[100:103], v[76:79], v[100:103], a[100:103]
    v_mfma_f32_16x16x32_bf16 a[104:107], v[76:79], v[104:107], a[104:107]
    ds_read_b64_tr_b16 v[142:143], v43 offset:34816
    v_mfma_f32_16x16x32_bf16 a[108:111], v[76:79], v[108:111], a[108:111]
    v_mfma_f32_16x16x32_bf16 a[112:115], v[76:79], v[112:115], a[112:115]
    ds_read_b128 v[176:179], v17 offset:36864
    s_waitcnt lgkmcnt(8)
    v_mfma_f32_16x16x32_bf16 a[116:119], v[76:79], v[116:119], a[116:119]
    v_mfma_f32_16x16x32_bf16 a[120:123], v[76:79], v[120:123], a[120:123]
    ds_read_b64_tr_b16 v[144:145], v44 offset:32768
    s_add_u32 m0, s48, 65536
    v_mfma_f32_16x16x32_bf16 a[124:127], v[76:79], v[124:127], a[124:127]
    buffer_load_dwordx4 v20, s[12:15], s41 offen offset:0 lds
    v_mfma_f32_16x16x32_bf16 a[128:131], v[80:83], v[96:99], a[128:131]
    ds_read_b64_tr_b16 v[146:147], v44 offset:34816
    v_mfma_f32_16x16x32_bf16 a[132:135], v[80:83], v[100:103], a[132:135]
    v_mfma_f32_16x16x32_bf16 a[136:139], v[80:83], v[104:107], a[136:139]
    ds_read_b128 v[180:183], v17 offset:37120
    v_mfma_f32_16x16x32_bf16 a[140:143], v[80:83], v[108:111], a[140:143]
    v_mfma_f32_16x16x32_bf16 a[144:147], v[80:83], v[112:115], a[144:147]
    ds_read_b64_tr_b16 v[148:149], v45 offset:32768
    v_mfma_f32_16x16x32_bf16 a[148:151], v[80:83], v[116:119], a[148:151]
    v_mfma_f32_16x16x32_bf16 a[152:155], v[80:83], v[120:123], a[152:155]
    buffer_load_dwordx4 v21, s[12:15], s41 offen offset:1024 lds
    v_mfma_f32_16x16x32_bf16 a[156:159], v[80:83], v[124:127], a[156:159]
    v_mfma_f32_16x16x32_bf16 a[160:163], v[84:87], v[96:99], a[160:163]
    ds_read_b64_tr_b16 v[150:151], v45 offset:34816
    v_mfma_f32_16x16x32_bf16 a[164:167], v[84:87], v[100:103], a[164:167]
    v_mfma_f32_16x16x32_bf16 a[168:171], v[84:87], v[104:107], a[168:171]
    ds_read_b128 v[184:187], v17 offset:38912
    v_mfma_f32_16x16x32_bf16 a[172:175], v[84:87], v[108:111], a[172:175]
    v_mfma_f32_16x16x32_bf16 a[176:179], v[84:87], v[112:115], a[176:179]
    ds_read_b64_tr_b16 v[152:153], v46 offset:32768
    v_mfma_f32_16x16x32_bf16 a[180:183], v[84:87], v[116:119], a[180:183]
    buffer_load_dwordx4 v22, s[12:15], s41 offen offset:2048 lds
    v_mfma_f32_16x16x32_bf16 a[184:187], v[84:87], v[120:123], a[184:187]
    ds_read_b64_tr_b16 v[154:155], v46 offset:34816
    v_mfma_f32_16x16x32_bf16 a[188:191], v[84:87], v[124:127], a[188:191]
    v_mfma_f32_16x16x32_bf16 a[192:195], v[88:91], v[96:99], a[192:195]
    ds_read_b128 v[188:191], v17 offset:39168
    v_mfma_f32_16x16x32_bf16 a[196:199], v[88:91], v[100:103], a[196:199]
    v_mfma_f32_16x16x32_bf16 a[200:203], v[88:91], v[104:107], a[200:203]
    ds_read_b64_tr_b16 v[156:157], v47 offset:32768
    v_mfma_f32_16x16x32_bf16 a[204:207], v[88:91], v[108:111], a[204:207]
    v_mfma_f32_16x16x32_bf16 a[208:211], v[88:91], v[112:115], a[208:211]
    buffer_load_dwordx4 v23, s[12:15], s41 offen offset:3072 lds
    s_add_u32 s41, s41, s45
    v_mfma_f32_16x16x32_bf16 a[212:215], v[88:91], v[116:119], a[212:215]
    v_mfma_f32_16x16x32_bf16 a[216:219], v[88:91], v[120:123], a[216:219]
    ds_read_b64_tr_b16 v[158:159], v47 offset:34816
    v_mfma_f32_16x16x32_bf16 a[220:223], v[88:91], v[124:127], a[220:223]
    v_mfma_f32_16x16x32_bf16 a[224:227], v[92:95], v[96:99], a[224:227]
    v_mfma_f32_16x16x32_bf16 a[228:231], v[92:95], v[100:103], a[228:231]
    v_mfma_f32_16x16x32_bf16 a[232:235], v[92:95], v[104:107], a[232:235]
    v_mfma_f32_16x16x32_bf16 a[236:239], v[92:95], v[108:111], a[236:239]
    v_mfma_f32_16x16x32_bf16 a[240:243], v[92:95], v[112:115], a[240:243]
    v_mfma_f32_16x16x32_bf16 a[244:247], v[92:95], v[116:119], a[244:247]
    v_mfma_f32_16x16x32_bf16 a[248:251], v[92:95], v[120:123], a[248:251]
    v_mfma_f32_16x16x32_bf16 a[252:255], v[92:95], v[124:127], a[252:255]
    s_waitcnt vmcnt(16) lgkmcnt(0)
    s_barrier
    v_mfma_f32_16x16x32_bf16 a[0:3], v[128:131], v[160:163], a[0:3]
    ds_read_b128 v[96:99], v16 offset:0
    v_mfma_f32_16x16x32_bf16 a[4:7], v[128:131], v[164:167], a[4:7]
    v_mfma_f32_16x16x32_bf16 a[8:11], v[128:131], v[168:171], a[8:11]
    ds_read_b64_tr_b16 v[64:65], v32 offset:0
    s_add_u32 m0, s47, 98304
    v_mfma_f32_16x16x32_bf16 a[12:15], v[128:131], v[172:175], a[12:15]
    buffer_load_dwordx4 v18, s[8:11], s40 offen offset:0 sc1 lds
    v_mfma_f32_16x16x32_bf16 a[16:19], v[128:131], v[176:179], a[16:19]
    ds_read_b64_tr_b16 v[66:67], v32 offset:2048
    v_mfma_f32_16x16x32_bf16 a[20:23], v[128:131], v[180:183], a[20:23]
    v_mfma_f32_16x16x32_bf16 a[24:27], v[128:131], v[184:187], a[24:27]
    ds_read_b128 v[100:103], v16 offset:256
    v_mfma_f32_16x16x32_bf16 a[28:31], v[128:131], v[188:191], a[28:31]
    v_mfma_f32_16x16x32_bf16 a[32:35], v[132:135], v[160:163], a[32:35]
    ds_read_b64_tr_b16 v[68:69], v33 offset:0
    v_mfma_f32_16x16x32_bf16 a[36:39], v[132:135], v[164:167], a[36:39]
    v_mfma_f32_16x16x32_bf16 a[40:43], v[132:135], v[168:171], a[40:43]
    buffer_load_dwordx4 v18, s[8:11], s40 offen offset:1024 sc1 lds
    v_mfma_f32_16x16x32_bf16 a[44:47], v[132:135], v[172:175], a[44:47]
    v_mfma_f32_16x16x32_bf16 a[48:51], v[132:135], v[176:179], a[48:51]
    ds_read_b64_tr_b16 v[70:71], v33 offset:2048
    v_mfma_f32_16x16x32_bf16 a[52:55], v[132:135], v[180:183], a[52:55]
    v_mfma_f32_16x16x32_bf16 a[56:59], v[132:135], v[184:187], a[56:59]
    ds_read_b128 v[104:107], v16 offset:2048
    v_mfma_f32_16x16x32_bf16 a[60:63], v[132:135], v[188:191], a[60:63]
    v_mfma_f32_16x16x32_bf16 a[64:67], v[136:139], v[160:163], a[64:67]
    ds_read_b64_tr_b16 v[72:73], v34 offset:0
    v_mfma_f32_16x16x32_bf16 a[68:71], v[136:139], v[164:167], a[68:71]
    buffer_load_dwordx4 v19, s[8:11], s40 offen offset:2048 sc1 lds
    v_mfma_f32_16x16x32_bf16 a[72:75], v[136:139], v[168:171], a[72:75]
    ds_read_b64_tr_b16 v[74:75], v34 offset:2048
    v_mfma_f32_16x16x32_bf16 a[76:79], v[136:139], v[172:175], a[76:79]
    v_mfma_f32_16x16x32_bf16 a[80:83], v[136:139], v[176:179], a[80:83]
    ds_read_b128 v[108:111], v16 offset:2304
    v_mfma_f32_16x16x32_bf16 a[84:87], v[136:139], v[180:183], a[84:87]
    v_mfma_f32_16x16x32_bf16 a[88:91], v[136:139], v[184:187], a[88:91]
    ds_read_b64_tr_b16 v[76:77], v35 offset:0
    v_mfma_f32_16x16x32_bf16 a[92:95], v[136:139], v[188:191], a[92:95]
    v_mfma_f32_16x16x32_bf16 a[96:99], v[140:143], v[160:163], a[96:99]
    buffer_load_dwordx4 v19, s[8:11], s40 offen offset:3072 sc1 lds
    s_add_u32 s40, s40, 2048
    v_mfma_f32_16x16x32_bf16 a[100:103], v[140:143], v[164:167], a[100:103]
    v_mfma_f32_16x16x32_bf16 a[104:107], v[140:143], v[168:171], a[104:107]
    ds_read_b64_tr_b16 v[78:79], v35 offset:2048
    v_mfma_f32_16x16x32_bf16 a[108:111], v[140:143], v[172:175], a[108:111]
    v_mfma_f32_16x16x32_bf16 a[112:115], v[140:143], v[176:179], a[112:115]
    ds_read_b128 v[112:115], v16 offset:4096
    s_waitcnt lgkmcnt(8)
    v_mfma_f32_16x16x32_bf16 a[116:119], v[140:143], v[180:183], a[116:119]
    v_mfma_f32_16x16x32_bf16 a[120:123], v[140:143], v[184:187], a[120:123]
    ds_read_b64_tr_b16 v[80:81], v36 offset:0
    s_add_u32 m0, s48, 98304
    v_mfma_f32_16x16x32_bf16 a[124:127], v[140:143], v[188:191], a[124:127]
    buffer_load_dwordx4 v20, s[12:15], s41 offen offset:0 lds
    v_mfma_f32_16x16x32_bf16 a[128:131], v[144:147], v[160:163], a[128:131]
    ds_read_b64_tr_b16 v[82:83], v36 offset:2048
    v_mfma_f32_16x16x32_bf16 a[132:135], v[144:147], v[164:167], a[132:135]
    v_mfma_f32_16x16x32_bf16 a[136:139], v[144:147], v[168:171], a[136:139]
    ds_read_b128 v[116:119], v16 offset:4352
    v_mfma_f32_16x16x32_bf16 a[140:143], v[144:147], v[172:175], a[140:143]
    v_mfma_f32_16x16x32_bf16 a[144:147], v[144:147], v[176:179], a[144:147]
    ds_read_b64_tr_b16 v[84:85], v37 offset:0
    v_mfma_f32_16x16x32_bf16 a[148:151], v[144:147], v[180:183], a[148:151]
    v_mfma_f32_16x16x32_bf16 a[152:155], v[144:147], v[184:187], a[152:155]
    buffer_load_dwordx4 v21, s[12:15], s41 offen offset:1024 lds
    v_mfma_f32_16x16x32_bf16 a[156:159], v[144:147], v[188:191], a[156:159]
    v_mfma_f32_16x16x32_bf16 a[160:163], v[148:151], v[160:163], a[160:163]
    ds_read_b64_tr_b16 v[86:87], v37 offset:2048
    v_mfma_f32_16x16x32_bf16 a[164:167], v[148:151], v[164:167], a[164:167]
    v_mfma_f32_16x16x32_bf16 a[168:171], v[148:151], v[168:171], a[168:171]
    ds_read_b128 v[120:123], v16 offset:6144
    v_mfma_f32_16x16x32_bf16 a[172:175], v[148:151], v[172:175], a[172:175]
    v_mfma_f32_16x16x32_bf16 a[176:179], v[148:151], v[176:179], a[176:179]
    ds_read_b64_tr_b16 v[88:89], v38 offset:0
    v_mfma_f32_16x16x32_bf16 a[180:183], v[148:151], v[180:183], a[180:183]
    buffer_load_dwordx4 v22, s[12:15], s41 offen offset:2048 lds
    v_mfma_f32_16x16x32_bf16 a[184:187], v[148:151], v[184:187], a[184:187]
    ds_read_b64_tr_b16 v[90:91], v38 offset:2048
    v_mfma_f32_16x16x32_bf16 a[188:191], v[148:151], v[188:191], a[188:191]
    v_mfma_f32_16x16x32_bf16 a[192:195], v[152:155], v[160:163], a[192:195]
    ds_read_b128 v[124:127], v16 offset:6400
    v_mfma_f32_16x16x32_bf16 a[196:199], v[152:155], v[164:167], a[196:199]
    v_mfma_f32_16x16x32_bf16 a[200:203], v[152:155], v[168:171], a[200:203]
    ds_read_b64_tr_b16 v[92:93], v39 offset:0
    v_mfma_f32_16x16x32_bf16 a[204:207], v[152:155], v[172:175], a[204:207]
    v_mfma_f32_16x16x32_bf16 a[208:211], v[152:155], v[176:179], a[208:211]
    buffer_load_dwordx4 v23, s[12:15], s41 offen offset:3072 lds
    s_add_u32 s41, s41, s45
    v_mfma_f32_16x16x32_bf16 a[212:215], v[152:155], v[180:183], a[212:215]
    v_mfma_f32_16x16x32_bf16 a[216:219], v[152:155], v[184:187], a[216:219]
    ds_read_b64_tr_b16 v[94:95], v39 offset:2048
    v_mfma_f32_16x16x32_bf16 a[220:223], v[152:155], v[188:191], a[220:223]
    v_mfma_f32_16x16x32_bf16 a[224:227], v[156:159], v[160:163], a[224:227]
    v_mfma_f32_16x16x32_bf16 a[228:231], v[156:159], v[164:167], a[228:231]
    v_mfma_f32_16x16x32_bf16 a[232:235], v[156:159], v[168:171], a[232:235]
    v_mfma_f32_16x16x32_bf16 a[236:239], v[156:159], v[172:175], a[236:239]
    v_mfma_f32_16x16x32_bf16 a[240:243], v[156:159], v[176:179], a[240:243]
    v_mfma_f32_16x16x32_bf16 a[244:247], v[156:159], v[180:183], a[244:247]
    v_mfma_f32_16x16x32_bf16 a[248:251], v[156:159], v[184:187], a[248:251]
    v_mfma_f32_16x16x32_bf16 a[252:255], v[156:159], v[188:191], a[252:255]
    s_sub_u32 s44, s44, 1
    s_cmp_lg_u32 s44, 0
    s_cbranch_scc1 Lg_loop_w
    s_waitcnt vmcnt(16) lgkmcnt(0)
    s_barrier
    v_mfma_f32_16x16x32_bf16 a[0:3], v[64:67], v[96:99], a[0:3]
    ds_read_b128 v[160:163], v16 offset:32768
    v_mfma_f32_16x16x32_bf16 a[4:7], v[64:67], v[100:103], a[4:7]
    v_mfma_f32_16x16x32_bf16 a[8:11], v[64:67], v[104:107], a[8:11]
    ds_read_b64_tr_b16 v[128:129], v32 offset:32768
    v_mfma_f32_16x16x32_bf16 a[12:15], v[64:67], v[108:111], a[12:15]
    v_mfma_f32_16x16x32_bf16 a[16:19], v[64:67], v[112:115], a[16:19]
    ds_read_b64_tr_b16 v[130:131], v32 offset:34816
    v_mfma_f32_16x16x32_bf16 a[20:23], v[64:67], v[116:119], a[20:23]
    v_mfma_f32_16x16x32_bf16 a[24:27], v[64:67], v[120:123], a[24:27]
    ds_read_b128 v[164:167], v16 offset:33024
    v_mfma_f32_16x16x32_bf16 a[28:31], v[64:67], v[124:127], a[28:31]
    v_mfma_f32_16x16x32_bf16 a[32:35], v[68:71], v[96:99], a[32:35]
    ds_read_b64_tr_b16 v[132:133], v33 offset:32768
    v_mfma_f32_16x16x32_bf16 a[36:39], v[68:71], v[100:103], a[36:39]
    v_mfma_f32_16x16x32_bf16 a[40:43], v[68:71], v[104:107], a[40:43]
    ds_read_b64_tr_b16 v[134:135], v33 offset:34816
    v_mfma_f32_16x16x32_bf16 a[44:47], v[68:71], v[108:111], a[44:47]
    v_mfma_f32_16x16x32_bf16 a[48:51], v[68:71], v[112:115], a[48:51]
    ds_read_b128 v[168:171], v16 offset:34816
    v_mfma_f32_16x16x32_bf16 a[52:55], v[68:71], v[116:119], a[52:55]
    v_mfma_f32_16x16x32_bf16 a[56:59], v[68:71], v[120:123], a[56:59]
    ds_read_b64_tr_b16 v[136:137], v34 offset:32768
    v_mfma_f32_16x16x32_bf16 a[60:63], v[68:71], v[124:127], a[60:63]
    v_mfma_f32_16x16x32_bf16 a[64:67], v[72:75], v[96:99], a[64:67]
    ds_read_b64_tr_b16 v[138:139], v34 offset:34816
    v_mfma_f32_16x16x32_bf16 a[68:71], v[72:75], v[100:103], a[68:71]
    v_mfma_f32_16x16x32_bf16 a[72:75], v[72:75], v[104:107], a[72:75]
    ds_read_b128 v[172:175], v16 offset:35072
    v_mfma_f32_16x16x32_bf16 a[76:79], v[72:75], v[108:111], a[76:79]
    v_mfma_f32_16x16x32_bf16 a[80:83], v[72:75], v[112:115], a[80:83]
    ds_read_b64_tr_b16 v[140:141], v35 offset:32768
    v_mfma_f32_16x16x32_bf16 a[84:87], v[72:75], v[116:119], a[84:87]
    v_mfma_f32_16x16x32_bf16 a[88:91], v[72:75], v[120:123], a[88:91]
    ds_read_b64_tr_b16 v[142:143], v35 offset:34816
    v_mfma_f32_16x16x32_bf16 a[92:95], v[72:75], v[124:127], a[92:95]
    v_mfma_f32_16x16x32_bf16 a[96:99], v[76:79], v[96:99], a[96:99]
    ds_read_b128 v[176:179], v16 offset:36864
    s_waitcnt lgkmcnt(8)
    v_mfma_f32_16x16x32_bf16 a[100:103], v[76:79], v[100:103], a[100:103]
    v_mfma_f32_16x16x32_bf16 a[104:107], v[76:79], v[104:107], a[104:107]
    ds_read_b64_tr_b16 v[144:145], v36 offset:32768
    v_mfma_f32_16x16x32_bf16 a[108:111], v[76:79], v[108:111], a[108:111]
    v_mfma_f32_16x16x32_bf16 a[112:115], v[76:79], v[112:115], a[112:115]
    ds_read_b64_tr_b16 v[146:147], v36 offset:34816
    v_mfma_f32_16x16x32_bf16 a[116:119], v[76:79], v[116:119], a[116:119]
    v_mfma_f32_16x16x32_bf16 a[120:123], v[76:79], v[120:123], a[120:123]
    ds_read_b128 v[180:183], v16 offset:37120
    v_mfma_f32_16x16x32_bf16 a[124:127], v[76:79], v[124:127], a[124:127]
    v_mfma_f32_16x16x32_bf16 a[128:131], v[80:83], v[96:99], a[128:131]
    ds_read_b64_tr_b16 v[148:149], v37 offset:32768
    v_mfma_f32_16x16x32_bf16 a[132:135], v[80:83], v[100:103], a[132:135]
    v_mfma_f32_16x16x32_bf16 a[136:139], v[80:83], v[104:107], a[136:139]
    ds_read_b64_tr_b16 v[150:151], v37 offset:34816
    v_mfma_f32_16x16x32_bf16 a[140:143], v[80:83], v[108:111], a[140:143]
    v_mfma_f32_16x16x32_bf16 a[144:147], v[80:83], v[112:115], a[144:147]
    ds_read_b128 v[184:187], v16 offset:38912
    v_mfma_f32_16x16x32_bf16 a[148:151], v[80:83], v[116:119], a[148:151]
    v_mfma_f32_16x16x32_bf16 a[152:155], v[80:83], v[120:123], a[152:155]
    ds_read_b64_tr_b16 v[152:153], v38 offset:32768
    v_mfma_f32_16x16x32_bf16 a[156:159], v[80:83], v[124:127], a[156:159]
    v_mfma_f32_16x16x32_bf16 a[160:163], v[84:87], v[96:99], a[160:163]
    ds_read_b64_tr_b16 v[154:155], v38 offset:34816
    v_mfma_f32_16x16x32_bf16 a[164:167], v[84:87], v[100:103], a[164:167]
    v_mfma_f32_16x16x32_bf16 a[168:171], v[84:87], v[104:107], a[168:171]
    ds_read_b128 v[188:191], v16 offset:39168
    v_mfma_f32_16x16x32_bf16 a[172:175], v[84:87], v[108:111], a[172:175]
    v_mfma_f32_16x16x32_bf16 a[176:179], v[84:87], v[112:115], a[176:179]
    ds_read_b64_tr_b16 v[156:157], v39 offset:32768
    v_mfma_f32_16x16x32_bf16 a[180:183], v[84:87], v[116:119], a[180:183]
    v_mfma_f32_16x16x32_bf16 a[184:187], v[84:87], v[120:123], a[184:187]
    ds_read_b64_tr_b16 v[158:159], v39 offset:34816
    v_mfma_f32_16x16x32_bf16 a[188:191], v[84:87], v[124:127], a[188:191]
    v_mfma_f32_16x16x32_bf16 a[192:195], v[88:91], v[96:99], a[192:195]
    v_mfma_f32_16x16x32_bf16 a[196:199], v[88:91], v[100:103], a[196:199]
    v_mfma_f32_16x16x32_bf16 a[200:203], v[88:91], v[104:107], a[200:203]
    v_mfma_f32_16x16x32_bf16 a[204:207], v[88:91], v[108:111], a[204:207]
    v_mfma_f32_16x16x32_bf16 a[208:211], v[88:91], v[112:115], a[208:211]
    v_mfma_f32_16x16x32_bf16 a[212:215], v[88:91], v[116:119], a[212:215]
    v_mfma_f32_16x16x32_bf16 a[216:219], v[88:91], v[120:123], a[216:219]
    v_mfma_f32_16x16x32_bf16 a[220:223], v[88:91], v[124:127], a[220:223]
    v_mfma_f32_16x16x32_bf16 a[224:227], v[92:95], v[96:99], a[224:227]
    v_mfma_f32_16x16x32_bf16 a[228:231], v[92:95], v[100:103], a[228:231]
    v_mfma_f32_16x16x32_bf16 a[232:235], v[92:95], v[104:107], a[232:235]
    v_mfma_f32_16x16x32_bf16 a[236:239], v[92:95], v[108:111], a[236:239]
    v_mfma_f32_16x16x32_bf16 a[240:243], v[92:95], v[112:115], a[240:243]
    v_mfma_f32_16x16x32_bf16 a[244:247], v[92:95], v[116:119], a[244:247]
    v_mfma_f32_16x16x32_bf16 a[248:251], v[92:95], v[120:123], a[248:251]
    v_mfma_f32_16x16x32_bf16 a[252:255], v[92:95], v[124:127], a[252:255]
    s_waitcnt vmcnt(8) lgkmcnt(0)
    s_barrier
    v_mfma_f32_16x16x32_bf16 a[0:3], v[128:131], v[160:163], a[0:3]
    ds_read_b128 v[96:99], v17 offset:0
    v_mfma_f32_16x16x32_bf16 a[4:7], v[128:131], v[164:167], a[4:7]
    v_mfma_f32_16x16x32_bf16 a[8:11], v[128:131], v[168:171], a[8:11]
    ds_read_b64_tr_b16 v[64:65], v40 offset:0
    v_mfma_f32_16x16x32_bf16 a[12:15], v[128:131], v[172:175], a[12:15]
    v_mfma_f32_16x16x32_bf16 a[16:19], v[128:131], v[176:179], a[16:19]
    ds_read_b64_tr_b16 v[66:67], v40 offset:2048
    v_mfma_f32_16x16x32_bf16 a[20:23], v[128:131], v[180:183], a[20:23]
    v_mfma_f32_16x16x32_bf16 a[24:27], v[128:131], v[184:187], a[24:27]
    ds_read_b128 v[100:103], v17 offset:256
    v_mfma_f32_16x16x32_bf16 a[28:31], v[128:131], v[188:191], a[28:31]
    v_mfma_f32_16x16x32_bf16 a[32:35], v[132:135], v[160:163], a[32:35]
    ds_read_b64_tr_b16 v[68:69], v41 offset:0
    v_mfma_f32_16x16x32_bf16 a[36:39], v[132:135], v[164:167], a[36:39]
    v_mfma_f32_16x16x32_bf16 a[40:43], v[132:135], v[168:171], a[40:43]
    ds_read_b64_tr_b16 v[70:71], v41 offset:2048
    v_mfma_f32_16x16x32_bf16 a[44:47], v[132:135], v[172:175], a[44:47]
    v_mfma_f32_16x16x32_bf16 a[48:51], v[132:135], v[176:179], a[48:51]
    ds_read_b128 v[104:107], v17 offset:2048
    v_mfma_f32_16x16x32_bf16 a[52:55], v[132:135], v[180:183], a[52:55]
    v_mfma_f32_16x16x32_bf16 a[56:59], v[132:135], v[184:187], a[56:59]
    ds_read_b64_tr_b16 v[72:73], v42 offset:0
    v_mfma_f32_16x16x32_bf16 a[60:63], v[132:135], v[188:191], a[60:63]
    v_mfma_f32_16x16x32_bf16 a[64:67], v[136:139], v[160:163], a[64:67]
    ds_read_b64_tr_b16 v[74:75], v42 offset:2048
    v_mfma_f32_16x16x32_bf16 a[68:71], v[136:139], v[164:167], a[68:71]
    v_mfma_f32_16x16x32_bf16 a[72:75], v[136:139], v[168:171], a[72:75]
    ds_read_b128 v[108:111], v17 offset:2304
    v_mfma_f32_16x16x32_bf16 a[76:79], v[136:139], v[172:175], a[76:79]
    v_mfma_f32_16x16x32_bf16 a[80:83], v[136:139], v[176:179], a[80:83]
    ds_read_b64_tr_b16 v[76:77], v43 offset:0
    v_mfma_f32_16x16x32_bf16 a[84:87], v[136:139], v[180:183], a[84:87]
    v_mfma_f32_16x16x32_bf16 a[88:91], v[136:139], v[184:187], a[88:91]
    ds_read_b64_tr_b16 v[78:79], v43 offset:2048
    v_mfma_f32_16x16x32_bf16 a[92:95], v[136:139], v[188:191], a[92:95]
    v_mfma_f32_16x16x32_bf16 a[96:99], v[140:143], v[160:163], a[96:99]
    ds_read_b128 v[112:115], v17 offset:4096
    s_waitcnt lgkmcnt(8)
    v_mfma_f32_16x16x32_bf16 a[100:103], v[140:143], v[164:167], a[100:103]
    v_mfma_f32_16x16x32_bf16 a[104:107], v[140:143], v[168:171], a[104:107]
    ds_read_b64_tr_b16 v[80:81], v44 offset:0
    v_mfma_f32_16x16x32_bf16 a[108:111], v[140:143], v[172:175], a[108:111]
    v_mfma_f32_16x16x32_bf16 a[112:115], v[140:143], v[176:179], a[112:115]
    ds_read_b64_tr_b16 v[82:83], v44 offset:2048
    v_mfma_f32_16x16x32_bf16 a[116:119], v[140:143], v[180:183], a[116:119]
    v_mfma_f32_16x16x32_bf16 a[120:123], v[140:143], v[184:187], a[120:123]
    ds_read_b128 v[116:119], v17 offset:4352
    v_mfma_f32_16x16x32_bf16 a[124:127], v[140:143], v[188:191], a[124:127]
    v_mfma_f32_16x16x32_bf16 a[128:131], v[144:147], v[160:163], a[128:131]
    ds_read_b64_tr_b16 v[84:85], v45 offset:0
    v_mfma_f32_16x16x32_bf16 a[132:135], v[144:147], v[164:167], a[132:135]
    v_mfma_f32_16x16x32_bf16 a[136:139], v[144:147], v[168:171], a[136:139]
    ds_read_b64_tr_b16 v[86:87], v45 offset:2048
    v_mfma_f32_16x16x32_bf16 a[140:143], v[144:147], v[172:175], a[140:143]
    v_mfma_f32_16x16x32_bf16 a[144:147], v[144:147], v[176:179], a[144:147]
    ds_read_b128 v[120:123], v17 offset:6144
    v_mfma_f32_16x16x32_bf16 a[148:151], v[144:147], v[180:183], a[148:151]
    v_mfma_f32_16x16x32_bf16 a[152:155], v[144:147], v[184:187], a[152:155]
    ds_read_b64_tr_b16 v[88:89], v46 offset:0
    v_mfma_f32_16x16x32_bf16 a[156:159], v[144:147], v[188:191], a[156:159]
    v_mfma_f32_16x16x32_bf16 a[160:163], v[148:151], v[160:163], a[160:163]
    ds_read_b64_tr_b16 v[90:91], v46 offset:2048
    v_mfma_f32_16x16x32_bf16 a[164:167], v[148:151], v[164:167], a[164:167]
    v_mfma_f32_16x16x32_bf16 a[168:171], v[148:151], v[168:171], a[168:171]
    ds_read_b128 v[124:127], v17 offset:6400
    v_mfma_f32_16x16x32_bf16 a[172:175], v[148:151], v[172:175], a[172:175]
    v_mfma_f32_16x16x32_bf16 a[176:179], v[148:151], v[176:179], a[176:179]
    ds_read_b64_tr_b16 v[92:93], v47 offset:0
    v_mfma_f32_16x16x32_bf16 a[180:183], v[148:151], v[180:183], a[180:183]
    v_mfma_f32_16x16x32_bf16 a[184:187], v[148:151], v[184:187], a[184:187]
    ds_read_b64_tr_b16 v[94:95], v47 offset:2048
    v_mfma_f32_16x16x32_bf16 a[188:191], v[148:151], v[188:191], a[188:191]
    v_mfma_f32_16x16x32_bf16 a[192:195], v[152:155], v[160:163], a[192:195]
    v_mfma_f32_16x16x32_bf16 a[196:199], v[152:155], v[164:167], a[196:199]
    v_mfma_f32_16x16x32_bf16 a[200:203], v[152:155], v[168:171], a[200:203]
    v_mfma_f32_16x16x32_bf16 a[204:207], v[152:155], v[172:175], a[204:207]
    v_mfma_f32_16x16x32_bf16 a[208:211], v[152:155], v[176:179], a[208:211]
    v_mfma_f32_16x16x32_bf16 a[212:215], v[152:155], v[180:183], a[212:215]
    v_mfma_f32_16x16x32_bf16 a[216:219], v[152:155], v[184:187], a[216:219]
    v_mfma_f32_16x16x32_bf16 a[220:223], v[152:155], v[188:191], a[220:223]
    v_mfma_f32_16x16x32_bf16 a[224:227], v[156:159], v[160:163], a[224:227]
    v_mfma_f32_16x16x32_bf16 a[228:231], v[156:159], v[164:167], a[228:231]
    v_mfma_f32_16x16x32_bf16 a[232:235], v[156:159], v[168:171], a[232:235]
    v_mfma_f32_16x16x32_bf16 a[236:239], v[156:159], v[172:175], a[236:239]
    v_mfma_f32_16x16x32_bf16 a[240:243], v[156:159], v[176:179], a[240:243]
    v_mfma_f32_16x16x32_bf16 a[244:247], v[156:159], v[180:183], a[244:247]
    v_mfma_f32_16x16x32_bf16 a[248:251], v[156:159], v[184:187], a[248:251]
    v_mfma_f32_16x16x32_bf16 a[252:255], v[156:159], v[188:191], a[252:255]
    s_waitcnt vmcnt(0) lgkmcnt(0)
    s_barrier
    v_mfma_f32_16x16x32_bf16 a[0:3], v[64:67], v[96:99], a[0:3]
    ds_read_b128 v[160:163], v17 offset:32768
    v_mfma_f32_16x16x32_bf16 a[4:7], v[64:67], v[100:103], a[4:7]
    v_mfma_f32_16x16x32_bf16 a[8:11], v[64:67], v[104:107], a[8:11]
    ds_read_b64_tr_b16 v[128:129], v40 offset:32768
    v_mfma_f32_16x16x32_bf16 a[12:15], v[64:67], v[108:111], a[12:15]
    v_mfma_f32_16x16x32_bf16 a[16:19], v[64:67], v[112:115], a[16:19]
    ds_read_b64_tr_b16 v[130:131], v40 offset:34816
    v_mfma_f32_16x16x32_bf16 a[20:23], v[64:67], v[116:119], a[20:23]
    v_mfma_f32_16x16x32_bf16 a[24:27], v[64:67], v[120:123], a[24:27]
    ds_read_b128 v[164:167], v17 offset:33024
    v_mfma_f32_16x16x32_bf16 a[28:31], v[64:67], v[124:127], a[28:31]
    v_mfma_f32_16x16x32_bf16 a[32:35], v[68:71], v[96:99], a[32:35]
    ds_read_b64_tr_b16 v[132:133], v41 offset:32768
    v_mfma_f32_16x16x32_bf16 a[36:39], v[68:71], v[100:103], a[36:39]
    v_mfma_f32_16x16x32_bf16 a[40:43], v[68:71], v[104:107], a[40:43]
    ds_read_b64_tr_b16 v[134:135], v41 offset:34816
    v_mfma_f32_16x16x32_bf16 a[44:47], v[68:71], v[108:111], a[44:47]
    v_mfma_f32_16x16x32_bf16 a[48:51], v[68:71], v[112:115], a[48:51]
    ds_read_b128 v[168:171], v17 offset:34816
    v_mfma_f32_16x16x32_bf16 a[52:55], v[68:71], v[116:119], a[52:55]
    v_mfma_f32_16x16x32_bf16 a[56:59], v[68:71], v[120:123], a[56:59]
    ds_read_b64_tr_b16 v[136:137], v42 offset:32768
    v_mfma_f32_16x16x32_bf16 a[60:63], v[68:71], v[124:127], a[60:63]
    v_mfma_f32_16x16x32_bf16 a[64:67], v[72:75], v[96:99], a[64:67]
    ds_read_b64_tr_b16 v[138:139], v42 offset:34816
    v_mfma_f32_16x16x32_bf16 a[68:71], v[72:75], v[100:103], a[68:71]
    v_mfma_f32_16x16x32_bf16 a[72:75], v[72:75], v[104:107], a[72:75]
    ds_read_b128 v[172:175], v17 offset:35072
    v_mfma_f32_16x16x32_bf16 a[76:79], v[72:75], v[108:111], a[76:79]
    v_mfma_f32_16x16x32_bf16 a[80:83], v[72:75], v[112:115], a[80:83]
    ds_read_b64_tr_b16 v[140:141], v43 offset:32768
    v_mfma_f32_16x16x32_bf16 a[84:87], v[72:75], v[116:119], a[84:87]
    v_mfma_f32_16x16x32_bf16 a[88:91], v[72:75], v[120:123], a[88:91]
    ds_read_b64_tr_b16 v[142:143], v43 offset:34816
    v_mfma_f32_16x16x32_bf16 a[92:95], v[72:75], v[124:127], a[92:95]
    v_mfma_f32_16x16x32_bf16 a[96:99], v[76:79], v[96:99], a[96:99]
    ds_read_b128 v[176:179], v17 offset:36864
    s_waitcnt lgkmcnt(8)
    v_mfma_f32_16x16x32_bf16 a[100:103], v[76:79], v[100:103], a[100:103]
    v_mfma_f32_16x16x32_bf16 a[104:107], v[76:79], v[104:107], a[104:107]
    ds_read_b64_tr_b16 v[144:145], v44 offset:32768
    v_mfma_f32_16x16x32_bf16 a[108:111], v[76:79], v[108:111], a[108:111]
    v_mfma_f32_16x16x32_bf16 a[112:115], v[76:79], v[112:115], a[112:115]
    ds_read_b64_tr_b16 v[146:147], v44 offset:34816
    v_mfma_f32_16x16x32_bf16 a[116:119], v[76:79], v[116:119], a[116:119]
    v_mfma_f32_16x16x32_bf16 a[120:123], v[76:79], v[120:123], a[120:123]
    ds_read_b128 v[180:183], v17 offset:37120
    v_mfma_f32_16x16x32_bf16 a[124:127], v[76:79], v[124:127], a[124:127]
    v_mfma_f32_16x16x32_bf16 a[128:131], v[80:83], v[96:99], a[128:131]
    ds_read_b64_tr_b16 v[148:149], v45 offset:32768
    v_mfma_f32_16x16x32_bf16 a[132:135], v[80:83], v[100:103], a[132:135]
    v_mfma_f32_16x16x32_bf16 a[136:139], v[80:83], v[104:107], a[136:139]
    ds_read_b64_tr_b16 v[150:151], v45 offset:34816
    v_mfma_f32_16x16x32_bf16 a[140:143], v[80:83], v[108:111], a[140:143]
    v_mfma_f32_16x16x32_bf16 a[144:147], v[80:83], v[112:115], a[144:147]
    ds_read_b128 v[184:187], v17 offset:38912
    v_mfma_f32_16x16x32_bf16 a[148:151], v[80:83], v[116:119], a[148:151]
    v_mfma_f32_16x16x32_bf16 a[152:155], v[80:83], v[120:123], a[152:155]
    ds_read_b64_tr_b16 v[152:153], v46 offset:32768
    v_mfma_f32_16x16x32_bf16 a[156:159], v[80:83], v[124:127], a[156:159]
    v_mfma_f32_16x16x32_bf16 a[160:163], v[84:87], v[96:99], a[160:163]
    ds_read_b64_tr_b16 v[154:155], v46 offset:34816
    v_mfma_f32_16x16x32_bf16 a[164:167], v[84:87], v[100:103], a[164:167]
    v_mfma_f32_16x16x32_bf16 a[168:171], v[84:87], v[104:107], a[168:171]
    ds_read_b128 v[188:191], v17 offset:39168
    v_mfma_f32_16x16x32_bf16 a[172:175], v[84:87], v[108:111], a[172:175]
    v_mfma_f32_16x16x32_bf16 a[176:179], v[84:87], v[112:115], a[176:179]
    ds_read_b64_tr_b16 v[156:157], v47 offset:32768
    v_mfma_f32_16x16x32_bf16 a[180:183], v[84:87], v[116:119], a[180:183]
    v_mfma_f32_16x16x32_bf16 a[184:187], v[84:87], v[120:123], a[184:187]
    ds_read_b64_tr_b16 v[158:159], v47 offset:34816
    v_mfma_f32_16x16x32_bf16 a[188:191], v[84:87], v[124:127], a[188:191]
    v_mfma_f32_16x16x32_bf16 a[192:195], v[88:91], v[96:99], a[192:195]
    v_mfma_f32_16x16x32_bf16 a[196:199], v[88:91], v[100:103], a[196:199]
    v_mfma_f32_16x16x32_bf16 a[200:203], v[88:91], v[104:107], a[200:203]
    v_mfma_f32_16x16x32_bf16 a[204:207], v[88:91], v[108:111], a[204:207]
    v_mfma_f32_16x16x32_bf16 a[208:211], v[88:91], v[112:115], a[208:211]
    v_mfma_f32_16x16x32_bf16 a[212:215], v[88:91], v[116:119], a[212:215]
    v_mfma_f32_16x16x32_bf16 a[216:219], v[88:91], v[120:123], a[216:219]
    v_mfma_f32_16x16x32_bf16 a[220:223], v[88:91], v[124:127], a[220:223]
    v_mfma_f32_16x16x32_bf16 a[224:227], v[92:95], v[96:99], a[224:227]
    v_mfma_f32_16x16x32_bf16 a[228:231], v[92:95], v[100:103], a[228:231]
    v_mfma_f32_16x16x32_bf16 a[232:235], v[92:95], v[104:107], a[232:235]
    v_mfma_f32_16x16x32_bf16 a[236:239], v[92:95], v[108:111], a[236:239]
    v_mfma_f32_16x16x32_bf16 a[240:243], v[92:95], v[112:115], a[240:243]
    v_mfma_f32_16x16x32_bf16 a[244:247], v[92:95], v[116:119], a[244:247]
    v_mfma_f32_16x16x32_bf16 a[248:251], v[92:95], v[120:123], a[248:251]
    v_mfma_f32_16x16x32_bf16 a[252:255], v[92:95], v[124:127], a[252:255]
    s_waitcnt lgkmcnt(0)
    s_barrier
    v_mfma_f32_16x16x32_bf16 a[0:3], v[128:131], v[160:163], a[0:3]
    v_mfma_f32_16x16x32_bf16 a[4:7], v[128:131], v[164:167], a[4:7]
    v_mfma_f32_16x16x32_bf16 a[8:11], v[128:131], v[168:171], a[8:11]
    v_mfma_f32_16x16x32_bf16 a[12:15], v[128:131], v[172:175], a[12:15]
    v_mfma_f32_16x16x32_bf16 a[16:19], v[128:131], v[176:179], a[16:19]
    v_mfma_f32_16x16x32_bf16 a[20:23], v[128:131], v[180:183], a[20:23]
    v_mfma_f32_16x16x32_bf16 a[24:27], v[128:131], v[184:187], a[24:27]
    v_mfma_f32_16x16x32_bf16 a[28:31], v[128:131], v[188:191], a[28:31]
    v_mfma_f32_16x16x32_bf16 a[32:35], v[132:135], v[160:163], a[32:35]
    v_mfma_f32_16x16x32_bf16 a[36:39], v[132:135], v[164:167], a[36:39]
    v_mfma_f32_16x16x32_bf16 a[40:43], v[132:135], v[168:171], a[40:43]
    v_mfma_f32_16x16x32_bf16 a[44:47], v[132:135], v[172:175], a[44:47]
    v_mfma_f32_16x16x32_bf16 a[48:51], v[132:135], v[176:179], a[48:51]
    v_mfma_f32_16x16x32_bf16 a[52:55], v[132:135], v[180:183], a[52:55]
    v_mfma_f32_16x16x32_bf16 a[56:59], v[132:135], v[184:187], a[56:59]
    v_mfma_f32_16x16x32_bf16 a[60:63], v[132:135], v[188:191], a[60:63]
    v_mfma_f32_16x16x32_bf16 a[64:67], v[136:139], v[160:163], a[64:67]
    v_mfma_f32_16x16x32_bf16 a[68:71], v[136:139], v[164:167], a[68:71]
    v_mfma_f32_16x16x32_bf16 a[72:75], v[136:139], v[168:171], a[72:75]
    v_mfma_f32_16x16x32_bf16 a[76:79], v[136:139], v[172:175], a[76:79]
    v_mfma_f32_16x16x32_bf16 a[80:83], v[136:139], v[176:179], a[80:83]
    v_mfma_f32_16x16x32_bf16 a[84:87], v[136:139], v[180:183], a[84:87]
    v_mfma_f32_16x16x32_bf16 a[88:91], v[136:139], v[184:187], a[88:91]
    v_mfma_f32_16x16x32_bf16 a[92:95], v[136:139], v[188:191], a[92:95]
    v_mfma_f32_16x16x32_bf16 a[96:99], v[140:143], v[160:163], a[96:99]
    v_mfma_f32_16x16x32_bf16 a[100:103], v[140:143], v[164:167], a[100:103]
    v_mfma_f32_16x16x32_bf16 a[104:107], v[140:143], v[168:171], a[104:107]
    v_mfma_f32_16x16x32_bf16 a[108:111], v[140:143], v[172:175], a[108:111]
    v_mfma_f32_16x16x32_bf16 a[112:115], v[140:143], v[176:179], a[112:115]
    v_mfma_f32_16x16x32_bf16 a[116:119], v[140:143], v[180:183], a[116:119]
    v_mfma_f32_16x16x32_bf16 a[120:123], v[140:143], v[184:187], a[120:123]
    v_mfma_f32_16x16x32_bf16 a[124:127], v[140:143], v[188:191], a[124:127]
    v_mfma_f32_16x16x32_bf16 a[128:131], v[144:147], v[160:163], a[128:131]
    v_mfma_f32_16x16x32_bf16 a[132:135], v[144:147], v[164:167], a[132:135]
    v_mfma_f32_16x16x32_bf16 a[136:139], v[144:147], v[168:171], a[136:139]
    v_mfma_f32_16x16x32_bf16 a[140:143], v[144:147], v[172:175], a[140:143]
    v_mfma_f32_16x16x32_bf16 a[144:147], v[144:147], v[176:179], a[144:147]
    v_mfma_f32_16x16x32_bf16 a[148:151], v[144:147], v[180:183], a[148:151]
    v_mfma_f32_16x16x32_bf16 a[152:155], v[144:147], v[184:187], a[152:155]
    v_mfma_f32_16x16x32_bf16 a[156:159], v[144:147], v[188:191], a[156:159]
    v_mfma_f32_16x16x32_bf16 a[160:163], v[148:151], v[160:163], a[160:163]
    v_mfma_f32_16x16x32_bf16 a[164:167], v[148:151], v[164:167], a[164:167]
    v_mfma_f32_16x16x32_bf16 a[168:171], v[148:151], v[168:171], a[168:171]
    v_mfma_f32_16x16x32_bf16 a[172:175], v[148:151], v[172:175], a[172:175]
    v_mfma_f32_16x16x32_bf16 a[176:179], v[148:151], v[176:179], a[176:179]
    v_mfma_f32_16x16x32_bf16 a[180:183], v[148:151], v[180:183], a[180:183]
    v_mfma_f32_16x16x32_bf16 a[184:187], v[148:151], v[184:187], a[184:187]
    v_mfma_f32_16x16x32_bf16 a[188:191], v[148:151], v[188:191], a[188:191]
    v_mfma_f32_16x16x32_bf16 a[192:195], v[152:155], v[160:163], a[192:195]
    v_mfma_f32_16x16x32_bf16 a[196:199], v[152:155], v[164:167], a[196:199]
    v_mfma_f32_16x16x32_bf16 a[200:203], v[152:155], v[168:171], a[200:203]
    v_mfma_f32_16x16x32_bf16 a[204:207], v[152:155], v[172:175], a[204:207]
    v_mfma_f32_16x16x32_bf16 a[208:211], v[152:155], v[176:179], a[208:211]
    v_mfma_f32_16x16x32_bf16 a[212:215], v[152:155], v[180:183], a[212:215]
    v_mfma_f32_16x16x32_bf16 a[216:219], v[152:155], v[184:187], a[216:219]
    v_mfma_f32_16x16x32_bf16 a[220:223], v[152:155], v[188:191], a[220:223]
    v_mfma_f32_16x16x32_bf16 a[224:227], v[156:159], v[160:163], a[224:227]
    v_mfma_f32_16x16x32_bf16 a[228:231], v[156:159], v[164:167], a[228:231]
    v_mfma_f32_16x16x32_bf16 a[232:235], v[156:159], v[168:171], a[232:235]
    v_mfma_f32_16x16x32_bf16 a[236:239], v[156:159], v[172:175], a[236:239]
    v_mfma_f32_16x16x32_bf16 a[240:243], v[156:159], v[176:179], a[240:243]
    v_mfma_f32_16x16x32_bf16 a[244:247], v[156:159], v[180:183], a[244:247]
    v_mfma_f32_16x16x32_bf16 a[248:251], v[156:159], v[184:187], a[248:251]
    v_mfma_f32_16x16x32_bf16 a[252:255], v[156:159], v[188:191], a[252:255]
    s_mov_b32 s90, s20
    s_mov_b32 s31, s22
    s_mov_b32 s32, s23
    s_mov_b32 s33, s30
    s_and_b32 s53, s46, 1
    s_lshl_b32 s53, s53, 8
    s_lshl_b32 s54, s33, 9
    s_add_u32 s53, s53, s54
    v_lshrrev_b32 v6, 4, v1
    v_lshlrev_b32 v6, 3, v6
    buffer_load_dwordx2 v[96:97], v6, s[16:19], s53 offen offset:0
    buffer_load_dwordx2 v[98:99], v6, s[16:19], s53 offen offset:32
    buffer_load_dwordx2 v[100:101], v6, s[16:19], s53 offen offset:64
    buffer_load_dwordx2 v[102:103], v6, s[16:19], s53 offen offset:96
    buffer_load_dwordx2 v[104:105], v6, s[16:19], s53 offen offset:128
    buffer_load_dwordx2 v[106:107], v6, s[16:19], s53 offen offset:160
    buffer_load_dwordx2 v[108:109], v6, s[16:19], s53 offen offset:192
    buffer_load_dwordx2 v[110:111], v6, s[16:19], s53 offen offset:224
    s_add_u32 s82, s82, 1
    s_lshl_b32 s26, s82, 4
    s_add_u32 s26, s26, s21
    s_cmp_ge_u32 s26, 48
    s_cbranch_scc1 Lw_nonext
    s_cmp_ge_u32 s26, 32
    s_cbranch_scc1 Lj2_b
    s_cmp_lt_u32 s26, 16
    s_cbranch_scc1 Ljk_b
    s_cmp_lt_u32 s26, 30
    s_cbranch_scc1 Ljf_b
    s_sub_u32 s26, s26, 14
Ljk_b:
    s_lshr_b32 s22, s26, 2
    s_add_u32 s22, s22, 3
    s_bfe_u32 s23, s26, 0x10001
    s_add_u32 s23, s23, 1
    s_branch Lnt_b
Lj2_b:
    s_and_b32 s24, s21, 12
    s_lshr_b32 s25, s20, 1
    s_add_u32 s24, s24, s25
    s_and_b32 s25, s21, 3
    s_lshl_b32 s25, s25, 1
    s_and_b32 s20, s20, 1
    s_add_u32 s20, s20, s25
    s_mov_b32 s21, s24
    s_lshl_b32 s28, s20, 4
    s_add_u32 s28, s28, s21
    s_lshl_b32 s28, s28, 2
    s_add_u32 s28, s28, s46
    s_mov_b32 s26, s21
    s_lshr_b32 s22, s26, 1
    s_mov_b32 s23, 0
    s_and_b32 s24, s46, 1
    s_lshl_b32 s24, s24, 2
    s_lshr_b32 s25, s46, 1
    s_add_u32 s24, s24, s25
    s_lshl_b32 s24, s24, 16
    v_lshl_add_u32 v18, v1, 4, s24
    v_add_u32 v19, 129024, v18
Lnt_b:
    s_and_b32 s30, s26, 1
    s_lshl_b32 s24, s20, 1
    s_add_u32 s30, s30, s24
    s_branch Lgo_b
Ljf_b:
    s_mul_i32 s24, s20, 14
    s_add_u32 s24, s24, s26
    s_sub_u32 s24, s24, 16
    s_lshr_b32 s30, s24, 3
    s_and_b32 s22, s24, 7
    s_mov_b32 s23, 3
Lgo_b:
    s_mov_b64 s[24:25], s[64:65]
    s_cmp_eq_u32 s23, 1
    s_cselect_b64 s[24:25], s[66:67], s[24:25]
    s_cmp_eq_u32 s23, 2
    s_cselect_b64 s[24:25], s[68:69], s[24:25]
    s_cmp_eq_u32 s23, 3
    s_cselect_b64 s[24:25], s[72:73], s[24:25]
    s_mov_b32 s43, 8192
    s_cselect_b32 s43, 7168, s43
    s_mov_b32 s12, s24
    s_mov_b32 s13, s25
    s_lshl_b32 s14, s43, 10
    s_mov_b32 s15, 0x20000
    s_lshl_b32 s41, s30, 9
    s_lshl_b32 s40, s22, 19
    s_add_u32 s40, s40, 0
    s_lshl_b32 s45, s43, 5
    s_lshl_b32 s49, s46, 3
    v_lshrrev_b32 v2, 5, v1
    v_add_u32 v2, s49, v2
    v_and_b32 v3, 31, v1
    s_and_b32 s50, s46, 1
    s_lshl_b32 s50, s50, 3
    v_xor_b32 v3, s50, v3
    v_add_u32 v4, 0, v2
    v_and_b32 v5, 3, v4
    v_lshlrev_b32 v5, 1, v5
    v_xor_b32 v5, v5, v3
    v_mul_lo_u32 v4, v4, s43
    v_lshl_add_u32 v4, v5, 4, v4
    v_subrev_u32 v20, 0, v4
    v_add_u32 v4, 2, v2
    v_and_b32 v5, 3, v4
    v_lshlrev_b32 v5, 1, v5
    v_xor_b32 v5, v5, v3
    v_mul_lo_u32 v4, v4, s43
    v_lshl_add_u32 v4, v5, 4, v4
    v_subrev_u32 v21, 1024, v4
    v_add_u32 v4, 4, v2
    v_and_b32 v5, 3, v4
    v_lshlrev_b32 v5, 1, v5
    v_xor_b32 v5, v5, v3
    v_mul_lo_u32 v4, v4, s43
    v_lshl_add_u32 v4, v5, 4, v4
    v_subrev_u32 v22, 2048, v4
    v_add_u32 v4, 6, v2
    v_and_b32 v5, 3, v4
    v_lshlrev_b32 v5, 1, v5
    v_xor_b32 v5, v5, v3
    v_mul_lo_u32 v4, v4, s43
    v_lshl_add_u32 v4, v5, 4, v4
    v_subrev_u32 v23, 3072, v4
    s_add_u32 m0, s47, 0
    s_nop 0
    buffer_load_dwordx4 v18, s[8:11], s40 offen offset:0 sc1 lds
    buffer_load_dwordx4 v18, s[8:11], s40 offen offset:1024 sc1 lds
    buffer_load_dwordx4 v19, s[8:11], s40 offen offset:2048 sc1 lds
    buffer_load_dwordx4 v19, s[8:11], s40 offen offset:3072 sc1 lds
    s_add_u32 s40, s40, 2048
    s_add_u32 m0, s48, 0
    s_nop 0
    buffer_load_dwordx4 v20, s[12:15], s41 offen offset:0 lds
    buffer_load_dwordx4 v21, s[12:15], s41 offen offset:1024 lds
    buffer_load_dwordx4 v22, s[12:15], s41 offen offset:2048 lds
    buffer_load_dwordx4 v23, s[12:15], s41 offen offset:3072 lds
    s_add_u32 s41, s41, s45
    s_add_u32 m0, s47, 32768
    s_nop 0
    buffer_load_dwordx4 v18, s[8:11], s40 offen offset:0 sc1 lds
    buffer_load_dwordx4 v18, s[8:11], s40 offen offset:1024 sc1 lds
    buffer_load_dwordx4 v19, s[8:11], s40 offen offset:2048 sc1 lds
    buffer_load_dwordx4 v19, s[8:11], s40 offen offset:3072 sc1 lds
    s_add_u32 s40, s40, 2048
    s_add_u32 m0, s48, 32768
    s_nop 0
    buffer_load_dwordx4 v20, s[12:15], s41 offen offset:0 lds
    buffer_load_dwordx4 v21, s[12:15], s41 offen offset:1024 lds
    buffer_load_dwordx4 v22, s[12:15], s41 offen offset:2048 lds
    buffer_load_dwordx4 v23, s[12:15], s41 offen offset:3072 lds
    s_add_u32 s41, s41, s45
    s_add_u32 m0, s47, 65536
    s_nop 0
    buffer_load_dwordx4 v18, s[8:11], s40 offen offset:0 sc1 lds
    buffer_load_dwordx4 v18, s[8:11], s40 offen offset:1024 sc1 lds
    buffer_load_dwordx4 v19, s[8:11], s40 offen offset:2048 sc1 lds
    buffer_load_dwordx4 v19, s[8:11], s40 offen offset:3072 sc1 lds
    s_add_u32 s40, s40, 2048
    s_add_u32 m0, s48, 65536
    s_nop 0
    buffer_load_dwordx4 v20, s[12:15], s41 offen offset:0 lds
    buffer_load_dwordx4 v21, s[12:15], s41 offen offset:1024 lds
    buffer_load_dwordx4 v22, s[12:15], s41 offen offset:2048 lds
    buffer_load_dwordx4 v23, s[12:15], s41 offen offset:3072 lds
    s_add_u32 s41, s41, s45
    s_add_u32 m0, s47, 98304
    s_nop 0
    buffer_load_dwordx4 v18, s[8:11], s40 offen offset:0 sc1 lds
    buffer_load_dwordx4 v18, s[8:11], s40 offen offset:1024 sc1 lds
    buffer_load_dwordx4 v19, s[8:11], s40 offen offset:2048 sc1 lds
    buffer_load_dwordx4 v19, s[8:11], s40 offen offset:3072 sc1 lds
    s_add_u32 s40, s40, 2048
    s_add_u32 m0, s48, 98304
    s_nop 0
    buffer_load_dwordx4 v20, s[12:15], s41 offen offset:0 lds
    buffer_load_dwordx4 v21, s[12:15], s41 offen offset:1024 lds
    buffer_load_dwordx4 v22, s[12:15], s41 offen offset:2048 lds
    buffer_load_dwordx4 v23, s[12:15], s41 offen offset:3072 lds
    s_add_u32 s41, s41, s45
    s_waitcnt vmcnt(32)
Lw_epi:
    s_cmp_eq_u32 s32, 3
    s_cbranch_scc1 Lw_mish
    s_lshl_b32 s53, s32, 24
    s_add_u32 s53, s53, 4194304
    s_lshl_b32 s54, s31, 21
    s_add_u32 s53, s53, s54
    s_lshl_b32 s54, s33, 14
    s_add_u32 s53, s53, s54
    s_mov_b32 s54, 0x40000
    s_lshr_b32 s49, s46, 1
    s_lshl_b32 s49, s49, 2
    s_mul_i32 s49, s49, s54
    s_and_b32 s50, s46, 1
    s_lshl_b32 s50, s50, 13
    s_add_u32 s49, s49, s50
    s_add_u32 s53, s53, s49
    v_accvgpr_read_b32 v128, a0
    v_accvgpr_read_b32 v129, a1
    v_accvgpr_read_b32 v130, a2
    v_accvgpr_read_b32 v131, a3
    v_accvgpr_read_b32 v132, a4
    v_accvgpr_read_b32 v133, a5
    v_accvgpr_read_b32 v134, a6
    v_accvgpr_read_b32 v135, a7
    v_cvt_pk_bf16_f32 v136, v128, v129
    v_cvt_pk_bf16_f32 v137, v130, v131
    v_cvt_pk_bf16_f32 v138, v132, v133
    v_cvt_pk_bf16_f32 v139, v134, v135
    s_nop 0
    v_permlane16_swap_b32 v136, v138
    v_permlane16_swap_b32 v137, v139
    buffer_store_dwordx4 v[136:139], v24, s[8:11], s53 offen offset:0 sc1
    v_accvgpr_read_b32 v156, a32
    v_accvgpr_read_b32 v157, a33
    v_accvgpr_read_b32 v158, a34
    v_accvgpr_read_b32 v159, a35
    v_accvgpr_read_b32 v160, a36
    v_accvgpr_read_b32 v161, a37
    v_accvgpr_read_b32 v162, a38
    v_accvgpr_read_b32 v163, a39
    v_cvt_pk_bf16_f32 v164, v156, v157
    v_cvt_pk_bf16_f32 v165, v158, v159
    v_cvt_pk_bf16_f32 v166, v160, v161
    v_cvt_pk_bf16_f32 v167, v162, v163
    s_nop 0
    v_permlane16_swap_b32 v164, v166
    v_permlane16_swap_b32 v165, v167
    buffer_store_dwordx4 v[164:167], v24, s[8:11], s53 offen offset:1024 sc1
    v_accvgpr_read_b32 v184, a64
    v_accvgpr_read_b32 v185, a65
    v_accvgpr_read_b32 v186, a66
    v_accvgpr_read_b32 v187, a67
    v_accvgpr_read_b32 v188, a68
    v_accvgpr_read_b32 v189, a69
    v_accvgpr_read_b32 v190, a70
    v_accvgpr_read_b32 v191, a71
    v_cvt_pk_bf16_f32 v192, v184, v185
    v_cvt_pk_bf16_f32 v193, v186, v187
    v_cvt_pk_bf16_f32 v194, v188, v189
    v_cvt_pk_bf16_f32 v195, v190, v191
    s_nop 0
    v_permlane16_swap_b32 v192, v194
    v_permlane16_swap_b32 v193, v195
    buffer_store_dwordx4 v[192:195], v24, s[8:11], s53 offen offset:2048 sc1
    v_accvgpr_read_b32 v212, a96
    v_accvgpr_read_b32 v213, a97
    v_accvgpr_read_b32 v214, a98
    v_accvgpr_read_b32 v215, a99
    v_accvgpr_read_b32 v216, a100
    v_accvgpr_read_b32 v217, a101
    v_accvgpr_read_b32 v218, a102
    v_accvgpr_read_b32 v219, a103
    v_cvt_pk_bf16_f32 v220, v212, v213
    v_cvt_pk_bf16_f32 v221, v214, v215
    v_cvt_pk_bf16_f32 v222, v216, v217
    v_cvt_pk_bf16_f32 v223, v218, v219
    s_nop 0
    v_permlane16_swap_b32 v220, v222
    v_permlane16_swap_b32 v221, v223
    buffer_store_dwordx4 v[220:223], v24, s[8:11], s53 offen offset:3072 sc1
    v_accvgpr_read_b32 v128, a128
    v_accvgpr_read_b32 v129, a129
    v_accvgpr_read_b32 v130, a130
    v_accvgpr_read_b32 v131, a131
    v_accvgpr_read_b32 v132, a132
    v_accvgpr_read_b32 v133, a133
    v_accvgpr_read_b32 v134, a134
    v_accvgpr_read_b32 v135, a135
    v_cvt_pk_bf16_f32 v136, v128, v129
    v_cvt_pk_bf16_f32 v137, v130, v131
    v_cvt_pk_bf16_f32 v138, v132, v133
    v_cvt_pk_bf16_f32 v139, v134, v135
    s_nop 0
    v_permlane16_swap_b32 v136, v138
    v_permlane16_swap_b32 v137, v139
    buffer_store_dwordx4 v[136:139], v25, s[8:11], s53 offen offset:0 sc1
    v_accvgpr_read_b32 v156, a160
    v_accvgpr_read_b32 v157, a161
    v_accvgpr_read_b32 v158, a162
    v_accvgpr_read_b32 v159, a163
    v_accvgpr_read_b32 v160, a164
    v_accvgpr_read_b32 v161, a165
    v_accvgpr_read_b32 v162, a166
    v_accvgpr_read_b32 v163, a167
    v_cvt_pk_bf16_f32 v164, v156, v157
    v_cvt_pk_bf16_f32 v165, v158, v159
    v_cvt_pk_bf16_f32 v166, v160, v161
    v_cvt_pk_bf16_f32 v167, v162, v163
    s_nop 0
    v_permlane16_swap_b32 v164, v166
    v_permlane16_swap_b32 v165, v167
    buffer_store_dwordx4 v[164:167], v25, s[8:11], s53 offen offset:1024 sc1
    v_accvgpr_read_b32 v184, a192
    v_accvgpr_read_b32 v185, a193
    v_accvgpr_read_b32 v186, a194
    v_accvgpr_read_b32 v187, a195
    v_accvgpr_read_b32 v188, a196
    v_accvgpr_read_b32 v189, a197
    v_accvgpr_read_b32 v190, a198
    v_accvgpr_read_b32 v191, a199
    v_cvt_pk_bf16_f32 v192, v184, v185
    v_cvt_pk_bf16_f32 v193, v186, v187
    v_cvt_pk_bf16_f32 v194, v188, v189
    v_cvt_pk_bf16_f32 v195, v190, v191
    s_nop 0
    v_permlane16_swap_b32 v192, v194
    v_permlane16_swap_b32 v193, v195
    buffer_store_dwordx4 v[192:195], v25, s[8:11], s53 offen offset:2048 sc1
    v_accvgpr_read_b32 v212, a224
    v_accvgpr_read_b32 v213, a225
    v_accvgpr_read_b32 v214, a226
    v_accvgpr_read_b32 v215, a227
    v_accvgpr_read_b32 v216, a228
    v_accvgpr_read_b32 v217, a229
    v_accvgpr_read_b32 v218, a230
    v_accvgpr_read_b32 v219, a231
    v_cvt_pk_bf16_f32 v220, v212, v213
    v_cvt_pk_bf16_f32 v221, v214, v215
    v_cvt_pk_bf16_f32 v222, v216, v217
    v_cvt_pk_bf16_f32 v223, v218, v219
    s_nop 0
    v_permlane16_swap_b32 v220, v222
    v_permlane16_swap_b32 v221, v223
    buffer_store_dwordx4 v[220:223], v25, s[8:11], s53 offen offset:3072 sc1
    s_add_u32 s53, s53, s54
    v_accvgpr_read_b32 v128, a8
    v_accvgpr_read_b32 v129, a9
    v_accvgpr_read_b32 v130, a10
    v_accvgpr_read_b32 v131, a11
    v_accvgpr_read_b32 v132, a12
    v_accvgpr_read_b32 v133, a13
    v_accvgpr_read_b32 v134, a14
    v_accvgpr_read_b32 v135, a15
    v_cvt_pk_bf16_f32 v136, v128, v129
    v_cvt_pk_bf16_f32 v137, v130, v131
    v_cvt_pk_bf16_f32 v138, v132, v133
    v_cvt_pk_bf16_f32 v139, v134, v135
    s_nop 0
    v_permlane16_swap_b32 v136, v138
    v_permlane16_swap_b32 v137, v139
    buffer_store_dwordx4 v[136:139], v24, s[8:11], s53 offen offset:0 sc1
    v_accvgpr_read_b32 v156, a40
    v_accvgpr_read_b32 v157, a41
    v_accvgpr_read_b32 v158, a42
    v_accvgpr_read_b32 v159, a43
    v_accvgpr_read_b32 v160, a44
    v_accvgpr_read_b32 v161, a45
    v_accvgpr_read_b32 v162, a46
    v_accvgpr_read_b32 v163, a47
    v_cvt_pk_bf16_f32 v164, v156, v157
    v_cvt_pk_bf16_f32 v165, v158, v159
    v_cvt_pk_bf16_f32 v166, v160, v161
    v_cvt_pk_bf16_f32 v167, v162, v163
    s_nop 0
    v_permlane16_swap_b32 v164, v166
    v_permlane16_swap_b32 v165, v167
    buffer_store_dwordx4 v[164:167], v24, s[8:11], s53 offen offset:1024 sc1
    v_accvgpr_read_b32 v184, a72
    v_accvgpr_read_b32 v185, a73
    v_accvgpr_read_b32 v186, a74
    v_accvgpr_read_b32 v187, a75
    v_accvgpr_read_b32 v188, a76
    v_accvgpr_read_b32 v189, a77
    v_accvgpr_read_b32 v190, a78
    v_accvgpr_read_b32 v191, a79
    v_cvt_pk_bf16_f32 v192, v184, v185
    v_cvt_pk_bf16_f32 v193, v186, v187
    v_cvt_pk_bf16_f32 v194, v188, v189
    v_cvt_pk_bf16_f32 v195, v190, v191
    s_nop 0
    v_permlane16_swap_b32 v192, v194
    v_permlane16_swap_b32 v193, v195
    buffer_store_dwordx4 v[192:195], v24, s[8:11], s53 offen offset:2048 sc1
    v_accvgpr_read_b32 v212, a104
    v_accvgpr_read_b32 v213, a105
    v_accvgpr_read_b32 v214, a106
    v_accvgpr_read_b32 v215, a107
    v_accvgpr_read_b32 v216, a108
    v_accvgpr_read_b32 v217, a109
    v_accvgpr_read_b32 v218, a110
    v_accvgpr_read_b32 v219, a111
    v_cvt_pk_bf16_f32 v220, v212, v213
    v_cvt_pk_bf16_f32 v221, v214, v215
    v_cvt_pk_bf16_f32 v222, v216, v217
    v_cvt_pk_bf16_f32 v223, v218, v219
    s_nop 0
    v_permlane16_swap_b32 v220, v222
    v_permlane16_swap_b32 v221, v223
    buffer_store_dwordx4 v[220:223], v24, s[8:11], s53 offen offset:3072 sc1
    v_accvgpr_read_b32 v128, a136
    v_accvgpr_read_b32 v129, a137
    v_accvgpr_read_b32 v130, a138
    v_accvgpr_read_b32 v131, a139
    v_accvgpr_read_b32 v132, a140
    v_accvgpr_read_b32 v133, a141
    v_accvgpr_read_b32 v134, a142
    v_accvgpr_read_b32 v135, a143
    v_cvt_pk_bf16_f32 v136, v128, v129
    v_cvt_pk_bf16_f32 v137, v130, v131
    v_cvt_pk_bf16_f32 v138, v132, v133
    v_cvt_pk_bf16_f32 v139, v134, v135
    s_nop 0
    v_permlane16_swap_b32 v136, v138
    v_permlane16_swap_b32 v137, v139
    buffer_store_dwordx4 v[136:139], v25, s[8:11], s53 offen offset:0 sc1
    v_accvgpr_read_b32 v156, a168
    v_accvgpr_read_b32 v157, a169
    v_accvgpr_read_b32 v158, a170
    v_accvgpr_read_b32 v159, a171
    v_accvgpr_read_b32 v160, a172
    v_accvgpr_read_b32 v161, a173
    v_accvgpr_read_b32 v162, a174
    v_accvgpr_read_b32 v163, a175
    v_cvt_pk_bf16_f32 v164, v156, v157
    v_cvt_pk_bf16_f32 v165, v158, v159
    v_cvt_pk_bf16_f32 v166, v160, v161
    v_cvt_pk_bf16_f32 v167, v162, v163
    s_nop 0
    v_permlane16_swap_b32 v164, v166
    v_permlane16_swap_b32 v165, v167
    buffer_store_dwordx4 v[164:167], v25, s[8:11], s53 offen offset:1024 sc1
    v_accvgpr_read_b32 v184, a200
    v_accvgpr_read_b32 v185, a201
    v_accvgpr_read_b32 v186, a202
    v_accvgpr_read_b32 v187, a203
    v_accvgpr_read_b32 v188, a204
    v_accvgpr_read_b32 v189, a205
    v_accvgpr_read_b32 v190, a206
    v_accvgpr_read_b32 v191, a207
    v_cvt_pk_bf16_f32 v192, v184, v185
    v_cvt_pk_bf16_f32 v193, v186, v187
    v_cvt_pk_bf16_f32 v194, v188, v189
    v_cvt_pk_bf16_f32 v195, v190, v191
    s_nop 0
    v_permlane16_swap_b32 v192, v194
    v_permlane16_swap_b32 v193, v195
    buffer_store_dwordx4 v[192:195], v25, s[8:11], s53 offen offset:2048 sc1
    v_accvgpr_read_b32 v212, a232
    v_accvgpr_read_b32 v213, a233
    v_accvgpr_read_b32 v214, a234
    v_accvgpr_read_b32 v215, a235
    v_accvgpr_read_b32 v216, a236
    v_accvgpr_read_b32 v217, a237
    v_accvgpr_read_b32 v218, a238
    v_accvgpr_read_b32 v219, a239
    v_cvt_pk_bf16_f32 v220, v212, v213
    v_cvt_pk_bf16_f32 v221, v214, v215
    v_cvt_pk_bf16_f32 v222, v216, v217
    v_cvt_pk_bf16_f32 v223, v218, v219
    s_nop 0
    v_permlane16_swap_b32 v220, v222
    v_permlane16_swap_b32 v221, v223
    buffer_store_dwordx4 v[220:223], v25, s[8:11], s53 offen offset:3072 sc1
    s_add_u32 s53, s53, s54
    v_accvgpr_read_b32 v128, a16
    v_accvgpr_read_b32 v129, a17
    v_accvgpr_read_b32 v130, a18
    v_accvgpr_read_b32 v131, a19
    v_accvgpr_read_b32 v132, a20
    v_accvgpr_read_b32 v133, a21
    v_accvgpr_read_b32 v134, a22
    v_accvgpr_read_b32 v135, a23
    v_cvt_pk_bf16_f32 v136, v128, v129
    v_cvt_pk_bf16_f32 v137, v130, v131
    v_cvt_pk_bf16_f32 v138, v132, v133
    v_cvt_pk_bf16_f32 v139, v134, v135
    s_nop 0
    v_permlane16_swap_b32 v136, v138
    v_permlane16_swap_b32 v137, v139
    buffer_store_dwordx4 v[136:139], v24, s[8:11], s53 offen offset:0 sc1
    v_accvgpr_read_b32 v156, a48
    v_accvgpr_read_b32 v157, a49
    v_accvgpr_read_b32 v158, a50
    v_accvgpr_read_b32 v159, a51
    v_accvgpr_read_b32 v160, a52
    v_accvgpr_read_b32 v161, a53
    v_accvgpr_read_b32 v162, a54
    v_accvgpr_read_b32 v163, a55
    v_cvt_pk_bf16_f32 v164, v156, v157
    v_cvt_pk_bf16_f32 v165, v158, v159
    v_cvt_pk_bf16_f32 v166, v160, v161
    v_cvt_pk_bf16_f32 v167, v162, v163
    s_nop 0
    v_permlane16_swap_b32 v164, v166
    v_permlane16_swap_b32 v165, v167
    buffer_store_dwordx4 v[164:167], v24, s[8:11], s53 offen offset:1024 sc1
    v_accvgpr_read_b32 v184, a80
    v_accvgpr_read_b32 v185, a81
    v_accvgpr_read_b32 v186, a82
    v_accvgpr_read_b32 v187, a83
    v_accvgpr_read_b32 v188, a84
    v_accvgpr_read_b32 v189, a85
    v_accvgpr_read_b32 v190, a86
    v_accvgpr_read_b32 v191, a87
    v_cvt_pk_bf16_f32 v192, v184, v185
    v_cvt_pk_bf16_f32 v193, v186, v187
    v_cvt_pk_bf16_f32 v194, v188, v189
    v_cvt_pk_bf16_f32 v195, v190, v191
    s_nop 0
    v_permlane16_swap_b32 v192, v194
    v_permlane16_swap_b32 v193, v195
    buffer_store_dwordx4 v[192:195], v24, s[8:11], s53 offen offset:2048 sc1
    v_accvgpr_read_b32 v212, a112
    v_accvgpr_read_b32 v213, a113
    v_accvgpr_read_b32 v214, a114
    v_accvgpr_read_b32 v215, a115
    v_accvgpr_read_b32 v216, a116
    v_accvgpr_read_b32 v217, a117
    v_accvgpr_read_b32 v218, a118
    v_accvgpr_read_b32 v219, a119
    v_cvt_pk_bf16_f32 v220, v212, v213
    v_cvt_pk_bf16_f32 v221, v214, v215
    v_cvt_pk_bf16_f32 v222, v216, v217
    v_cvt_pk_bf16_f32 v223, v218, v219
    s_nop 0
    v_permlane16_swap_b32 v220, v222
    v_permlane16_swap_b32 v221, v223
    buffer_store_dwordx4 v[220:223], v24, s[8:11], s53 offen offset:3072 sc1
    v_accvgpr_read_b32 v128, a144
    v_accvgpr_read_b32 v129, a145
    v_accvgpr_read_b32 v130, a146
    v_accvgpr_read_b32 v131, a147
    v_accvgpr_read_b32 v132, a148
    v_accvgpr_read_b32 v133, a149
    v_accvgpr_read_b32 v134, a150
    v_accvgpr_read_b32 v135, a151
    v_cvt_pk_bf16_f32 v136, v128, v129
    v_cvt_pk_bf16_f32 v137, v130, v131
    v_cvt_pk_bf16_f32 v138, v132, v133
    v_cvt_pk_bf16_f32 v139, v134, v135
    s_nop 0
    v_permlane16_swap_b32 v136, v138
    v_permlane16_swap_b32 v137, v139
    buffer_store_dwordx4 v[136:139], v25, s[8:11], s53 offen offset:0 sc1
    v_accvgpr_read_b32 v156, a176
    v_accvgpr_read_b32 v157, a177
    v_accvgpr_read_b32 v158, a178
    v_accvgpr_read_b32 v159, a179
    v_accvgpr_read_b32 v160, a180
    v_accvgpr_read_b32 v161, a181
    v_accvgpr_read_b32 v162, a182
    v_accvgpr_read_b32 v163, a183
    v_cvt_pk_bf16_f32 v164, v156, v157
    v_cvt_pk_bf16_f32 v165, v158, v159
    v_cvt_pk_bf16_f32 v166, v160, v161
    v_cvt_pk_bf16_f32 v167, v162, v163
    s_nop 0
    v_permlane16_swap_b32 v164, v166
    v_permlane16_swap_b32 v165, v167
    buffer_store_dwordx4 v[164:167], v25, s[8:11], s53 offen offset:1024 sc1
    v_accvgpr_read_b32 v184, a208
    v_accvgpr_read_b32 v185, a209
    v_accvgpr_read_b32 v186, a210
    v_accvgpr_read_b32 v187, a211
    v_accvgpr_read_b32 v188, a212
    v_accvgpr_read_b32 v189, a213
    v_accvgpr_read_b32 v190, a214
    v_accvgpr_read_b32 v191, a215
    v_cvt_pk_bf16_f32 v192, v184, v185
    v_cvt_pk_bf16_f32 v193, v186, v187
    v_cvt_pk_bf16_f32 v194, v188, v189
    v_cvt_pk_bf16_f32 v195, v190, v191
    s_nop 0
    v_permlane16_swap_b32 v192, v194
    v_permlane16_swap_b32 v193, v195
    buffer_store_dwordx4 v[192:195], v25, s[8:11], s53 offen offset:2048 sc1
    v_accvgpr_read_b32 v212, a240
    v_accvgpr_read_b32 v213, a241
    v_accvgpr_read_b32 v214, a242
    v_accvgpr_read_b32 v215, a243
    v_accvgpr_read_b32 v216, a244
    v_accvgpr_read_b32 v217, a245
    v_accvgpr_read_b32 v218, a246
    v_accvgpr_read_b32 v219, a247
    v_cvt_pk_bf16_f32 v220, v212, v213
    v_cvt_pk_bf16_f32 v221, v214, v215
    v_cvt_pk_bf16_f32 v222, v216, v217
    v_cvt_pk_bf16_f32 v223, v218, v219
    s_nop 0
    v_permlane16_swap_b32 v220, v222
    v_permlane16_swap_b32 v221, v223
    buffer_store_dwordx4 v[220:223], v25, s[8:11], s53 offen offset:3072 sc1
    s_add_u32 s53, s53, s54
    v_accvgpr_read_b32 v128, a24
    v_accvgpr_read_b32 v129, a25
    v_accvgpr_read_b32 v130, a26
    v_accvgpr_read_b32 v131, a27
    v_accvgpr_read_b32 v132, a28
    v_accvgpr_read_b32 v133, a29
    v_accvgpr_read_b32 v134, a30
    v_accvgpr_read_b32 v135, a31
    v_cvt_pk_bf16_f32 v136, v128, v129
    v_cvt_pk_bf16_f32 v137, v130, v131
    v_cvt_pk_bf16_f32 v138, v132, v133
    v_cvt_pk_bf16_f32 v139, v134, v135
    s_nop 0
    v_permlane16_swap_b32 v136, v138
    v_permlane16_swap_b32 v137, v139
    buffer_store_dwordx4 v[136:139], v24, s[8:11], s53 offen offset:0 sc1
    v_accvgpr_read_b32 v156, a56
    v_accvgpr_read_b32 v157, a57
    v_accvgpr_read_b32 v158, a58
    v_accvgpr_read_b32 v159, a59
    v_accvgpr_read_b32 v160, a60
    v_accvgpr_read_b32 v161, a61
    v_accvgpr_read_b32 v162, a62
    v_accvgpr_read_b32 v163, a63
    v_cvt_pk_bf16_f32 v164, v156, v157
    v_cvt_pk_bf16_f32 v165, v158, v159
    v_cvt_pk_bf16_f32 v166, v160, v161
    v_cvt_pk_bf16_f32 v167, v162, v163
    s_nop 0
    v_permlane16_swap_b32 v164, v166
    v_permlane16_swap_b32 v165, v167
    buffer_store_dwordx4 v[164:167], v24, s[8:11], s53 offen offset:1024 sc1
    v_accvgpr_read_b32 v184, a88
    v_accvgpr_read_b32 v185, a89
    v_accvgpr_read_b32 v186, a90
    v_accvgpr_read_b32 v187, a91
    v_accvgpr_read_b32 v188, a92
    v_accvgpr_read_b32 v189, a93
    v_accvgpr_read_b32 v190, a94
    v_accvgpr_read_b32 v191, a95
    v_cvt_pk_bf16_f32 v192, v184, v185
    v_cvt_pk_bf16_f32 v193, v186, v187
    v_cvt_pk_bf16_f32 v194, v188, v189
    v_cvt_pk_bf16_f32 v195, v190, v191
    s_nop 0
    v_permlane16_swap_b32 v192, v194
    v_permlane16_swap_b32 v193, v195
    buffer_store_dwordx4 v[192:195], v24, s[8:11], s53 offen offset:2048 sc1
    v_accvgpr_read_b32 v212, a120
    v_accvgpr_read_b32 v213, a121
    v_accvgpr_read_b32 v214, a122
    v_accvgpr_read_b32 v215, a123
    v_accvgpr_read_b32 v216, a124
    v_accvgpr_read_b32 v217, a125
    v_accvgpr_read_b32 v218, a126
    v_accvgpr_read_b32 v219, a127
    v_cvt_pk_bf16_f32 v220, v212, v213
    v_cvt_pk_bf16_f32 v221, v214, v215
    v_cvt_pk_bf16_f32 v222, v216, v217
    v_cvt_pk_bf16_f32 v223, v218, v219
    s_nop 0
    v_permlane16_swap_b32 v220, v222
    v_permlane16_swap_b32 v221, v223
    buffer_store_dwordx4 v[220:223], v24, s[8:11], s53 offen offset:3072 sc1
    v_accvgpr_read_b32 v128, a152
    v_accvgpr_read_b32 v129, a153
    v_accvgpr_read_b32 v130, a154
    v_accvgpr_read_b32 v131, a155
    v_accvgpr_read_b32 v132, a156
    v_accvgpr_read_b32 v133, a157
    v_accvgpr_read_b32 v134, a158
    v_accvgpr_read_b32 v135, a159
    v_cvt_pk_bf16_f32 v136, v128, v129
    v_cvt_pk_bf16_f32 v137, v130, v131
    v_cvt_pk_bf16_f32 v138, v132, v133
    v_cvt_pk_bf16_f32 v139, v134, v135
    s_nop 0
    v_permlane16_swap_b32 v136, v138
    v_permlane16_swap_b32 v137, v139
    buffer_store_dwordx4 v[136:139], v25, s[8:11], s53 offen offset:0 sc1
    v_accvgpr_read_b32 v156, a184
    v_accvgpr_read_b32 v157, a185
    v_accvgpr_read_b32 v158, a186
    v_accvgpr_read_b32 v159, a187
    v_accvgpr_read_b32 v160, a188
    v_accvgpr_read_b32 v161, a189
    v_accvgpr_read_b32 v162, a190
    v_accvgpr_read_b32 v163, a191
    v_cvt_pk_bf16_f32 v164, v156, v157
    v_cvt_pk_bf16_f32 v165, v158, v159
    v_cvt_pk_bf16_f32 v166, v160, v161
    v_cvt_pk_bf16_f32 v167, v162, v163
    s_nop 0
    v_permlane16_swap_b32 v164, v166
    v_permlane16_swap_b32 v165, v167
    buffer_store_dwordx4 v[164:167], v25, s[8:11], s53 offen offset:1024 sc1
    v_accvgpr_read_b32 v184, a216
    v_accvgpr_read_b32 v185, a217
    v_accvgpr_read_b32 v186, a218
    v_accvgpr_read_b32 v187, a219
    v_accvgpr_read_b32 v188, a220
    v_accvgpr_read_b32 v189, a221
    v_accvgpr_read_b32 v190, a222
    v_accvgpr_read_b32 v191, a223
    v_cvt_pk_bf16_f32 v192, v184, v185
    v_cvt_pk_bf16_f32 v193, v186, v187
    v_cvt_pk_bf16_f32 v194, v188, v189
    v_cvt_pk_bf16_f32 v195, v190, v191
    s_nop 0
    v_permlane16_swap_b32 v192, v194
    v_permlane16_swap_b32 v193, v195
    buffer_store_dwordx4 v[192:195], v25, s[8:11], s53 offen offset:2048 sc1
    v_accvgpr_read_b32 v212, a248
    v_accvgpr_read_b32 v213, a249
    v_accvgpr_read_b32 v214, a250
    v_accvgpr_read_b32 v215, a251
    v_accvgpr_read_b32 v216, a252
    v_accvgpr_read_b32 v217, a253
    v_accvgpr_read_b32 v218, a254
    v_accvgpr_read_b32 v219, a255
    v_cvt_pk_bf16_f32 v220, v212, v213
    v_cvt_pk_bf16_f32 v221, v214, v215
    v_cvt_pk_bf16_f32 v222, v216, v217
    v_cvt_pk_bf16_f32 v223, v218, v219
    s_nop 0
    v_permlane16_swap_b32 v220, v222
    v_permlane16_swap_b32 v221, v223
    buffer_store_dwordx4 v[220:223], v25, s[8:11], s53 offen offset:3072 sc1
    s_add_u32 s53, s53, s54
    s_lshl_b32 s53, s90, 9
    s_lshl_b32 s54, s31, 5
    s_add_u32 s53, s53, s54
    s_add_u32 s92, s53, 120061952
    s_mov_b32 s93, 2
    s_mov_b32 s94, 0xff
    s_branch Lw_next
Lw_mish:
    s_mov_b32 s54, 0xffff0000
    v_lshlrev_b32 v64, 16, v96
    v_and_b32 v65, s54, v96
    v_lshlrev_b32 v66, 16, v97
    v_and_b32 v67, s54, v97
    v_lshlrev_b32 v68, 16, v98
    v_and_b32 v69, s54, v98
    v_lshlrev_b32 v70, 16, v99
    v_and_b32 v71, s54, v99
    v_lshlrev_b32 v72, 16, v100
    v_and_b32 v73, s54, v100
    v_lshlrev_b32 v74, 16, v101
    v_and_b32 v75, s54, v101
    v_lshlrev_b32 v76, 16, v102
    v_and_b32 v77, s54, v102
    v_lshlrev_b32 v78, 16, v103
    v_and_b32 v79, s54, v103
    v_lshlrev_b32 v80, 16, v104
    v_and_b32 v81, s54, v104
    v_lshlrev_b32 v82, 16, v105
    v_and_b32 v83, s54, v105
    v_lshlrev_b32 v84, 16, v106
    v_and_b32 v85, s54, v106
    v_lshlrev_b32 v86, 16, v107
    v_and_b32 v87, s54, v107
    v_lshlrev_b32 v88, 16, v108
    v_and_b32 v89, s54, v108
    v_lshlrev_b32 v90, 16, v109
    v_and_b32 v91, s54, v109
    v_lshlrev_b32 v92, 16, v110
    v_and_b32 v93, s54, v110
    v_lshlrev_b32 v94, 16, v111
    v_and_b32 v95, s54, v111
    s_mov_b32 s54, 229376
    s_mul_i32 s53, s31, 1835008
    s_add_u32 s53, s53, 54525952
    s_lshl_b32 s55, s33, 14
    s_add_u32 s53, s53, s55
    s_lshr_b32 s49, s46, 1
    s_lshl_b32 s49, s49, 2
    s_mul_i32 s49, s49, s54
    s_and_b32 s50, s46, 1
    s_lshl_b32 s50, s50, 13
    s_add_u32 s49, s49, s50
    s_add_u32 s53, s53, s49
    s_mov_b32 s56, 0x3fb8aa3b
    s_mov_b32 s57, 0x3fb8aa3b
    v_accvgpr_read_b32 v128, a0
    v_accvgpr_read_b32 v129, a1
    v_accvgpr_read_b32 v130, a2
    v_accvgpr_read_b32 v131, a3
    v_accvgpr_read_b32 v132, a4
    v_accvgpr_read_b32 v133, a5
    v_accvgpr_read_b32 v134, a6
    v_accvgpr_read_b32 v135, a7
    v_pk_add_f32 v[128:129], v[128:129], v[64:65]
    v_pk_add_f32 v[130:131], v[130:131], v[66:67]
    v_pk_add_f32 v[132:133], v[132:133], v[64:65]
    v_pk_add_f32 v[134:135], v[134:135], v[66:67]
    v_pk_mul_f32 v[140:141], v[128:129], s[56:57]
    v_pk_mul_f32 v[142:143], v[130:131], s[56:57]
    v_pk_mul_f32 v[144:145], v[132:133], s[56:57]
    v_pk_mul_f32 v[146:147], v[134:135], s[56:57]
    v_exp_f32 v140, v140
    v_exp_f32 v141, v141
    v_exp_f32 v142, v142
    v_exp_f32 v143, v143
    v_exp_f32 v144, v144
    v_exp_f32 v145, v145
    v_exp_f32 v146, v146
    v_exp_f32 v147, v147
    v_pk_fma_f32 v[148:149], v[140:141], 0.5, 1.0 op_sel_hi:[1,0,0]
    v_pk_fma_f32 v[150:151], v[142:143], 0.5, 1.0 op_sel_hi:[1,0,0]
    v_pk_fma_f32 v[152:153], v[144:145], 0.5, 1.0 op_sel_hi:[1,0,0]
    v_pk_fma_f32 v[154:155], v[146:147], 0.5, 1.0 op_sel_hi:[1,0,0]
    v_pk_fma_f32 v[140:141], v[140:141], v[148:149], 1.0 op_sel_hi:[1,1,0]
    v_pk_fma_f32 v[142:143], v[142:143], v[150:151], 1.0 op_sel_hi:[1,1,0]
    v_pk_fma_f32 v[144:145], v[144:145], v[152:153], 1.0 op_sel_hi:[1,1,0]
    v_pk_fma_f32 v[146:147], v[146:147], v[154:155], 1.0 op_sel_hi:[1,1,0]
    v_rcp_f32 v140, v140
    v_rcp_f32 v141, v141
    v_rcp_f32 v142, v142
    v_rcp_f32 v143, v143
    v_rcp_f32 v144, v144
    v_rcp_f32 v145, v145
    v_rcp_f32 v146, v146
    v_rcp_f32 v147, v147
    v_pk_fma_f32 v[128:129], v[128:129], v[140:141], v[128:129] neg_lo:[1,0,0] neg_hi:[1,0,0]
    v_pk_fma_f32 v[130:131], v[130:131], v[142:143], v[130:131] neg_lo:[1,0,0] neg_hi:[1,0,0]
    v_pk_fma_f32 v[132:133], v[132:133], v[144:145], v[132:133] neg_lo:[1,0,0] neg_hi:[1,0,0]
    v_pk_fma_f32 v[134:135], v[134:135], v[146:147], v[134:135] neg_lo:[1,0,0] neg_hi:[1,0,0]
    v_cvt_pk_bf16_f32 v136, v128, v129
    v_cvt_pk_bf16_f32 v137, v130, v131
    v_cvt_pk_bf16_f32 v138, v132, v133
    v_cvt_pk_bf16_f32 v139, v134, v135
    s_nop 0
    v_permlane16_swap_b32 v136, v138
    v_permlane16_swap_b32 v137, v139
    buffer_store_dwordx4 v[136:139], v24, s[8:11], s53 offen offset:0 sc1
    v_accvgpr_read_b32 v156, a32
    v_accvgpr_read_b32 v157, a33
    v_accvgpr_read_b32 v158, a34
    v_accvgpr_read_b32 v159, a35
    v_accvgpr_read_b32 v160, a36
    v_accvgpr_read_b32 v161, a37
    v_accvgpr_read_b32 v162, a38
    v_accvgpr_read_b32 v163, a39
    v_pk_add_f32 v[156:157], v[156:157], v[68:69]
    v_pk_add_f32 v[158:159], v[158:159], v[70:71]
    v_pk_add_f32 v[160:161], v[160:161], v[68:69]
    v_pk_add_f32 v[162:163], v[162:163], v[70:71]
    v_pk_mul_f32 v[168:169], v[156:157], s[56:57]
    v_pk_mul_f32 v[170:171], v[158:159], s[56:57]
    v_pk_mul_f32 v[172:173], v[160:161], s[56:57]
    v_pk_mul_f32 v[174:175], v[162:163], s[56:57]
    v_exp_f32 v168, v168
    v_exp_f32 v169, v169
    v_exp_f32 v170, v170
    v_exp_f32 v171, v171
    v_exp_f32 v172, v172
    v_exp_f32 v173, v173
    v_exp_f32 v174, v174
    v_exp_f32 v175, v175
    v_pk_fma_f32 v[176:177], v[168:169], 0.5, 1.0 op_sel_hi:[1,0,0]
    v_pk_fma_f32 v[178:179], v[170:171], 0.5, 1.0 op_sel_hi:[1,0,0]
    v_pk_fma_f32 v[180:181], v[172:173], 0.5, 1.0 op_sel_hi:[1,0,0]
    v_pk_fma_f32 v[182:183], v[174:175], 0.5, 1.0 op_sel_hi:[1,0,0]
    v_pk_fma_f32 v[168:169], v[168:169], v[176:177], 1.0 op_sel_hi:[1,1,0]
    v_pk_fma_f32 v[170:171], v[170:171], v[178:179], 1.0 op_sel_hi:[1,1,0]
    v_pk_fma_f32 v[172:173], v[172:173], v[180:181], 1.0 op_sel_hi:[1,1,0]
    v_pk_fma_f32 v[174:175], v[174:175], v[182:183], 1.0 op_sel_hi:[1,1,0]
    v_rcp_f32 v168, v168
    v_rcp_f32 v169, v169
    v_rcp_f32 v170, v170
    v_rcp_f32 v171, v171
    v_rcp_f32 v172, v172
    v_rcp_f32 v173, v173
    v_rcp_f32 v174, v174
    v_rcp_f32 v175, v175
    v_pk_fma_f32 v[156:157], v[156:157], v[168:169], v[156:157] neg_lo:[1,0,0] neg_hi:[1,0,0]
    v_pk_fma_f32 v[158:159], v[158:159], v[170:171], v[158:159] neg_lo:[1,0,0] neg_hi:[1,0,0]
    v_pk_fma_f32 v[160:161], v[160:161], v[172:173], v[160:161] neg_lo:[1,0,0] neg_hi:[1,0,0]
    v_pk_fma_f32 v[162:163], v[162:163], v[174:175], v[162:163] neg_lo:[1,0,0] neg_hi:[1,0,0]
    v_cvt_pk_bf16_f32 v164, v156, v157
    v_cvt_pk_bf16_f32 v165, v158, v159
    v_cvt_pk_bf16_f32 v166, v160, v161
    v_cvt_pk_bf16_f32 v167, v162, v163
    s_nop 0
    v_permlane16_swap_b32 v164, v166
    v_permlane16_swap_b32 v165, v167
    buffer_store_dwordx4 v[164:167], v24, s[8:11], s53 offen offset:1024 sc1
    v_accvgpr_read_b32 v184, a64
    v_accvgpr_read_b32 v185, a65
    v_accvgpr_read_b32 v186, a66
    v_accvgpr_read_b32 v187, a67
    v_accvgpr_read_b32 v188, a68
    v_accvgpr_read_b32 v189, a69
    v_accvgpr_read_b32 v190, a70
    v_accvgpr_read_b32 v191, a71
    v_pk_add_f32 v[184:185], v[184:185], v[72:73]
    v_pk_add_f32 v[186:187], v[186:187], v[74:75]
    v_pk_add_f32 v[188:189], v[188:189], v[72:73]
    v_pk_add_f32 v[190:191], v[190:191], v[74:75]
    v_pk_mul_f32 v[196:197], v[184:185], s[56:57]
    v_pk_mul_f32 v[198:199], v[186:187], s[56:57]
    v_pk_mul_f32 v[200:201], v[188:189], s[56:57]
    v_pk_mul_f32 v[202:203], v[190:191], s[56:57]
    v_exp_f32 v196, v196
    v_exp_f32 v197, v197
    v_exp_f32 v198, v198
    v_exp_f32 v199, v199
    v_exp_f32 v200, v200
    v_exp_f32 v201, v201
    v_exp_f32 v202, v202
    v_exp_f32 v203, v203
    v_pk_fma_f32 v[204:205], v[196:197], 0.5, 1.0 op_sel_hi:[1,0,0]
    v_pk_fma_f32 v[206:207], v[198:199], 0.5, 1.0 op_sel_hi:[1,0,0]
    v_pk_fma_f32 v[208:209], v[200:201], 0.5, 1.0 op_sel_hi:[1,0,0]
    v_pk_fma_f32 v[210:211], v[202:203], 0.5, 1.0 op_sel_hi:[1,0,0]
    v_pk_fma_f32 v[196:197], v[196:197], v[204:205], 1.0 op_sel_hi:[1,1,0]
    v_pk_fma_f32 v[198:199], v[198:199], v[206:207], 1.0 op_sel_hi:[1,1,0]
    v_pk_fma_f32 v[200:201], v[200:201], v[208:209], 1.0 op_sel_hi:[1,1,0]
    v_pk_fma_f32 v[202:203], v[202:203], v[210:211], 1.0 op_sel_hi:[1,1,0]
    v_rcp_f32 v196, v196
    v_rcp_f32 v197, v197
    v_rcp_f32 v198, v198
    v_rcp_f32 v199, v199
    v_rcp_f32 v200, v200
    v_rcp_f32 v201, v201
    v_rcp_f32 v202, v202
    v_rcp_f32 v203, v203
    v_pk_fma_f32 v[184:185], v[184:185], v[196:197], v[184:185] neg_lo:[1,0,0] neg_hi:[1,0,0]
    v_pk_fma_f32 v[186:187], v[186:187], v[198:199], v[186:187] neg_lo:[1,0,0] neg_hi:[1,0,0]
    v_pk_fma_f32 v[188:189], v[188:189], v[200:201], v[188:189] neg_lo:[1,0,0] neg_hi:[1,0,0]
    v_pk_fma_f32 v[190:191], v[190:191], v[202:203], v[190:191] neg_lo:[1,0,0] neg_hi:[1,0,0]
    v_cvt_pk_bf16_f32 v192, v184, v185
    v_cvt_pk_bf16_f32 v193, v186, v187
    v_cvt_pk_bf16_f32 v194, v188, v189
    v_cvt_pk_bf16_f32 v195, v190, v191
    s_nop 0
    v_permlane16_swap_b32 v192, v194
    v_permlane16_swap_b32 v193, v195
    buffer_store_dwordx4 v[192:195], v24, s[8:11], s53 offen offset:2048 sc1
    v_accvgpr_read_b32 v212, a96
    v_accvgpr_read_b32 v213, a97
    v_accvgpr_read_b32 v214, a98
    v_accvgpr_read_b32 v215, a99
    v_accvgpr_read_b32 v216, a100
    v_accvgpr_read_b32 v217, a101
    v_accvgpr_read_b32 v218, a102
    v_accvgpr_read_b32 v219, a103
    v_pk_add_f32 v[212:213], v[212:213], v[76:77]
    v_pk_add_f32 v[214:215], v[214:215], v[78:79]
    v_pk_add_f32 v[216:217], v[216:217], v[76:77]
    v_pk_add_f32 v[218:219], v[218:219], v[78:79]
    v_pk_mul_f32 v[224:225], v[212:213], s[56:57]
    v_pk_mul_f32 v[226:227], v[214:215], s[56:57]
    v_pk_mul_f32 v[228:229], v[216:217], s[56:57]
    v_pk_mul_f32 v[230:231], v[218:219], s[56:57]
    v_exp_f32 v224, v224
    v_exp_f32 v225, v225
    v_exp_f32 v226, v226
    v_exp_f32 v227, v227
    v_exp_f32 v228, v228
    v_exp_f32 v229, v229
    v_exp_f32 v230, v230
    v_exp_f32 v231, v231
    v_pk_fma_f32 v[232:233], v[224:225], 0.5, 1.0 op_sel_hi:[1,0,0]
    v_pk_fma_f32 v[234:235], v[226:227], 0.5, 1.0 op_sel_hi:[1,0,0]
    v_pk_fma_f32 v[236:237], v[228:229], 0.5, 1.0 op_sel_hi:[1,0,0]
    v_pk_fma_f32 v[238:239], v[230:231], 0.5, 1.0 op_sel_hi:[1,0,0]
    v_pk_fma_f32 v[224:225], v[224:225], v[232:233], 1.0 op_sel_hi:[1,1,0]
    v_pk_fma_f32 v[226:227], v[226:227], v[234:235], 1.0 op_sel_hi:[1,1,0]
    v_pk_fma_f32 v[228:229], v[228:229], v[236:237], 1.0 op_sel_hi:[1,1,0]
    v_pk_fma_f32 v[230:231], v[230:231], v[238:239], 1.0 op_sel_hi:[1,1,0]
    v_rcp_f32 v224, v224
    v_rcp_f32 v225, v225
    v_rcp_f32 v226, v226
    v_rcp_f32 v227, v227
    v_rcp_f32 v228, v228
    v_rcp_f32 v229, v229
    v_rcp_f32 v230, v230
    v_rcp_f32 v231, v231
    v_pk_fma_f32 v[212:213], v[212:213], v[224:225], v[212:213] neg_lo:[1,0,0] neg_hi:[1,0,0]
    v_pk_fma_f32 v[214:215], v[214:215], v[226:227], v[214:215] neg_lo:[1,0,0] neg_hi:[1,0,0]
    v_pk_fma_f32 v[216:217], v[216:217], v[228:229], v[216:217] neg_lo:[1,0,0] neg_hi:[1,0,0]
    v_pk_fma_f32 v[218:219], v[218:219], v[230:231], v[218:219] neg_lo:[1,0,0] neg_hi:[1,0,0]
    v_cvt_pk_bf16_f32 v220, v212, v213
    v_cvt_pk_bf16_f32 v221, v214, v215
    v_cvt_pk_bf16_f32 v222, v216, v217
    v_cvt_pk_bf16_f32 v223, v218, v219
    s_nop 0
    v_permlane16_swap_b32 v220, v222
    v_permlane16_swap_b32 v221, v223
    buffer_store_dwordx4 v[220:223], v24, s[8:11], s53 offen offset:3072 sc1
    v_accvgpr_read_b32 v128, a128
    v_accvgpr_read_b32 v129, a129
    v_accvgpr_read_b32 v130, a130
    v_accvgpr_read_b32 v131, a131
    v_accvgpr_read_b32 v132, a132
    v_accvgpr_read_b32 v133, a133
    v_accvgpr_read_b32 v134, a134
    v_accvgpr_read_b32 v135, a135
    v_pk_add_f32 v[128:129], v[128:129], v[80:81]
    v_pk_add_f32 v[130:131], v[130:131], v[82:83]
    v_pk_add_f32 v[132:133], v[132:133], v[80:81]
    v_pk_add_f32 v[134:135], v[134:135], v[82:83]
    v_pk_mul_f32 v[140:141], v[128:129], s[56:57]
    v_pk_mul_f32 v[142:143], v[130:131], s[56:57]
    v_pk_mul_f32 v[144:145], v[132:133], s[56:57]
    v_pk_mul_f32 v[146:147], v[134:135], s[56:57]
    v_exp_f32 v140, v140
    v_exp_f32 v141, v141
    v_exp_f32 v142, v142
    v_exp_f32 v143, v143
    v_exp_f32 v144, v144
    v_exp_f32 v145, v145
    v_exp_f32 v146, v146
    v_exp_f32 v147, v147
    v_pk_fma_f32 v[148:149], v[140:141], 0.5, 1.0 op_sel_hi:[1,0,0]
    v_pk_fma_f32 v[150:151], v[142:143], 0.5, 1.0 op_sel_hi:[1,0,0]
    v_pk_fma_f32 v[152:153], v[144:145], 0.5, 1.0 op_sel_hi:[1,0,0]
    v_pk_fma_f32 v[154:155], v[146:147], 0.5, 1.0 op_sel_hi:[1,0,0]
    v_pk_fma_f32 v[140:141], v[140:141], v[148:149], 1.0 op_sel_hi:[1,1,0]
    v_pk_fma_f32 v[142:143], v[142:143], v[150:151], 1.0 op_sel_hi:[1,1,0]
    v_pk_fma_f32 v[144:145], v[144:145], v[152:153], 1.0 op_sel_hi:[1,1,0]
    v_pk_fma_f32 v[146:147], v[146:147], v[154:155], 1.0 op_sel_hi:[1,1,0]
    v_rcp_f32 v140, v140
    v_rcp_f32 v141, v141
    v_rcp_f32 v142, v142
    v_rcp_f32 v143, v143
    v_rcp_f32 v144, v144
    v_rcp_f32 v145, v145
    v_rcp_f32 v146, v146
    v_rcp_f32 v147, v147
    v_pk_fma_f32 v[128:129], v[128:129], v[140:141], v[128:129] neg_lo:[1,0,0] neg_hi:[1,0,0]
    v_pk_fma_f32 v[130:131], v[130:131], v[142:143], v[130:131] neg_lo:[1,0,0] neg_hi:[1,0,0]
    v_pk_fma_f32 v[132:133], v[132:133], v[144:145], v[132:133] neg_lo:[1,0,0] neg_hi:[1,0,0]
    v_pk_fma_f32 v[134:135], v[134:135], v[146:147], v[134:135] neg_lo:[1,0,0] neg_hi:[1,0,0]
    v_cvt_pk_bf16_f32 v136, v128, v129
    v_cvt_pk_bf16_f32 v137, v130, v131
    v_cvt_pk_bf16_f32 v138, v132, v133
    v_cvt_pk_bf16_f32 v139, v134, v135
    s_nop 0
    v_permlane16_swap_b32 v136, v138
    v_permlane16_swap_b32 v137, v139
    buffer_store_dwordx4 v[136:139], v25, s[8:11], s53 offen offset:0 sc1
    v_accvgpr_read_b32 v156, a160
    v_accvgpr_read_b32 v157, a161
    v_accvgpr_read_b32 v158, a162
    v_accvgpr_read_b32 v159, a163
    v_accvgpr_read_b32 v160, a164
    v_accvgpr_read_b32 v161, a165
    v_accvgpr_read_b32 v162, a166
    v_accvgpr_read_b32 v163, a167
    v_pk_add_f32 v[156:157], v[156:157], v[84:85]
    v_pk_add_f32 v[158:159], v[158:159], v[86:87]
    v_pk_add_f32 v[160:161], v[160:161], v[84:85]
    v_pk_add_f32 v[162:163], v[162:163], v[86:87]
    v_pk_mul_f32 v[168:169], v[156:157], s[56:57]
    v_pk_mul_f32 v[170:171], v[158:159], s[56:57]
    v_pk_mul_f32 v[172:173], v[160:161], s[56:57]
    v_pk_mul_f32 v[174:175], v[162:163], s[56:57]
    v_exp_f32 v168, v168
    v_exp_f32 v169, v169
    v_exp_f32 v170, v170
    v_exp_f32 v171, v171
    v_exp_f32 v172, v172
    v_exp_f32 v173, v173
    v_exp_f32 v174, v174
    v_exp_f32 v175, v175
    v_pk_fma_f32 v[176:177], v[168:169], 0.5, 1.0 op_sel_hi:[1,0,0]
    v_pk_fma_f32 v[178:179], v[170:171], 0.5, 1.0 op_sel_hi:[1,0,0]
    v_pk_fma_f32 v[180:181], v[172:173], 0.5, 1.0 op_sel_hi:[1,0,0]
    v_pk_fma_f32 v[182:183], v[174:175], 0.5, 1.0 op_sel_hi:[1,0,0]
    v_pk_fma_f32 v[168:169], v[168:169], v[176:177], 1.0 op_sel_hi:[1,1,0]
    v_pk_fma_f32 v[170:171], v[170:171], v[178:179], 1.0 op_sel_hi:[1,1,0]
    v_pk_fma_f32 v[172:173], v[172:173], v[180:181], 1.0 op_sel_hi:[1,1,0]
    v_pk_fma_f32 v[174:175], v[174:175], v[182:183], 1.0 op_sel_hi:[1,1,0]
    v_rcp_f32 v168, v168
    v_rcp_f32 v169, v169
    v_rcp_f32 v170, v170
    v_rcp_f32 v171, v171
    v_rcp_f32 v172, v172
    v_rcp_f32 v173, v173
    v_rcp_f32 v174, v174
    v_rcp_f32 v175, v175
    v_pk_fma_f32 v[156:157], v[156:157], v[168:169], v[156:157] neg_lo:[1,0,0] neg_hi:[1,0,0]
    v_pk_fma_f32 v[158:159], v[158:159], v[170:171], v[158:159] neg_lo:[1,0,0] neg_hi:[1,0,0]
    v_pk_fma_f32 v[160:161], v[160:161], v[172:173], v[160:161] neg_lo:[1,0,0] neg_hi:[1,0,0]
    v_pk_fma_f32 v[162:163], v[162:163], v[174:175], v[162:163] neg_lo:[1,0,0] neg_hi:[1,0,0]
    v_cvt_pk_bf16_f32 v164, v156, v157
    v_cvt_pk_bf16_f32 v165, v158, v159
    v_cvt_pk_bf16_f32 v166, v160, v161
    v_cvt_pk_bf16_f32 v167, v162, v163
    s_nop 0
    v_permlane16_swap_b32 v164, v166
    v_permlane16_swap_b32 v165, v167
    buffer_store_dwordx4 v[164:167], v25, s[8:11], s53 offen offset:1024 sc1
    v_accvgpr_read_b32 v184, a192
    v_accvgpr_read_b32 v185, a193
    v_accvgpr_read_b32 v186, a194
    v_accvgpr_read_b32 v187, a195
    v_accvgpr_read_b32 v188, a196
    v_accvgpr_read_b32 v189, a197
    v_accvgpr_read_b32 v190, a198
    v_accvgpr_read_b32 v191, a199
    v_pk_add_f32 v[184:185], v[184:185], v[88:89]
    v_pk_add_f32 v[186:187], v[186:187], v[90:91]
    v_pk_add_f32 v[188:189], v[188:189], v[88:89]
    v_pk_add_f32 v[190:191], v[190:191], v[90:91]
    v_pk_mul_f32 v[196:197], v[184:185], s[56:57]
    v_pk_mul_f32 v[198:199], v[186:187], s[56:57]
    v_pk_mul_f32 v[200:201], v[188:189], s[56:57]
    v_pk_mul_f32 v[202:203], v[190:191], s[56:57]
    v_exp_f32 v196, v196
    v_exp_f32 v197, v197
    v_exp_f32 v198, v198
    v_exp_f32 v199, v199
    v_exp_f32 v200, v200
    v_exp_f32 v201, v201
    v_exp_f32 v202, v202
    v_exp_f32 v203, v203
    v_pk_fma_f32 v[204:205], v[196:197], 0.5, 1.0 op_sel_hi:[1,0,0]
    v_pk_fma_f32 v[206:207], v[198:199], 0.5, 1.0 op_sel_hi:[1,0,0]
    v_pk_fma_f32 v[208:209], v[200:201], 0.5, 1.0 op_sel_hi:[1,0,0]
    v_pk_fma_f32 v[210:211], v[202:203], 0.5, 1.0 op_sel_hi:[1,0,0]
    v_pk_fma_f32 v[196:197], v[196:197], v[204:205], 1.0 op_sel_hi:[1,1,0]
    v_pk_fma_f32 v[198:199], v[198:199], v[206:207], 1.0 op_sel_hi:[1,1,0]
    v_pk_fma_f32 v[200:201], v[200:201], v[208:209], 1.0 op_sel_hi:[1,1,0]
    v_pk_fma_f32 v[202:203], v[202:203], v[210:211], 1.0 op_sel_hi:[1,1,0]
    v_rcp_f32 v196, v196
    v_rcp_f32 v197, v197
    v_rcp_f32 v198, v198
    v_rcp_f32 v199, v199
    v_rcp_f32 v200, v200
    v_rcp_f32 v201, v201
    v_rcp_f32 v202, v202
    v_rcp_f32 v203, v203
    v_pk_fma_f32 v[184:185], v[184:185], v[196:197], v[184:185] neg_lo:[1,0,0] neg_hi:[1,0,0]
    v_pk_fma_f32 v[186:187], v[186:187], v[198:199], v[186:187] neg_lo:[1,0,0] neg_hi:[1,0,0]
    v_pk_fma_f32 v[188:189], v[188:189], v[200:201], v[188:189] neg_lo:[1,0,0] neg_hi:[1,0,0]
    v_pk_fma_f32 v[190:191], v[190:191], v[202:203], v[190:191] neg_lo:[1,0,0] neg_hi:[1,0,0]
    v_cvt_pk_bf16_f32 v192, v184, v185
    v_cvt_pk_bf16_f32 v193, v186, v187
    v_cvt_pk_bf16_f32 v194, v188, v189
    v_cvt_pk_bf16_f32 v195, v190, v191
    s_nop 0
    v_permlane16_swap_b32 v192, v194
    v_permlane16_swap_b32 v193, v195
    buffer_store_dwordx4 v[192:195], v25, s[8:11], s53 offen offset:2048 sc1
    v_accvgpr_read_b32 v212, a224
    v_accvgpr_read_b32 v213, a225
    v_accvgpr_read_b32 v214, a226
    v_accvgpr_read_b32 v215, a227
    v_accvgpr_read_b32 v216, a228
    v_accvgpr_read_b32 v217, a229
    v_accvgpr_read_b32 v218, a230
    v_accvgpr_read_b32 v219, a231
    v_pk_add_f32 v[212:213], v[212:213], v[92:93]
    v_pk_add_f32 v[214:215], v[214:215], v[94:95]
    v_pk_add_f32 v[216:217], v[216:217], v[92:93]
    v_pk_add_f32 v[218:219], v[218:219], v[94:95]
    v_pk_mul_f32 v[224:225], v[212:213], s[56:57]
    v_pk_mul_f32 v[226:227], v[214:215], s[56:57]
    v_pk_mul_f32 v[228:229], v[216:217], s[56:57]
    v_pk_mul_f32 v[230:231], v[218:219], s[56:57]
    v_exp_f32 v224, v224
    v_exp_f32 v225, v225
    v_exp_f32 v226, v226
    v_exp_f32 v227, v227
    v_exp_f32 v228, v228
    v_exp_f32 v229, v229
    v_exp_f32 v230, v230
    v_exp_f32 v231, v231
    v_pk_fma_f32 v[232:233], v[224:225], 0.5, 1.0 op_sel_hi:[1,0,0]
    v_pk_fma_f32 v[234:235], v[226:227], 0.5, 1.0 op_sel_hi:[1,0,0]
    v_pk_fma_f32 v[236:237], v[228:229], 0.5, 1.0 op_sel_hi:[1,0,0]
    v_pk_fma_f32 v[238:239], v[230:231], 0.5, 1.0 op_sel_hi:[1,0,0]
    v_pk_fma_f32 v[224:225], v[224:225], v[232:233], 1.0 op_sel_hi:[1,1,0]
    v_pk_fma_f32 v[226:227], v[226:227], v[234:235], 1.0 op_sel_hi:[1,1,0]
    v_pk_fma_f32 v[228:229], v[228:229], v[236:237], 1.0 op_sel_hi:[1,1,0]
    v_pk_fma_f32 v[230:231], v[230:231], v[238:239], 1.0 op_sel_hi:[1,1,0]
    v_rcp_f32 v224, v224
    v_rcp_f32 v225, v225
    v_rcp_f32 v226, v226
    v_rcp_f32 v227, v227
    v_rcp_f32 v228, v228
    v_rcp_f32 v229, v229
    v_rcp_f32 v230, v230
    v_rcp_f32 v231, v231
    v_pk_fma_f32 v[212:213], v[212:213], v[224:225], v[212:213] neg_lo:[1,0,0] neg_hi:[1,0,0]
    v_pk_fma_f32 v[214:215], v[214:215], v[226:227], v[214:215] neg_lo:[1,0,0] neg_hi:[1,0,0]
    v_pk_fma_f32 v[216:217], v[216:217], v[228:229], v[216:217] neg_lo:[1,0,0] neg_hi:[1,0,0]
    v_pk_fma_f32 v[218:219], v[218:219], v[230:231], v[218:219] neg_lo:[1,0,0] neg_hi:[1,0,0]
    v_cvt_pk_bf16_f32 v220, v212, v213
    v_cvt_pk_bf16_f32 v221, v214, v215
    v_cvt_pk_bf16_f32 v222, v216, v217
    v_cvt_pk_bf16_f32 v223, v218, v219
    s_nop 0
    v_permlane16_swap_b32 v220, v222
    v_permlane16_swap_b32 v221, v223
    buffer_store_dwordx4 v[220:223], v25, s[8:11], s53 offen offset:3072 sc1
    s_add_u32 s53, s53, s54
    v_accvgpr_read_b32 v128, a8
    v_accvgpr_read_b32 v129, a9
    v_accvgpr_read_b32 v130, a10
    v_accvgpr_read_b32 v131, a11
    v_accvgpr_read_b32 v132, a12
    v_accvgpr_read_b32 v133, a13
    v_accvgpr_read_b32 v134, a14
    v_accvgpr_read_b32 v135, a15
    v_pk_add_f32 v[128:129], v[128:129], v[64:65]
    v_pk_add_f32 v[130:131], v[130:131], v[66:67]
    v_pk_add_f32 v[132:133], v[132:133], v[64:65]
    v_pk_add_f32 v[134:135], v[134:135], v[66:67]
    v_pk_mul_f32 v[140:141], v[128:129], s[56:57]
    v_pk_mul_f32 v[142:143], v[130:131], s[56:57]
    v_pk_mul_f32 v[144:145], v[132:133], s[56:57]
    v_pk_mul_f32 v[146:147], v[134:135], s[56:57]
    v_exp_f32 v140, v140
    v_exp_f32 v141, v141
    v_exp_f32 v142, v142
    v_exp_f32 v143, v143
    v_exp_f32 v144, v144
    v_exp_f32 v145, v145
    v_exp_f32 v146, v146
    v_exp_f32 v147, v147
    v_pk_fma_f32 v[148:149], v[140:141], 0.5, 1.0 op_sel_hi:[1,0,0]
    v_pk_fma_f32 v[150:151], v[142:143], 0.5, 1.0 op_sel_hi:[1,0,0]
    v_pk_fma_f32 v[152:153], v[144:145], 0.5, 1.0 op_sel_hi:[1,0,0]
    v_pk_fma_f32 v[154:155], v[146:147], 0.5, 1.0 op_sel_hi:[1,0,0]
    v_pk_fma_f32 v[140:141], v[140:141], v[148:149], 1.0 op_sel_hi:[1,1,0]
    v_pk_fma_f32 v[142:143], v[142:143], v[150:151], 1.0 op_sel_hi:[1,1,0]
    v_pk_fma_f32 v[144:145], v[144:145], v[152:153], 1.0 op_sel_hi:[1,1,0]
    v_pk_fma_f32 v[146:147], v[146:147], v[154:155], 1.0 op_sel_hi:[1,1,0]
    v_rcp_f32 v140, v140
    v_rcp_f32 v141, v141
    v_rcp_f32 v142, v142
    v_rcp_f32 v143, v143
    v_rcp_f32 v144, v144
    v_rcp_f32 v145, v145
    v_rcp_f32 v146, v146
    v_rcp_f32 v147, v147
    v_pk_fma_f32 v[128:129], v[128:129], v[140:141], v[128:129] neg_lo:[1,0,0] neg_hi:[1,0,0]
    v_pk_fma_f32 v[130:131], v[130:131], v[142:143], v[130:131] neg_lo:[1,0,0] neg_hi:[1,0,0]
    v_pk_fma_f32 v[132:133], v[132:133], v[144:145], v[132:133] neg_lo:[1,0,0] neg_hi:[1,0,0]
    v_pk_fma_f32 v[134:135], v[134:135], v[146:147], v[134:135] neg_lo:[1,0,0] neg_hi:[1,0,0]
    v_cvt_pk_bf16_f32 v136, v128, v129
    v_cvt_pk_bf16_f32 v137, v130, v131
    v_cvt_pk_bf16_f32 v138, v132, v133
    v_cvt_pk_bf16_f32 v139, v134, v135
    s_nop 0
    v_permlane16_swap_b32 v136, v138
    v_permlane16_swap_b32 v137, v139
    buffer_store_dwordx4 v[136:139], v24, s[8:11], s53 offen offset:0 sc1
    v_accvgpr_read_b32 v156, a40
    v_accvgpr_read_b32 v157, a41
    v_accvgpr_read_b32 v158, a42
    v_accvgpr_read_b32 v159, a43
    v_accvgpr_read_b32 v160, a44
    v_accvgpr_read_b32 v161, a45
    v_accvgpr_read_b32 v162, a46
    v_accvgpr_read_b32 v163, a47
    v_pk_add_f32 v[156:157], v[156:157], v[68:69]
    v_pk_add_f32 v[158:159], v[158:159], v[70:71]
    v_pk_add_f32 v[160:161], v[160:161], v[68:69]
    v_pk_add_f32 v[162:163], v[162:163], v[70:71]
    v_pk_mul_f32 v[168:169], v[156:157], s[56:57]
    v_pk_mul_f32 v[170:171], v[158:159], s[56:57]
    v_pk_mul_f32 v[172:173], v[160:161], s[56:57]
    v_pk_mul_f32 v[174:175], v[162:163], s[56:57]
    v_exp_f32 v168, v168
    v_exp_f32 v169, v169
    v_exp_f32 v170, v170
    v_exp_f32 v171, v171
    v_exp_f32 v172, v172
    v_exp_f32 v173, v173
    v_exp_f32 v174, v174
    v_exp_f32 v175, v175
    v_pk_fma_f32 v[176:177], v[168:169], 0.5, 1.0 op_sel_hi:[1,0,0]
    v_pk_fma_f32 v[178:179], v[170:171], 0.5, 1.0 op_sel_hi:[1,0,0]
    v_pk_fma_f32 v[180:181], v[172:173], 0.5, 1.0 op_sel_hi:[1,0,0]
    v_pk_fma_f32 v[182:183], v[174:175], 0.5, 1.0 op_sel_hi:[1,0,0]
    v_pk_fma_f32 v[168:169], v[168:169], v[176:177], 1.0 op_sel_hi:[1,1,0]
    v_pk_fma_f32 v[170:171], v[170:171], v[178:179], 1.0 op_sel_hi:[1,1,0]
    v_pk_fma_f32 v[172:173], v[172:173], v[180:181], 1.0 op_sel_hi:[1,1,0]
    v_pk_fma_f32 v[174:175], v[174:175], v[182:183], 1.0 op_sel_hi:[1,1,0]
    v_rcp_f32 v168, v168
    v_rcp_f32 v169, v169
    v_rcp_f32 v170, v170
    v_rcp_f32 v171, v171
    v_rcp_f32 v172, v172
    v_rcp_f32 v173, v173
    v_rcp_f32 v174, v174
    v_rcp_f32 v175, v175
    v_pk_fma_f32 v[156:157], v[156:157], v[168:169], v[156:157] neg_lo:[1,0,0] neg_hi:[1,0,0]
    v_pk_fma_f32 v[158:159], v[158:159], v[170:171], v[158:159] neg_lo:[1,0,0] neg_hi:[1,0,0]
    v_pk_fma_f32 v[160:161], v[160:161], v[172:173], v[160:161] neg_lo:[1,0,0] neg_hi:[1,0,0]
    v_pk_fma_f32 v[162:163], v[162:163], v[174:175], v[162:163] neg_lo:[1,0,0] neg_hi:[1,0,0]
    v_cvt_pk_bf16_f32 v164, v156, v157
    v_cvt_pk_bf16_f32 v165, v158, v159
    v_cvt_pk_bf16_f32 v166, v160, v161
    v_cvt_pk_bf16_f32 v167, v162, v163
    s_nop 0
    v_permlane16_swap_b32 v164, v166
    v_permlane16_swap_b32 v165, v167
    buffer_store_dwordx4 v[164:167], v24, s[8:11], s53 offen offset:1024 sc1
    v_accvgpr_read_b32 v184, a72
    v_accvgpr_read_b32 v185, a73
    v_accvgpr_read_b32 v186, a74
    v_accvgpr_read_b32 v187, a75
    v_accvgpr_read_b32 v188, a76
    v_accvgpr_read_b32 v189, a77
    v_accvgpr_read_b32 v190, a78
    v_accvgpr_read_b32 v191, a79
    v_pk_add_f32 v[184:185], v[184:185], v[72:73]
    v_pk_add_f32 v[186:187], v[186:187], v[74:75]
    v_pk_add_f32 v[188:189], v[188:189], v[72:73]
    v_pk_add_f32 v[190:191], v[190:191], v[74:75]
    v_pk_mul_f32 v[196:197], v[184:185], s[56:57]
    v_pk_mul_f32 v[198:199], v[186:187], s[56:57]
    v_pk_mul_f32 v[200:201], v[188:189], s[56:57]
    v_pk_mul_f32 v[202:203], v[190:191], s[56:57]
    v_exp_f32 v196, v196
    v_exp_f32 v197, v197
    v_exp_f32 v198, v198
    v_exp_f32 v199, v199
    v_exp_f32 v200, v200
    v_exp_f32 v201, v201
    v_exp_f32 v202, v202
    v_exp_f32 v203, v203
    v_pk_fma_f32 v[204:205], v[196:197], 0.5, 1.0 op_sel_hi:[1,0,0]
    v_pk_fma_f32 v[206:207], v[198:199], 0.5, 1.0 op_sel_hi:[1,0,0]
    v_pk_fma_f32 v[208:209], v[200:201], 0.5, 1.0 op_sel_hi:[1,0,0]
    v_pk_fma_f32 v[210:211], v[202:203], 0.5, 1.0 op_sel_hi:[1,0,0]
    v_pk_fma_f32 v[196:197], v[196:197], v[204:205], 1.0 op_sel_hi:[1,1,0]
    v_pk_fma_f32 v[198:199], v[198:199], v[206:207], 1.0 op_sel_hi:[1,1,0]
    v_pk_fma_f32 v[200:201], v[200:201], v[208:209], 1.0 op_sel_hi:[1,1,0]
    v_pk_fma_f32 v[202:203], v[202:203], v[210:211], 1.0 op_sel_hi:[1,1,0]
    v_rcp_f32 v196, v196
    v_rcp_f32 v197, v197
    v_rcp_f32 v198, v198
    v_rcp_f32 v199, v199
    v_rcp_f32 v200, v200
    v_rcp_f32 v201, v201
    v_rcp_f32 v202, v202
    v_rcp_f32 v203, v203
    v_pk_fma_f32 v[184:185], v[184:185], v[196:197], v[184:185] neg_lo:[1,0,0] neg_hi:[1,0,0]
    v_pk_fma_f32 v[186:187], v[186:187], v[198:199], v[186:187] neg_lo:[1,0,0] neg_hi:[1,0,0]
    v_pk_fma_f32 v[188:189], v[188:189], v[200:201], v[188:189] neg_lo:[1,0,0] neg_hi:[1,0,0]
    v_pk_fma_f32 v[190:191], v[190:191], v[202:203], v[190:191] neg_lo:[1,0,0] neg_hi:[1,0,0]
    v_cvt_pk_bf16_f32 v192, v184, v185
    v_cvt_pk_bf16_f32 v193, v186, v187
    v_cvt_pk_bf16_f32 v194, v188, v189
    v_cvt_pk_bf16_f32 v195, v190, v191
    s_nop 0
    v_permlane16_swap_b32 v192, v194
    v_permlane16_swap_b32 v193, v195
    buffer_store_dwordx4 v[192:195], v24, s[8:11], s53 offen offset:2048 sc1
    v_accvgpr_read_b32 v212, a104
    v_accvgpr_read_b32 v213, a105
    v_accvgpr_read_b32 v214, a106
    v_accvgpr_read_b32 v215, a107
    v_accvgpr_read_b32 v216, a108
    v_accvgpr_read_b32 v217, a109
    v_accvgpr_read_b32 v218, a110
    v_accvgpr_read_b32 v219, a111
    v_pk_add_f32 v[212:213], v[212:213], v[76:77]
    v_pk_add_f32 v[214:215], v[214:215], v[78:79]
    v_pk_add_f32 v[216:217], v[216:217], v[76:77]
    v_pk_add_f32 v[218:219], v[218:219], v[78:79]
    v_pk_mul_f32 v[224:225], v[212:213], s[56:57]
    v_pk_mul_f32 v[226:227], v[214:215], s[56:57]
    v_pk_mul_f32 v[228:229], v[216:217], s[56:57]
    v_pk_mul_f32 v[230:231], v[218:219], s[56:57]
    v_exp_f32 v224, v224
    v_exp_f32 v225, v225
    v_exp_f32 v226, v226
    v_exp_f32 v227, v227
    v_exp_f32 v228, v228
    v_exp_f32 v229, v229
    v_exp_f32 v230, v230
    v_exp_f32 v231, v231
    v_pk_fma_f32 v[232:233], v[224:225], 0.5, 1.0 op_sel_hi:[1,0,0]
    v_pk_fma_f32 v[234:235], v[226:227], 0.5, 1.0 op_sel_hi:[1,0,0]
    v_pk_fma_f32 v[236:237], v[228:229], 0.5, 1.0 op_sel_hi:[1,0,0]
    v_pk_fma_f32 v[238:239], v[230:231], 0.5, 1.0 op_sel_hi:[1,0,0]
    v_pk_fma_f32 v[224:225], v[224:225], v[232:233], 1.0 op_sel_hi:[1,1,0]
    v_pk_fma_f32 v[226:227], v[226:227], v[234:235], 1.0 op_sel_hi:[1,1,0]
    v_pk_fma_f32 v[228:229], v[228:229], v[236:237], 1.0 op_sel_hi:[1,1,0]
    v_pk_fma_f32 v[230:231], v[230:231], v[238:239], 1.0 op_sel_hi:[1,1,0]
    v_rcp_f32 v224, v224
    v_rcp_f32 v225, v225
    v_rcp_f32 v226, v226
    v_rcp_f32 v227, v227
    v_rcp_f32 v228, v228
    v_rcp_f32 v229, v229
    v_rcp_f32 v230, v230
    v_rcp_f32 v231, v231
    v_pk_fma_f32 v[212:213], v[212:213], v[224:225], v[212:213] neg_lo:[1,0,0] neg_hi:[1,0,0]
    v_pk_fma_f32 v[214:215], v[214:215], v[226:227], v[214:215] neg_lo:[1,0,0] neg_hi:[1,0,0]
    v_pk_fma_f32 v[216:217], v[216:217], v[228:229], v[216:217] neg_lo:[1,0,0] neg_hi:[1,0,0]
    v_pk_fma_f32 v[218:219], v[218:219], v[230:231], v[218:219] neg_lo:[1,0,0] neg_hi:[1,0,0]
    v_cvt_pk_bf16_f32 v220, v212, v213
    v_cvt_pk_bf16_f32 v221, v214, v215
    v_cvt_pk_bf16_f32 v222, v216, v217
    v_cvt_pk_bf16_f32 v223, v218, v219
    s_nop 0
    v_permlane16_swap_b32 v220, v222
    v_permlane16_swap_b32 v221, v223
    buffer_store_dwordx4 v[220:223], v24, s[8:11], s53 offen offset:3072 sc1
    v_accvgpr_read_b32 v128, a136
    v_accvgpr_read_b32 v129, a137
    v_accvgpr_read_b32 v130, a138
    v_accvgpr_read_b32 v131, a139
    v_accvgpr_read_b32 v132, a140
    v_accvgpr_read_b32 v133, a141
    v_accvgpr_read_b32 v134, a142
    v_accvgpr_read_b32 v135, a143
    v_pk_add_f32 v[128:129], v[128:129], v[80:81]
    v_pk_add_f32 v[130:131], v[130:131], v[82:83]
    v_pk_add_f32 v[132:133], v[132:133], v[80:81]
    v_pk_add_f32 v[134:135], v[134:135], v[82:83]
    v_pk_mul_f32 v[140:141], v[128:129], s[56:57]
    v_pk_mul_f32 v[142:143], v[130:131], s[56:57]
    v_pk_mul_f32 v[144:145], v[132:133], s[56:57]
    v_pk_mul_f32 v[146:147], v[134:135], s[56:57]
    v_exp_f32 v140, v140
    v_exp_f32 v141, v141
    v_exp_f32 v142, v142
    v_exp_f32 v143, v143
    v_exp_f32 v144, v144
    v_exp_f32 v145, v145
    v_exp_f32 v146, v146
    v_exp_f32 v147, v147
    v_pk_fma_f32 v[148:149], v[140:141], 0.5, 1.0 op_sel_hi:[1,0,0]
    v_pk_fma_f32 v[150:151], v[142:143], 0.5, 1.0 op_sel_hi:[1,0,0]
    v_pk_fma_f32 v[152:153], v[144:145], 0.5, 1.0 op_sel_hi:[1,0,0]
    v_pk_fma_f32 v[154:155], v[146:147], 0.5, 1.0 op_sel_hi:[1,0,0]
    v_pk_fma_f32 v[140:141], v[140:141], v[148:149], 1.0 op_sel_hi:[1,1,0]
    v_pk_fma_f32 v[142:143], v[142:143], v[150:151], 1.0 op_sel_hi:[1,1,0]
    v_pk_fma_f32 v[144:145], v[144:145], v[152:153], 1.0 op_sel_hi:[1,1,0]
    v_pk_fma_f32 v[146:147], v[146:147], v[154:155], 1.0 op_sel_hi:[1,1,0]
    v_rcp_f32 v140, v140
    v_rcp_f32 v141, v141
    v_rcp_f32 v142, v142
    v_rcp_f32 v143, v143
    v_rcp_f32 v144, v144
    v_rcp_f32 v145, v145
    v_rcp_f32 v146, v146
    v_rcp_f32 v147, v147
    v_pk_fma_f32 v[128:129], v[128:129], v[140:141], v[128:129] neg_lo:[1,0,0] neg_hi:[1,0,0]
    v_pk_fma_f32 v[130:131], v[130:131], v[142:143], v[130:131] neg_lo:[1,0,0] neg_hi:[1,0,0]
    v_pk_fma_f32 v[132:133], v[132:133], v[144:145], v[132:133] neg_lo:[1,0,0] neg_hi:[1,0,0]
    v_pk_fma_f32 v[134:135], v[134:135], v[146:147], v[134:135] neg_lo:[1,0,0] neg_hi:[1,0,0]
    v_cvt_pk_bf16_f32 v136, v128, v129
    v_cvt_pk_bf16_f32 v137, v130, v131
    v_cvt_pk_bf16_f32 v138, v132, v133
    v_cvt_pk_bf16_f32 v139, v134, v135
    s_nop 0
    v_permlane16_swap_b32 v136, v138
    v_permlane16_swap_b32 v137, v139
    buffer_store_dwordx4 v[136:139], v25, s[8:11], s53 offen offset:0 sc1
    v_accvgpr_read_b32 v156, a168
    v_accvgpr_read_b32 v157, a169
    v_accvgpr_read_b32 v158, a170
    v_accvgpr_read_b32 v159, a171
    v_accvgpr_read_b32 v160, a172
    v_accvgpr_read_b32 v161, a173
    v_accvgpr_read_b32 v162, a174
    v_accvgpr_read_b32 v163, a175
    v_pk_add_f32 v[156:157], v[156:157], v[84:85]
    v_pk_add_f32 v[158:159], v[158:159], v[86:87]
    v_pk_add_f32 v[160:161], v[160:161], v[84:85]
    v_pk_add_f32 v[162:163], v[162:163], v[86:87]
    v_pk_mul_f32 v[168:169], v[156:157], s[56:57]
    v_pk_mul_f32 v[170:171], v[158:159], s[56:57]
    v_pk_mul_f32 v[172:173], v[160:161], s[56:57]
    v_pk_mul_f32 v[174:175], v[162:163], s[56:57]
    v_exp_f32 v168, v168
    v_exp_f32 v169, v169
    v_exp_f32 v170, v170
    v_exp_f32 v171, v171
    v_exp_f32 v172, v172
    v_exp_f32 v173, v173
    v_exp_f32 v174, v174
    v_exp_f32 v175, v175
    v_pk_fma_f32 v[176:177], v[168:169], 0.5, 1.0 op_sel_hi:[1,0,0]
    v_pk_fma_f32 v[178:179], v[170:171], 0.5, 1.0 op_sel_hi:[1,0,0]
    v_pk_fma_f32 v[180:181], v[172:173], 0.5, 1.0 op_sel_hi:[1,0,0]
    v_pk_fma_f32 v[182:183], v[174:175], 0.5, 1.0 op_sel_hi:[1,0,0]
    v_pk_fma_f32 v[168:169], v[168:169], v[176:177], 1.0 op_sel_hi:[1,1,0]
    v_pk_fma_f32 v[170:171], v[170:171], v[178:179], 1.0 op_sel_hi:[1,1,0]
    v_pk_fma_f32 v[172:173], v[172:173], v[180:181], 1.0 op_sel_hi:[1,1,0]
    v_pk_fma_f32 v[174:175], v[174:175], v[182:183], 1.0 op_sel_hi:[1,1,0]
    v_rcp_f32 v168, v168
    v_rcp_f32 v169, v169
    v_rcp_f32 v170, v170
    v_rcp_f32 v171, v171
    v_rcp_f32 v172, v172
    v_rcp_f32 v173, v173
    v_rcp_f32 v174, v174
    v_rcp_f32 v175, v175
    v_pk_fma_f32 v[156:157], v[156:157], v[168:169], v[156:157] neg_lo:[1,0,0] neg_hi:[1,0,0]
    v_pk_fma_f32 v[158:159], v[158:159], v[170:171], v[158:159] neg_lo:[1,0,0] neg_hi:[1,0,0]
    v_pk_fma_f32 v[160:161], v[160:161], v[172:173], v[160:161] neg_lo:[1,0,0] neg_hi:[1,0,0]
    v_pk_fma_f32 v[162:163], v[162:163], v[174:175], v[162:163] neg_lo:[1,0,0] neg_hi:[1,0,0]
    v_cvt_pk_bf16_f32 v164, v156, v157
    v_cvt_pk_bf16_f32 v165, v158, v159
    v_cvt_pk_bf16_f32 v166, v160, v161
    v_cvt_pk_bf16_f32 v167, v162, v163
    s_nop 0
    v_permlane16_swap_b32 v164, v166
    v_permlane16_swap_b32 v165, v167
    buffer_store_dwordx4 v[164:167], v25, s[8:11], s53 offen offset:1024 sc1
    v_accvgpr_read_b32 v184, a200
    v_accvgpr_read_b32 v185, a201
    v_accvgpr_read_b32 v186, a202
    v_accvgpr_read_b32 v187, a203
    v_accvgpr_read_b32 v188, a204
    v_accvgpr_read_b32 v189, a205
    v_accvgpr_read_b32 v190, a206
    v_accvgpr_read_b32 v191, a207
    v_pk_add_f32 v[184:185], v[184:185], v[88:89]
    v_pk_add_f32 v[186:187], v[186:187], v[90:91]
    v_pk_add_f32 v[188:189], v[188:189], v[88:89]
    v_pk_add_f32 v[190:191], v[190:191], v[90:91]
    v_pk_mul_f32 v[196:197], v[184:185], s[56:57]
    v_pk_mul_f32 v[198:199], v[186:187], s[56:57]
    v_pk_mul_f32 v[200:201], v[188:189], s[56:57]
    v_pk_mul_f32 v[202:203], v[190:191], s[56:57]
    v_exp_f32 v196, v196
    v_exp_f32 v197, v197
    v_exp_f32 v198, v198
    v_exp_f32 v199, v199
    v_exp_f32 v200, v200
    v_exp_f32 v201, v201
    v_exp_f32 v202, v202
    v_exp_f32 v203, v203
    v_pk_fma_f32 v[204:205], v[196:197], 0.5, 1.0 op_sel_hi:[1,0,0]
    v_pk_fma_f32 v[206:207], v[198:199], 0.5, 1.0 op_sel_hi:[1,0,0]
    v_pk_fma_f32 v[208:209], v[200:201], 0.5, 1.0 op_sel_hi:[1,0,0]
    v_pk_fma_f32 v[210:211], v[202:203], 0.5, 1.0 op_sel_hi:[1,0,0]
    v_pk_fma_f32 v[196:197], v[196:197], v[204:205], 1.0 op_sel_hi:[1,1,0]
    v_pk_fma_f32 v[198:199], v[198:199], v[206:207], 1.0 op_sel_hi:[1,1,0]
    v_pk_fma_f32 v[200:201], v[200:201], v[208:209], 1.0 op_sel_hi:[1,1,0]
    v_pk_fma_f32 v[202:203], v[202:203], v[210:211], 1.0 op_sel_hi:[1,1,0]
    v_rcp_f32 v196, v196
    v_rcp_f32 v197, v197
    v_rcp_f32 v198, v198
    v_rcp_f32 v199, v199
    v_rcp_f32 v200, v200
    v_rcp_f32 v201, v201
    v_rcp_f32 v202, v202
    v_rcp_f32 v203, v203
    v_pk_fma_f32 v[184:185], v[184:185], v[196:197], v[184:185] neg_lo:[1,0,0] neg_hi:[1,0,0]
    v_pk_fma_f32 v[186:187], v[186:187], v[198:199], v[186:187] neg_lo:[1,0,0] neg_hi:[1,0,0]
    v_pk_fma_f32 v[188:189], v[188:189], v[200:201], v[188:189] neg_lo:[1,0,0] neg_hi:[1,0,0]
    v_pk_fma_f32 v[190:191], v[190:191], v[202:203], v[190:191] neg_lo:[1,0,0] neg_hi:[1,0,0]
    v_cvt_pk_bf16_f32 v192, v184, v185
    v_cvt_pk_bf16_f32 v193, v186, v187
    v_cvt_pk_bf16_f32 v194, v188, v189
    v_cvt_pk_bf16_f32 v195, v190, v191
    s_nop 0
    v_permlane16_swap_b32 v192, v194
    v_permlane16_swap_b32 v193, v195
    buffer_store_dwordx4 v[192:195], v25, s[8:11], s53 offen offset:2048 sc1
    v_accvgpr_read_b32 v212, a232
    v_accvgpr_read_b32 v213, a233
    v_accvgpr_read_b32 v214, a234
    v_accvgpr_read_b32 v215, a235
    v_accvgpr_read_b32 v216, a236
    v_accvgpr_read_b32 v217, a237
    v_accvgpr_read_b32 v218, a238
    v_accvgpr_read_b32 v219, a239
    v_pk_add_f32 v[212:213], v[212:213], v[92:93]
    v_pk_add_f32 v[214:215], v[214:215], v[94:95]
    v_pk_add_f32 v[216:217], v[216:217], v[92:93]
    v_pk_add_f32 v[218:219], v[218:219], v[94:95]
    v_pk_mul_f32 v[224:225], v[212:213], s[56:57]
    v_pk_mul_f32 v[226:227], v[214:215], s[56:57]
    v_pk_mul_f32 v[228:229], v[216:217], s[56:57]
    v_pk_mul_f32 v[230:231], v[218:219], s[56:57]
    v_exp_f32 v224, v224
    v_exp_f32 v225, v225
    v_exp_f32 v226, v226
    v_exp_f32 v227, v227
    v_exp_f32 v228, v228
    v_exp_f32 v229, v229
    v_exp_f32 v230, v230
    v_exp_f32 v231, v231
    v_pk_fma_f32 v[232:233], v[224:225], 0.5, 1.0 op_sel_hi:[1,0,0]
    v_pk_fma_f32 v[234:235], v[226:227], 0.5, 1.0 op_sel_hi:[1,0,0]
    v_pk_fma_f32 v[236:237], v[228:229], 0.5, 1.0 op_sel_hi:[1,0,0]
    v_pk_fma_f32 v[238:239], v[230:231], 0.5, 1.0 op_sel_hi:[1,0,0]
    v_pk_fma_f32 v[224:225], v[224:225], v[232:233], 1.0 op_sel_hi:[1,1,0]
    v_pk_fma_f32 v[226:227], v[226:227], v[234:235], 1.0 op_sel_hi:[1,1,0]
    v_pk_fma_f32 v[228:229], v[228:229], v[236:237], 1.0 op_sel_hi:[1,1,0]
    v_pk_fma_f32 v[230:231], v[230:231], v[238:239], 1.0 op_sel_hi:[1,1,0]
    v_rcp_f32 v224, v224
    v_rcp_f32 v225, v225
    v_rcp_f32 v226, v226
    v_rcp_f32 v227, v227
    v_rcp_f32 v228, v228
    v_rcp_f32 v229, v229
    v_rcp_f32 v230, v230
    v_rcp_f32 v231, v231
    v_pk_fma_f32 v[212:213], v[212:213], v[224:225], v[212:213] neg_lo:[1,0,0] neg_hi:[1,0,0]
    v_pk_fma_f32 v[214:215], v[214:215], v[226:227], v[214:215] neg_lo:[1,0,0] neg_hi:[1,0,0]
    v_pk_fma_f32 v[216:217], v[216:217], v[228:229], v[216:217] neg_lo:[1,0,0] neg_hi:[1,0,0]
    v_pk_fma_f32 v[218:219], v[218:219], v[230:231], v[218:219] neg_lo:[1,0,0] neg_hi:[1,0,0]
    v_cvt_pk_bf16_f32 v220, v212, v213
    v_cvt_pk_bf16_f32 v221, v214, v215
    v_cvt_pk_bf16_f32 v222, v216, v217
    v_cvt_pk_bf16_f32 v223, v218, v219
    s_nop 0
    v_permlane16_swap_b32 v220, v222
    v_permlane16_swap_b32 v221, v223
    buffer_store_dwordx4 v[220:223], v25, s[8:11], s53 offen offset:3072 sc1
    s_add_u32 s53, s53, s54
    v_accvgpr_read_b32 v128, a16
    v_accvgpr_read_b32 v129, a17
    v_accvgpr_read_b32 v130, a18
    v_accvgpr_read_b32 v131, a19
    v_accvgpr_read_b32 v132, a20
    v_accvgpr_read_b32 v133, a21
    v_accvgpr_read_b32 v134, a22
    v_accvgpr_read_b32 v135, a23
    v_pk_add_f32 v[128:129], v[128:129], v[64:65]
    v_pk_add_f32 v[130:131], v[130:131], v[66:67]
    v_pk_add_f32 v[132:133], v[132:133], v[64:65]
    v_pk_add_f32 v[134:135], v[134:135], v[66:67]
    v_pk_mul_f32 v[140:141], v[128:129], s[56:57]
    v_pk_mul_f32 v[142:143], v[130:131], s[56:57]
    v_pk_mul_f32 v[144:145], v[132:133], s[56:57]
    v_pk_mul_f32 v[146:147], v[134:135], s[56:57]
    v_exp_f32 v140, v140
    v_exp_f32 v141, v141
    v_exp_f32 v142, v142
    v_exp_f32 v143, v143
    v_exp_f32 v144, v144
    v_exp_f32 v145, v145
    v_exp_f32 v146, v146
    v_exp_f32 v147, v147
    v_pk_fma_f32 v[148:149], v[140:141], 0.5, 1.0 op_sel_hi:[1,0,0]
    v_pk_fma_f32 v[150:151], v[142:143], 0.5, 1.0 op_sel_hi:[1,0,0]
    v_pk_fma_f32 v[152:153], v[144:145], 0.5, 1.0 op_sel_hi:[1,0,0]
    v_pk_fma_f32 v[154:155], v[146:147], 0.5, 1.0 op_sel_hi:[1,0,0]
    v_pk_fma_f32 v[140:141], v[140:141], v[148:149], 1.0 op_sel_hi:[1,1,0]
    v_pk_fma_f32 v[142:143], v[142:143], v[150:151], 1.0 op_sel_hi:[1,1,0]
    v_pk_fma_f32 v[144:145], v[144:145], v[152:153], 1.0 op_sel_hi:[1,1,0]
    v_pk_fma_f32 v[146:147], v[146:147], v[154:155], 1.0 op_sel_hi:[1,1,0]
    v_rcp_f32 v140, v140
    v_rcp_f32 v141, v141
    v_rcp_f32 v142, v142
    v_rcp_f32 v143, v143
    v_rcp_f32 v144, v144
    v_rcp_f32 v145, v145
    v_rcp_f32 v146, v146
    v_rcp_f32 v147, v147
    v_pk_fma_f32 v[128:129], v[128:129], v[140:141], v[128:129] neg_lo:[1,0,0] neg_hi:[1,0,0]
    v_pk_fma_f32 v[130:131], v[130:131], v[142:143], v[130:131] neg_lo:[1,0,0] neg_hi:[1,0,0]
    v_pk_fma_f32 v[132:133], v[132:133], v[144:145], v[132:133] neg_lo:[1,0,0] neg_hi:[1,0,0]
    v_pk_fma_f32 v[134:135], v[134:135], v[146:147], v[134:135] neg_lo:[1,0,0] neg_hi:[1,0,0]
    v_cvt_pk_bf16_f32 v136, v128, v129
    v_cvt_pk_bf16_f32 v137, v130, v131
    v_cvt_pk_bf16_f32 v138, v132, v133
    v_cvt_pk_bf16_f32 v139, v134, v135
    s_nop 0
    v_permlane16_swap_b32 v136, v138
    v_permlane16_swap_b32 v137, v139
    buffer_store_dwordx4 v[136:139], v24, s[8:11], s53 offen offset:0 sc1
    v_accvgpr_read_b32 v156, a48
    v_accvgpr_read_b32 v157, a49
    v_accvgpr_read_b32 v158, a50
    v_accvgpr_read_b32 v159, a51
    v_accvgpr_read_b32 v160, a52
    v_accvgpr_read_b32 v161, a53
    v_accvgpr_read_b32 v162, a54
    v_accvgpr_read_b32 v163, a55
    v_pk_add_f32 v[156:157], v[156:157], v[68:69]
    v_pk_add_f32 v[158:159], v[158:159], v[70:71]
    v_pk_add_f32 v[160:161], v[160:161], v[68:69]
    v_pk_add_f32 v[162:163], v[162:163], v[70:71]
    v_pk_mul_f32 v[168:169], v[156:157], s[56:57]
    v_pk_mul_f32 v[170:171], v[158:159], s[56:57]
    v_pk_mul_f32 v[172:173], v[160:161], s[56:57]
    v_pk_mul_f32 v[174:175], v[162:163], s[56:57]
    v_exp_f32 v168, v168
    v_exp_f32 v169, v169
    v_exp_f32 v170, v170
    v_exp_f32 v171, v171
    v_exp_f32 v172, v172
    v_exp_f32 v173, v173
    v_exp_f32 v174, v174
    v_exp_f32 v175, v175
    v_pk_fma_f32 v[176:177], v[168:169], 0.5, 1.0 op_sel_hi:[1,0,0]
    v_pk_fma_f32 v[178:179], v[170:171], 0.5, 1.0 op_sel_hi:[1,0,0]
    v_pk_fma_f32 v[180:181], v[172:173], 0.5, 1.0 op_sel_hi:[1,0,0]
    v_pk_fma_f32 v[182:183], v[174:175], 0.5, 1.0 op_sel_hi:[1,0,0]
    v_pk_fma_f32 v[168:169], v[168:169], v[176:177], 1.0 op_sel_hi:[1,1,0]
    v_pk_fma_f32 v[170:171], v[170:171], v[178:179], 1.0 op_sel_hi:[1,1,0]
    v_pk_fma_f32 v[172:173], v[172:173], v[180:181], 1.0 op_sel_hi:[1,1,0]
    v_pk_fma_f32 v[174:175], v[174:175], v[182:183], 1.0 op_sel_hi:[1,1,0]
    v_rcp_f32 v168, v168
    v_rcp_f32 v169, v169
    v_rcp_f32 v170, v170
    v_rcp_f32 v171, v171
    v_rcp_f32 v172, v172
    v_rcp_f32 v173, v173
    v_rcp_f32 v174, v174
    v_rcp_f32 v175, v175
    v_pk_fma_f32 v[156:157], v[156:157], v[168:169], v[156:157] neg_lo:[1,0,0] neg_hi:[1,0,0]
    v_pk_fma_f32 v[158:159], v[158:159], v[170:171], v[158:159] neg_lo:[1,0,0] neg_hi:[1,0,0]
    v_pk_fma_f32 v[160:161], v[160:161], v[172:173], v[160:161] neg_lo:[1,0,0] neg_hi:[1,0,0]
    v_pk_fma_f32 v[162:163], v[162:163], v[174:175], v[162:163] neg_lo:[1,0,0] neg_hi:[1,0,0]
    v_cvt_pk_bf16_f32 v164, v156, v157
    v_cvt_pk_bf16_f32 v165, v158, v159
    v_cvt_pk_bf16_f32 v166, v160, v161
    v_cvt_pk_bf16_f32 v167, v162, v163
    s_nop 0
    v_permlane16_swap_b32 v164, v166
    v_permlane16_swap_b32 v165, v167
    buffer_store_dwordx4 v[164:167], v24, s[8:11], s53 offen offset:1024 sc1
    v_accvgpr_read_b32 v184, a80
    v_accvgpr_read_b32 v185, a81
    v_accvgpr_read_b32 v186, a82
    v_accvgpr_read_b32 v187, a83
    v_accvgpr_read_b32 v188, a84
    v_accvgpr_read_b32 v189, a85
    v_accvgpr_read_b32 v190, a86
    v_accvgpr_read_b32 v191, a87
    v_pk_add_f32 v[184:185], v[184:185], v[72:73]
    v_pk_add_f32 v[186:187], v[186:187], v[74:75]
    v_pk_add_f32 v[188:189], v[188:189], v[72:73]
    v_pk_add_f32 v[190:191], v[190:191], v[74:75]
    v_pk_mul_f32 v[196:197], v[184:185], s[56:57]
    v_pk_mul_f32 v[198:199], v[186:187], s[56:57]
    v_pk_mul_f32 v[200:201], v[188:189], s[56:57]
    v_pk_mul_f32 v[202:203], v[190:191], s[56:57]
    v_exp_f32 v196, v196
    v_exp_f32 v197, v197
    v_exp_f32 v198, v198
    v_exp_f32 v199, v199
    v_exp_f32 v200, v200
    v_exp_f32 v201, v201
    v_exp_f32 v202, v202
    v_exp_f32 v203, v203
    v_pk_fma_f32 v[204:205], v[196:197], 0.5, 1.0 op_sel_hi:[1,0,0]
    v_pk_fma_f32 v[206:207], v[198:199], 0.5, 1.0 op_sel_hi:[1,0,0]
    v_pk_fma_f32 v[208:209], v[200:201], 0.5, 1.0 op_sel_hi:[1,0,0]
    v_pk_fma_f32 v[210:211], v[202:203], 0.5, 1.0 op_sel_hi:[1,0,0]
    v_pk_fma_f32 v[196:197], v[196:197], v[204:205], 1.0 op_sel_hi:[1,1,0]
    v_pk_fma_f32 v[198:199], v[198:199], v[206:207], 1.0 op_sel_hi:[1,1,0]
    v_pk_fma_f32 v[200:201], v[200:201], v[208:209], 1.0 op_sel_hi:[1,1,0]
    v_pk_fma_f32 v[202:203], v[202:203], v[210:211], 1.0 op_sel_hi:[1,1,0]
    v_rcp_f32 v196, v196
    v_rcp_f32 v197, v197
    v_rcp_f32 v198, v198
    v_rcp_f32 v199, v199
    v_rcp_f32 v200, v200
    v_rcp_f32 v201, v201
    v_rcp_f32 v202, v202
    v_rcp_f32 v203, v203
    v_pk_fma_f32 v[184:185], v[184:185], v[196:197], v[184:185] neg_lo:[1,0,0] neg_hi:[1,0,0]
    v_pk_fma_f32 v[186:187], v[186:187], v[198:199], v[186:187] neg_lo:[1,0,0] neg_hi:[1,0,0]
    v_pk_fma_f32 v[188:189], v[188:189], v[200:201], v[188:189] neg_lo:[1,0,0] neg_hi:[1,0,0]
    v_pk_fma_f32 v[190:191], v[190:191], v[202:203], v[190:191] neg_lo:[1,0,0] neg_hi:[1,0,0]
    v_cvt_pk_bf16_f32 v192, v184, v185
    v_cvt_pk_bf16_f32 v193, v186, v187
    v_cvt_pk_bf16_f32 v194, v188, v189
    v_cvt_pk_bf16_f32 v195, v190, v191
    s_nop 0
    v_permlane16_swap_b32 v192, v194
    v_permlane16_swap_b32 v193, v195
    buffer_store_dwordx4 v[192:195], v24, s[8:11], s53 offen offset:2048 sc1
    v_accvgpr_read_b32 v212, a112
    v_accvgpr_read_b32 v213, a113
    v_accvgpr_read_b32 v214, a114
    v_accvgpr_read_b32 v215, a115
    v_accvgpr_read_b32 v216, a116
    v_accvgpr_read_b32 v217, a117
    v_accvgpr_read_b32 v218, a118
    v_accvgpr_read_b32 v219, a119
    v_pk_add_f32 v[212:213], v[212:213], v[76:77]
    v_pk_add_f32 v[214:215], v[214:215], v[78:79]
    v_pk_add_f32 v[216:217], v[216:217], v[76:77]
    v_pk_add_f32 v[218:219], v[218:219], v[78:79]
    v_pk_mul_f32 v[224:225], v[212:213], s[56:57]
    v_pk_mul_f32 v[226:227], v[214:215], s[56:57]
    v_pk_mul_f32 v[228:229], v[216:217], s[56:57]
    v_pk_mul_f32 v[230:231], v[218:219], s[56:57]
    v_exp_f32 v224, v224
    v_exp_f32 v225, v225
    v_exp_f32 v226, v226
    v_exp_f32 v227, v227
    v_exp_f32 v228, v228
    v_exp_f32 v229, v229
    v_exp_f32 v230, v230
    v_exp_f32 v231, v231
    v_pk_fma_f32 v[232:233], v[224:225], 0.5, 1.0 op_sel_hi:[1,0,0]
    v_pk_fma_f32 v[234:235], v[226:227], 0.5, 1.0 op_sel_hi:[1,0,0]
    v_pk_fma_f32 v[236:237], v[228:229], 0.5, 1.0 op_sel_hi:[1,0,0]
    v_pk_fma_f32 v[238:239], v[230:231], 0.5, 1.0 op_sel_hi:[1,0,0]
    v_pk_fma_f32 v[224:225], v[224:225], v[232:233], 1.0 op_sel_hi:[1,1,0]
    v_pk_fma_f32 v[226:227], v[226:227], v[234:235], 1.0 op_sel_hi:[1,1,0]
    v_pk_fma_f32 v[228:229], v[228:229], v[236:237], 1.0 op_sel_hi:[1,1,0]
    v_pk_fma_f32 v[230:231], v[230:231], v[238:239], 1.0 op_sel_hi:[1,1,0]
    v_rcp_f32 v224, v224
    v_rcp_f32 v225, v225
    v_rcp_f32 v226, v226
    v_rcp_f32 v227, v227
    v_rcp_f32 v228, v228
    v_rcp_f32 v229, v229
    v_rcp_f32 v230, v230
    v_rcp_f32 v231, v231
    v_pk_fma_f32 v[212:213], v[212:213], v[224:225], v[212:213] neg_lo:[1,0,0] neg_hi:[1,0,0]
    v_pk_fma_f32 v[214:215], v[214:215], v[226:227], v[214:215] neg_lo:[1,0,0] neg_hi:[1,0,0]
    v_pk_fma_f32 v[216:217], v[216:217], v[228:229], v[216:217] neg_lo:[1,0,0] neg_hi:[1,0,0]
    v_pk_fma_f32 v[218:219], v[218:219], v[230:231], v[218:219] neg_lo:[1,0,0] neg_hi:[1,0,0]
    v_cvt_pk_bf16_f32 v220, v212, v213
    v_cvt_pk_bf16_f32 v221, v214, v215
    v_cvt_pk_bf16_f32 v222, v216, v217
    v_cvt_pk_bf16_f32 v223, v218, v219
    s_nop 0
    v_permlane16_swap_b32 v220, v222
    v_permlane16_swap_b32 v221, v223
    buffer_store_dwordx4 v[220:223], v24, s[8:11], s53 offen offset:3072 sc1
    v_accvgpr_read_b32 v128, a144
    v_accvgpr_read_b32 v129, a145
    v_accvgpr_read_b32 v130, a146
    v_accvgpr_read_b32 v131, a147
    v_accvgpr_read_b32 v132, a148
    v_accvgpr_read_b32 v133, a149
    v_accvgpr_read_b32 v134, a150
    v_accvgpr_read_b32 v135, a151
    v_pk_add_f32 v[128:129], v[128:129], v[80:81]
    v_pk_add_f32 v[130:131], v[130:131], v[82:83]
    v_pk_add_f32 v[132:133], v[132:133], v[80:81]
    v_pk_add_f32 v[134:135], v[134:135], v[82:83]
    v_pk_mul_f32 v[140:141], v[128:129], s[56:57]
    v_pk_mul_f32 v[142:143], v[130:131], s[56:57]
    v_pk_mul_f32 v[144:145], v[132:133], s[56:57]
    v_pk_mul_f32 v[146:147], v[134:135], s[56:57]
    v_exp_f32 v140, v140
    v_exp_f32 v141, v141
    v_exp_f32 v142, v142
    v_exp_f32 v143, v143
    v_exp_f32 v144, v144
    v_exp_f32 v145, v145
    v_exp_f32 v146, v146
    v_exp_f32 v147, v147
    v_pk_fma_f32 v[148:149], v[140:141], 0.5, 1.0 op_sel_hi:[1,0,0]
    v_pk_fma_f32 v[150:151], v[142:143], 0.5, 1.0 op_sel_hi:[1,0,0]
    v_pk_fma_f32 v[152:153], v[144:145], 0.5, 1.0 op_sel_hi:[1,0,0]
    v_pk_fma_f32 v[154:155], v[146:147], 0.5, 1.0 op_sel_hi:[1,0,0]
    v_pk_fma_f32 v[140:141], v[140:141], v[148:149], 1.0 op_sel_hi:[1,1,0]
    v_pk_fma_f32 v[142:143], v[142:143], v[150:151], 1.0 op_sel_hi:[1,1,0]
    v_pk_fma_f32 v[144:145], v[144:145], v[152:153], 1.0 op_sel_hi:[1,1,0]
    v_pk_fma_f32 v[146:147], v[146:147], v[154:155], 1.0 op_sel_hi:[1,1,0]
    v_rcp_f32 v140, v140
    v_rcp_f32 v141, v141
    v_rcp_f32 v142, v142
    v_rcp_f32 v143, v143
    v_rcp_f32 v144, v144
    v_rcp_f32 v145, v145
    v_rcp_f32 v146, v146
    v_rcp_f32 v147, v147
    v_pk_fma_f32 v[128:129], v[128:129], v[140:141], v[128:129] neg_lo:[1,0,0] neg_hi:[1,0,0]
    v_pk_fma_f32 v[130:131], v[130:131], v[142:143], v[130:131] neg_lo:[1,0,0] neg_hi:[1,0,0]
    v_pk_fma_f32 v[132:133], v[132:133], v[144:145], v[132:133] neg_lo:[1,0,0] neg_hi:[1,0,0]
    v_pk_fma_f32 v[134:135], v[134:135], v[146:147], v[134:135] neg_lo:[1,0,0] neg_hi:[1,0,0]
    v_cvt_pk_bf16_f32 v136, v128, v129
    v_cvt_pk_bf16_f32 v137, v130, v131
    v_cvt_pk_bf16_f32 v138, v132, v133
    v_cvt_pk_bf16_f32 v139, v134, v135
    s_nop 0
    v_permlane16_swap_b32 v136, v138
    v_permlane16_swap_b32 v137, v139
    buffer_store_dwordx4 v[136:139], v25, s[8:11], s53 offen offset:0 sc1
    v_accvgpr_read_b32 v156, a176
    v_accvgpr_read_b32 v157, a177
    v_accvgpr_read_b32 v158, a178
    v_accvgpr_read_b32 v159, a179
    v_accvgpr_read_b32 v160, a180
    v_accvgpr_read_b32 v161, a181
    v_accvgpr_read_b32 v162, a182
    v_accvgpr_read_b32 v163, a183
    v_pk_add_f32 v[156:157], v[156:157], v[84:85]
    v_pk_add_f32 v[158:159], v[158:159], v[86:87]
    v_pk_add_f32 v[160:161], v[160:161], v[84:85]
    v_pk_add_f32 v[162:163], v[162:163], v[86:87]
    v_pk_mul_f32 v[168:169], v[156:157], s[56:57]
    v_pk_mul_f32 v[170:171], v[158:159], s[56:57]
    v_pk_mul_f32 v[172:173], v[160:161], s[56:57]
    v_pk_mul_f32 v[174:175], v[162:163], s[56:57]
    v_exp_f32 v168, v168
    v_exp_f32 v169, v169
    v_exp_f32 v170, v170
    v_exp_f32 v171, v171
    v_exp_f32 v172, v172
    v_exp_f32 v173, v173
    v_exp_f32 v174, v174
    v_exp_f32 v175, v175
    v_pk_fma_f32 v[176:177], v[168:169], 0.5, 1.0 op_sel_hi:[1,0,0]
    v_pk_fma_f32 v[178:179], v[170:171], 0.5, 1.0 op_sel_hi:[1,0,0]
    v_pk_fma_f32 v[180:181], v[172:173], 0.5, 1.0 op_sel_hi:[1,0,0]
    v_pk_fma_f32 v[182:183], v[174:175], 0.5, 1.0 op_sel_hi:[1,0,0]
    v_pk_fma_f32 v[168:169], v[168:169], v[176:177], 1.0 op_sel_hi:[1,1,0]
    v_pk_fma_f32 v[170:171], v[170:171], v[178:179], 1.0 op_sel_hi:[1,1,0]
    v_pk_fma_f32 v[172:173], v[172:173], v[180:181], 1.0 op_sel_hi:[1,1,0]
    v_pk_fma_f32 v[174:175], v[174:175], v[182:183], 1.0 op_sel_hi:[1,1,0]
    v_rcp_f32 v168, v168
    v_rcp_f32 v169, v169
    v_rcp_f32 v170, v170
    v_rcp_f32 v171, v171
    v_rcp_f32 v172, v172
    v_rcp_f32 v173, v173
    v_rcp_f32 v174, v174
    v_rcp_f32 v175, v175
    v_pk_fma_f32 v[156:157], v[156:157], v[168:169], v[156:157] neg_lo:[1,0,0] neg_hi:[1,0,0]
    v_pk_fma_f32 v[158:159], v[158:159], v[170:171], v[158:159] neg_lo:[1,0,0] neg_hi:[1,0,0]
    v_pk_fma_f32 v[160:161], v[160:161], v[172:173], v[160:161] neg_lo:[1,0,0] neg_hi:[1,0,0]
    v_pk_fma_f32 v[162:163], v[162:163], v[174:175], v[162:163] neg_lo:[1,0,0] neg_hi:[1,0,0]
    v_cvt_pk_bf16_f32 v164, v156, v157
    v_cvt_pk_bf16_f32 v165, v158, v159
    v_cvt_pk_bf16_f32 v166, v160, v161
    v_cvt_pk_bf16_f32 v167, v162, v163
    s_nop 0
    v_permlane16_swap_b32 v164, v166
    v_permlane16_swap_b32 v165, v167
    buffer_store_dwordx4 v[164:167], v25, s[8:11], s53 offen offset:1024 sc1
    v_accvgpr_read_b32 v184, a208
    v_accvgpr_read_b32 v185, a209
    v_accvgpr_read_b32 v186, a210
    v_accvgpr_read_b32 v187, a211
    v_accvgpr_read_b32 v188, a212
    v_accvgpr_read_b32 v189, a213
    v_accvgpr_read_b32 v190, a214
    v_accvgpr_read_b32 v191, a215
    v_pk_add_f32 v[184:185], v[184:185], v[88:89]
    v_pk_add_f32 v[186:187], v[186:187], v[90:91]
    v_pk_add_f32 v[188:189], v[188:189], v[88:89]
    v_pk_add_f32 v[190:191], v[190:191], v[90:91]
    v_pk_mul_f32 v[196:197], v[184:185], s[56:57]
    v_pk_mul_f32 v[198:199], v[186:187], s[56:57]
    v_pk_mul_f32 v[200:201], v[188:189], s[56:57]
    v_pk_mul_f32 v[202:203], v[190:191], s[56:57]
    v_exp_f32 v196, v196
    v_exp_f32 v197, v197
    v_exp_f32 v198, v198
    v_exp_f32 v199, v199
    v_exp_f32 v200, v200
    v_exp_f32 v201, v201
    v_exp_f32 v202, v202
    v_exp_f32 v203, v203
    v_pk_fma_f32 v[204:205], v[196:197], 0.5, 1.0 op_sel_hi:[1,0,0]
    v_pk_fma_f32 v[206:207], v[198:199], 0.5, 1.0 op_sel_hi:[1,0,0]
    v_pk_fma_f32 v[208:209], v[200:201], 0.5, 1.0 op_sel_hi:[1,0,0]
    v_pk_fma_f32 v[210:211], v[202:203], 0.5, 1.0 op_sel_hi:[1,0,0]
    v_pk_fma_f32 v[196:197], v[196:197], v[204:205], 1.0 op_sel_hi:[1,1,0]
    v_pk_fma_f32 v[198:199], v[198:199], v[206:207], 1.0 op_sel_hi:[1,1,0]
    v_pk_fma_f32 v[200:201], v[200:201], v[208:209], 1.0 op_sel_hi:[1,1,0]
    v_pk_fma_f32 v[202:203], v[202:203], v[210:211], 1.0 op_sel_hi:[1,1,0]
    v_rcp_f32 v196, v196
    v_rcp_f32 v197, v197
    v_rcp_f32 v198, v198
    v_rcp_f32 v199, v199
    v_rcp_f32 v200, v200
    v_rcp_f32 v201, v201
    v_rcp_f32 v202, v202
    v_rcp_f32 v203, v203
    v_pk_fma_f32 v[184:185], v[184:185], v[196:197], v[184:185] neg_lo:[1,0,0] neg_hi:[1,0,0]
    v_pk_fma_f32 v[186:187], v[186:187], v[198:199], v[186:187] neg_lo:[1,0,0] neg_hi:[1,0,0]
    v_pk_fma_f32 v[188:189], v[188:189], v[200:201], v[188:189] neg_lo:[1,0,0] neg_hi:[1,0,0]
    v_pk_fma_f32 v[190:191], v[190:191], v[202:203], v[190:191] neg_lo:[1,0,0] neg_hi:[1,0,0]
    v_cvt_pk_bf16_f32 v192, v184, v185
    v_cvt_pk_bf16_f32 v193, v186, v187
    v_cvt_pk_bf16_f32 v194, v188, v189
    v_cvt_pk_bf16_f32 v195, v190, v191
    s_nop 0
    v_permlane16_swap_b32 v192, v194
    v_permlane16_swap_b32 v193, v195
    buffer_store_dwordx4 v[192:195], v25, s[8:11], s53 offen offset:2048 sc1
    v_accvgpr_read_b32 v212, a240
    v_accvgpr_read_b32 v213, a241
    v_accvgpr_read_b32 v214, a242
    v_accvgpr_read_b32 v215, a243
    v_accvgpr_read_b32 v216, a244
    v_accvgpr_read_b32 v217, a245
    v_accvgpr_read_b32 v218, a246
    v_accvgpr_read_b32 v219, a247
    v_pk_add_f32 v[212:213], v[212:213], v[92:93]
    v_pk_add_f32 v[214:215], v[214:215], v[94:95]
    v_pk_add_f32 v[216:217], v[216:217], v[92:93]
    v_pk_add_f32 v[218:219], v[218:219], v[94:95]
    v_pk_mul_f32 v[224:225], v[212:213], s[56:57]
    v_pk_mul_f32 v[226:227], v[214:215], s[56:57]
    v_pk_mul_f32 v[228:229], v[216:217], s[56:57]
    v_pk_mul_f32 v[230:231], v[218:219], s[56:57]
    v_exp_f32 v224, v224
    v_exp_f32 v225, v225
    v_exp_f32 v226, v226
    v_exp_f32 v227, v227
    v_exp_f32 v228, v228
    v_exp_f32 v229, v229
    v_exp_f32 v230, v230
    v_exp_f32 v231, v231
    v_pk_fma_f32 v[232:233], v[224:225], 0.5, 1.0 op_sel_hi:[1,0,0]
    v_pk_fma_f32 v[234:235], v[226:227], 0.5, 1.0 op_sel_hi:[1,0,0]
    v_pk_fma_f32 v[236:237], v[228:229], 0.5, 1.0 op_sel_hi:[1,0,0]
    v_pk_fma_f32 v[238:239], v[230:231], 0.5, 1.0 op_sel_hi:[1,0,0]
    v_pk_fma_f32 v[224:225], v[224:225], v[232:233], 1.0 op_sel_hi:[1,1,0]
    v_pk_fma_f32 v[226:227], v[226:227], v[234:235], 1.0 op_sel_hi:[1,1,0]
    v_pk_fma_f32 v[228:229], v[228:229], v[236:237], 1.0 op_sel_hi:[1,1,0]
    v_pk_fma_f32 v[230:231], v[230:231], v[238:239], 1.0 op_sel_hi:[1,1,0]
    v_rcp_f32 v224, v224
    v_rcp_f32 v225, v225
    v_rcp_f32 v226, v226
    v_rcp_f32 v227, v227
    v_rcp_f32 v228, v228
    v_rcp_f32 v229, v229
    v_rcp_f32 v230, v230
    v_rcp_f32 v231, v231
    v_pk_fma_f32 v[212:213], v[212:213], v[224:225], v[212:213] neg_lo:[1,0,0] neg_hi:[1,0,0]
    v_pk_fma_f32 v[214:215], v[214:215], v[226:227], v[214:215] neg_lo:[1,0,0] neg_hi:[1,0,0]
    v_pk_fma_f32 v[216:217], v[216:217], v[228:229], v[216:217] neg_lo:[1,0,0] neg_hi:[1,0,0]
    v_pk_fma_f32 v[218:219], v[218:219], v[230:231], v[218:219] neg_lo:[1,0,0] neg_hi:[1,0,0]
    v_cvt_pk_bf16_f32 v220, v212, v213
    v_cvt_pk_bf16_f32 v221, v214, v215
    v_cvt_pk_bf16_f32 v222, v216, v217
    v_cvt_pk_bf16_f32 v223, v218, v219
    s_nop 0
    v_permlane16_swap_b32 v220, v222
    v_permlane16_swap_b32 v221, v223
    buffer_store_dwordx4 v[220:223], v25, s[8:11], s53 offen offset:3072 sc1
    s_add_u32 s53, s53, s54
    v_accvgpr_read_b32 v128, a24
    v_accvgpr_read_b32 v129, a25
    v_accvgpr_read_b32 v130, a26
    v_accvgpr_read_b32 v131, a27
    v_accvgpr_read_b32 v132, a28
    v_accvgpr_read_b32 v133, a29
    v_accvgpr_read_b32 v134, a30
    v_accvgpr_read_b32 v135, a31
    v_pk_add_f32 v[128:129], v[128:129], v[64:65]
    v_pk_add_f32 v[130:131], v[130:131], v[66:67]
    v_pk_add_f32 v[132:133], v[132:133], v[64:65]
    v_pk_add_f32 v[134:135], v[134:135], v[66:67]
    v_pk_mul_f32 v[140:141], v[128:129], s[56:57]
    v_pk_mul_f32 v[142:143], v[130:131], s[56:57]
    v_pk_mul_f32 v[144:145], v[132:133], s[56:57]
    v_pk_mul_f32 v[146:147], v[134:135], s[56:57]
    v_exp_f32 v140, v140
    v_exp_f32 v141, v141
    v_exp_f32 v142, v142
    v_exp_f32 v143, v143
    v_exp_f32 v144, v144
    v_exp_f32 v145, v145
    v_exp_f32 v146, v146
    v_exp_f32 v147, v147
    v_pk_fma_f32 v[148:149], v[140:141], 0.5, 1.0 op_sel_hi:[1,0,0]
    v_pk_fma_f32 v[150:151], v[142:143], 0.5, 1.0 op_sel_hi:[1,0,0]
    v_pk_fma_f32 v[152:153], v[144:145], 0.5, 1.0 op_sel_hi:[1,0,0]
    v_pk_fma_f32 v[154:155], v[146:147], 0.5, 1.0 op_sel_hi:[1,0,0]
    v_pk_fma_f32 v[140:141], v[140:141], v[148:149], 1.0 op_sel_hi:[1,1,0]
    v_pk_fma_f32 v[142:143], v[142:143], v[150:151], 1.0 op_sel_hi:[1,1,0]
    v_pk_fma_f32 v[144:145], v[144:145], v[152:153], 1.0 op_sel_hi:[1,1,0]
    v_pk_fma_f32 v[146:147], v[146:147], v[154:155], 1.0 op_sel_hi:[1,1,0]
    v_rcp_f32 v140, v140
    v_rcp_f32 v141, v141
    v_rcp_f32 v142, v142
    v_rcp_f32 v143, v143
    v_rcp_f32 v144, v144
    v_rcp_f32 v145, v145
    v_rcp_f32 v146, v146
    v_rcp_f32 v147, v147
    v_pk_fma_f32 v[128:129], v[128:129], v[140:141], v[128:129] neg_lo:[1,0,0] neg_hi:[1,0,0]
    v_pk_fma_f32 v[130:131], v[130:131], v[142:143], v[130:131] neg_lo:[1,0,0] neg_hi:[1,0,0]
    v_pk_fma_f32 v[132:133], v[132:133], v[144:145], v[132:133] neg_lo:[1,0,0] neg_hi:[1,0,0]
    v_pk_fma_f32 v[134:135], v[134:135], v[146:147], v[134:135] neg_lo:[1,0,0] neg_hi:[1,0,0]
    v_cvt_pk_bf16_f32 v136, v128, v129
    v_cvt_pk_bf16_f32 v137, v130, v131
    v_cvt_pk_bf16_f32 v138, v132, v133
    v_cvt_pk_bf16_f32 v139, v134, v135
    s_nop 0
    v_permlane16_swap_b32 v136, v138
    v_permlane16_swap_b32 v137, v139
    buffer_store_dwordx4 v[136:139], v24, s[8:11], s53 offen offset:0 sc1
    v_accvgpr_read_b32 v156, a56
    v_accvgpr_read_b32 v157, a57
    v_accvgpr_read_b32 v158, a58
    v_accvgpr_read_b32 v159, a59
    v_accvgpr_read_b32 v160, a60
    v_accvgpr_read_b32 v161, a61
    v_accvgpr_read_b32 v162, a62
    v_accvgpr_read_b32 v163, a63
    v_pk_add_f32 v[156:157], v[156:157], v[68:69]
    v_pk_add_f32 v[158:159], v[158:159], v[70:71]
    v_pk_add_f32 v[160:161], v[160:161], v[68:69]
    v_pk_add_f32 v[162:163], v[162:163], v[70:71]
    v_pk_mul_f32 v[168:169], v[156:157], s[56:57]
    v_pk_mul_f32 v[170:171], v[158:159], s[56:57]
    v_pk_mul_f32 v[172:173], v[160:161], s[56:57]
    v_pk_mul_f32 v[174:175], v[162:163], s[56:57]
    v_exp_f32 v168, v168
    v_exp_f32 v169, v169
    v_exp_f32 v170, v170
    v_exp_f32 v171, v171
    v_exp_f32 v172, v172
    v_exp_f32 v173, v173
    v_exp_f32 v174, v174
    v_exp_f32 v175, v175
    v_pk_fma_f32 v[176:177], v[168:169], 0.5, 1.0 op_sel_hi:[1,0,0]
    v_pk_fma_f32 v[178:179], v[170:171], 0.5, 1.0 op_sel_hi:[1,0,0]
    v_pk_fma_f32 v[180:181], v[172:173], 0.5, 1.0 op_sel_hi:[1,0,0]
    v_pk_fma_f32 v[182:183], v[174:175], 0.5, 1.0 op_sel_hi:[1,0,0]
    v_pk_fma_f32 v[168:169], v[168:169], v[176:177], 1.0 op_sel_hi:[1,1,0]
    v_pk_fma_f32 v[170:171], v[170:171], v[178:179], 1.0 op_sel_hi:[1,1,0]
    v_pk_fma_f32 v[172:173], v[172:173], v[180:181], 1.0 op_sel_hi:[1,1,0]
    v_pk_fma_f32 v[174:175], v[174:175], v[182:183], 1.0 op_sel_hi:[1,1,0]
    v_rcp_f32 v168, v168
    v_rcp_f32 v169, v169
    v_rcp_f32 v170, v170
    v_rcp_f32 v171, v171
    v_rcp_f32 v172, v172
    v_rcp_f32 v173, v173
    v_rcp_f32 v174, v174
    v_rcp_f32 v175, v175
    v_pk_fma_f32 v[156:157], v[156:157], v[168:169], v[156:157] neg_lo:[1,0,0] neg_hi:[1,0,0]
    v_pk_fma_f32 v[158:159], v[158:159], v[170:171], v[158:159] neg_lo:[1,0,0] neg_hi:[1,0,0]
    v_pk_fma_f32 v[160:161], v[160:161], v[172:173], v[160:161] neg_lo:[1,0,0] neg_hi:[1,0,0]
    v_pk_fma_f32 v[162:163], v[162:163], v[174:175], v[162:163] neg_lo:[1,0,0] neg_hi:[1,0,0]
    v_cvt_pk_bf16_f32 v164, v156, v157
    v_cvt_pk_bf16_f32 v165, v158, v159
    v_cvt_pk_bf16_f32 v166, v160, v161
    v_cvt_pk_bf16_f32 v167, v162, v163
    s_nop 0
    v_permlane16_swap_b32 v164, v166
    v_permlane16_swap_b32 v165, v167
    buffer_store_dwordx4 v[164:167], v24, s[8:11], s53 offen offset:1024 sc1
    v_accvgpr_read_b32 v184, a88
    v_accvgpr_read_b32 v185, a89
    v_accvgpr_read_b32 v186, a90
    v_accvgpr_read_b32 v187, a91
    v_accvgpr_read_b32 v188, a92
    v_accvgpr_read_b32 v189, a93
    v_accvgpr_read_b32 v190, a94
    v_accvgpr_read_b32 v191, a95
    v_pk_add_f32 v[184:185], v[184:185], v[72:73]
    v_pk_add_f32 v[186:187], v[186:187], v[74:75]
    v_pk_add_f32 v[188:189], v[188:189], v[72:73]
    v_pk_add_f32 v[190:191], v[190:191], v[74:75]
    v_pk_mul_f32 v[196:197], v[184:185], s[56:57]
    v_pk_mul_f32 v[198:199], v[186:187], s[56:57]
    v_pk_mul_f32 v[200:201], v[188:189], s[56:57]
    v_pk_mul_f32 v[202:203], v[190:191], s[56:57]
    v_exp_f32 v196, v196
    v_exp_f32 v197, v197
    v_exp_f32 v198, v198
    v_exp_f32 v199, v199
    v_exp_f32 v200, v200
    v_exp_f32 v201, v201
    v_exp_f32 v202, v202
    v_exp_f32 v203, v203
    v_pk_fma_f32 v[204:205], v[196:197], 0.5, 1.0 op_sel_hi:[1,0,0]
    v_pk_fma_f32 v[206:207], v[198:199], 0.5, 1.0 op_sel_hi:[1,0,0]
    v_pk_fma_f32 v[208:209], v[200:201], 0.5, 1.0 op_sel_hi:[1,0,0]
    v_pk_fma_f32 v[210:211], v[202:203], 0.5, 1.0 op_sel_hi:[1,0,0]
    v_pk_fma_f32 v[196:197], v[196:197], v[204:205], 1.0 op_sel_hi:[1,1,0]
    v_pk_fma_f32 v[198:199], v[198:199], v[206:207], 1.0 op_sel_hi:[1,1,0]
    v_pk_fma_f32 v[200:201], v[200:201], v[208:209], 1.0 op_sel_hi:[1,1,0]
    v_pk_fma_f32 v[202:203], v[202:203], v[210:211], 1.0 op_sel_hi:[1,1,0]
    v_rcp_f32 v196, v196
    v_rcp_f32 v197, v197
    v_rcp_f32 v198, v198
    v_rcp_f32 v199, v199
    v_rcp_f32 v200, v200
    v_rcp_f32 v201, v201
    v_rcp_f32 v202, v202
    v_rcp_f32 v203, v203
    v_pk_fma_f32 v[184:185], v[184:185], v[196:197], v[184:185] neg_lo:[1,0,0] neg_hi:[1,0,0]
    v_pk_fma_f32 v[186:187], v[186:187], v[198:199], v[186:187] neg_lo:[1,0,0] neg_hi:[1,0,0]
    v_pk_fma_f32 v[188:189], v[188:189], v[200:201], v[188:189] neg_lo:[1,0,0] neg_hi:[1,0,0]
    v_pk_fma_f32 v[190:191], v[190:191], v[202:203], v[190:191] neg_lo:[1,0,0] neg_hi:[1,0,0]
    v_cvt_pk_bf16_f32 v192, v184, v185
    v_cvt_pk_bf16_f32 v193, v186, v187
    v_cvt_pk_bf16_f32 v194, v188, v189
    v_cvt_pk_bf16_f32 v195, v190, v191
    s_nop 0
    v_permlane16_swap_b32 v192, v194
    v_permlane16_swap_b32 v193, v195
    buffer_store_dwordx4 v[192:195], v24, s[8:11], s53 offen offset:2048 sc1
    v_accvgpr_read_b32 v212, a120
    v_accvgpr_read_b32 v213, a121
    v_accvgpr_read_b32 v214, a122
    v_accvgpr_read_b32 v215, a123
    v_accvgpr_read_b32 v216, a124
    v_accvgpr_read_b32 v217, a125
    v_accvgpr_read_b32 v218, a126
    v_accvgpr_read_b32 v219, a127
    v_pk_add_f32 v[212:213], v[212:213], v[76:77]
    v_pk_add_f32 v[214:215], v[214:215], v[78:79]
    v_pk_add_f32 v[216:217], v[216:217], v[76:77]
    v_pk_add_f32 v[218:219], v[218:219], v[78:79]
    v_pk_mul_f32 v[224:225], v[212:213], s[56:57]
    v_pk_mul_f32 v[226:227], v[214:215], s[56:57]
    v_pk_mul_f32 v[228:229], v[216:217], s[56:57]
    v_pk_mul_f32 v[230:231], v[218:219], s[56:57]
    v_exp_f32 v224, v224
    v_exp_f32 v225, v225
    v_exp_f32 v226, v226
    v_exp_f32 v227, v227
    v_exp_f32 v228, v228
    v_exp_f32 v229, v229
    v_exp_f32 v230, v230
    v_exp_f32 v231, v231
    v_pk_fma_f32 v[232:233], v[224:225], 0.5, 1.0 op_sel_hi:[1,0,0]
    v_pk_fma_f32 v[234:235], v[226:227], 0.5, 1.0 op_sel_hi:[1,0,0]
    v_pk_fma_f32 v[236:237], v[228:229], 0.5, 1.0 op_sel_hi:[1,0,0]
    v_pk_fma_f32 v[238:239], v[230:231], 0.5, 1.0 op_sel_hi:[1,0,0]
    v_pk_fma_f32 v[224:225], v[224:225], v[232:233], 1.0 op_sel_hi:[1,1,0]
    v_pk_fma_f32 v[226:227], v[226:227], v[234:235], 1.0 op_sel_hi:[1,1,0]
    v_pk_fma_f32 v[228:229], v[228:229], v[236:237], 1.0 op_sel_hi:[1,1,0]
    v_pk_fma_f32 v[230:231], v[230:231], v[238:239], 1.0 op_sel_hi:[1,1,0]
    v_rcp_f32 v224, v224
    v_rcp_f32 v225, v225
    v_rcp_f32 v226, v226
    v_rcp_f32 v227, v227
    v_rcp_f32 v228, v228
    v_rcp_f32 v229, v229
    v_rcp_f32 v230, v230
    v_rcp_f32 v231, v231
    v_pk_fma_f32 v[212:213], v[212:213], v[224:225], v[212:213] neg_lo:[1,0,0] neg_hi:[1,0,0]
    v_pk_fma_f32 v[214:215], v[214:215], v[226:227], v[214:215] neg_lo:[1,0,0] neg_hi:[1,0,0]
    v_pk_fma_f32 v[216:217], v[216:217], v[228:229], v[216:217] neg_lo:[1,0,0] neg_hi:[1,0,0]
    v_pk_fma_f32 v[218:219], v[218:219], v[230:231], v[218:219] neg_lo:[1,0,0] neg_hi:[1,0,0]
    v_cvt_pk_bf16_f32 v220, v212, v213
    v_cvt_pk_bf16_f32 v221, v214, v215
    v_cvt_pk_bf16_f32 v222, v216, v217
    v_cvt_pk_bf16_f32 v223, v218, v219
    s_nop 0
    v_permlane16_swap_b32 v220, v222
    v_permlane16_swap_b32 v221, v223
    buffer_store_dwordx4 v[220:223], v24, s[8:11], s53 offen offset:3072 sc1
    v_accvgpr_read_b32 v128, a152
    v_accvgpr_read_b32 v129, a153
    v_accvgpr_read_b32 v130, a154
    v_accvgpr_read_b32 v131, a155
    v_accvgpr_read_b32 v132, a156
    v_accvgpr_read_b32 v133, a157
    v_accvgpr_read_b32 v134, a158
    v_accvgpr_read_b32 v135, a159
    v_pk_add_f32 v[128:129], v[128:129], v[80:81]
    v_pk_add_f32 v[130:131], v[130:131], v[82:83]
    v_pk_add_f32 v[132:133], v[132:133], v[80:81]
    v_pk_add_f32 v[134:135], v[134:135], v[82:83]
    v_pk_mul_f32 v[140:141], v[128:129], s[56:57]
    v_pk_mul_f32 v[142:143], v[130:131], s[56:57]
    v_pk_mul_f32 v[144:145], v[132:133], s[56:57]
    v_pk_mul_f32 v[146:147], v[134:135], s[56:57]
    v_exp_f32 v140, v140
    v_exp_f32 v141, v141
    v_exp_f32 v142, v142
    v_exp_f32 v143, v143
    v_exp_f32 v144, v144
    v_exp_f32 v145, v145
    v_exp_f32 v146, v146
    v_exp_f32 v147, v147
    v_pk_fma_f32 v[148:149], v[140:141], 0.5, 1.0 op_sel_hi:[1,0,0]
    v_pk_fma_f32 v[150:151], v[142:143], 0.5, 1.0 op_sel_hi:[1,0,0]
    v_pk_fma_f32 v[152:153], v[144:145], 0.5, 1.0 op_sel_hi:[1,0,0]
    v_pk_fma_f32 v[154:155], v[146:147], 0.5, 1.0 op_sel_hi:[1,0,0]
    v_pk_fma_f32 v[140:141], v[140:141], v[148:149], 1.0 op_sel_hi:[1,1,0]
    v_pk_fma_f32 v[142:143], v[142:143], v[150:151], 1.0 op_sel_hi:[1,1,0]
    v_pk_fma_f32 v[144:145], v[144:145], v[152:153], 1.0 op_sel_hi:[1,1,0]
    v_pk_fma_f32 v[146:147], v[146:147], v[154:155], 1.0 op_sel_hi:[1,1,0]
    v_rcp_f32 v140, v140
    v_rcp_f32 v141, v141
    v_rcp_f32 v142, v142
    v_rcp_f32 v143, v143
    v_rcp_f32 v144, v144
    v_rcp_f32 v145, v145
    v_rcp_f32 v146, v146
    v_rcp_f32 v147, v147
    v_pk_fma_f32 v[128:129], v[128:129], v[140:141], v[128:129] neg_lo:[1,0,0] neg_hi:[1,0,0]
    v_pk_fma_f32 v[130:131], v[130:131], v[142:143], v[130:131] neg_lo:[1,0,0] neg_hi:[1,0,0]
    v_pk_fma_f32 v[132:133], v[132:133], v[144:145], v[132:133] neg_lo:[1,0,0] neg_hi:[1,0,0]
    v_pk_fma_f32 v[134:135], v[134:135], v[146:147], v[134:135] neg_lo:[1,0,0] neg_hi:[1,0,0]
    v_cvt_pk_bf16_f32 v136, v128, v129
    v_cvt_pk_bf16_f32 v137, v130, v131
    v_cvt_pk_bf16_f32 v138, v132, v133
    v_cvt_pk_bf16_f32 v139, v134, v135
    s_nop 0
    v_permlane16_swap_b32 v136, v138
    v_permlane16_swap_b32 v137, v139
    buffer_store_dwordx4 v[136:139], v25, s[8:11], s53 offen offset:0 sc1
    v_accvgpr_read_b32 v156, a184
    v_accvgpr_read_b32 v157, a185
    v_accvgpr_read_b32 v158, a186
    v_accvgpr_read_b32 v159, a187
    v_accvgpr_read_b32 v160, a188
    v_accvgpr_read_b32 v161, a189
    v_accvgpr_read_b32 v162, a190
    v_accvgpr_read_b32 v163, a191
    v_pk_add_f32 v[156:157], v[156:157], v[84:85]
    v_pk_add_f32 v[158:159], v[158:159], v[86:87]
    v_pk_add_f32 v[160:161], v[160:161], v[84:85]
    v_pk_add_f32 v[162:163], v[162:163], v[86:87]
    v_pk_mul_f32 v[168:169], v[156:157], s[56:57]
    v_pk_mul_f32 v[170:171], v[158:159], s[56:57]
    v_pk_mul_f32 v[172:173], v[160:161], s[56:57]
    v_pk_mul_f32 v[174:175], v[162:163], s[56:57]
    v_exp_f32 v168, v168
    v_exp_f32 v169, v169
    v_exp_f32 v170, v170
    v_exp_f32 v171, v171
    v_exp_f32 v172, v172
    v_exp_f32 v173, v173
    v_exp_f32 v174, v174
    v_exp_f32 v175, v175
    v_pk_fma_f32 v[176:177], v[168:169], 0.5, 1.0 op_sel_hi:[1,0,0]
    v_pk_fma_f32 v[178:179], v[170:171], 0.5, 1.0 op_sel_hi:[1,0,0]
    v_pk_fma_f32 v[180:181], v[172:173], 0.5, 1.0 op_sel_hi:[1,0,0]
    v_pk_fma_f32 v[182:183], v[174:175], 0.5, 1.0 op_sel_hi:[1,0,0]
    v_pk_fma_f32 v[168:169], v[168:169], v[176:177], 1.0 op_sel_hi:[1,1,0]
    v_pk_fma_f32 v[170:171], v[170:171], v[178:179], 1.0 op_sel_hi:[1,1,0]
    v_pk_fma_f32 v[172:173], v[172:173], v[180:181], 1.0 op_sel_hi:[1,1,0]
    v_pk_fma_f32 v[174:175], v[174:175], v[182:183], 1.0 op_sel_hi:[1,1,0]
    v_rcp_f32 v168, v168
    v_rcp_f32 v169, v169
    v_rcp_f32 v170, v170
    v_rcp_f32 v171, v171
    v_rcp_f32 v172, v172
    v_rcp_f32 v173, v173
    v_rcp_f32 v174, v174
    v_rcp_f32 v175, v175
    v_pk_fma_f32 v[156:157], v[156:157], v[168:169], v[156:157] neg_lo:[1,0,0] neg_hi:[1,0,0]
    v_pk_fma_f32 v[158:159], v[158:159], v[170:171], v[158:159] neg_lo:[1,0,0] neg_hi:[1,0,0]
    v_pk_fma_f32 v[160:161], v[160:161], v[172:173], v[160:161] neg_lo:[1,0,0] neg_hi:[1,0,0]
    v_pk_fma_f32 v[162:163], v[162:163], v[174:175], v[162:163] neg_lo:[1,0,0] neg_hi:[1,0,0]
    v_cvt_pk_bf16_f32 v164, v156, v157
    v_cvt_pk_bf16_f32 v165, v158, v159
    v_cvt_pk_bf16_f32 v166, v160, v161
    v_cvt_pk_bf16_f32 v167, v162, v163
    s_nop 0
    v_permlane16_swap_b32 v164, v166
    v_permlane16_swap_b32 v165, v167
    buffer_store_dwordx4 v[164:167], v25, s[8:11], s53 offen offset:1024 sc1
    v_accvgpr_read_b32 v184, a216
    v_accvgpr_read_b32 v185, a217
    v_accvgpr_read_b32 v186, a218
    v_accvgpr_read_b32 v187, a219
    v_accvgpr_read_b32 v188, a220
    v_accvgpr_read_b32 v189, a221
    v_accvgpr_read_b32 v190, a222
    v_accvgpr_read_b32 v191, a223
    v_pk_add_f32 v[184:185], v[184:185], v[88:89]
    v_pk_add_f32 v[186:187], v[186:187], v[90:91]
    v_pk_add_f32 v[188:189], v[188:189], v[88:89]
    v_pk_add_f32 v[190:191], v[190:191], v[90:91]
    v_pk_mul_f32 v[196:197], v[184:185], s[56:57]
    v_pk_mul_f32 v[198:199], v[186:187], s[56:57]
    v_pk_mul_f32 v[200:201], v[188:189], s[56:57]
    v_pk_mul_f32 v[202:203], v[190:191], s[56:57]
    v_exp_f32 v196, v196
    v_exp_f32 v197, v197
    v_exp_f32 v198, v198
    v_exp_f32 v199, v199
    v_exp_f32 v200, v200
    v_exp_f32 v201, v201
    v_exp_f32 v202, v202
    v_exp_f32 v203, v203
    v_pk_fma_f32 v[204:205], v[196:197], 0.5, 1.0 op_sel_hi:[1,0,0]
    v_pk_fma_f32 v[206:207], v[198:199], 0.5, 1.0 op_sel_hi:[1,0,0]
    v_pk_fma_f32 v[208:209], v[200:201], 0.5, 1.0 op_sel_hi:[1,0,0]
    v_pk_fma_f32 v[210:211], v[202:203], 0.5, 1.0 op_sel_hi:[1,0,0]
    v_pk_fma_f32 v[196:197], v[196:197], v[204:205], 1.0 op_sel_hi:[1,1,0]
    v_pk_fma_f32 v[198:199], v[198:199], v[206:207], 1.0 op_sel_hi:[1,1,0]
    v_pk_fma_f32 v[200:201], v[200:201], v[208:209], 1.0 op_sel_hi:[1,1,0]
    v_pk_fma_f32 v[202:203], v[202:203], v[210:211], 1.0 op_sel_hi:[1,1,0]
    v_rcp_f32 v196, v196
    v_rcp_f32 v197, v197
    v_rcp_f32 v198, v198
    v_rcp_f32 v199, v199
    v_rcp_f32 v200, v200
    v_rcp_f32 v201, v201
    v_rcp_f32 v202, v202
    v_rcp_f32 v203, v203
    v_pk_fma_f32 v[184:185], v[184:185], v[196:197], v[184:185] neg_lo:[1,0,0] neg_hi:[1,0,0]
    v_pk_fma_f32 v[186:187], v[186:187], v[198:199], v[186:187] neg_lo:[1,0,0] neg_hi:[1,0,0]
    v_pk_fma_f32 v[188:189], v[188:189], v[200:201], v[188:189] neg_lo:[1,0,0] neg_hi:[1,0,0]
    v_pk_fma_f32 v[190:191], v[190:191], v[202:203], v[190:191] neg_lo:[1,0,0] neg_hi:[1,0,0]
    v_cvt_pk_bf16_f32 v192, v184, v185
    v_cvt_pk_bf16_f32 v193, v186, v187
    v_cvt_pk_bf16_f32 v194, v188, v189
    v_cvt_pk_bf16_f32 v195, v190, v191
    s_nop 0
    v_permlane16_swap_b32 v192, v194
    v_permlane16_swap_b32 v193, v195
    buffer_store_dwordx4 v[192:195], v25, s[8:11], s53 offen offset:2048 sc1
    v_accvgpr_read_b32 v212, a248
    v_accvgpr_read_b32 v213, a249
    v_accvgpr_read_b32 v214, a250
    v_accvgpr_read_b32 v215, a251
    v_accvgpr_read_b32 v216, a252
    v_accvgpr_read_b32 v217, a253
    v_accvgpr_read_b32 v218, a254
    v_accvgpr_read_b32 v219, a255
    v_pk_add_f32 v[212:213], v[212:213], v[92:93]
    v_pk_add_f32 v[214:215], v[214:215], v[94:95]
    v_pk_add_f32 v[216:217], v[216:217], v[92:93]
    v_pk_add_f32 v[218:219], v[218:219], v[94:95]
    v_pk_mul_f32 v[224:225], v[212:213], s[56:57]
    v_pk_mul_f32 v[226:227], v[214:215], s[56:57]
    v_pk_mul_f32 v[228:229], v[216:217], s[56:57]
    v_pk_mul_f32 v[230:231], v[218:219], s[56:57]
    v_exp_f32 v224, v224
    v_exp_f32 v225, v225
    v_exp_f32 v226, v226
    v_exp_f32 v227, v227
    v_exp_f32 v228, v228
    v_exp_f32 v229, v229
    v_exp_f32 v230, v230
    v_exp_f32 v231, v231
    v_pk_fma_f32 v[232:233], v[224:225], 0.5, 1.0 op_sel_hi:[1,0,0]
    v_pk_fma_f32 v[234:235], v[226:227], 0.5, 1.0 op_sel_hi:[1,0,0]
    v_pk_fma_f32 v[236:237], v[228:229], 0.5, 1.0 op_sel_hi:[1,0,0]
    v_pk_fma_f32 v[238:239], v[230:231], 0.5, 1.0 op_sel_hi:[1,0,0]
    v_pk_fma_f32 v[224:225], v[224:225], v[232:233], 1.0 op_sel_hi:[1,1,0]
    v_pk_fma_f32 v[226:227], v[226:227], v[234:235], 1.0 op_sel_hi:[1,1,0]
    v_pk_fma_f32 v[228:229], v[228:229], v[236:237], 1.0 op_sel_hi:[1,1,0]
    v_pk_fma_f32 v[230:231], v[230:231], v[238:239], 1.0 op_sel_hi:[1,1,0]
    v_rcp_f32 v224, v224
    v_rcp_f32 v225, v225
    v_rcp_f32 v226, v226
    v_rcp_f32 v227, v227
    v_rcp_f32 v228, v228
    v_rcp_f32 v229, v229
    v_rcp_f32 v230, v230
    v_rcp_f32 v231, v231
    v_pk_fma_f32 v[212:213], v[212:213], v[224:225], v[212:213] neg_lo:[1,0,0] neg_hi:[1,0,0]
    v_pk_fma_f32 v[214:215], v[214:215], v[226:227], v[214:215] neg_lo:[1,0,0] neg_hi:[1,0,0]
    v_pk_fma_f32 v[216:217], v[216:217], v[228:229], v[216:217] neg_lo:[1,0,0] neg_hi:[1,0,0]
    v_pk_fma_f32 v[218:219], v[218:219], v[230:231], v[218:219] neg_lo:[1,0,0] neg_hi:[1,0,0]
    v_cvt_pk_bf16_f32 v220, v212, v213
    v_cvt_pk_bf16_f32 v221, v214, v215
    v_cvt_pk_bf16_f32 v222, v216, v217
    v_cvt_pk_bf16_f32 v223, v218, v219
    s_nop 0
    v_permlane16_swap_b32 v220, v222
    v_permlane16_swap_b32 v221, v223
    buffer_store_dwordx4 v[220:223], v25, s[8:11], s53 offen offset:3072 sc1
    s_add_u32 s53, s53, s54
    s_lshl_b32 s53, s31, 7
    s_add_u32 s92, s53, 120066048
    s_mov_b32 s93, 1
    s_mov_b32 s94, 1
Lw_next:
    s_waitcnt vmcnt(32)
    s_branch Lw_job
Lw_nonext:
    s_waitcnt vmcnt(0)
    s_and_b32 s23, s21, 1
    s_cmp_ge_u32 s21, 12
    s_cbranch_scc1 Lw_pk
    s_call_b64 s[88:89], Lw_fpro
Lw_pk:
    v_accvgpr_read_b32 v192, a0
    v_accvgpr_read_b32 v193, a1
    v_accvgpr_read_b32 v194, a2
    v_accvgpr_read_b32 v195, a3
    v_accvgpr_read_b32 v196, a4
    v_accvgpr_read_b32 v197, a5
    v_accvgpr_read_b32 v198, a6
    v_accvgpr_read_b32 v199, a7
    v_cvt_pk_bf16_f32 v64, v192, v193
    v_cvt_pk_bf16_f32 v65, v194, v195
    v_cvt_pk_bf16_f32 v66, v196, v197
    v_cvt_pk_bf16_f32 v67, v198, v199
    s_nop 0
    v_permlane16_swap_b32 v64, v66
    v_permlane16_swap_b32 v65, v67
    v_accvgpr_read_b32 v200, a32
    v_accvgpr_read_b32 v201, a33
    v_accvgpr_read_b32 v202, a34
    v_accvgpr_read_b32 v203, a35
    v_accvgpr_read_b32 v204, a36
    v_accvgpr_read_b32 v205, a37
    v_accvgpr_read_b32 v206, a38
    v_accvgpr_read_b32 v207, a39
    v_cvt_pk_bf16_f32 v68, v200, v201
    v_cvt_pk_bf16_f32 v69, v202, v203
    v_cvt_pk_bf16_f32 v70, v204, v205
    v_cvt_pk_bf16_f32 v71, v206, v207
    s_nop 0
    v_permlane16_swap_b32 v68, v70
    v_permlane16_swap_b32 v69, v71
    v_accvgpr_read_b32 v208, a64
    v_accvgpr_read_b32 v209, a65
    v_accvgpr_read_b32 v210, a66
    v_accvgpr_read_b32 v211, a67
    v_accvgpr_read_b32 v212, a68
    v_accvgpr_read_b32 v213, a69
    v_accvgpr_read_b32 v214, a70
    v_accvgpr_read_b32 v215, a71
    v_cvt_pk_bf16_f32 v72, v208, v209
    v_cvt_pk_bf16_f32 v73, v210, v211
    v_cvt_pk_bf16_f32 v74, v212, v213
    v_cvt_pk_bf16_f32 v75, v214, v215
    s_nop 0
    v_permlane16_swap_b32 v72, v74
    v_permlane16_swap_b32 v73, v75
    v_accvgpr_read_b32 v216, a96
    v_accvgpr_read_b32 v217, a97
    v_accvgpr_read_b32 v218, a98
    v_accvgpr_read_b32 v219, a99
    v_accvgpr_read_b32 v220, a100
    v_accvgpr_read_b32 v221, a101
    v_accvgpr_read_b32 v222, a102
    v_accvgpr_read_b32 v223, a103
    v_cvt_pk_bf16_f32 v76, v216, v217
    v_cvt_pk_bf16_f32 v77, v218, v219
    v_cvt_pk_bf16_f32 v78, v220, v221
    v_cvt_pk_bf16_f32 v79, v222, v223
    s_nop 0
    v_permlane16_swap_b32 v76, v78
    v_permlane16_swap_b32 v77, v79
    v_accvgpr_read_b32 v192, a128
    v_accvgpr_read_b32 v193, a129
    v_accvgpr_read_b32 v194, a130
    v_accvgpr_read_b32 v195, a131
    v_accvgpr_read_b32 v196, a132
    v_accvgpr_read_b32 v197, a133
    v_accvgpr_read_b32 v198, a134
    v_accvgpr_read_b32 v199, a135
    v_cvt_pk_bf16_f32 v80, v192, v193
    v_cvt_pk_bf16_f32 v81, v194, v195
    v_cvt_pk_bf16_f32 v82, v196, v197
    v_cvt_pk_bf16_f32 v83, v198, v199
    s_nop 0
    v_permlane16_swap_b32 v80, v82
    v_permlane16_swap_b32 v81, v83
    v_accvgpr_read_b32 v200, a160
    v_accvgpr_read_b32 v201, a161
    v_accvgpr_read_b32 v202, a162
    v_accvgpr_read_b32 v203, a163
    v_accvgpr_read_b32 v204, a164
    v_accvgpr_read_b32 v205, a165
    v_accvgpr_read_b32 v206, a166
    v_accvgpr_read_b32 v207, a167
    v_cvt_pk_bf16_f32 v84, v200, v201
    v_cvt_pk_bf16_f32 v85, v202, v203
    v_cvt_pk_bf16_f32 v86, v204, v205
    v_cvt_pk_bf16_f32 v87, v206, v207
    s_nop 0
    v_permlane16_swap_b32 v84, v86
    v_permlane16_swap_b32 v85, v87
    v_accvgpr_read_b32 v208, a192
    v_accvgpr_read_b32 v209, a193
    v_accvgpr_read_b32 v210, a194
    v_accvgpr_read_b32 v211, a195
    v_accvgpr_read_b32 v212, a196
    v_accvgpr_read_b32 v213, a197
    v_accvgpr_read_b32 v214, a198
    v_accvgpr_read_b32 v215, a199
    v_cvt_pk_bf16_f32 v88, v208, v209
    v_cvt_pk_bf16_f32 v89, v210, v211
    v_cvt_pk_bf16_f32 v90, v212, v213
    v_cvt_pk_bf16_f32 v91, v214, v215
    s_nop 0
    v_permlane16_swap_b32 v88, v90
    v_permlane16_swap_b32 v89, v91
    v_accvgpr_read_b32 v216, a224
    v_accvgpr_read_b32 v217, a225
    v_accvgpr_read_b32 v218, a226
    v_accvgpr_read_b32 v219, a227
    v_accvgpr_read_b32 v220, a228
    v_accvgpr_read_b32 v221, a229
    v_accvgpr_read_b32 v222, a230
    v_accvgpr_read_b32 v223, a231
    v_cvt_pk_bf16_f32 v92, v216, v217
    v_cvt_pk_bf16_f32 v93, v218, v219
    v_cvt_pk_bf16_f32 v94, v220, v221
    v_cvt_pk_bf16_f32 v95, v222, v223
    s_nop 0
    v_permlane16_swap_b32 v92, v94
    v_permlane16_swap_b32 v93, v95
    v_accvgpr_read_b32 v192, a8
    v_accvgpr_read_b32 v193, a9
    v_accvgpr_read_b32 v194, a10
    v_accvgpr_read_b32 v195, a11
    v_accvgpr_read_b32 v196, a12
    v_accvgpr_read_b32 v197, a13
    v_accvgpr_read_b32 v198, a14
    v_accvgpr_read_b32 v199, a15
    v_cvt_pk_bf16_f32 v96, v192, v193
    v_cvt_pk_bf16_f32 v97, v194, v195
    v_cvt_pk_bf16_f32 v98, v196, v197
    v_cvt_pk_bf16_f32 v99, v198, v199
    s_nop 0
    v_permlane16_swap_b32 v96, v98
    v_permlane16_swap_b32 v97, v99
    v_accvgpr_read_b32 v200, a40
    v_accvgpr_read_b32 v201, a41
    v_accvgpr_read_b32 v202, a42
    v_accvgpr_read_b32 v203, a43
    v_accvgpr_read_b32 v204, a44
    v_accvgpr_read_b32 v205, a45
    v_accvgpr_read_b32 v206, a46
    v_accvgpr_read_b32 v207, a47
    v_cvt_pk_bf16_f32 v100, v200, v201
    v_cvt_pk_bf16_f32 v101, v202, v203
    v_cvt_pk_bf16_f32 v102, v204, v205
    v_cvt_pk_bf16_f32 v103, v206, v207
    s_nop 0
    v_permlane16_swap_b32 v100, v102
    v_permlane16_swap_b32 v101, v103
    v_accvgpr_read_b32 v208, a72
    v_accvgpr_read_b32 v209, a73
    v_accvgpr_read_b32 v210, a74
    v_accvgpr_read_b32 v211, a75
    v_accvgpr_read_b32 v212, a76
    v_accvgpr_read_b32 v213, a77
    v_accvgpr_read_b32 v214, a78
    v_accvgpr_read_b32 v215, a79
    v_cvt_pk_bf16_f32 v104, v208, v209
    v_cvt_pk_bf16_f32 v105, v210, v211
    v_cvt_pk_bf16_f32 v106, v212, v213
    v_cvt_pk_bf16_f32 v107, v214, v215
    s_nop 0
    v_permlane16_swap_b32 v104, v106
    v_permlane16_swap_b32 v105, v107
    v_accvgpr_read_b32 v216, a104
    v_accvgpr_read_b32 v217, a105
    v_accvgpr_read_b32 v218, a106
    v_accvgpr_read_b32 v219, a107
    v_accvgpr_read_b32 v220, a108
    v_accvgpr_read_b32 v221, a109
    v_accvgpr_read_b32 v222, a110
    v_accvgpr_read_b32 v223, a111
    v_cvt_pk_bf16_f32 v108, v216, v217
    v_cvt_pk_bf16_f32 v109, v218, v219
    v_cvt_pk_bf16_f32 v110, v220, v221
    v_cvt_pk_bf16_f32 v111, v222, v223
    s_nop 0
    v_permlane16_swap_b32 v108, v110
    v_permlane16_swap_b32 v109, v111
    v_accvgpr_read_b32 v192, a136
    v_accvgpr_read_b32 v193, a137
    v_accvgpr_read_b32 v194, a138
    v_accvgpr_read_b32 v195, a139
    v_accvgpr_read_b32 v196, a140
    v_accvgpr_read_b32 v197, a141
    v_accvgpr_read_b32 v198, a142
    v_accvgpr_read_b32 v199, a143
    v_cvt_pk_bf16_f32 v112, v192, v193
    v_cvt_pk_bf16_f32 v113, v194, v195
    v_cvt_pk_bf16_f32 v114, v196, v197
    v_cvt_pk_bf16_f32 v115, v198, v199
    s_nop 0
    v_permlane16_swap_b32 v112, v114
    v_permlane16_swap_b32 v113, v115
    v_accvgpr_read_b32 v200, a168
    v_accvgpr_read_b32 v201, a169
    v_accvgpr_read_b32 v202, a170
    v_accvgpr_read_b32 v203, a171
    v_accvgpr_read_b32 v204, a172
    v_accvgpr_read_b32 v205, a173
    v_accvgpr_read_b32 v206, a174
    v_accvgpr_read_b32 v207, a175
    v_cvt_pk_bf16_f32 v116, v200, v201
    v_cvt_pk_bf16_f32 v117, v202, v203
    v_cvt_pk_bf16_f32 v118, v204, v205
    v_cvt_pk_bf16_f32 v119, v206, v207
    s_nop 0
    v_permlane16_swap_b32 v116, v118
    v_permlane16_swap_b32 v117, v119
    v_accvgpr_read_b32 v208, a200
    v_accvgpr_read_b32 v209, a201
    v_accvgpr_read_b32 v210, a202
    v_accvgpr_read_b32 v211, a203
    v_accvgpr_read_b32 v212, a204
    v_accvgpr_read_b32 v213, a205
    v_accvgpr_read_b32 v214, a206
    v_accvgpr_read_b32 v215, a207
    v_cvt_pk_bf16_f32 v120, v208, v209
    v_cvt_pk_bf16_f32 v121, v210, v211
    v_cvt_pk_bf16_f32 v122, v212, v213
    v_cvt_pk_bf16_f32 v123, v214, v215
    s_nop 0
    v_permlane16_swap_b32 v120, v122
    v_permlane16_swap_b32 v121, v123
    v_accvgpr_read_b32 v216, a232
    v_accvgpr_read_b32 v217, a233
    v_accvgpr_read_b32 v218, a234
    v_accvgpr_read_b32 v219, a235
    v_accvgpr_read_b32 v220, a236
    v_accvgpr_read_b32 v221, a237
    v_accvgpr_read_b32 v222, a238
    v_accvgpr_read_b32 v223, a239
    v_cvt_pk_bf16_f32 v124, v216, v217
    v_cvt_pk_bf16_f32 v125, v218, v219
    v_cvt_pk_bf16_f32 v126, v220, v221
    v_cvt_pk_bf16_f32 v127, v222, v223
    s_nop 0
    v_permlane16_swap_b32 v124, v126
    v_permlane16_swap_b32 v125, v127
    v_accvgpr_read_b32 v192, a16
    v_accvgpr_read_b32 v193, a17
    v_accvgpr_read_b32 v194, a18
    v_accvgpr_read_b32 v195, a19
    v_accvgpr_read_b32 v196, a20
    v_accvgpr_read_b32 v197, a21
    v_accvgpr_read_b32 v198, a22
    v_accvgpr_read_b32 v199, a23
    v_cvt_pk_bf16_f32 v128, v192, v193
    v_cvt_pk_bf16_f32 v129, v194, v195
    v_cvt_pk_bf16_f32 v130, v196, v197
    v_cvt_pk_bf16_f32 v131, v198, v199
    s_nop 0
    v_permlane16_swap_b32 v128, v130
    v_permlane16_swap_b32 v129, v131
    v_accvgpr_read_b32 v200, a48
    v_accvgpr_read_b32 v201, a49
    v_accvgpr_read_b32 v202, a50
    v_accvgpr_read_b32 v203, a51
    v_accvgpr_read_b32 v204, a52
    v_accvgpr_read_b32 v205, a53
    v_accvgpr_read_b32 v206, a54
    v_accvgpr_read_b32 v207, a55
    v_cvt_pk_bf16_f32 v132, v200, v201
    v_cvt_pk_bf16_f32 v133, v202, v203
    v_cvt_pk_bf16_f32 v134, v204, v205
    v_cvt_pk_bf16_f32 v135, v206, v207
    s_nop 0
    v_permlane16_swap_b32 v132, v134
    v_permlane16_swap_b32 v133, v135
    v_accvgpr_read_b32 v208, a80
    v_accvgpr_read_b32 v209, a81
    v_accvgpr_read_b32 v210, a82
    v_accvgpr_read_b32 v211, a83
    v_accvgpr_read_b32 v212, a84
    v_accvgpr_read_b32 v213, a85
    v_accvgpr_read_b32 v214, a86
    v_accvgpr_read_b32 v215, a87
    v_cvt_pk_bf16_f32 v136, v208, v209
    v_cvt_pk_bf16_f32 v137, v210, v211
    v_cvt_pk_bf16_f32 v138, v212, v213
    v_cvt_pk_bf16_f32 v139, v214, v215
    s_nop 0
    v_permlane16_swap_b32 v136, v138
    v_permlane16_swap_b32 v137, v139
    v_accvgpr_read_b32 v216, a112
    v_accvgpr_read_b32 v217, a113
    v_accvgpr_read_b32 v218, a114
    v_accvgpr_read_b32 v219, a115
    v_accvgpr_read_b32 v220, a116
    v_accvgpr_read_b32 v221, a117
    v_accvgpr_read_b32 v222, a118
    v_accvgpr_read_b32 v223, a119
    v_cvt_pk_bf16_f32 v140, v216, v217
    v_cvt_pk_bf16_f32 v141, v218, v219
    v_cvt_pk_bf16_f32 v142, v220, v221
    v_cvt_pk_bf16_f32 v143, v222, v223
    s_nop 0
    v_permlane16_swap_b32 v140, v142
    v_permlane16_swap_b32 v141, v143
    v_accvgpr_read_b32 v192, a144
    v_accvgpr_read_b32 v193, a145
    v_accvgpr_read_b32 v194, a146
    v_accvgpr_read_b32 v195, a147
    v_accvgpr_read_b32 v196, a148
    v_accvgpr_read_b32 v197, a149
    v_accvgpr_read_b32 v198, a150
    v_accvgpr_read_b32 v199, a151
    v_cvt_pk_bf16_f32 v144, v192, v193
    v_cvt_pk_bf16_f32 v145, v194, v195
    v_cvt_pk_bf16_f32 v146, v196, v197
    v_cvt_pk_bf16_f32 v147, v198, v199
    s_nop 0
    v_permlane16_swap_b32 v144, v146
    v_permlane16_swap_b32 v145, v147
    v_accvgpr_read_b32 v200, a176
    v_accvgpr_read_b32 v201, a177
    v_accvgpr_read_b32 v202, a178
    v_accvgpr_read_b32 v203, a179
    v_accvgpr_read_b32 v204, a180
    v_accvgpr_read_b32 v205, a181
    v_accvgpr_read_b32 v206, a182
    v_accvgpr_read_b32 v207, a183
    v_cvt_pk_bf16_f32 v148, v200, v201
    v_cvt_pk_bf16_f32 v149, v202, v203
    v_cvt_pk_bf16_f32 v150, v204, v205
    v_cvt_pk_bf16_f32 v151, v206, v207
    s_nop 0
    v_permlane16_swap_b32 v148, v150
    v_permlane16_swap_b32 v149, v151
    v_accvgpr_read_b32 v208, a208
    v_accvgpr_read_b32 v209, a209
    v_accvgpr_read_b32 v210, a210
    v_accvgpr_read_b32 v211, a211
    v_accvgpr_read_b32 v212, a212
    v_accvgpr_read_b32 v213, a213
    v_accvgpr_read_b32 v214, a214
    v_accvgpr_read_b32 v215, a215
    v_cvt_pk_bf16_f32 v152, v208, v209
    v_cvt_pk_bf16_f32 v153, v210, v211
    v_cvt_pk_bf16_f32 v154, v212, v213
    v_cvt_pk_bf16_f32 v155, v214, v215
    s_nop 0
    v_permlane16_swap_b32 v152, v154
    v_permlane16_swap_b32 v153, v155
    v_accvgpr_read_b32 v216, a240
    v_accvgpr_read_b32 v217, a241
    v_accvgpr_read_b32 v218, a242
    v_accvgpr_read_b32 v219, a243
    v_accvgpr_read_b32 v220, a244
    v_accvgpr_read_b32 v221, a245
    v_accvgpr_read_b32 v222, a246
    v_accvgpr_read_b32 v223, a247
    v_cvt_pk_bf16_f32 v156, v216, v217
    v_cvt_pk_bf16_f32 v157, v218, v219
    v_cvt_pk_bf16_f32 v158, v220, v221
    v_cvt_pk_bf16_f32 v159, v222, v223
    s_nop 0
    v_permlane16_swap_b32 v156, v158
    v_permlane16_swap_b32 v157, v159
    v_accvgpr_read_b32 v192, a24
    v_accvgpr_read_b32 v193, a25
    v_accvgpr_read_b32 v194, a26
    v_accvgpr_read_b32 v195, a27
    v_accvgpr_read_b32 v196, a28
    v_accvgpr_read_b32 v197, a29
    v_accvgpr_read_b32 v198, a30
    v_accvgpr_read_b32 v199, a31
    v_cvt_pk_bf16_f32 v160, v192, v193
    v_cvt_pk_bf16_f32 v161, v194, v195
    v_cvt_pk_bf16_f32 v162, v196, v197
    v_cvt_pk_bf16_f32 v163, v198, v199
    s_nop 0
    v_permlane16_swap_b32 v160, v162
    v_permlane16_swap_b32 v161, v163
    v_accvgpr_read_b32 v200, a56
    v_accvgpr_read_b32 v201, a57
    v_accvgpr_read_b32 v202, a58
    v_accvgpr_read_b32 v203, a59
    v_accvgpr_read_b32 v204, a60
    v_accvgpr_read_b32 v205, a61
    v_accvgpr_read_b32 v206, a62
    v_accvgpr_read_b32 v207, a63
    v_cvt_pk_bf16_f32 v164, v200, v201
    v_cvt_pk_bf16_f32 v165, v202, v203
    v_cvt_pk_bf16_f32 v166, v204, v205
    v_cvt_pk_bf16_f32 v167, v206, v207
    s_nop 0
    v_permlane16_swap_b32 v164, v166
    v_permlane16_swap_b32 v165, v167
    v_accvgpr_read_b32 v208, a88
    v_accvgpr_read_b32 v209, a89
    v_accvgpr_read_b32 v210, a90
    v_accvgpr_read_b32 v211, a91
    v_accvgpr_read_b32 v212, a92
    v_accvgpr_read_b32 v213, a93
    v_accvgpr_read_b32 v214, a94
    v_accvgpr_read_b32 v215, a95
    v_cvt_pk_bf16_f32 v168, v208, v209
    v_cvt_pk_bf16_f32 v169, v210, v211
    v_cvt_pk_bf16_f32 v170, v212, v213
    v_cvt_pk_bf16_f32 v171, v214, v215
    s_nop 0
    v_permlane16_swap_b32 v168, v170
    v_permlane16_swap_b32 v169, v171
    v_accvgpr_read_b32 v216, a120
    v_accvgpr_read_b32 v217, a121
    v_accvgpr_read_b32 v218, a122
    v_accvgpr_read_b32 v219, a123
    v_accvgpr_read_b32 v220, a124
    v_accvgpr_read_b32 v221, a125
    v_accvgpr_read_b32 v222, a126
    v_accvgpr_read_b32 v223, a127
    v_cvt_pk_bf16_f32 v172, v216, v217
    v_cvt_pk_bf16_f32 v173, v218, v219
    v_cvt_pk_bf16_f32 v174, v220, v221
    v_cvt_pk_bf16_f32 v175, v222, v223
    s_nop 0
    v_permlane16_swap_b32 v172, v174
    v_permlane16_swap_b32 v173, v175
    v_accvgpr_read_b32 v192, a152
    v_accvgpr_read_b32 v193, a153
    v_accvgpr_read_b32 v194, a154
    v_accvgpr_read_b32 v195, a155
    v_accvgpr_read_b32 v196, a156
    v_accvgpr_read_b32 v197, a157
    v_accvgpr_read_b32 v198, a158
    v_accvgpr_read_b32 v199, a159
    v_cvt_pk_bf16_f32 v176, v192, v193
    v_cvt_pk_bf16_f32 v177, v194, v195
    v_cvt_pk_bf16_f32 v178, v196, v197
    v_cvt_pk_bf16_f32 v179, v198, v199
    s_nop 0
    v_permlane16_swap_b32 v176, v178
    v_permlane16_swap_b32 v177, v179
    v_accvgpr_read_b32 v200, a184
    v_accvgpr_read_b32 v201, a185
    v_accvgpr_read_b32 v202, a186
    v_accvgpr_read_b32 v203, a187
    v_accvgpr_read_b32 v204, a188
    v_accvgpr_read_b32 v205, a189
    v_accvgpr_read_b32 v206, a190
    v_accvgpr_read_b32 v207, a191
    v_cvt_pk_bf16_f32 v180, v200, v201
    v_cvt_pk_bf16_f32 v181, v202, v203
    v_cvt_pk_bf16_f32 v182, v204, v205
    v_cvt_pk_bf16_f32 v183, v206, v207
    s_nop 0
    v_permlane16_swap_b32 v180, v182
    v_permlane16_swap_b32 v181, v183
    v_accvgpr_read_b32 v208, a216
    v_accvgpr_read_b32 v209, a217
    v_accvgpr_read_b32 v210, a218
    v_accvgpr_read_b32 v211, a219
    v_accvgpr_read_b32 v212, a220
    v_accvgpr_read_b32 v213, a221
    v_accvgpr_read_b32 v214, a222
    v_accvgpr_read_b32 v215, a223
    v_cvt_pk_bf16_f32 v184, v208, v209
    v_cvt_pk_bf16_f32 v185, v210, v211
    v_cvt_pk_bf16_f32 v186, v212, v213
    v_cvt_pk_bf16_f32 v187, v214, v215
    s_nop 0
    v_permlane16_swap_b32 v184, v186
    v_permlane16_swap_b32 v185, v187
    v_accvgpr_read_b32 v216, a248
    v_accvgpr_read_b32 v217, a249
    v_accvgpr_read_b32 v218, a250
    v_accvgpr_read_b32 v219, a251
    v_accvgpr_read_b32 v220, a252
    v_accvgpr_read_b32 v221, a253
    v_accvgpr_read_b32 v222, a254
    v_accvgpr_read_b32 v223, a255
    v_cvt_pk_bf16_f32 v188, v216, v217
    v_cvt_pk_bf16_f32 v189, v218, v219
    v_cvt_pk_bf16_f32 v190, v220, v221
    v_cvt_pk_bf16_f32 v191, v222, v223
    s_nop 0
    v_permlane16_swap_b32 v188, v190
    v_permlane16_swap_b32 v189, v191
    v_accvgpr_write_b32 a128, v64
    v_accvgpr_write_b32 a129, v65
    v_accvgpr_write_b32 a130, v66
    v_accvgpr_write_b32 a131, v67
    v_accvgpr_write_b32 a132, v68
    v_accvgpr_write_b32 a133, v69
    v_accvgpr_write_b32 a134, v70
    v_accvgpr_write_b32 a135, v71
    v_accvgpr_write_b32 a136, v72
    v_accvgpr_write_b32 a137, v73
    v_accvgpr_write_b32 a138, v74
    v_accvgpr_write_b32 a139, v75
    v_accvgpr_write_b32 a140, v76
    v_accvgpr_write_b32 a141, v77
    v_accvgpr_write_b32 a142, v78
    v_accvgpr_write_b32 a143, v79
    v_accvgpr_write_b32 a144, v80
    v_accvgpr_write_b32 a145, v81
    v_accvgpr_write_b32 a146, v82
    v_accvgpr_write_b32 a147, v83
    v_accvgpr_write_b32 a148, v84
    v_accvgpr_write_b32 a149, v85
    v_accvgpr_write_b32 a150, v86
    v_accvgpr_write_b32 a151, v87
    v_accvgpr_write_b32 a152, v88
    v_accvgpr_write_b32 a153, v89
    v_accvgpr_write_b32 a154, v90
    v_accvgpr_write_b32 a155, v91
    v_accvgpr_write_b32 a156, v92
    v_accvgpr_write_b32 a157, v93
    v_accvgpr_write_b32 a158, v94
    v_accvgpr_write_b32 a159, v95
    v_accvgpr_write_b32 a160, v96
    v_accvgpr_write_b32 a161, v97
    v_accvgpr_write_b32 a162, v98
    v_accvgpr_write_b32 a163, v99
    v_accvgpr_write_b32 a164, v100
    v_accvgpr_write_b32 a165, v101
    v_accvgpr_write_b32 a166, v102
    v_accvgpr_write_b32 a167, v103
    v_accvgpr_write_b32 a168, v104
    v_accvgpr_write_b32 a169, v105
    v_accvgpr_write_b32 a170, v106
    v_accvgpr_write_b32 a171, v107
    v_accvgpr_write_b32 a172, v108
    v_accvgpr_write_b32 a173, v109
    v_accvgpr_write_b32 a174, v110
    v_accvgpr_write_b32 a175, v111
    v_accvgpr_write_b32 a176, v112
    v_accvgpr_write_b32 a177, v113
    v_accvgpr_write_b32 a178, v114
    v_accvgpr_write_b32 a179, v115
    v_accvgpr_write_b32 a180, v116
    v_accvgpr_write_b32 a181, v117
    v_accvgpr_write_b32 a182, v118
    v_accvgpr_write_b32 a183, v119
    v_accvgpr_write_b32 a184, v120
    v_accvgpr_write_b32 a185, v121
    v_accvgpr_write_b32 a186, v122
    v_accvgpr_write_b32 a187, v123
    v_accvgpr_write_b32 a188, v124
    v_accvgpr_write_b32 a189, v125
    v_accvgpr_write_b32 a190, v126
    v_accvgpr_write_b32 a191, v127
    v_accvgpr_write_b32 a192, v128
    v_accvgpr_write_b32 a193, v129
    v_accvgpr_write_b32 a194, v130
    v_accvgpr_write_b32 a195, v131
    v_accvgpr_write_b32 a196, v132
    v_accvgpr_write_b32 a197, v133
    v_accvgpr_write_b32 a198, v134
    v_accvgpr_write_b32 a199, v135
    v_accvgpr_write_b32 a200, v136
    v_accvgpr_write_b32 a201, v137
    v_accvgpr_write_b32 a202, v138
    v_accvgpr_write_b32 a203, v139
    v_accvgpr_write_b32 a204, v140
    v_accvgpr_write_b32 a205, v141
    v_accvgpr_write_b32 a206, v142
    v_accvgpr_write_b32 a207, v143
    v_accvgpr_write_b32 a208, v144
    v_accvgpr_write_b32 a209, v145
    v_accvgpr_write_b32 a210, v146
    v_accvgpr_write_b32 a211, v147
    v_accvgpr_write_b32 a212, v148
    v_accvgpr_write_b32 a213, v149
    v_accvgpr_write_b32 a214, v150
    v_accvgpr_write_b32 a215, v151
    v_accvgpr_write_b32 a216, v152
    v_accvgpr_write_b32 a217, v153
    v_accvgpr_write_b32 a218, v154
    v_accvgpr_write_b32 a219, v155
    v_accvgpr_write_b32 a220, v156
    v_accvgpr_write_b32 a221, v157
    v_accvgpr_write_b32 a222, v158
    v_accvgpr_write_b32 a223, v159
    v_accvgpr_write_b32 a224, v160
    v_accvgpr_write_b32 a225, v161
    v_accvgpr_write_b32 a226, v162
    v_accvgpr_write_b32 a227, v163
    v_accvgpr_write_b32 a228, v164
    v_accvgpr_write_b32 a229, v165
    v_accvgpr_write_b32 a230, v166
    v_accvgpr_write_b32 a231, v167
    v_accvgpr_write_b32 a232, v168
    v_accvgpr_write_b32 a233, v169
    v_accvgpr_write_b32 a234, v170
    v_accvgpr_write_b32 a235, v171
    v_accvgpr_write_b32 a236, v172
    v_accvgpr_write_b32 a237, v173
    v_accvgpr_write_b32 a238, v174
    v_accvgpr_write_b32 a239, v175
    v_accvgpr_write_b32 a240, v176
    v_accvgpr_write_b32 a241, v177
    v_accvgpr_write_b32 a242, v178
    v_accvgpr_write_b32 a243, v179
    v_accvgpr_write_b32 a244, v180
    v_accvgpr_write_b32 a245, v181
    v_accvgpr_write_b32 a246, v182
    v_accvgpr_write_b32 a247, v183
    v_accvgpr_write_b32 a248, v184
    v_accvgpr_write_b32 a249, v185
    v_accvgpr_write_b32 a250, v186
    v_accvgpr_write_b32 a251, v187
    v_accvgpr_write_b32 a252, v188
    v_accvgpr_write_b32 a253, v189
    v_accvgpr_write_b32 a254, v190
    v_accvgpr_write_b32 a255, v191
    v_accvgpr_write_b32 a0, 0
    v_accvgpr_write_b32 a1, 0
    v_accvgpr_write_b32 a2, 0
    v_accvgpr_write_b32 a3, 0
    v_accvgpr_write_b32 a4, 0
    v_accvgpr_write_b32 a5, 0
    v_accvgpr_write_b32 a6, 0
    v_accvgpr_write_b32 a7, 0
    v_accvgpr_write_b32 a8, 0
    v_accvgpr_write_b32 a9, 0
    v_accvgpr_write_b32 a10, 0
    v_accvgpr_write_b32 a11, 0
    v_accvgpr_write_b32 a12, 0
    v_accvgpr_write_b32 a13, 0
    v_accvgpr_write_b32 a14, 0
    v_accvgpr_write_b32 a15, 0
    v_accvgpr_write_b32 a16, 0
    v_accvgpr_write_b32 a17, 0
    v_accvgpr_write_b32 a18, 0
    v_accvgpr_write_b32 a19, 0
    v_accvgpr_write_b32 a20, 0
    v_accvgpr_write_b32 a21, 0
    v_accvgpr_write_b32 a22, 0
    v_accvgpr_write_b32 a23, 0
    v_accvgpr_write_b32 a24, 0
    v_accvgpr_write_b32 a25, 0
    v_accvgpr_write_b32 a26, 0
    v_accvgpr_write_b32 a27, 0
    v_accvgpr_write_b32 a28, 0
    v_accvgpr_write_b32 a29, 0
    v_accvgpr_write_b32 a30, 0
    v_accvgpr_write_b32 a31, 0
    v_accvgpr_write_b32 a32, 0
    v_accvgpr_write_b32 a33, 0
    v_accvgpr_write_b32 a34, 0
    v_accvgpr_write_b32 a35, 0
    v_accvgpr_write_b32 a36, 0
    v_accvgpr_write_b32 a37, 0
    v_accvgpr_write_b32 a38, 0
    v_accvgpr_write_b32 a39, 0
    v_accvgpr_write_b32 a40, 0
    v_accvgpr_write_b32 a41, 0
    v_accvgpr_write_b32 a42, 0
    v_accvgpr_write_b32 a43, 0
    v_accvgpr_write_b32 a44, 0
    v_accvgpr_write_b32 a45, 0
    v_accvgpr_write_b32 a46, 0
    v_accvgpr_write_b32 a47, 0
    v_accvgpr_write_b32 a48, 0
    v_accvgpr_write_b32 a49, 0
    v_accvgpr_write_b32 a50, 0
    v_accvgpr_write_b32 a51, 0
    v_accvgpr_write_b32 a52, 0
    v_accvgpr_write_b32 a53, 0
    v_accvgpr_write_b32 a54, 0
    v_accvgpr_write_b32 a55, 0
    v_accvgpr_write_b32 a56, 0
    v_accvgpr_write_b32 a57, 0
    v_accvgpr_write_b32 a58, 0
    v_accvgpr_write_b32 a59, 0
    v_accvgpr_write_b32 a60, 0
    v_accvgpr_write_b32 a61, 0
    v_accvgpr_write_b32 a62, 0
    v_accvgpr_write_b32 a63, 0
    v_accvgpr_write_b32 a64, 0
    v_accvgpr_write_b32 a65, 0
    v_accvgpr_write_b32 a66, 0
    v_accvgpr_write_b32 a67, 0
    v_accvgpr_write_b32 a68, 0
    v_accvgpr_write_b32 a69, 0
    v_accvgpr_write_b32 a70, 0
    v_accvgpr_write_b32 a71, 0
    v_accvgpr_write_b32 a72, 0
    v_accvgpr_write_b32 a73, 0
    v_accvgpr_write_b32 a74, 0
    v_accvgpr_write_b32 a75, 0
    v_accvgpr_write_b32 a76, 0
    v_accvgpr_write_b32 a77, 0
    v_accvgpr_write_b32 a78, 0
    v_accvgpr_write_b32 a79, 0
    v_accvgpr_write_b32 a80, 0
    v_accvgpr_write_b32 a81, 0
    v_accvgpr_write_b32 a82, 0
    v_accvgpr_write_b32 a83, 0
    v_accvgpr_write_b32 a84, 0
    v_accvgpr_write_b32 a85, 0
    v_accvgpr_write_b32 a86, 0
    v_accvgpr_write_b32 a87, 0
    v_accvgpr_write_b32 a88, 0
    v_accvgpr_write_b32 a89, 0
    v_accvgpr_write_b32 a90, 0
    v_accvgpr_write_b32 a91, 0
    v_accvgpr_write_b32 a92, 0
    v_accvgpr_write_b32 a93, 0
    v_accvgpr_write_b32 a94, 0
    v_accvgpr_write_b32 a95, 0
    v_accvgpr_write_b32 a96, 0
    v_accvgpr_write_b32 a97, 0
    v_accvgpr_write_b32 a98, 0
    v_accvgpr_write_b32 a99, 0
    v_accvgpr_write_b32 a100, 0
    v_accvgpr_write_b32 a101, 0
    v_accvgpr_write_b32 a102, 0
    v_accvgpr_write_b32 a103, 0
    v_accvgpr_write_b32 a104, 0
    v_accvgpr_write_b32 a105, 0
    v_accvgpr_write_b32 a106, 0
    v_accvgpr_write_b32 a107, 0
    v_accvgpr_write_b32 a108, 0
    v_accvgpr_write_b32 a109, 0
    v_accvgpr_write_b32 a110, 0
    v_accvgpr_write_b32 a111, 0
    v_accvgpr_write_b32 a112, 0
    v_accvgpr_write_b32 a113, 0
    v_accvgpr_write_b32 a114, 0
    v_accvgpr_write_b32 a115, 0
    v_accvgpr_write_b32 a116, 0
    v_accvgpr_write_b32 a117, 0
    v_accvgpr_write_b32 a118, 0
    v_accvgpr_write_b32 a119, 0
    v_accvgpr_write_b32 a120, 0
    v_accvgpr_write_b32 a121, 0
    v_accvgpr_write_b32 a122, 0
    v_accvgpr_write_b32 a123, 0
    v_accvgpr_write_b32 a124, 0
    v_accvgpr_write_b32 a125, 0
    v_accvgpr_write_b32 a126, 0
    v_accvgpr_write_b32 a127, 0
    s_cmp_lt_u32 s21, 12
    s_cbranch_scc1 Lw_lqd
    s_mov_b32 s4, s84
    s_mov_b32 s5, s85
    s_mov_b32 s6, 0x100
    s_mov_b32 s7, 0x20000
    s_mov_b32 s37, 2
    s_add_u32 s36, s23, 14
    s_lshl_b32 s38, s20, 2
    s_cmp_lt_u32 s21, 14
    s_cselect_b32 s24, 3, 2
    s_add_u32 s38, s38, s24
    s_call_b64 s[62:63], Lw_spro
    s_call_b64 s[62:63], Lw_srun
    s_cmp_lt_u32 s21, 14
    s_cbranch_scc1 Lw_lqe
    s_mov_b32 s39, 7
    s_and_b32 s38, s38, 28
    s_add_u32 s38, s38, s23
    s_call_b64 s[62:63], Lw_upro
    s_waitcnt vmcnt(36)
    s_barrier
    s_cmp_lg_u32 s46, 0
    s_cbranch_scc1 Lw_s1d
    v_lshlrev_b32 v2, 2, v1
    v_mov_b32 v3, s93
    s_mov_b64 exec, s[94:95]
    buffer_atomic_add v3, v2, s[8:11], s92 offen sc1
    s_mov_b64 exec, -1
Lw_s1d:
    s_call_b64 s[62:63], Lw_urun
    v_accvgpr_write_b32 a0, 0
    v_accvgpr_write_b32 a1, 0
    v_accvgpr_write_b32 a2, 0
    v_accvgpr_write_b32 a3, 0
    v_accvgpr_write_b32 a4, 0
    v_accvgpr_write_b32 a5, 0
    v_accvgpr_write_b32 a6, 0
    v_accvgpr_write_b32 a7, 0
    v_accvgpr_write_b32 a8, 0
    v_accvgpr_write_b32 a9, 0
    v_accvgpr_write_b32 a10, 0
    v_accvgpr_write_b32 a11, 0
    v_accvgpr_write_b32 a12, 0
    v_accvgpr_write_b32 a13, 0
    v_accvgpr_write_b32 a14, 0
    v_accvgpr_write_b32 a15, 0
    v_accvgpr_write_b32 a16, 0
    v_accvgpr_write_b32 a17, 0
    v_accvgpr_write_b32 a18, 0
    v_accvgpr_write_b32 a19, 0
    v_accvgpr_write_b32 a20, 0
    v_accvgpr_write_b32 a21, 0
    v_accvgpr_write_b32 a22, 0
    v_accvgpr_write_b32 a23, 0
    v_accvgpr_write_b32 a24, 0
    v_accvgpr_write_b32 a25, 0
    v_accvgpr_write_b32 a26, 0
    v_accvgpr_write_b32 a27, 0
    v_accvgpr_write_b32 a28, 0
    v_accvgpr_write_b32 a29, 0
    v_accvgpr_write_b32 a30, 0
    v_accvgpr_write_b32 a31, 0
    v_accvgpr_write_b32 a32, 0
    v_accvgpr_write_b32 a33, 0
    v_accvgpr_write_b32 a34, 0
    v_accvgpr_write_b32 a35, 0
    v_accvgpr_write_b32 a36, 0
    v_accvgpr_write_b32 a37, 0
    v_accvgpr_write_b32 a38, 0
    v_accvgpr_write_b32 a39, 0
    v_accvgpr_write_b32 a40, 0
    v_accvgpr_write_b32 a41, 0
    v_accvgpr_write_b32 a42, 0
    v_accvgpr_write_b32 a43, 0
    v_accvgpr_write_b32 a44, 0
    v_accvgpr_write_b32 a45, 0
    v_accvgpr_write_b32 a46, 0
    v_accvgpr_write_b32 a47, 0
    v_accvgpr_write_b32 a48, 0
    v_accvgpr_write_b32 a49, 0
    v_accvgpr_write_b32 a50, 0
    v_accvgpr_write_b32 a51, 0
    v_accvgpr_write_b32 a52, 0
    v_accvgpr_write_b32 a53, 0
    v_accvgpr_write_b32 a54, 0
    v_accvgpr_write_b32 a55, 0
    v_accvgpr_write_b32 a56, 0
    v_accvgpr_write_b32 a57, 0
    v_accvgpr_write_b32 a58, 0
    v_accvgpr_write_b32 a59, 0
    v_accvgpr_write_b32 a60, 0
    v_accvgpr_write_b32 a61, 0
    v_accvgpr_write_b32 a62, 0
    v_accvgpr_write_b32 a63, 0
    v_accvgpr_write_b32 a64, 0
    v_accvgpr_write_b32 a65, 0
    v_accvgpr_write_b32 a66, 0
    v_accvgpr_write_b32 a67, 0
    v_accvgpr_write_b32 a68, 0
    v_accvgpr_write_b32 a69, 0
    v_accvgpr_write_b32 a70, 0
    v_accvgpr_write_b32 a71, 0
    v_accvgpr_write_b32 a72, 0
    v_accvgpr_write_b32 a73, 0
    v_accvgpr_write_b32 a74, 0
    v_accvgpr_write_b32 a75, 0
    v_accvgpr_write_b32 a76, 0
    v_accvgpr_write_b32 a77, 0
    v_accvgpr_write_b32 a78, 0
    v_accvgpr_write_b32 a79, 0
    v_accvgpr_write_b32 a80, 0
    v_accvgpr_write_b32 a81, 0
    v_accvgpr_write_b32 a82, 0
    v_accvgpr_write_b32 a83, 0
    v_accvgpr_write_b32 a84, 0
    v_accvgpr_write_b32 a85, 0
    v_accvgpr_write_b32 a86, 0
    v_accvgpr_write_b32 a87, 0
    v_accvgpr_write_b32 a88, 0
    v_accvgpr_write_b32 a89, 0
    v_accvgpr_write_b32 a90, 0
    v_accvgpr_write_b32 a91, 0
    v_accvgpr_write_b32 a92, 0
    v_accvgpr_write_b32 a93, 0
    v_accvgpr_write_b32 a94, 0
    v_accvgpr_write_b32 a95, 0
    v_accvgpr_write_b32 a96, 0
    v_accvgpr_write_b32 a97, 0
    v_accvgpr_write_b32 a98, 0
    v_accvgpr_write_b32 a99, 0
    v_accvgpr_write_b32 a100, 0
    v_accvgpr_write_b32 a101, 0
    v_accvgpr_write_b32 a102, 0
    v_accvgpr_write_b32 a103, 0
    v_accvgpr_write_b32 a104, 0
    v_accvgpr_write_b32 a105, 0
    v_accvgpr_write_b32 a106, 0
    v_accvgpr_write_b32 a107, 0
    v_accvgpr_write_b32 a108, 0
    v_accvgpr_write_b32 a109, 0
    v_accvgpr_write_b32 a110, 0
    v_accvgpr_write_b32 a111, 0
    v_accvgpr_write_b32 a112, 0
    v_accvgpr_write_b32 a113, 0
    v_accvgpr_write_b32 a114, 0
    v_accvgpr_write_b32 a115, 0
    v_accvgpr_write_b32 a116, 0
    v_accvgpr_write_b32 a117, 0
    v_accvgpr_write_b32 a118, 0
    v_accvgpr_write_b32 a119, 0
    v_accvgpr_write_b32 a120, 0
    v_accvgpr_write_b32 a121, 0
    v_accvgpr_write_b32 a122, 0
    v_accvgpr_write_b32 a123, 0
    v_accvgpr_write_b32 a124, 0
    v_accvgpr_write_b32 a125, 0
    v_accvgpr_write_b32 a126, 0
    v_accvgpr_write_b32 a127, 0
Lw_lqe:
    s_call_b64 s[88:89], Lw_fpro
    s_waitcnt vmcnt(36)
    s_barrier
    s_cmp_lg_u32 s46, 0
    s_cbranch_scc1 Lw_s1e
    v_lshlrev_b32 v2, 2, v1
    v_mov_b32 v3, s93
    s_mov_b64 exec, s[94:95]
    buffer_atomic_add v3, v2, s[8:11], s92 offen sc1
    s_mov_b64 exec, -1
Lw_s1e:
Lw_lqd:
    s_call_b64 s[80:81], Lw_mrun
    s_cmp_ge_u32 s21, 8
    s_cbranch_scc1 Lw_f3
    s_call_b64 s[62:63], Lw_att
    s_sub_u32 s44, 22, s27
    s_call_b64 s[62:63], Lw_mq
    s_call_b64 s[80:81], Lw_mrun
Lw_f3:
    s_cmp_lt_u32 s21, 14
    s_cbranch_scc1 Lw_f4
    s_mov_b32 s16, s60
    s_mov_b32 s17, s61
    s_mov_b32 s18, 0x400000
    s_mov_b32 s19, 0x20000
    s_lshr_b32 s49, s46, 1
    s_lshl_b32 s49, s49, 18
    s_lshl_b32 s50, s22, 19
    s_add_u32 s49, s49, s50
    s_and_b32 s50, s46, 1
    s_lshl_b32 s50, s50, 7
    s_add_u32 s49, s49, s50
    s_lshl_b32 s50, s20, 8
    s_add_u32 s49, s49, s50
    v_and_b32 v5, 15, v1
    v_lshlrev_b32 v5, 11, v5
    v_add_u32 v5, s49, v5
    v_bfe_u32 v6, v1, 4, 1
    v_lshl_add_u32 v6, v6, 5, v5
    v_lshrrev_b32 v7, 5, v1
    v_lshl_add_u32 v6, v7, 4, v6
    v_lshrrev_b32 v7, 4, v1
    v_lshl_add_u32 v7, v7, 3, v5
    s_lshl_b32 s49, s23, 17
    buffer_load_dwordx2 v[192:193], v7, s[16:19], s49 offen offset:0
    buffer_load_dwordx2 v[194:195], v7, s[16:19], s49 offen offset:32
    buffer_load_dwordx2 v[196:197], v7, s[16:19], s49 offen offset:64
    buffer_load_dwordx2 v[198:199], v7, s[16:19], s49 offen offset:96
    s_add_u32 s49, s49, 0x8000
    buffer_load_dwordx2 v[200:201], v7, s[16:19], s49 offen offset:0
    buffer_load_dwordx2 v[202:203], v7, s[16:19], s49 offen offset:32
    buffer_load_dwordx2 v[204:205], v7, s[16:19], s49 offen offset:64
    buffer_load_dwordx2 v[206:207], v7, s[16:19], s49 offen offset:96
    s_add_u32 s49, s49, 0x8000
    buffer_load_dwordx2 v[208:209], v7, s[16:19], s49 offen offset:0
    buffer_load_dwordx2 v[210:211], v7, s[16:19], s49 offen offset:32
    buffer_load_dwordx2 v[212:213], v7, s[16:19], s49 offen offset:64
    buffer_load_dwordx2 v[214:215], v7, s[16:19], s49 offen offset:96
    s_add_u32 s49, s49, 0x8000
    buffer_load_dwordx2 v[216:217], v7, s[16:19], s49 offen offset:0
    buffer_load_dwordx2 v[218:219], v7, s[16:19], s49 offen offset:32
    buffer_load_dwordx2 v[220:221], v7, s[16:19], s49 offen offset:64
    buffer_load_dwordx2 v[222:223], v7, s[16:19], s49 offen offset:96
    s_add_u32 s49, s49, 0x8000
    s_branch Lw_fin
Lw_f4:
    s_cmp_lt_u32 s21, 8
    s_cbranch_scc1 Lw_wo
    s_call_b64 s[62:63], Lw_att
Lw_wo:
    s_mov_b32 s12, s70
    s_mov_b32 s13, s71
    s_mov_b32 s14, 0x800000
    s_mov_b32 s15, 0x20000
    s_mov_b32 s42, 0x40000
    s_lshl_b32 s40, s22, 21
    s_lshl_b32 s24, s23, 17
    s_add_u32 s40, s40, s24
    s_add_u32 s40, s40, 71303168
    s_lshl_b32 s41, s23, 22
    s_mov_b32 s44, 29
    s_lshl_b32 s24, s20, 8
    s_add_u32 s41, s41, s24
    s_lshr_b32 s49, s46, 1
    s_lshl_b32 s49, s49, 13
    v_lshrrev_b32 v2, 4, v1
    v_and_b32 v3, 15, v1
    v_lshlrev_b32 v4, 9, v2
    v_lshl_add_u32 v4, v3, 4, v4
    v_add_u32 v32, s49, v4
    v_lshrrev_b32 v4, 2, v3
    v_lshl_add_u32 v6, v2, 3, v4
    v_lshlrev_b32 v6, 8, v6
    v_and_b32 v7, 3, v3
    v_lshl_add_u32 v6, v7, 3, v6
    v_and_b32 v7, 1, v2
    v_lshl_add_u32 v4, v7, 2, v4
    v_lshl_add_u32 v6, v4, 5, v6
    v_add_u32 v6, 16384, v6
    s_and_b32 s50, s46, 1
    s_lshl_b32 s49, s50, 7
    v_xor_b32 v6, s49, v6
    v_xor_b32 v40, 0, v6
    v_xor_b32 v41, 32, v6
    v_xor_b32 v42, 64, v6
    v_xor_b32 v43, 96, v6
    s_lshl_b32 s49, s46, 3
    v_lshlrev_b32 v4, 1, v2
    v_xor_b32 v3, v3, v4
    s_lshl_b32 s50, s50, 3
    v_xor_b32 v3, s50, v3
    v_add_u32 v2, s49, v2
    v_lshlrev_b32 v2, s43, v2
    v_lshl_add_u32 v36, v3, 4, v2
    s_lshl_b32 s49, 4, s43
    s_sub_u32 s49, s49, 1024
    v_add_u32 v37, s49, v36
    s_lshl_b32 s59, 32, s43
    s_mul_i32 s49, s46, s42
    s_lshl_b32 s49, s49, 1
    v_lshl_add_u32 v34, v1, 4, s49
    s_sub_u32 s49, s42, 2048
    v_add_u32 v35, s49, v34
    s_lshl_b32 s47, s46, 12
    s_lshl_b32 s48, s46, 11
    s_add_u32 s48, s48, 16384
    s_mov_b32 s51, 0
    s_mov_b32 s52, 0
    s_lshl_b32 s53, s21, 7
    s_add_u32 s53, s53, 120070144
    s_xor_b32 s54, s28, 4
    s_lshl_b32 s54, s54, 2
    s_add_u32 s54, s54, 120072192
    v_mov_b32 v2, s53
    v_mov_b32 v4, 8
    v_writelane_b32 v2, s54, 1
    v_writelane_b32 v4, 1, 1
    s_mov_b32 s54, 0
    s_mov_b64 exec, 3
Lw_o0:
    buffer_load_dword v3, v2, s[8:11], 0 offen sc1
    s_waitcnt vmcnt(0)
    v_cmp_ne_u32 vcc, v3, v4
    s_cbranch_vccz Lw_o1
    s_sleep 2
    s_add_u32 s54, s54, 1
    s_cmp_lt_u32 s54, 2000000
    s_cbranch_scc1 Lw_o0
    s_mov_b64 exec, -1
    s_branch Lw_fail
Lw_o1:
    s_mov_b64 exec, -1
    s_call_b64 s[62:63], Lw_mdma
    s_call_b64 s[80:81], Lw_mrun
Lw_fin:
    s_lshl_b32 s30, s28, 13
    s_add_u32 s30, s30, 115867648
    s_xor_b32 s24, s28, 4
    s_lshl_b32 s31, s24, 13
    s_add_u32 s31, s31, 115867648
    s_cmp_ge_u32 s21, 14
    s_cselect_b64 s[24:25], s[86:87], s[78:79]
    s_cselect_b32 s34, 111673344, 0
    s_mov_b32 s6, 4194304
    s_cselect_b32 s6, s10, s6
    s_mov_b32 s4, s24
    s_mov_b32 s5, s25
    s_mov_b32 s7, 0x20000
    s_cselect_b32 s31, 268435456, s31
    s_lshr_b32 s49, s46, 1
    s_lshl_b32 s49, s49, 18
    s_lshl_b32 s50, s22, 19
    s_add_u32 s49, s49, s50
    s_and_b32 s50, s46, 1
    s_lshl_b32 s50, s50, 7
    s_add_u32 s49, s49, s50
    s_lshl_b32 s50, s20, 8
    s_add_u32 s49, s49, s50
    v_and_b32 v5, 15, v1
    v_lshlrev_b32 v5, 11, v5
    v_add_u32 v5, s49, v5
    v_bfe_u32 v6, v1, 4, 1
    v_lshl_add_u32 v6, v6, 5, v5
    v_lshrrev_b32 v7, 5, v1
    v_lshl_add_u32 v6, v7, 4, v6
    s_cmp_eq_u32 s23, 1
    s_cbranch_scc1 Lw_k1
    v_lshlrev_b32 v8, 4, v1
    v_add_u32 v9, 4096, v8
    v_accvgpr_read_b32 v16, a16
    v_accvgpr_read_b32 v20, a48
    v_accvgpr_read_b32 v17, a17
    v_accvgpr_read_b32 v21, a49
    v_accvgpr_read_b32 v18, a18
    v_accvgpr_read_b32 v22, a50
    v_accvgpr_read_b32 v19, a19
    v_accvgpr_read_b32 v23, a51
    v_cvt_pk_bf16_f32 v24, v16, v17
    v_cvt_pk_bf16_f32 v25, v18, v19
    v_cvt_pk_bf16_f32 v26, v20, v21
    v_cvt_pk_bf16_f32 v27, v22, v23
    v_min_u32 v24, -2, v24
    v_min_u32 v25, -2, v25
    v_min_u32 v26, -2, v26
    v_min_u32 v27, -2, v27
    buffer_store_dwordx4 v[24:27], v8, s[8:11], s30 offen offset:0 sc1
    v_accvgpr_read_b32 v28, a80
    v_accvgpr_read_b32 v32, a112
    v_accvgpr_read_b32 v29, a81
    v_accvgpr_read_b32 v33, a113
    v_accvgpr_read_b32 v30, a82
    v_accvgpr_read_b32 v34, a114
    v_accvgpr_read_b32 v31, a83
    v_accvgpr_read_b32 v35, a115
    v_cvt_pk_bf16_f32 v36, v28, v29
    v_cvt_pk_bf16_f32 v37, v30, v31
    v_cvt_pk_bf16_f32 v38, v32, v33
    v_cvt_pk_bf16_f32 v39, v34, v35
    v_min_u32 v36, -2, v36
    v_min_u32 v37, -2, v37
    v_min_u32 v38, -2, v38
    v_min_u32 v39, -2, v39
    buffer_store_dwordx4 v[36:39], v8, s[8:11], s30 offen offset:1024 sc1
    v_accvgpr_read_b32 v40, a20
    v_accvgpr_read_b32 v44, a52
    v_accvgpr_read_b32 v41, a21
    v_accvgpr_read_b32 v45, a53
    v_accvgpr_read_b32 v42, a22
    v_accvgpr_read_b32 v46, a54
    v_accvgpr_read_b32 v43, a23
    v_accvgpr_read_b32 v47, a55
    v_cvt_pk_bf16_f32 v48, v40, v41
    v_cvt_pk_bf16_f32 v49, v42, v43
    v_cvt_pk_bf16_f32 v50, v44, v45
    v_cvt_pk_bf16_f32 v51, v46, v47
    v_min_u32 v48, -2, v48
    v_min_u32 v49, -2, v49
    v_min_u32 v50, -2, v50
    v_min_u32 v51, -2, v51
    buffer_store_dwordx4 v[48:51], v8, s[8:11], s30 offen offset:2048 sc1
    v_accvgpr_read_b32 v52, a84
    v_accvgpr_read_b32 v56, a116
    v_accvgpr_read_b32 v53, a85
    v_accvgpr_read_b32 v57, a117
    v_accvgpr_read_b32 v54, a86
    v_accvgpr_read_b32 v58, a118
    v_accvgpr_read_b32 v55, a87
    v_accvgpr_read_b32 v59, a119
    v_cvt_pk_bf16_f32 v60, v52, v53
    v_cvt_pk_bf16_f32 v61, v54, v55
    v_cvt_pk_bf16_f32 v62, v56, v57
    v_cvt_pk_bf16_f32 v63, v58, v59
    v_min_u32 v60, -2, v60
    v_min_u32 v61, -2, v61
    v_min_u32 v62, -2, v62
    v_min_u32 v63, -2, v63
    buffer_store_dwordx4 v[60:63], v8, s[8:11], s30 offen offset:3072 sc1
    v_accvgpr_read_b32 v16, a24
    v_accvgpr_read_b32 v20, a56
    v_accvgpr_read_b32 v17, a25
    v_accvgpr_read_b32 v21, a57
    v_accvgpr_read_b32 v18, a26
    v_accvgpr_read_b32 v22, a58
    v_accvgpr_read_b32 v19, a27
    v_accvgpr_read_b32 v23, a59
    v_cvt_pk_bf16_f32 v24, v16, v17
    v_cvt_pk_bf16_f32 v25, v18, v19
    v_cvt_pk_bf16_f32 v26, v20, v21
    v_cvt_pk_bf16_f32 v27, v22, v23
    v_min_u32 v24, -2, v24
    v_min_u32 v25, -2, v25
    v_min_u32 v26, -2, v26
    v_min_u32 v27, -2, v27
    buffer_store_dwordx4 v[24:27], v9, s[8:11], s30 offen offset:0 sc1
    v_accvgpr_read_b32 v28, a88
    v_accvgpr_read_b32 v32, a120
    v_accvgpr_read_b32 v29, a89
    v_accvgpr_read_b32 v33, a121
    v_accvgpr_read_b32 v30, a90
    v_accvgpr_read_b32 v34, a122
    v_accvgpr_read_b32 v31, a91
    v_accvgpr_read_b32 v35, a123
    v_cvt_pk_bf16_f32 v36, v28, v29
    v_cvt_pk_bf16_f32 v37, v30, v31
    v_cvt_pk_bf16_f32 v38, v32, v33
    v_cvt_pk_bf16_f32 v39, v34, v35
    v_min_u32 v36, -2, v36
    v_min_u32 v37, -2, v37
    v_min_u32 v38, -2, v38
    v_min_u32 v39, -2, v39
    buffer_store_dwordx4 v[36:39], v9, s[8:11], s30 offen offset:1024 sc1
    v_accvgpr_read_b32 v40, a28
    v_accvgpr_read_b32 v44, a60
    v_accvgpr_read_b32 v41, a29
    v_accvgpr_read_b32 v45, a61
    v_accvgpr_read_b32 v42, a30
    v_accvgpr_read_b32 v46, a62
    v_accvgpr_read_b32 v43, a31
    v_accvgpr_read_b32 v47, a63
    v_cvt_pk_bf16_f32 v48, v40, v41
    v_cvt_pk_bf16_f32 v49, v42, v43
    v_cvt_pk_bf16_f32 v50, v44, v45
    v_cvt_pk_bf16_f32 v51, v46, v47
    v_min_u32 v48, -2, v48
    v_min_u32 v49, -2, v49
    v_min_u32 v50, -2, v50
    v_min_u32 v51, -2, v51
    buffer_store_dwordx4 v[48:51], v9, s[8:11], s30 offen offset:2048 sc1
    v_accvgpr_read_b32 v52, a92
    v_accvgpr_read_b32 v56, a124
    v_accvgpr_read_b32 v53, a93
    v_accvgpr_read_b32 v57, a125
    v_accvgpr_read_b32 v54, a94
    v_accvgpr_read_b32 v58, a126
    v_accvgpr_read_b32 v55, a95
    v_accvgpr_read_b32 v59, a127
    v_cvt_pk_bf16_f32 v60, v52, v53
    v_cvt_pk_bf16_f32 v61, v54, v55
    v_cvt_pk_bf16_f32 v62, v56, v57
    v_cvt_pk_bf16_f32 v63, v58, v59
    v_min_u32 v60, -2, v60
    v_min_u32 v61, -2, v61
    v_min_u32 v62, -2, v62
    v_min_u32 v63, -2, v63
    buffer_store_dwordx4 v[60:63], v9, s[8:11], s30 offen offset:3072 sc1
    s_mov_b32 s50, 0xffff0000
    s_add_u32 s34, s34, 0
    s_waitcnt vmcnt(8)
    v_accvgpr_read_b32 v96, a0
    v_accvgpr_read_b32 v100, a32
    v_accvgpr_read_b32 v97, a1
    v_accvgpr_read_b32 v101, a33
    v_accvgpr_read_b32 v98, a2
    v_accvgpr_read_b32 v102, a34
    v_accvgpr_read_b32 v99, a3
    v_accvgpr_read_b32 v103, a35
    v_lshlrev_b32 v2, 16, v192
    v_and_b32 v3, s50, v192
    v_pk_add_f32 v[96:97], v[96:97], v[2:3]
    v_lshlrev_b32 v2, 16, v193
    v_and_b32 v3, s50, v193
    v_pk_add_f32 v[98:99], v[98:99], v[2:3]
    v_lshlrev_b32 v2, 16, v194
    v_and_b32 v3, s50, v194
    v_pk_add_f32 v[100:101], v[100:101], v[2:3]
    v_lshlrev_b32 v2, 16, v195
    v_and_b32 v3, s50, v195
    v_pk_add_f32 v[102:103], v[102:103], v[2:3]
    v_accvgpr_read_b32 v104, a64
    v_accvgpr_read_b32 v108, a96
    v_accvgpr_read_b32 v105, a65
    v_accvgpr_read_b32 v109, a97
    v_accvgpr_read_b32 v106, a66
    v_accvgpr_read_b32 v110, a98
    v_accvgpr_read_b32 v107, a67
    v_accvgpr_read_b32 v111, a99
    v_lshlrev_b32 v2, 16, v196
    v_and_b32 v3, s50, v196
    v_pk_add_f32 v[104:105], v[104:105], v[2:3]
    v_lshlrev_b32 v2, 16, v197
    v_and_b32 v3, s50, v197
    v_pk_add_f32 v[106:107], v[106:107], v[2:3]
    v_lshlrev_b32 v2, 16, v198
    v_and_b32 v3, s50, v198
    v_pk_add_f32 v[108:109], v[108:109], v[2:3]
    v_lshlrev_b32 v2, 16, v199
    v_and_b32 v3, s50, v199
    v_pk_add_f32 v[110:111], v[110:111], v[2:3]
    v_accvgpr_read_b32 v112, a4
    v_accvgpr_read_b32 v116, a36
    v_accvgpr_read_b32 v113, a5
    v_accvgpr_read_b32 v117, a37
    v_accvgpr_read_b32 v114, a6
    v_accvgpr_read_b32 v118, a38
    v_accvgpr_read_b32 v115, a7
    v_accvgpr_read_b32 v119, a39
    v_lshlrev_b32 v2, 16, v200
    v_and_b32 v3, s50, v200
    v_pk_add_f32 v[112:113], v[112:113], v[2:3]
    v_lshlrev_b32 v2, 16, v201
    v_and_b32 v3, s50, v201
    v_pk_add_f32 v[114:115], v[114:115], v[2:3]
    v_lshlrev_b32 v2, 16, v202
    v_and_b32 v3, s50, v202
    v_pk_add_f32 v[116:117], v[116:117], v[2:3]
    v_lshlrev_b32 v2, 16, v203
    v_and_b32 v3, s50, v203
    v_pk_add_f32 v[118:119], v[118:119], v[2:3]
    v_accvgpr_read_b32 v120, a68
    v_accvgpr_read_b32 v124, a100
    v_accvgpr_read_b32 v121, a69
    v_accvgpr_read_b32 v125, a101
    v_accvgpr_read_b32 v122, a70
    v_accvgpr_read_b32 v126, a102
    v_accvgpr_read_b32 v123, a71
    v_accvgpr_read_b32 v127, a103
    v_lshlrev_b32 v2, 16, v204
    v_and_b32 v3, s50, v204
    v_pk_add_f32 v[120:121], v[120:121], v[2:3]
    v_lshlrev_b32 v2, 16, v205
    v_and_b32 v3, s50, v205
    v_pk_add_f32 v[122:123], v[122:123], v[2:3]
    v_lshlrev_b32 v2, 16, v206
    v_and_b32 v3, s50, v206
    v_pk_add_f32 v[124:125], v[124:125], v[2:3]
    v_lshlrev_b32 v2, 16, v207
    v_and_b32 v3, s50, v207
    v_pk_add_f32 v[126:127], v[126:127], v[2:3]
    v_accvgpr_read_b32 v128, a8
    v_accvgpr_read_b32 v132, a40
    v_accvgpr_read_b32 v129, a9
    v_accvgpr_read_b32 v133, a41
    v_accvgpr_read_b32 v130, a10
    v_accvgpr_read_b32 v134, a42
    v_accvgpr_read_b32 v131, a11
    v_accvgpr_read_b32 v135, a43
    v_lshlrev_b32 v2, 16, v208
    v_and_b32 v3, s50, v208
    v_pk_add_f32 v[128:129], v[128:129], v[2:3]
    v_lshlrev_b32 v2, 16, v209
    v_and_b32 v3, s50, v209
    v_pk_add_f32 v[130:131], v[130:131], v[2:3]
    v_lshlrev_b32 v2, 16, v210
    v_and_b32 v3, s50, v210
    v_pk_add_f32 v[132:133], v[132:133], v[2:3]
    v_lshlrev_b32 v2, 16, v211
    v_and_b32 v3, s50, v211
    v_pk_add_f32 v[134:135], v[134:135], v[2:3]
    v_accvgpr_read_b32 v136, a72
    v_accvgpr_read_b32 v140, a104
    v_accvgpr_read_b32 v137, a73
    v_accvgpr_read_b32 v141, a105
    v_accvgpr_read_b32 v138, a74
    v_accvgpr_read_b32 v142, a106
    v_accvgpr_read_b32 v139, a75
    v_accvgpr_read_b32 v143, a107
    v_lshlrev_b32 v2, 16, v212
    v_and_b32 v3, s50, v212
    v_pk_add_f32 v[136:137], v[136:137], v[2:3]
    v_lshlrev_b32 v2, 16, v213
    v_and_b32 v3, s50, v213
    v_pk_add_f32 v[138:139], v[138:139], v[2:3]
    v_lshlrev_b32 v2, 16, v214
    v_and_b32 v3, s50, v214
    v_pk_add_f32 v[140:141], v[140:141], v[2:3]
    v_lshlrev_b32 v2, 16, v215
    v_and_b32 v3, s50, v215
    v_pk_add_f32 v[142:143], v[142:143], v[2:3]
    v_accvgpr_read_b32 v144, a12
    v_accvgpr_read_b32 v148, a44
    v_accvgpr_read_b32 v145, a13
    v_accvgpr_read_b32 v149, a45
    v_accvgpr_read_b32 v146, a14
    v_accvgpr_read_b32 v150, a46
    v_accvgpr_read_b32 v147, a15
    v_accvgpr_read_b32 v151, a47
    v_lshlrev_b32 v2, 16, v216
    v_and_b32 v3, s50, v216
    v_pk_add_f32 v[144:145], v[144:145], v[2:3]
    v_lshlrev_b32 v2, 16, v217
    v_and_b32 v3, s50, v217
    v_pk_add_f32 v[146:147], v[146:147], v[2:3]
    v_lshlrev_b32 v2, 16, v218
    v_and_b32 v3, s50, v218
    v_pk_add_f32 v[148:149], v[148:149], v[2:3]
    v_lshlrev_b32 v2, 16, v219
    v_and_b32 v3, s50, v219
    v_pk_add_f32 v[150:151], v[150:151], v[2:3]
    v_accvgpr_read_b32 v152, a76
    v_accvgpr_read_b32 v156, a108
    v_accvgpr_read_b32 v153, a77
    v_accvgpr_read_b32 v157, a109
    v_accvgpr_read_b32 v154, a78
    v_accvgpr_read_b32 v158, a110
    v_accvgpr_read_b32 v155, a79
    v_accvgpr_read_b32 v159, a111
    v_lshlrev_b32 v2, 16, v220
    v_and_b32 v3, s50, v220
    v_pk_add_f32 v[152:153], v[152:153], v[2:3]
    v_lshlrev_b32 v2, 16, v221
    v_and_b32 v3, s50, v221
    v_pk_add_f32 v[154:155], v[154:155], v[2:3]
    v_lshlrev_b32 v2, 16, v222
    v_and_b32 v3, s50, v222
    v_pk_add_f32 v[156:157], v[156:157], v[2:3]
    v_lshlrev_b32 v2, 16, v223
    v_and_b32 v3, s50, v223
    v_pk_add_f32 v[158:159], v[158:159], v[2:3]
    s_mov_b32 s49, 0
Lfx_0:
    buffer_load_dwordx4 v[64:67], v8, s[8:11], s31 offen offset:0 sc1
    buffer_load_dwordx4 v[68:71], v8, s[8:11], s31 offen offset:1024 sc1
    buffer_load_dwordx4 v[72:75], v8, s[8:11], s31 offen offset:2048 sc1
    buffer_load_dwordx4 v[76:79], v8, s[8:11], s31 offen offset:3072 sc1
    buffer_load_dwordx4 v[80:83], v9, s[8:11], s31 offen offset:0 sc1
    buffer_load_dwordx4 v[84:87], v9, s[8:11], s31 offen offset:1024 sc1
    buffer_load_dwordx4 v[88:91], v9, s[8:11], s31 offen offset:2048 sc1
    buffer_load_dwordx4 v[92:95], v9, s[8:11], s31 offen offset:3072 sc1
    s_waitcnt vmcnt(0)
    v_max_u32 v2, v64, v65
    v_max3_u32 v2, v66, v67, v2
    v_max3_u32 v2, v68, v69, v2
    v_max3_u32 v2, v70, v71, v2
    v_max3_u32 v2, v72, v73, v2
    v_max3_u32 v2, v74, v75, v2
    v_max3_u32 v2, v76, v77, v2
    v_max3_u32 v2, v78, v79, v2
    v_max3_u32 v2, v80, v81, v2
    v_max3_u32 v2, v82, v83, v2
    v_max3_u32 v2, v84, v85, v2
    v_max3_u32 v2, v86, v87, v2
    v_max3_u32 v2, v88, v89, v2
    v_max3_u32 v2, v90, v91, v2
    v_max3_u32 v2, v92, v93, v2
    v_max3_u32 v2, v94, v95, v2
    v_cmp_eq_u32 vcc, -1, v2
    s_cbranch_vccz Lfy_0
Lfz_0:
    s_add_u32 s49, s49, 1
    s_cmp_ge_u32 s49, 4000000
    s_cbranch_scc1 Lw_fail
    s_mov_b64 exec, 1
    buffer_load_dword v2, v9, s[8:11], s31 offen offset:4092 sc1
    s_waitcnt vmcnt(0)
    v_cmp_eq_u32 vcc, -1, v2
    s_mov_b64 exec, -1
    s_cbranch_vccz Lfx_0
    s_sleep 1
    s_branch Lfz_0
Lfy_0:
    v_lshlrev_b32 v2, 16, v64
    v_and_b32 v3, s50, v64
    v_pk_add_f32 v[96:97], v[96:97], v[2:3]
    v_lshlrev_b32 v2, 16, v65
    v_and_b32 v3, s50, v65
    v_pk_add_f32 v[98:99], v[98:99], v[2:3]
    v_lshlrev_b32 v2, 16, v66
    v_and_b32 v3, s50, v66
    v_pk_add_f32 v[100:101], v[100:101], v[2:3]
    v_lshlrev_b32 v2, 16, v67
    v_and_b32 v3, s50, v67
    v_pk_add_f32 v[102:103], v[102:103], v[2:3]
    v_cvt_pk_bf16_f32 v160, v96, v97
    v_cvt_pk_bf16_f32 v161, v98, v99
    v_cvt_pk_bf16_f32 v162, v100, v101
    v_cvt_pk_bf16_f32 v163, v102, v103
    s_nop 0
    v_permlane16_swap_b32 v160, v162
    v_permlane16_swap_b32 v161, v163
    buffer_store_dwordx4 v[160:163], v6, s[4:7], s34 offen offset:0 sc1
    v_lshlrev_b32 v2, 16, v68
    v_and_b32 v3, s50, v68
    v_pk_add_f32 v[104:105], v[104:105], v[2:3]
    v_lshlrev_b32 v2, 16, v69
    v_and_b32 v3, s50, v69
    v_pk_add_f32 v[106:107], v[106:107], v[2:3]
    v_lshlrev_b32 v2, 16, v70
    v_and_b32 v3, s50, v70
    v_pk_add_f32 v[108:109], v[108:109], v[2:3]
    v_lshlrev_b32 v2, 16, v71
    v_and_b32 v3, s50, v71
    v_pk_add_f32 v[110:111], v[110:111], v[2:3]
    v_cvt_pk_bf16_f32 v164, v104, v105
    v_cvt_pk_bf16_f32 v165, v106, v107
    v_cvt_pk_bf16_f32 v166, v108, v109
    v_cvt_pk_bf16_f32 v167, v110, v111
    s_nop 0
    v_permlane16_swap_b32 v164, v166
    v_permlane16_swap_b32 v165, v167
    buffer_store_dwordx4 v[164:167], v6, s[4:7], s34 offen offset:64 sc1
    s_add_u32 s34, s34, 0x8000
    v_lshlrev_b32 v2, 16, v72
    v_and_b32 v3, s50, v72
    v_pk_add_f32 v[112:113], v[112:113], v[2:3]
    v_lshlrev_b32 v2, 16, v73
    v_and_b32 v3, s50, v73
    v_pk_add_f32 v[114:115], v[114:115], v[2:3]
    v_lshlrev_b32 v2, 16, v74
    v_and_b32 v3, s50, v74
    v_pk_add_f32 v[116:117], v[116:117], v[2:3]
    v_lshlrev_b32 v2, 16, v75
    v_and_b32 v3, s50, v75
    v_pk_add_f32 v[118:119], v[118:119], v[2:3]
    v_cvt_pk_bf16_f32 v168, v112, v113
    v_cvt_pk_bf16_f32 v169, v114, v115
    v_cvt_pk_bf16_f32 v170, v116, v117
    v_cvt_pk_bf16_f32 v171, v118, v119
    s_nop 0
    v_permlane16_swap_b32 v168, v170
    v_permlane16_swap_b32 v169, v171
    buffer_store_dwordx4 v[168:171], v6, s[4:7], s34 offen offset:0 sc1
    v_lshlrev_b32 v2, 16, v76
    v_and_b32 v3, s50, v76
    v_pk_add_f32 v[120:121], v[120:121], v[2:3]
    v_lshlrev_b32 v2, 16, v77
    v_and_b32 v3, s50, v77
    v_pk_add_f32 v[122:123], v[122:123], v[2:3]
    v_lshlrev_b32 v2, 16, v78
    v_and_b32 v3, s50, v78
    v_pk_add_f32 v[124:125], v[124:125], v[2:3]
    v_lshlrev_b32 v2, 16, v79
    v_and_b32 v3, s50, v79
    v_pk_add_f32 v[126:127], v[126:127], v[2:3]
    v_cvt_pk_bf16_f32 v172, v120, v121
    v_cvt_pk_bf16_f32 v173, v122, v123
    v_cvt_pk_bf16_f32 v174, v124, v125
    v_cvt_pk_bf16_f32 v175, v126, v127
    s_nop 0
    v_permlane16_swap_b32 v172, v174
    v_permlane16_swap_b32 v173, v175
    buffer_store_dwordx4 v[172:175], v6, s[4:7], s34 offen offset:64 sc1
    s_add_u32 s34, s34, 0x8000
    v_lshlrev_b32 v2, 16, v80
    v_and_b32 v3, s50, v80
    v_pk_add_f32 v[128:129], v[128:129], v[2:3]
    v_lshlrev_b32 v2, 16, v81
    v_and_b32 v3, s50, v81
    v_pk_add_f32 v[130:131], v[130:131], v[2:3]
    v_lshlrev_b32 v2, 16, v82
    v_and_b32 v3, s50, v82
    v_pk_add_f32 v[132:133], v[132:133], v[2:3]
    v_lshlrev_b32 v2, 16, v83
    v_and_b32 v3, s50, v83
    v_pk_add_f32 v[134:135], v[134:135], v[2:3]
    v_cvt_pk_bf16_f32 v176, v128, v129
    v_cvt_pk_bf16_f32 v177, v130, v131
    v_cvt_pk_bf16_f32 v178, v132, v133
    v_cvt_pk_bf16_f32 v179, v134, v135
    s_nop 0
    v_permlane16_swap_b32 v176, v178
    v_permlane16_swap_b32 v177, v179
    buffer_store_dwordx4 v[176:179], v6, s[4:7], s34 offen offset:0 sc1
    v_lshlrev_b32 v2, 16, v84
    v_and_b32 v3, s50, v84
    v_pk_add_f32 v[136:137], v[136:137], v[2:3]
    v_lshlrev_b32 v2, 16, v85
    v_and_b32 v3, s50, v85
    v_pk_add_f32 v[138:139], v[138:139], v[2:3]
    v_lshlrev_b32 v2, 16, v86
    v_and_b32 v3, s50, v86
    v_pk_add_f32 v[140:141], v[140:141], v[2:3]
    v_lshlrev_b32 v2, 16, v87
    v_and_b32 v3, s50, v87
    v_pk_add_f32 v[142:143], v[142:143], v[2:3]
    v_cvt_pk_bf16_f32 v180, v136, v137
    v_cvt_pk_bf16_f32 v181, v138, v139
    v_cvt_pk_bf16_f32 v182, v140, v141
    v_cvt_pk_bf16_f32 v183, v142, v143
    s_nop 0
    v_permlane16_swap_b32 v180, v182
    v_permlane16_swap_b32 v181, v183
    buffer_store_dwordx4 v[180:183], v6, s[4:7], s34 offen offset:64 sc1
    s_add_u32 s34, s34, 0x8000
    v_lshlrev_b32 v2, 16, v88
    v_and_b32 v3, s50, v88
    v_pk_add_f32 v[144:145], v[144:145], v[2:3]
    v_lshlrev_b32 v2, 16, v89
    v_and_b32 v3, s50, v89
    v_pk_add_f32 v[146:147], v[146:147], v[2:3]
    v_lshlrev_b32 v2, 16, v90
    v_and_b32 v3, s50, v90
    v_pk_add_f32 v[148:149], v[148:149], v[2:3]
    v_lshlrev_b32 v2, 16, v91
    v_and_b32 v3, s50, v91
    v_pk_add_f32 v[150:151], v[150:151], v[2:3]
    v_cvt_pk_bf16_f32 v184, v144, v145
    v_cvt_pk_bf16_f32 v185, v146, v147
    v_cvt_pk_bf16_f32 v186, v148, v149
    v_cvt_pk_bf16_f32 v187, v150, v151
    s_nop 0
    v_permlane16_swap_b32 v184, v186
    v_permlane16_swap_b32 v185, v187
    buffer_store_dwordx4 v[184:187], v6, s[4:7], s34 offen offset:0 sc1
    v_lshlrev_b32 v2, 16, v92
    v_and_b32 v3, s50, v92
    v_pk_add_f32 v[152:153], v[152:153], v[2:3]
    v_lshlrev_b32 v2, 16, v93
    v_and_b32 v3, s50, v93
    v_pk_add_f32 v[154:155], v[154:155], v[2:3]
    v_lshlrev_b32 v2, 16, v94
    v_and_b32 v3, s50, v94
    v_pk_add_f32 v[156:157], v[156:157], v[2:3]
    v_lshlrev_b32 v2, 16, v95
    v_and_b32 v3, s50, v95
    v_pk_add_f32 v[158:159], v[158:159], v[2:3]
    v_cvt_pk_bf16_f32 v188, v152, v153
    v_cvt_pk_bf16_f32 v189, v154, v155
    v_cvt_pk_bf16_f32 v190, v156, v157
    v_cvt_pk_bf16_f32 v191, v158, v159
    s_nop 0
    v_permlane16_swap_b32 v188, v190
    v_permlane16_swap_b32 v189, v191
    buffer_store_dwordx4 v[188:191], v6, s[4:7], s34 offen offset:64 sc1
    s_add_u32 s34, s34, 0x8000
    s_branch Lw_done
Lw_k1:
    v_lshlrev_b32 v8, 4, v1
    v_add_u32 v9, 4096, v8
    v_accvgpr_read_b32 v16, a0
    v_accvgpr_read_b32 v20, a32
    v_accvgpr_read_b32 v17, a1
    v_accvgpr_read_b32 v21, a33
    v_accvgpr_read_b32 v18, a2
    v_accvgpr_read_b32 v22, a34
    v_accvgpr_read_b32 v19, a3
    v_accvgpr_read_b32 v23, a35
    v_cvt_pk_bf16_f32 v24, v16, v17
    v_cvt_pk_bf16_f32 v25, v18, v19
    v_cvt_pk_bf16_f32 v26, v20, v21
    v_cvt_pk_bf16_f32 v27, v22, v23
    v_min_u32 v24, -2, v24
    v_min_u32 v25, -2, v25
    v_min_u32 v26, -2, v26
    v_min_u32 v27, -2, v27
    buffer_store_dwordx4 v[24:27], v8, s[8:11], s30 offen offset:0 sc1
    v_accvgpr_read_b32 v28, a64
    v_accvgpr_read_b32 v32, a96
    v_accvgpr_read_b32 v29, a65
    v_accvgpr_read_b32 v33, a97
    v_accvgpr_read_b32 v30, a66
    v_accvgpr_read_b32 v34, a98
    v_accvgpr_read_b32 v31, a67
    v_accvgpr_read_b32 v35, a99
    v_cvt_pk_bf16_f32 v36, v28, v29
    v_cvt_pk_bf16_f32 v37, v30, v31
    v_cvt_pk_bf16_f32 v38, v32, v33
    v_cvt_pk_bf16_f32 v39, v34, v35
    v_min_u32 v36, -2, v36
    v_min_u32 v37, -2, v37
    v_min_u32 v38, -2, v38
    v_min_u32 v39, -2, v39
    buffer_store_dwordx4 v[36:39], v8, s[8:11], s30 offen offset:1024 sc1
    v_accvgpr_read_b32 v40, a4
    v_accvgpr_read_b32 v44, a36
    v_accvgpr_read_b32 v41, a5
    v_accvgpr_read_b32 v45, a37
    v_accvgpr_read_b32 v42, a6
    v_accvgpr_read_b32 v46, a38
    v_accvgpr_read_b32 v43, a7
    v_accvgpr_read_b32 v47, a39
    v_cvt_pk_bf16_f32 v48, v40, v41
    v_cvt_pk_bf16_f32 v49, v42, v43
    v_cvt_pk_bf16_f32 v50, v44, v45
    v_cvt_pk_bf16_f32 v51, v46, v47
    v_min_u32 v48, -2, v48
    v_min_u32 v49, -2, v49
    v_min_u32 v50, -2, v50
    v_min_u32 v51, -2, v51
    buffer_store_dwordx4 v[48:51], v8, s[8:11], s30 offen offset:2048 sc1
    v_accvgpr_read_b32 v52, a68
    v_accvgpr_read_b32 v56, a100
    v_accvgpr_read_b32 v53, a69
    v_accvgpr_read_b32 v57, a101
    v_accvgpr_read_b32 v54, a70
    v_accvgpr_read_b32 v58, a102
    v_accvgpr_read_b32 v55, a71
    v_accvgpr_read_b32 v59, a103
    v_cvt_pk_bf16_f32 v60, v52, v53
    v_cvt_pk_bf16_f32 v61, v54, v55
    v_cvt_pk_bf16_f32 v62, v56, v57
    v_cvt_pk_bf16_f32 v63, v58, v59
    v_min_u32 v60, -2, v60
    v_min_u32 v61, -2, v61
    v_min_u32 v62, -2, v62
    v_min_u32 v63, -2, v63
    buffer_store_dwordx4 v[60:63], v8, s[8:11], s30 offen offset:3072 sc1
    v_accvgpr_read_b32 v16, a8
    v_accvgpr_read_b32 v20, a40
    v_accvgpr_read_b32 v17, a9
    v_accvgpr_read_b32 v21, a41
    v_accvgpr_read_b32 v18, a10
    v_accvgpr_read_b32 v22, a42
    v_accvgpr_read_b32 v19, a11
    v_accvgpr_read_b32 v23, a43
    v_cvt_pk_bf16_f32 v24, v16, v17
    v_cvt_pk_bf16_f32 v25, v18, v19
    v_cvt_pk_bf16_f32 v26, v20, v21
    v_cvt_pk_bf16_f32 v27, v22, v23
    v_min_u32 v24, -2, v24
    v_min_u32 v25, -2, v25
    v_min_u32 v26, -2, v26
    v_min_u32 v27, -2, v27
    buffer_store_dwordx4 v[24:27], v9, s[8:11], s30 offen offset:0 sc1
    v_accvgpr_read_b32 v28, a72
    v_accvgpr_read_b32 v32, a104
    v_accvgpr_read_b32 v29, a73
    v_accvgpr_read_b32 v33, a105
    v_accvgpr_read_b32 v30, a74
    v_accvgpr_read_b32 v34, a106
    v_accvgpr_read_b32 v31, a75
    v_accvgpr_read_b32 v35, a107
    v_cvt_pk_bf16_f32 v36, v28, v29
    v_cvt_pk_bf16_f32 v37, v30, v31
    v_cvt_pk_bf16_f32 v38, v32, v33
    v_cvt_pk_bf16_f32 v39, v34, v35
    v_min_u32 v36, -2, v36
    v_min_u32 v37, -2, v37
    v_min_u32 v38, -2, v38
    v_min_u32 v39, -2, v39
    buffer_store_dwordx4 v[36:39], v9, s[8:11], s30 offen offset:1024 sc1
    v_accvgpr_read_b32 v40, a12
    v_accvgpr_read_b32 v44, a44
    v_accvgpr_read_b32 v41, a13
    v_accvgpr_read_b32 v45, a45
    v_accvgpr_read_b32 v42, a14
    v_accvgpr_read_b32 v46, a46
    v_accvgpr_read_b32 v43, a15
    v_accvgpr_read_b32 v47, a47
    v_cvt_pk_bf16_f32 v48, v40, v41
    v_cvt_pk_bf16_f32 v49, v42, v43
    v_cvt_pk_bf16_f32 v50, v44, v45
    v_cvt_pk_bf16_f32 v51, v46, v47
    v_min_u32 v48, -2, v48
    v_min_u32 v49, -2, v49
    v_min_u32 v50, -2, v50
    v_min_u32 v51, -2, v51
    buffer_store_dwordx4 v[48:51], v9, s[8:11], s30 offen offset:2048 sc1
    v_accvgpr_read_b32 v52, a76
    v_accvgpr_read_b32 v56, a108
    v_accvgpr_read_b32 v53, a77
    v_accvgpr_read_b32 v57, a109
    v_accvgpr_read_b32 v54, a78
    v_accvgpr_read_b32 v58, a110
    v_accvgpr_read_b32 v55, a79
    v_accvgpr_read_b32 v59, a111
    v_cvt_pk_bf16_f32 v60, v52, v53
    v_cvt_pk_bf16_f32 v61, v54, v55
    v_cvt_pk_bf16_f32 v62, v56, v57
    v_cvt_pk_bf16_f32 v63, v58, v59
    v_min_u32 v60, -2, v60
    v_min_u32 v61, -2, v61
    v_min_u32 v62, -2, v62
    v_min_u32 v63, -2, v63
    buffer_store_dwordx4 v[60:63], v9, s[8:11], s30 offen offset:3072 sc1
    s_mov_b32 s50, 0xffff0000
    s_add_u32 s34, s34, 131072
    s_waitcnt vmcnt(8)
    v_accvgpr_read_b32 v96, a16
    v_accvgpr_read_b32 v100, a48
    v_accvgpr_read_b32 v97, a17
    v_accvgpr_read_b32 v101, a49
    v_accvgpr_read_b32 v98, a18
    v_accvgpr_read_b32 v102, a50
    v_accvgpr_read_b32 v99, a19
    v_accvgpr_read_b32 v103, a51
    v_lshlrev_b32 v2, 16, v192
    v_and_b32 v3, s50, v192
    v_pk_add_f32 v[96:97], v[96:97], v[2:3]
    v_lshlrev_b32 v2, 16, v193
    v_and_b32 v3, s50, v193
    v_pk_add_f32 v[98:99], v[98:99], v[2:3]
    v_lshlrev_b32 v2, 16, v194
    v_and_b32 v3, s50, v194
    v_pk_add_f32 v[100:101], v[100:101], v[2:3]
    v_lshlrev_b32 v2, 16, v195
    v_and_b32 v3, s50, v195
    v_pk_add_f32 v[102:103], v[102:103], v[2:3]
    v_accvgpr_read_b32 v104, a80
    v_accvgpr_read_b32 v108, a112
    v_accvgpr_read_b32 v105, a81
    v_accvgpr_read_b32 v109, a113
    v_accvgpr_read_b32 v106, a82
    v_accvgpr_read_b32 v110, a114
    v_accvgpr_read_b32 v107, a83
    v_accvgpr_read_b32 v111, a115
    v_lshlrev_b32 v2, 16, v196
    v_and_b32 v3, s50, v196
    v_pk_add_f32 v[104:105], v[104:105], v[2:3]
    v_lshlrev_b32 v2, 16, v197
    v_and_b32 v3, s50, v197
    v_pk_add_f32 v[106:107], v[106:107], v[2:3]
    v_lshlrev_b32 v2, 16, v198
    v_and_b32 v3, s50, v198
    v_pk_add_f32 v[108:109], v[108:109], v[2:3]
    v_lshlrev_b32 v2, 16, v199
    v_and_b32 v3, s50, v199
    v_pk_add_f32 v[110:111], v[110:111], v[2:3]
    v_accvgpr_read_b32 v112, a20
    v_accvgpr_read_b32 v116, a52
    v_accvgpr_read_b32 v113, a21
    v_accvgpr_read_b32 v117, a53
    v_accvgpr_read_b32 v114, a22
    v_accvgpr_read_b32 v118, a54
    v_accvgpr_read_b32 v115, a23
    v_accvgpr_read_b32 v119, a55
    v_lshlrev_b32 v2, 16, v200
    v_and_b32 v3, s50, v200
    v_pk_add_f32 v[112:113], v[112:113], v[2:3]
    v_lshlrev_b32 v2, 16, v201
    v_and_b32 v3, s50, v201
    v_pk_add_f32 v[114:115], v[114:115], v[2:3]
    v_lshlrev_b32 v2, 16, v202
    v_and_b32 v3, s50, v202
    v_pk_add_f32 v[116:117], v[116:117], v[2:3]
    v_lshlrev_b32 v2, 16, v203
    v_and_b32 v3, s50, v203
    v_pk_add_f32 v[118:119], v[118:119], v[2:3]
    v_accvgpr_read_b32 v120, a84
    v_accvgpr_read_b32 v124, a116
    v_accvgpr_read_b32 v121, a85
    v_accvgpr_read_b32 v125, a117
    v_accvgpr_read_b32 v122, a86
    v_accvgpr_read_b32 v126, a118
    v_accvgpr_read_b32 v123, a87
    v_accvgpr_read_b32 v127, a119
    v_lshlrev_b32 v2, 16, v204
    v_and_b32 v3, s50, v204
    v_pk_add_f32 v[120:121], v[120:121], v[2:3]
    v_lshlrev_b32 v2, 16, v205
    v_and_b32 v3, s50, v205
    v_pk_add_f32 v[122:123], v[122:123], v[2:3]
    v_lshlrev_b32 v2, 16, v206
    v_and_b32 v3, s50, v206
    v_pk_add_f32 v[124:125], v[124:125], v[2:3]
    v_lshlrev_b32 v2, 16, v207
    v_and_b32 v3, s50, v207
    v_pk_add_f32 v[126:127], v[126:127], v[2:3]
    v_accvgpr_read_b32 v128, a24
    v_accvgpr_read_b32 v132, a56
    v_accvgpr_read_b32 v129, a25
    v_accvgpr_read_b32 v133, a57
    v_accvgpr_read_b32 v130, a26
    v_accvgpr_read_b32 v134, a58
    v_accvgpr_read_b32 v131, a27
    v_accvgpr_read_b32 v135, a59
    v_lshlrev_b32 v2, 16, v208
    v_and_b32 v3, s50, v208
    v_pk_add_f32 v[128:129], v[128:129], v[2:3]
    v_lshlrev_b32 v2, 16, v209
    v_and_b32 v3, s50, v209
    v_pk_add_f32 v[130:131], v[130:131], v[2:3]
    v_lshlrev_b32 v2, 16, v210
    v_and_b32 v3, s50, v210
    v_pk_add_f32 v[132:133], v[132:133], v[2:3]
    v_lshlrev_b32 v2, 16, v211
    v_and_b32 v3, s50, v211
    v_pk_add_f32 v[134:135], v[134:135], v[2:3]
    v_accvgpr_read_b32 v136, a88
    v_accvgpr_read_b32 v140, a120
    v_accvgpr_read_b32 v137, a89
    v_accvgpr_read_b32 v141, a121
    v_accvgpr_read_b32 v138, a90
    v_accvgpr_read_b32 v142, a122
    v_accvgpr_read_b32 v139, a91
    v_accvgpr_read_b32 v143, a123
    v_lshlrev_b32 v2, 16, v212
    v_and_b32 v3, s50, v212
    v_pk_add_f32 v[136:137], v[136:137], v[2:3]
    v_lshlrev_b32 v2, 16, v213
    v_and_b32 v3, s50, v213
    v_pk_add_f32 v[138:139], v[138:139], v[2:3]
    v_lshlrev_b32 v2, 16, v214
    v_and_b32 v3, s50, v214
    v_pk_add_f32 v[140:141], v[140:141], v[2:3]
    v_lshlrev_b32 v2, 16, v215
    v_and_b32 v3, s50, v215
    v_pk_add_f32 v[142:143], v[142:143], v[2:3]
    v_accvgpr_read_b32 v144, a28
    v_accvgpr_read_b32 v148, a60
    v_accvgpr_read_b32 v145, a29
    v_accvgpr_read_b32 v149, a61
    v_accvgpr_read_b32 v146, a30
    v_accvgpr_read_b32 v150, a62
    v_accvgpr_read_b32 v147, a31
    v_accvgpr_read_b32 v151, a63
    v_lshlrev_b32 v2, 16, v216
    v_and_b32 v3, s50, v216
    v_pk_add_f32 v[144:145], v[144:145], v[2:3]
    v_lshlrev_b32 v2, 16, v217
    v_and_b32 v3, s50, v217
    v_pk_add_f32 v[146:147], v[146:147], v[2:3]
    v_lshlrev_b32 v2, 16, v218
    v_and_b32 v3, s50, v218
    v_pk_add_f32 v[148:149], v[148:149], v[2:3]
    v_lshlrev_b32 v2, 16, v219
    v_and_b32 v3, s50, v219
    v_pk_add_f32 v[150:151], v[150:151], v[2:3]
    v_accvgpr_read_b32 v152, a92
    v_accvgpr_read_b32 v156, a124
    v_accvgpr_read_b32 v153, a93
    v_accvgpr_read_b32 v157, a125
    v_accvgpr_read_b32 v154, a94
    v_accvgpr_read_b32 v158, a126
    v_accvgpr_read_b32 v155, a95
    v_accvgpr_read_b32 v159, a127
    v_lshlrev_b32 v2, 16, v220
    v_and_b32 v3, s50, v220
    v_pk_add_f32 v[152:153], v[152:153], v[2:3]
    v_lshlrev_b32 v2, 16, v221
    v_and_b32 v3, s50, v221
    v_pk_add_f32 v[154:155], v[154:155], v[2:3]
    v_lshlrev_b32 v2, 16, v222
    v_and_b32 v3, s50, v222
    v_pk_add_f32 v[156:157], v[156:157], v[2:3]
    v_lshlrev_b32 v2, 16, v223
    v_and_b32 v3, s50, v223
    v_pk_add_f32 v[158:159], v[158:159], v[2:3]
    s_mov_b32 s49, 0
Lfx_4:
    buffer_load_dwordx4 v[64:67], v8, s[8:11], s31 offen offset:0 sc1
    buffer_load_dwordx4 v[68:71], v8, s[8:11], s31 offen offset:1024 sc1
    buffer_load_dwordx4 v[72:75], v8, s[8:11], s31 offen offset:2048 sc1
    buffer_load_dwordx4 v[76:79], v8, s[8:11], s31 offen offset:3072 sc1
    buffer_load_dwordx4 v[80:83], v9, s[8:11], s31 offen offset:0 sc1
    buffer_load_dwordx4 v[84:87], v9, s[8:11], s31 offen offset:1024 sc1
    buffer_load_dwordx4 v[88:91], v9, s[8:11], s31 offen offset:2048 sc1
    buffer_load_dwordx4 v[92:95], v9, s[8:11], s31 offen offset:3072 sc1
    s_waitcnt vmcnt(0)
    v_max_u32 v2, v64, v65
    v_max3_u32 v2, v66, v67, v2
    v_max3_u32 v2, v68, v69, v2
    v_max3_u32 v2, v70, v71, v2
    v_max3_u32 v2, v72, v73, v2
    v_max3_u32 v2, v74, v75, v2
    v_max3_u32 v2, v76, v77, v2
    v_max3_u32 v2, v78, v79, v2
    v_max3_u32 v2, v80, v81, v2
    v_max3_u32 v2, v82, v83, v2
    v_max3_u32 v2, v84, v85, v2
    v_max3_u32 v2, v86, v87, v2
    v_max3_u32 v2, v88, v89, v2
    v_max3_u32 v2, v90, v91, v2
    v_max3_u32 v2, v92, v93, v2
    v_max3_u32 v2, v94, v95, v2
    v_cmp_eq_u32 vcc, -1, v2
    s_cbranch_vccz Lfy_4
Lfz_4:
    s_add_u32 s49, s49, 1
    s_cmp_ge_u32 s49, 4000000
    s_cbranch_scc1 Lw_fail
    s_mov_b64 exec, 1
    buffer_load_dword v2, v9, s[8:11], s31 offen offset:4092 sc1
    s_waitcnt vmcnt(0)
    v_cmp_eq_u32 vcc, -1, v2
    s_mov_b64 exec, -1
    s_cbranch_vccz Lfx_4
    s_sleep 1
    s_branch Lfz_4
Lfy_4:
    v_lshlrev_b32 v2, 16, v64
    v_and_b32 v3, s50, v64
    v_pk_add_f32 v[96:97], v[96:97], v[2:3]
    v_lshlrev_b32 v2, 16, v65
    v_and_b32 v3, s50, v65
    v_pk_add_f32 v[98:99], v[98:99], v[2:3]
    v_lshlrev_b32 v2, 16, v66
    v_and_b32 v3, s50, v66
    v_pk_add_f32 v[100:101], v[100:101], v[2:3]
    v_lshlrev_b32 v2, 16, v67
    v_and_b32 v3, s50, v67
    v_pk_add_f32 v[102:103], v[102:103], v[2:3]
    v_cvt_pk_bf16_f32 v160, v96, v97
    v_cvt_pk_bf16_f32 v161, v98, v99
    v_cvt_pk_bf16_f32 v162, v100, v101
    v_cvt_pk_bf16_f32 v163, v102, v103
    s_nop 0
    v_permlane16_swap_b32 v160, v162
    v_permlane16_swap_b32 v161, v163
    buffer_store_dwordx4 v[160:163], v6, s[4:7], s34 offen offset:0 sc1
    v_lshlrev_b32 v2, 16, v68
    v_and_b32 v3, s50, v68
    v_pk_add_f32 v[104:105], v[104:105], v[2:3]
    v_lshlrev_b32 v2, 16, v69
    v_and_b32 v3, s50, v69
    v_pk_add_f32 v[106:107], v[106:107], v[2:3]
    v_lshlrev_b32 v2, 16, v70
    v_and_b32 v3, s50, v70
    v_pk_add_f32 v[108:109], v[108:109], v[2:3]
    v_lshlrev_b32 v2, 16, v71
    v_and_b32 v3, s50, v71
    v_pk_add_f32 v[110:111], v[110:111], v[2:3]
    v_cvt_pk_bf16_f32 v164, v104, v105
    v_cvt_pk_bf16_f32 v165, v106, v107
    v_cvt_pk_bf16_f32 v166, v108, v109
    v_cvt_pk_bf16_f32 v167, v110, v111
    s_nop 0
    v_permlane16_swap_b32 v164, v166
    v_permlane16_swap_b32 v165, v167
    buffer_store_dwordx4 v[164:167], v6, s[4:7], s34 offen offset:64 sc1
    s_add_u32 s34, s34, 0x8000
    v_lshlrev_b32 v2, 16, v72
    v_and_b32 v3, s50, v72
    v_pk_add_f32 v[112:113], v[112:113], v[2:3]
    v_lshlrev_b32 v2, 16, v73
    v_and_b32 v3, s50, v73
    v_pk_add_f32 v[114:115], v[114:115], v[2:3]
    v_lshlrev_b32 v2, 16, v74
    v_and_b32 v3, s50, v74
    v_pk_add_f32 v[116:117], v[116:117], v[2:3]
    v_lshlrev_b32 v2, 16, v75
    v_and_b32 v3, s50, v75
    v_pk_add_f32 v[118:119], v[118:119], v[2:3]
    v_cvt_pk_bf16_f32 v168, v112, v113
    v_cvt_pk_bf16_f32 v169, v114, v115
    v_cvt_pk_bf16_f32 v170, v116, v117
    v_cvt_pk_bf16_f32 v171, v118, v119
    s_nop 0
    v_permlane16_swap_b32 v168, v170
    v_permlane16_swap_b32 v169, v171
    buffer_store_dwordx4 v[168:171], v6, s[4:7], s34 offen offset:0 sc1
    v_lshlrev_b32 v2, 16, v76
    v_and_b32 v3, s50, v76
    v_pk_add_f32 v[120:121], v[120:121], v[2:3]
    v_lshlrev_b32 v2, 16, v77
    v_and_b32 v3, s50, v77
    v_pk_add_f32 v[122:123], v[122:123], v[2:3]
    v_lshlrev_b32 v2, 16, v78
    v_and_b32 v3, s50, v78
    v_pk_add_f32 v[124:125], v[124:125], v[2:3]
    v_lshlrev_b32 v2, 16, v79
    v_and_b32 v3, s50, v79
    v_pk_add_f32 v[126:127], v[126:127], v[2:3]
    v_cvt_pk_bf16_f32 v172, v120, v121
    v_cvt_pk_bf16_f32 v173, v122, v123
    v_cvt_pk_bf16_f32 v174, v124, v125
    v_cvt_pk_bf16_f32 v175, v126, v127
    s_nop 0
    v_permlane16_swap_b32 v172, v174
    v_permlane16_swap_b32 v173, v175
    buffer_store_dwordx4 v[172:175], v6, s[4:7], s34 offen offset:64 sc1
    s_add_u32 s34, s34, 0x8000
    v_lshlrev_b32 v2, 16, v80
    v_and_b32 v3, s50, v80
    v_pk_add_f32 v[128:129], v[128:129], v[2:3]
    v_lshlrev_b32 v2, 16, v81
    v_and_b32 v3, s50, v81
    v_pk_add_f32 v[130:131], v[130:131], v[2:3]
    v_lshlrev_b32 v2, 16, v82
    v_and_b32 v3, s50, v82
    v_pk_add_f32 v[132:133], v[132:133], v[2:3]
    v_lshlrev_b32 v2, 16, v83
    v_and_b32 v3, s50, v83
    v_pk_add_f32 v[134:135], v[134:135], v[2:3]
    v_cvt_pk_bf16_f32 v176, v128, v129
    v_cvt_pk_bf16_f32 v177, v130, v131
    v_cvt_pk_bf16_f32 v178, v132, v133
    v_cvt_pk_bf16_f32 v179, v134, v135
    s_nop 0
    v_permlane16_swap_b32 v176, v178
    v_permlane16_swap_b32 v177, v179
    buffer_store_dwordx4 v[176:179], v6, s[4:7], s34 offen offset:0 sc1
    v_lshlrev_b32 v2, 16, v84
    v_and_b32 v3, s50, v84
    v_pk_add_f32 v[136:137], v[136:137], v[2:3]
    v_lshlrev_b32 v2, 16, v85
    v_and_b32 v3, s50, v85
    v_pk_add_f32 v[138:139], v[138:139], v[2:3]
    v_lshlrev_b32 v2, 16, v86
    v_and_b32 v3, s50, v86
    v_pk_add_f32 v[140:141], v[140:141], v[2:3]
    v_lshlrev_b32 v2, 16, v87
    v_and_b32 v3, s50, v87
    v_pk_add_f32 v[142:143], v[142:143], v[2:3]
    v_cvt_pk_bf16_f32 v180, v136, v137
    v_cvt_pk_bf16_f32 v181, v138, v139
    v_cvt_pk_bf16_f32 v182, v140, v141
    v_cvt_pk_bf16_f32 v183, v142, v143
    s_nop 0
    v_permlane16_swap_b32 v180, v182
    v_permlane16_swap_b32 v181, v183
    buffer_store_dwordx4 v[180:183], v6, s[4:7], s34 offen offset:64 sc1
    s_add_u32 s34, s34, 0x8000
    v_lshlrev_b32 v2, 16, v88
    v_and_b32 v3, s50, v88
    v_pk_add_f32 v[144:145], v[144:145], v[2:3]
    v_lshlrev_b32 v2, 16, v89
    v_and_b32 v3, s50, v89
    v_pk_add_f32 v[146:147], v[146:147], v[2:3]
    v_lshlrev_b32 v2, 16, v90
    v_and_b32 v3, s50, v90
    v_pk_add_f32 v[148:149], v[148:149], v[2:3]
    v_lshlrev_b32 v2, 16, v91
    v_and_b32 v3, s50, v91
    v_pk_add_f32 v[150:151], v[150:151], v[2:3]
    v_cvt_pk_bf16_f32 v184, v144, v145
    v_cvt_pk_bf16_f32 v185, v146, v147
    v_cvt_pk_bf16_f32 v186, v148, v149
    v_cvt_pk_bf16_f32 v187, v150, v151
    s_nop 0
    v_permlane16_swap_b32 v184, v186
    v_permlane16_swap_b32 v185, v187
    buffer_store_dwordx4 v[184:187], v6, s[4:7], s34 offen offset:0 sc1
    v_lshlrev_b32 v2, 16, v92
    v_and_b32 v3, s50, v92
    v_pk_add_f32 v[152:153], v[152:153], v[2:3]
    v_lshlrev_b32 v2, 16, v93
    v_and_b32 v3, s50, v93
    v_pk_add_f32 v[154:155], v[154:155], v[2:3]
    v_lshlrev_b32 v2, 16, v94
    v_and_b32 v3, s50, v94
    v_pk_add_f32 v[156:157], v[156:157], v[2:3]
    v_lshlrev_b32 v2, 16, v95
    v_and_b32 v3, s50, v95
    v_pk_add_f32 v[158:159], v[158:159], v[2:3]
    v_cvt_pk_bf16_f32 v188, v152, v153
    v_cvt_pk_bf16_f32 v189, v154, v155
    v_cvt_pk_bf16_f32 v190, v156, v157
    v_cvt_pk_bf16_f32 v191, v158, v159
    s_nop 0
    v_permlane16_swap_b32 v188, v190
    v_permlane16_swap_b32 v189, v191
    buffer_store_dwordx4 v[188:191], v6, s[4:7], s34 offen offset:64 sc1
    s_add_u32 s34, s34, 0x8000
Lw_done:
    s_cmp_lt_u32 s21, 14
    s_cbranch_scc1 Lch_end
    s_mov_b32 s53, 120071936
    s_mov_b32 s54, 1
    s_waitcnt vmcnt(0)
    s_barrier
    s_cmp_lg_u32 s46, 0
    s_cbranch_scc1 Lsg_b
    v_mov_b32 v2, 0
    v_mov_b32 v3, s54
    s_mov_b64 exec, 1
    buffer_atomic_add v3, v2, s[8:11], s53 offen sc1
    s_mov_b64 exec, -1
Lsg_b:
    s_call_b64 s[62:63], Lw_att
    s_endpgm
Lw_fpro:
    s_lshl_b32 s53, s22, 7
    s_add_u32 s53, s53, 120066048
    s_mov_b32 s54, 0
    v_mov_b32 v2, 0
Lwf_act:
    buffer_load_dword v3, v2, s[8:11], s53 offen sc1
    s_waitcnt vmcnt(0)
    v_readfirstlane_b32 s55, v3
    s_and_b32 s55, s55, 255
    s_cmp_eq_u32 s55, 14
    s_cbranch_scc1 Lwd_act
    s_sleep 4
    s_add_u32 s54, s54, 1
    s_cmp_lt_u32 s54, 2000000
    s_cbranch_scc1 Lwf_act
    s_branch Lw_fail
Lwd_act:
    s_mov_b32 s12, s76
    s_mov_b32 s13, s77
    s_mov_b32 s14, 0x700000
    s_mov_b32 s15, 0x20000
    s_mov_b32 s42, 229376
    s_mul_i32 s40, s22, 1835008
    s_mul_i32 s24, s23, 114688
    s_add_u32 s40, s40, s24
    s_add_u32 s40, s40, 54525952
    s_mul_i32 s41, s23, 3670016
    s_cmp_lt_u32 s21, 8
    s_cselect_b32 s27, 15, 25
    s_cmp_lt_u32 s21, 4
    s_cselect_b32 s27, 4, s27
    s_mov_b32 s44, s27
    s_call_b64 s[62:63], Lw_mpro
    s_setpc_b64 s[88:89]
Lw_upro:
    s_mov_b32 s42, 65536
    s_lshl_b32 s40, s39, 19
    s_add_u32 s40, s40, 0
    s_lshl_b32 s41, s38, 8
    s_mov_b32 s44, 13
    s_mov_b32 s43, 13
    s_branch Lw_mq
Lw_mpro:
    s_lshl_b32 s24, s20, 8
    s_add_u32 s41, s41, s24
    s_mov_b32 s43, 11
Lw_mq:
    s_lshr_b32 s49, s46, 1
    s_lshl_b32 s49, s49, 13
    v_lshrrev_b32 v2, 4, v1
    v_and_b32 v3, 15, v1
    v_lshlrev_b32 v4, 9, v2
    v_lshl_add_u32 v4, v3, 4, v4
    v_add_u32 v32, s49, v4
    v_lshrrev_b32 v4, 2, v3
    v_lshl_add_u32 v6, v2, 3, v4
    v_lshlrev_b32 v6, 8, v6
    v_and_b32 v7, 3, v3
    v_lshl_add_u32 v6, v7, 3, v6
    v_and_b32 v7, 1, v2
    v_lshl_add_u32 v4, v7, 2, v4
    v_lshl_add_u32 v6, v4, 5, v6
    v_add_u32 v6, 16384, v6
    s_and_b32 s50, s46, 1
    s_lshl_b32 s49, s50, 7
    v_xor_b32 v6, s49, v6
    v_xor_b32 v40, 0, v6
    v_xor_b32 v41, 32, v6
    v_xor_b32 v42, 64, v6
    v_xor_b32 v43, 96, v6
    s_lshl_b32 s49, s46, 3
    v_lshlrev_b32 v4, 1, v2
    v_xor_b32 v3, v3, v4
    s_lshl_b32 s50, s50, 3
    v_xor_b32 v3, s50, v3
    v_add_u32 v2, s49, v2
    v_lshlrev_b32 v2, s43, v2
    v_lshl_add_u32 v36, v3, 4, v2
    s_lshl_b32 s49, 4, s43
    s_sub_u32 s49, s49, 1024
    v_add_u32 v37, s49, v36
    s_lshl_b32 s59, 32, s43
    s_mul_i32 s49, s46, s42
    s_lshl_b32 s49, s49, 1
    v_lshl_add_u32 v34, v1, 4, s49
    s_sub_u32 s49, s42, 2048
    v_add_u32 v35, s49, v34
    s_lshl_b32 s47, s46, 12
    s_lshl_b32 s48, s46, 11
    s_add_u32 s48, s48, 16384
    s_mov_b32 s51, 0
    s_mov_b32 s52, 0
Lw_mdma:
    s_add_u32 m0, s47, s52
    s_nop 0
    buffer_load_dwordx4 v34, s[8:11], s40 offen offset:0 sc1 lds
    buffer_load_dwordx4 v34, s[8:11], s40 offen offset:1024 sc1 lds
    buffer_load_dwordx4 v35, s[8:11], s40 offen offset:2048 sc1 lds
    buffer_load_dwordx4 v35, s[8:11], s40 offen offset:3072 sc1 lds
    s_add_u32 s40, s40, 2048
    s_add_u32 m0, s48, s52
    s_nop 0
    buffer_load_dwordx4 v36, s[12:15], s41 offen offset:0 lds
    buffer_load_dwordx4 v37, s[12:15], s41 offen offset:1024 lds
    s_add_u32 s41, s41, s59
    s_add_u32 s52, s52, 24576
    s_cmp_eq_u32 s52, 147456
    s_cselect_b32 s52, 0, s52
    s_sub_u32 s83, s83, 1
    s_cmp_lg_u32 s83, 0
    s_cbranch_scc1 Lw_mdma
    s_mov_b32 s83, 6
    s_setpc_b64 s[62:63]
Lw_urun:
    s_call_b64 s[80:81], Lw_mrun
    s_lshl_b32 s53, s39, 21
    s_lshl_b32 s54, s38, 13
    s_add_u32 s53, s53, s54
    s_lshl_b32 s54, s37, 24
    s_add_u32 s53, s53, s54
    s_add_u32 s53, s53, 4194304
    s_lshr_b32 s49, s46, 1
    s_lshl_b32 s49, s49, 20
    s_and_b32 s50, s46, 1
    s_lshl_b32 s50, s50, 12
    s_add_u32 s49, s49, s50
    s_add_u32 s53, s53, s49
    v_lshlrev_b32 v8, 4, v1
    v_accvgpr_read_b32 v160, a0
    v_accvgpr_read_b32 v161, a1
    v_accvgpr_read_b32 v162, a2
    v_accvgpr_read_b32 v163, a3
    v_accvgpr_read_b32 v164, a4
    v_accvgpr_read_b32 v165, a5
    v_accvgpr_read_b32 v166, a6
    v_accvgpr_read_b32 v167, a7
    v_cvt_pk_bf16_f32 v168, v160, v161
    v_cvt_pk_bf16_f32 v169, v162, v163
    v_cvt_pk_bf16_f32 v170, v164, v165
    v_cvt_pk_bf16_f32 v171, v166, v167
    s_nop 0
    v_permlane16_swap_b32 v168, v170
    v_permlane16_swap_b32 v169, v171
    buffer_store_dwordx4 v[168:171], v8, s[8:11], s53 offen offset:0 sc1
    v_accvgpr_read_b32 v172, a32
    v_accvgpr_read_b32 v173, a33
    v_accvgpr_read_b32 v174, a34
    v_accvgpr_read_b32 v175, a35
    v_accvgpr_read_b32 v176, a36
    v_accvgpr_read_b32 v177, a37
    v_accvgpr_read_b32 v178, a38
    v_accvgpr_read_b32 v179, a39
    v_cvt_pk_bf16_f32 v180, v172, v173
    v_cvt_pk_bf16_f32 v181, v174, v175
    v_cvt_pk_bf16_f32 v182, v176, v177
    v_cvt_pk_bf16_f32 v183, v178, v179
    s_nop 0
    v_permlane16_swap_b32 v180, v182
    v_permlane16_swap_b32 v181, v183
    buffer_store_dwordx4 v[180:183], v8, s[8:11], s53 offen offset:1024 sc1
    v_accvgpr_read_b32 v184, a64
    v_accvgpr_read_b32 v185, a65
    v_accvgpr_read_b32 v186, a66
    v_accvgpr_read_b32 v187, a67
    v_accvgpr_read_b32 v188, a68
    v_accvgpr_read_b32 v189, a69
    v_accvgpr_read_b32 v190, a70
    v_accvgpr_read_b32 v191, a71
    v_cvt_pk_bf16_f32 v192, v184, v185
    v_cvt_pk_bf16_f32 v193, v186, v187
    v_cvt_pk_bf16_f32 v194, v188, v189
    v_cvt_pk_bf16_f32 v195, v190, v191
    s_nop 0
    v_permlane16_swap_b32 v192, v194
    v_permlane16_swap_b32 v193, v195
    buffer_store_dwordx4 v[192:195], v8, s[8:11], s53 offen offset:2048 sc1
    v_accvgpr_read_b32 v196, a96
    v_accvgpr_read_b32 v197, a97
    v_accvgpr_read_b32 v198, a98
    v_accvgpr_read_b32 v199, a99
    v_accvgpr_read_b32 v200, a100
    v_accvgpr_read_b32 v201, a101
    v_accvgpr_read_b32 v202, a102
    v_accvgpr_read_b32 v203, a103
    v_cvt_pk_bf16_f32 v204, v196, v197
    v_cvt_pk_bf16_f32 v205, v198, v199
    v_cvt_pk_bf16_f32 v206, v200, v201
    v_cvt_pk_bf16_f32 v207, v202, v203
    s_nop 0
    v_permlane16_swap_b32 v204, v206
    v_permlane16_swap_b32 v205, v207
    buffer_store_dwordx4 v[204:207], v8, s[8:11], s53 offen offset:3072 sc1
    s_add_u32 s53, s53, 0x40000
    v_accvgpr_read_b32 v160, a8
    v_accvgpr_read_b32 v161, a9
    v_accvgpr_read_b32 v162, a10
    v_accvgpr_read_b32 v163, a11
    v_accvgpr_read_b32 v164, a12
    v_accvgpr_read_b32 v165, a13
    v_accvgpr_read_b32 v166, a14
    v_accvgpr_read_b32 v167, a15
    v_cvt_pk_bf16_f32 v168, v160, v161
    v_cvt_pk_bf16_f32 v169, v162, v163
    v_cvt_pk_bf16_f32 v170, v164, v165
    v_cvt_pk_bf16_f32 v171, v166, v167
    s_nop 0
    v_permlane16_swap_b32 v168, v170
    v_permlane16_swap_b32 v169, v171
    buffer_store_dwordx4 v[168:171], v8, s[8:11], s53 offen offset:0 sc1
    v_accvgpr_read_b32 v172, a40
    v_accvgpr_read_b32 v173, a41
    v_accvgpr_read_b32 v174, a42
    v_accvgpr_read_b32 v175, a43
    v_accvgpr_read_b32 v176, a44
    v_accvgpr_read_b32 v177, a45
    v_accvgpr_read_b32 v178, a46
    v_accvgpr_read_b32 v179, a47
    v_cvt_pk_bf16_f32 v180, v172, v173
    v_cvt_pk_bf16_f32 v181, v174, v175
    v_cvt_pk_bf16_f32 v182, v176, v177
    v_cvt_pk_bf16_f32 v183, v178, v179
    s_nop 0
    v_permlane16_swap_b32 v180, v182
    v_permlane16_swap_b32 v181, v183
    buffer_store_dwordx4 v[180:183], v8, s[8:11], s53 offen offset:1024 sc1
    v_accvgpr_read_b32 v184, a72
    v_accvgpr_read_b32 v185, a73
    v_accvgpr_read_b32 v186, a74
    v_accvgpr_read_b32 v187, a75
    v_accvgpr_read_b32 v188, a76
    v_accvgpr_read_b32 v189, a77
    v_accvgpr_read_b32 v190, a78
    v_accvgpr_read_b32 v191, a79
    v_cvt_pk_bf16_f32 v192, v184, v185
    v_cvt_pk_bf16_f32 v193, v186, v187
    v_cvt_pk_bf16_f32 v194, v188, v189
    v_cvt_pk_bf16_f32 v195, v190, v191
    s_nop 0
    v_permlane16_swap_b32 v192, v194
    v_permlane16_swap_b32 v193, v195
    buffer_store_dwordx4 v[192:195], v8, s[8:11], s53 offen offset:2048 sc1
    v_accvgpr_read_b32 v196, a104
    v_accvgpr_read_b32 v197, a105
    v_accvgpr_read_b32 v198, a106
    v_accvgpr_read_b32 v199, a107
    v_accvgpr_read_b32 v200, a108
    v_accvgpr_read_b32 v201, a109
    v_accvgpr_read_b32 v202, a110
    v_accvgpr_read_b32 v203, a111
    v_cvt_pk_bf16_f32 v204, v196, v197
    v_cvt_pk_bf16_f32 v205, v198, v199
    v_cvt_pk_bf16_f32 v206, v200, v201
    v_cvt_pk_bf16_f32 v207, v202, v203
    s_nop 0
    v_permlane16_swap_b32 v204, v206
    v_permlane16_swap_b32 v205, v207
    buffer_store_dwordx4 v[204:207], v8, s[8:11], s53 offen offset:3072 sc1
    s_add_u32 s53, s53, 0x40000
    v_accvgpr_read_b32 v160, a16
    v_accvgpr_read_b32 v161, a17
    v_accvgpr_read_b32 v162, a18
    v_accvgpr_read_b32 v163, a19
    v_accvgpr_read_b32 v164, a20
    v_accvgpr_read_b32 v165, a21
    v_accvgpr_read_b32 v166, a22
    v_accvgpr_read_b32 v167, a23
    v_cvt_pk_bf16_f32 v168, v160, v161
    v_cvt_pk_bf16_f32 v169, v162, v163
    v_cvt_pk_bf16_f32 v170, v164, v165
    v_cvt_pk_bf16_f32 v171, v166, v167
    s_nop 0
    v_permlane16_swap_b32 v168, v170
    v_permlane16_swap_b32 v169, v171
    buffer_store_dwordx4 v[168:171], v8, s[8:11], s53 offen offset:0 sc1
    v_accvgpr_read_b32 v172, a48
    v_accvgpr_read_b32 v173, a49
    v_accvgpr_read_b32 v174, a50
    v_accvgpr_read_b32 v175, a51
    v_accvgpr_read_b32 v176, a52
    v_accvgpr_read_b32 v177, a53
    v_accvgpr_read_b32 v178, a54
    v_accvgpr_read_b32 v179, a55
    v_cvt_pk_bf16_f32 v180, v172, v173
    v_cvt_pk_bf16_f32 v181, v174, v175
    v_cvt_pk_bf16_f32 v182, v176, v177
    v_cvt_pk_bf16_f32 v183, v178, v179
    s_nop 0
    v_permlane16_swap_b32 v180, v182
    v_permlane16_swap_b32 v181, v183
    buffer_store_dwordx4 v[180:183], v8, s[8:11], s53 offen offset:1024 sc1
    v_accvgpr_read_b32 v184, a80
    v_accvgpr_read_b32 v185, a81
    v_accvgpr_read_b32 v186, a82
    v_accvgpr_read_b32 v187, a83
    v_accvgpr_read_b32 v188, a84
    v_accvgpr_read_b32 v189, a85
    v_accvgpr_read_b32 v190, a86
    v_accvgpr_read_b32 v191, a87
    v_cvt_pk_bf16_f32 v192, v184, v185
    v_cvt_pk_bf16_f32 v193, v186, v187
    v_cvt_pk_bf16_f32 v194, v188, v189
    v_cvt_pk_bf16_f32 v195, v190, v191
    s_nop 0
    v_permlane16_swap_b32 v192, v194
    v_permlane16_swap_b32 v193, v195
    buffer_store_dwordx4 v[192:195], v8, s[8:11], s53 offen offset:2048 sc1
    v_accvgpr_read_b32 v196, a112
    v_accvgpr_read_b32 v197, a113
    v_accvgpr_read_b32 v198, a114
    v_accvgpr_read_b32 v199, a115
    v_accvgpr_read_b32 v200, a116
    v_accvgpr_read_b32 v201, a117
    v_accvgpr_read_b32 v202, a118
    v_accvgpr_read_b32 v203, a119
    v_cvt_pk_bf16_f32 v204, v196, v197
    v_cvt_pk_bf16_f32 v205, v198, v199
    v_cvt_pk_bf16_f32 v206, v200, v201
    v_cvt_pk_bf16_f32 v207, v202, v203
    s_nop 0
    v_permlane16_swap_b32 v204, v206
    v_permlane16_swap_b32 v205, v207
    buffer_store_dwordx4 v[204:207], v8, s[8:11], s53 offen offset:3072 sc1
    s_add_u32 s53, s53, 0x40000
    v_accvgpr_read_b32 v160, a24
    v_accvgpr_read_b32 v161, a25
    v_accvgpr_read_b32 v162, a26
    v_accvgpr_read_b32 v163, a27
    v_accvgpr_read_b32 v164, a28
    v_accvgpr_read_b32 v165, a29
    v_accvgpr_read_b32 v166, a30
    v_accvgpr_read_b32 v167, a31
    v_cvt_pk_bf16_f32 v168, v160, v161
    v_cvt_pk_bf16_f32 v169, v162, v163
    v_cvt_pk_bf16_f32 v170, v164, v165
    v_cvt_pk_bf16_f32 v171, v166, v167
    s_nop 0
    v_permlane16_swap_b32 v168, v170
    v_permlane16_swap_b32 v169, v171
    buffer_store_dwordx4 v[168:171], v8, s[8:11], s53 offen offset:0 sc1
    v_accvgpr_read_b32 v172, a56
    v_accvgpr_read_b32 v173, a57
    v_accvgpr_read_b32 v174, a58
    v_accvgpr_read_b32 v175, a59
    v_accvgpr_read_b32 v176, a60
    v_accvgpr_read_b32 v177, a61
    v_accvgpr_read_b32 v178, a62
    v_accvgpr_read_b32 v179, a63
    v_cvt_pk_bf16_f32 v180, v172, v173
    v_cvt_pk_bf16_f32 v181, v174, v175
    v_cvt_pk_bf16_f32 v182, v176, v177
    v_cvt_pk_bf16_f32 v183, v178, v179
    s_nop 0
    v_permlane16_swap_b32 v180, v182
    v_permlane16_swap_b32 v181, v183
    buffer_store_dwordx4 v[180:183], v8, s[8:11], s53 offen offset:1024 sc1
    v_accvgpr_read_b32 v184, a88
    v_accvgpr_read_b32 v185, a89
    v_accvgpr_read_b32 v186, a90
    v_accvgpr_read_b32 v187, a91
    v_accvgpr_read_b32 v188, a92
    v_accvgpr_read_b32 v189, a93
    v_accvgpr_read_b32 v190, a94
    v_accvgpr_read_b32 v191, a95
    v_cvt_pk_bf16_f32 v192, v184, v185
    v_cvt_pk_bf16_f32 v193, v186, v187
    v_cvt_pk_bf16_f32 v194, v188, v189
    v_cvt_pk_bf16_f32 v195, v190, v191
    s_nop 0
    v_permlane16_swap_b32 v192, v194
    v_permlane16_swap_b32 v193, v195
    buffer_store_dwordx4 v[192:195], v8, s[8:11], s53 offen offset:2048 sc1
    v_accvgpr_read_b32 v196, a120
    v_accvgpr_read_b32 v197, a121
    v_accvgpr_read_b32 v198, a122
    v_accvgpr_read_b32 v199, a123
    v_accvgpr_read_b32 v200, a124
    v_accvgpr_read_b32 v201, a125
    v_accvgpr_read_b32 v202, a126
    v_accvgpr_read_b32 v203, a127
    v_cvt_pk_bf16_f32 v204, v196, v197
    v_cvt_pk_bf16_f32 v205, v198, v199
    v_cvt_pk_bf16_f32 v206, v200, v201
    v_cvt_pk_bf16_f32 v207, v202, v203
    s_nop 0
    v_permlane16_swap_b32 v204, v206
    v_permlane16_swap_b32 v205, v207
    buffer_store_dwordx4 v[204:207], v8, s[8:11], s53 offen offset:3072 sc1
    s_add_u32 s53, s53, 0x40000
    s_lshl_b32 s53, s20, 9
    s_lshl_b32 s54, s39, 5
    s_add_u32 s53, s53, s54
    s_add_u32 s92, s53, 120061952
    s_cmp_eq_u32 s37, 0
    s_cselect_b32 s93, 16, 1
    s_mov_b64 s[94:95], 0xff
    s_setpc_b64 s[62:63]
Lw_mrun:
    s_waitcnt vmcnt(30)
    s_barrier
    ds_read_b128 v[80:83], v32 offset:0
    ds_read_b64_tr_b16 v[64:65], v40 offset:0
    ds_read_b128 v[84:87], v32 offset:256
    ds_read_b64_tr_b16 v[66:67], v40 offset:1024
    ds_read_b128 v[88:91], v32 offset:2048
    ds_read_b64_tr_b16 v[68:69], v41 offset:0
    ds_read_b128 v[92:95], v32 offset:2304
    ds_read_b64_tr_b16 v[70:71], v41 offset:1024
    ds_read_b128 v[96:99], v32 offset:4096
    ds_read_b64_tr_b16 v[72:73], v42 offset:0
    ds_read_b128 v[100:103], v32 offset:4352
    ds_read_b64_tr_b16 v[74:75], v42 offset:1024
    s_waitcnt lgkmcnt(4)
    ds_read_b128 v[104:107], v32 offset:6144
    ds_read_b64_tr_b16 v[76:77], v43 offset:0
    ds_read_b128 v[108:111], v32 offset:6400
    ds_read_b64_tr_b16 v[78:79], v43 offset:1024
    s_add_u32 s51, s51, 1
    s_cmp_eq_u32 s51, 6
    s_cselect_b32 s51, 0, s51
    s_mov_b32 s45, 24576
    s_cselect_b32 s45, -122880, s45
    v_add_u32 v32, s45, v32
    v_add_u32 v40, s45, v40
    v_add_u32 v41, s45, v41
    v_add_u32 v42, s45, v42
    v_add_u32 v43, s45, v43
Lm_loop_w:
    s_waitcnt vmcnt(24) lgkmcnt(0)
    s_barrier
    v_mfma_f32_16x16x32_bf16 a[0:3], v[64:67], v[80:83], a[0:3]
    ds_read_b128 v[128:131], v32 offset:0
    v_mfma_f32_16x16x32_bf16 a[4:7], v[64:67], v[84:87], a[4:7]
    ds_read_b64_tr_b16 v[112:113], v40 offset:0
    s_add_u32 m0, s47, s52
    v_mfma_f32_16x16x32_bf16 a[8:11], v[64:67], v[88:91], a[8:11]
    buffer_load_dwordx4 v34, s[8:11], s40 offen offset:0 sc1 lds
    v_mfma_f32_16x16x32_bf16 a[12:15], v[64:67], v[92:95], a[12:15]
    ds_read_b128 v[132:135], v32 offset:256
    v_mfma_f32_16x16x32_bf16 a[16:19], v[64:67], v[96:99], a[16:19]
    ds_read_b64_tr_b16 v[114:115], v40 offset:1024
    v_mfma_f32_16x16x32_bf16 a[20:23], v[64:67], v[100:103], a[20:23]
    ds_read_b128 v[136:139], v32 offset:2048
    v_mfma_f32_16x16x32_bf16 a[24:27], v[64:67], v[104:107], a[24:27]
    ds_read_b64_tr_b16 v[116:117], v41 offset:0
    v_mfma_f32_16x16x32_bf16 a[28:31], v[64:67], v[108:111], a[28:31]
    buffer_load_dwordx4 v34, s[8:11], s40 offen offset:1024 sc1 lds
    v_mfma_f32_16x16x32_bf16 a[32:35], v[68:71], v[80:83], a[32:35]
    ds_read_b128 v[140:143], v32 offset:2304
    v_mfma_f32_16x16x32_bf16 a[36:39], v[68:71], v[84:87], a[36:39]
    ds_read_b64_tr_b16 v[118:119], v41 offset:1024
    v_mfma_f32_16x16x32_bf16 a[40:43], v[68:71], v[88:91], a[40:43]
    ds_read_b128 v[144:147], v32 offset:4096
    v_mfma_f32_16x16x32_bf16 a[44:47], v[68:71], v[92:95], a[44:47]
    ds_read_b64_tr_b16 v[120:121], v42 offset:0
    v_mfma_f32_16x16x32_bf16 a[48:51], v[68:71], v[96:99], a[48:51]
    buffer_load_dwordx4 v35, s[8:11], s40 offen offset:2048 sc1 lds
    v_mfma_f32_16x16x32_bf16 a[52:55], v[68:71], v[100:103], a[52:55]
    ds_read_b128 v[148:151], v32 offset:4352
    v_mfma_f32_16x16x32_bf16 a[56:59], v[68:71], v[104:107], a[56:59]
    ds_read_b64_tr_b16 v[122:123], v42 offset:1024
    v_mfma_f32_16x16x32_bf16 a[60:63], v[68:71], v[108:111], a[60:63]
    ds_read_b128 v[152:155], v32 offset:6144
    v_mfma_f32_16x16x32_bf16 a[64:67], v[72:75], v[80:83], a[64:67]
    ds_read_b64_tr_b16 v[124:125], v43 offset:0
    v_mfma_f32_16x16x32_bf16 a[68:71], v[72:75], v[84:87], a[68:71]
    buffer_load_dwordx4 v35, s[8:11], s40 offen offset:3072 sc1 lds
    s_add_u32 s40, s40, 2048
    v_mfma_f32_16x16x32_bf16 a[72:75], v[72:75], v[88:91], a[72:75]
    ds_read_b128 v[156:159], v32 offset:6400
    v_mfma_f32_16x16x32_bf16 a[76:79], v[72:75], v[92:95], a[76:79]
    ds_read_b64_tr_b16 v[126:127], v43 offset:1024
    v_mfma_f32_16x16x32_bf16 a[80:83], v[72:75], v[96:99], a[80:83]
    s_add_u32 s51, s51, 1
    s_cmp_eq_u32 s51, 6
    s_cselect_b32 s51, 0, s51
    s_mov_b32 s45, 24576
    s_cselect_b32 s45, -122880, s45
    v_mfma_f32_16x16x32_bf16 a[84:87], v[72:75], v[100:103], a[84:87]
    v_add_u32 v32, s45, v32
    s_add_u32 m0, s48, s52
    v_mfma_f32_16x16x32_bf16 a[88:91], v[72:75], v[104:107], a[88:91]
    buffer_load_dwordx4 v36, s[12:15], s41 offen offset:0 lds
    v_mfma_f32_16x16x32_bf16 a[92:95], v[72:75], v[108:111], a[92:95]
    v_add_u32 v40, s45, v40
    v_mfma_f32_16x16x32_bf16 a[96:99], v[76:79], v[80:83], a[96:99]
    v_add_u32 v41, s45, v41
    v_mfma_f32_16x16x32_bf16 a[100:103], v[76:79], v[84:87], a[100:103]
    v_add_u32 v42, s45, v42
    v_mfma_f32_16x16x32_bf16 a[104:107], v[76:79], v[88:91], a[104:107]
    v_add_u32 v43, s45, v43
    v_mfma_f32_16x16x32_bf16 a[108:111], v[76:79], v[92:95], a[108:111]
    buffer_load_dwordx4 v37, s[12:15], s41 offen offset:1024 lds
    s_add_u32 s41, s41, s59
    s_add_u32 s52, s52, 24576
    s_cmp_eq_u32 s52, 147456
    s_cselect_b32 s52, 0, s52
    v_mfma_f32_16x16x32_bf16 a[112:115], v[76:79], v[96:99], a[112:115]
    v_mfma_f32_16x16x32_bf16 a[116:119], v[76:79], v[100:103], a[116:119]
    v_mfma_f32_16x16x32_bf16 a[120:123], v[76:79], v[104:107], a[120:123]
    v_mfma_f32_16x16x32_bf16 a[124:127], v[76:79], v[108:111], a[124:127]
    s_waitcnt vmcnt(24) lgkmcnt(0)
    s_barrier
    v_mfma_f32_16x16x32_bf16 a[0:3], v[112:115], v[128:131], a[0:3]
    ds_read_b128 v[80:83], v32 offset:0
    v_mfma_f32_16x16x32_bf16 a[4:7], v[112:115], v[132:135], a[4:7]
    ds_read_b64_tr_b16 v[64:65], v40 offset:0
    s_add_u32 m0, s47, s52
    v_mfma_f32_16x16x32_bf16 a[8:11], v[112:115], v[136:139], a[8:11]
    buffer_load_dwordx4 v34, s[8:11], s40 offen offset:0 sc1 lds
    v_mfma_f32_16x16x32_bf16 a[12:15], v[112:115], v[140:143], a[12:15]
    ds_read_b128 v[84:87], v32 offset:256
    v_mfma_f32_16x16x32_bf16 a[16:19], v[112:115], v[144:147], a[16:19]
    ds_read_b64_tr_b16 v[66:67], v40 offset:1024
    v_mfma_f32_16x16x32_bf16 a[20:23], v[112:115], v[148:151], a[20:23]
    ds_read_b128 v[88:91], v32 offset:2048
    v_mfma_f32_16x16x32_bf16 a[24:27], v[112:115], v[152:155], a[24:27]
    ds_read_b64_tr_b16 v[68:69], v41 offset:0
    v_mfma_f32_16x16x32_bf16 a[28:31], v[112:115], v[156:159], a[28:31]
    buffer_load_dwordx4 v34, s[8:11], s40 offen offset:1024 sc1 lds
    v_mfma_f32_16x16x32_bf16 a[32:35], v[116:119], v[128:131], a[32:35]
    ds_read_b128 v[92:95], v32 offset:2304
    v_mfma_f32_16x16x32_bf16 a[36:39], v[116:119], v[132:135], a[36:39]
    ds_read_b64_tr_b16 v[70:71], v41 offset:1024
    v_mfma_f32_16x16x32_bf16 a[40:43], v[116:119], v[136:139], a[40:43]
    ds_read_b128 v[96:99], v32 offset:4096
    v_mfma_f32_16x16x32_bf16 a[44:47], v[116:119], v[140:143], a[44:47]
    ds_read_b64_tr_b16 v[72:73], v42 offset:0
    v_mfma_f32_16x16x32_bf16 a[48:51], v[116:119], v[144:147], a[48:51]
    buffer_load_dwordx4 v35, s[8:11], s40 offen offset:2048 sc1 lds
    v_mfma_f32_16x16x32_bf16 a[52:55], v[116:119], v[148:151], a[52:55]
    ds_read_b128 v[100:103], v32 offset:4352
    v_mfma_f32_16x16x32_bf16 a[56:59], v[116:119], v[152:155], a[56:59]
    ds_read_b64_tr_b16 v[74:75], v42 offset:1024
    v_mfma_f32_16x16x32_bf16 a[60:63], v[116:119], v[156:159], a[60:63]
    ds_read_b128 v[104:107], v32 offset:6144
    v_mfma_f32_16x16x32_bf16 a[64:67], v[120:123], v[128:131], a[64:67]
    ds_read_b64_tr_b16 v[76:77], v43 offset:0
    v_mfma_f32_16x16x32_bf16 a[68:71], v[120:123], v[132:135], a[68:71]
    buffer_load_dwordx4 v35, s[8:11], s40 offen offset:3072 sc1 lds
    s_add_u32 s40, s40, 2048
    v_mfma_f32_16x16x32_bf16 a[72:75], v[120:123], v[136:139], a[72:75]
    ds_read_b128 v[108:111], v32 offset:6400
    v_mfma_f32_16x16x32_bf16 a[76:79], v[120:123], v[140:143], a[76:79]
    ds_read_b64_tr_b16 v[78:79], v43 offset:1024
    v_mfma_f32_16x16x32_bf16 a[80:83], v[120:123], v[144:147], a[80:83]
    s_add_u32 s51, s51, 1
    s_cmp_eq_u32 s51, 6
    s_cselect_b32 s51, 0, s51
    s_mov_b32 s45, 24576
    s_cselect_b32 s45, -122880, s45
    v_mfma_f32_16x16x32_bf16 a[84:87], v[120:123], v[148:151], a[84:87]
    v_add_u32 v32, s45, v32
    s_add_u32 m0, s48, s52
    v_mfma_f32_16x16x32_bf16 a[88:91], v[120:123], v[152:155], a[88:91]
    buffer_load_dwordx4 v36, s[12:15], s41 offen offset:0 lds
    v_mfma_f32_16x16x32_bf16 a[92:95], v[120:123], v[156:159], a[92:95]
    v_add_u32 v40, s45, v40
    v_mfma_f32_16x16x32_bf16 a[96:99], v[124:127], v[128:131], a[96:99]
    v_add_u32 v41, s45, v41
    v_mfma_f32_16x16x32_bf16 a[100:103], v[124:127], v[132:135], a[100:103]
    v_add_u32 v42, s45, v42
    v_mfma_f32_16x16x32_bf16 a[104:107], v[124:127], v[136:139], a[104:107]
    v_add_u32 v43, s45, v43
    v_mfma_f32_16x16x32_bf16 a[108:111], v[124:127], v[140:143], a[108:111]
    buffer_load_dwordx4 v37, s[12:15], s41 offen offset:1024 lds
    s_add_u32 s41, s41, s59
    s_add_u32 s52, s52, 24576
    s_cmp_eq_u32 s52, 147456
    s_cselect_b32 s52, 0, s52
    v_mfma_f32_16x16x32_bf16 a[112:115], v[124:127], v[144:147], a[112:115]
    v_mfma_f32_16x16x32_bf16 a[116:119], v[124:127], v[148:151], a[116:119]
    v_mfma_f32_16x16x32_bf16 a[120:123], v[124:127], v[152:155], a[120:123]
    v_mfma_f32_16x16x32_bf16 a[124:127], v[124:127], v[156:159], a[124:127]
    s_sub_u32 s44, s44, 1
    s_cmp_lg_u32 s44, 0
    s_cbranch_scc1 Lm_loop_w
    s_waitcnt vmcnt(24) lgkmcnt(0)
    s_barrier
    v_mfma_f32_16x16x32_bf16 a[0:3], v[64:67], v[80:83], a[0:3]
    ds_read_b128 v[128:131], v32 offset:0
    v_mfma_f32_16x16x32_bf16 a[4:7], v[64:67], v[84:87], a[4:7]
    ds_read_b64_tr_b16 v[112:113], v40 offset:0
    v_mfma_f32_16x16x32_bf16 a[8:11], v[64:67], v[88:91], a[8:11]
    ds_read_b128 v[132:135], v32 offset:256
    v_mfma_f32_16x16x32_bf16 a[12:15], v[64:67], v[92:95], a[12:15]
    ds_read_b64_tr_b16 v[114:115], v40 offset:1024
    v_mfma_f32_16x16x32_bf16 a[16:19], v[64:67], v[96:99], a[16:19]
    ds_read_b128 v[136:139], v32 offset:2048
    v_mfma_f32_16x16x32_bf16 a[20:23], v[64:67], v[100:103], a[20:23]
    ds_read_b64_tr_b16 v[116:117], v41 offset:0
    v_mfma_f32_16x16x32_bf16 a[24:27], v[64:67], v[104:107], a[24:27]
    ds_read_b128 v[140:143], v32 offset:2304
    v_mfma_f32_16x16x32_bf16 a[28:31], v[64:67], v[108:111], a[28:31]
    ds_read_b64_tr_b16 v[118:119], v41 offset:1024
    v_mfma_f32_16x16x32_bf16 a[32:35], v[68:71], v[80:83], a[32:35]
    ds_read_b128 v[144:147], v32 offset:4096
    v_mfma_f32_16x16x32_bf16 a[36:39], v[68:71], v[84:87], a[36:39]
    ds_read_b64_tr_b16 v[120:121], v42 offset:0
    v_mfma_f32_16x16x32_bf16 a[40:43], v[68:71], v[88:91], a[40:43]
    ds_read_b128 v[148:151], v32 offset:4352
    v_mfma_f32_16x16x32_bf16 a[44:47], v[68:71], v[92:95], a[44:47]
    ds_read_b64_tr_b16 v[122:123], v42 offset:1024
    v_mfma_f32_16x16x32_bf16 a[48:51], v[68:71], v[96:99], a[48:51]
    ds_read_b128 v[152:155], v32 offset:6144
    v_mfma_f32_16x16x32_bf16 a[52:55], v[68:71], v[100:103], a[52:55]
    ds_read_b64_tr_b16 v[124:125], v43 offset:0
    v_mfma_f32_16x16x32_bf16 a[56:59], v[68:71], v[104:107], a[56:59]
    ds_read_b128 v[156:159], v32 offset:6400
    v_mfma_f32_16x16x32_bf16 a[60:63], v[68:71], v[108:111], a[60:63]
    ds_read_b64_tr_b16 v[126:127], v43 offset:1024
    v_mfma_f32_16x16x32_bf16 a[64:67], v[72:75], v[80:83], a[64:67]
    s_add_u32 s51, s51, 1
    s_cmp_eq_u32 s51, 6
    s_cselect_b32 s51, 0, s51
    s_mov_b32 s45, 24576
    s_cselect_b32 s45, -122880, s45
    v_mfma_f32_16x16x32_bf16 a[68:71], v[72:75], v[84:87], a[68:71]
    v_add_u32 v32, s45, v32
    v_mfma_f32_16x16x32_bf16 a[72:75], v[72:75], v[88:91], a[72:75]
    v_add_u32 v40, s45, v40
    v_mfma_f32_16x16x32_bf16 a[76:79], v[72:75], v[92:95], a[76:79]
    v_add_u32 v41, s45, v41
    v_mfma_f32_16x16x32_bf16 a[80:83], v[72:75], v[96:99], a[80:83]
    v_add_u32 v42, s45, v42
    v_mfma_f32_16x16x32_bf16 a[84:87], v[72:75], v[100:103], a[84:87]
    v_add_u32 v43, s45, v43
    v_mfma_f32_16x16x32_bf16 a[88:91], v[72:75], v[104:107], a[88:91]
    v_mfma_f32_16x16x32_bf16 a[92:95], v[72:75], v[108:111], a[92:95]
    v_mfma_f32_16x16x32_bf16 a[96:99], v[76:79], v[80:83], a[96:99]
    v_mfma_f32_16x16x32_bf16 a[100:103], v[76:79], v[84:87], a[100:103]
    v_mfma_f32_16x16x32_bf16 a[104:107], v[76:79], v[88:91], a[104:107]
    v_mfma_f32_16x16x32_bf16 a[108:111], v[76:79], v[92:95], a[108:111]
    v_mfma_f32_16x16x32_bf16 a[112:115], v[76:79], v[96:99], a[112:115]
    v_mfma_f32_16x16x32_bf16 a[116:119], v[76:79], v[100:103], a[116:119]
    v_mfma_f32_16x16x32_bf16 a[120:123], v[76:79], v[104:107], a[120:123]
    v_mfma_f32_16x16x32_bf16 a[124:127], v[76:79], v[108:111], a[124:127]
    s_waitcnt vmcnt(18) lgkmcnt(0)
    s_barrier
    v_mfma_f32_16x16x32_bf16 a[0:3], v[112:115], v[128:131], a[0:3]
    ds_read_b128 v[80:83], v32 offset:0
    v_mfma_f32_16x16x32_bf16 a[4:7], v[112:115], v[132:135], a[4:7]
    ds_read_b64_tr_b16 v[64:65], v40 offset:0
    v_mfma_f32_16x16x32_bf16 a[8:11], v[112:115], v[136:139], a[8:11]
    ds_read_b128 v[84:87], v32 offset:256
    v_mfma_f32_16x16x32_bf16 a[12:15], v[112:115], v[140:143], a[12:15]
    ds_read_b64_tr_b16 v[66:67], v40 offset:1024
    v_mfma_f32_16x16x32_bf16 a[16:19], v[112:115], v[144:147], a[16:19]
    ds_read_b128 v[88:91], v32 offset:2048
    v_mfma_f32_16x16x32_bf16 a[20:23], v[112:115], v[148:151], a[20:23]
    ds_read_b64_tr_b16 v[68:69], v41 offset:0
    v_mfma_f32_16x16x32_bf16 a[24:27], v[112:115], v[152:155], a[24:27]
    ds_read_b128 v[92:95], v32 offset:2304
    v_mfma_f32_16x16x32_bf16 a[28:31], v[112:115], v[156:159], a[28:31]
    ds_read_b64_tr_b16 v[70:71], v41 offset:1024
    v_mfma_f32_16x16x32_bf16 a[32:35], v[116:119], v[128:131], a[32:35]
    ds_read_b128 v[96:99], v32 offset:4096
    v_mfma_f32_16x16x32_bf16 a[36:39], v[116:119], v[132:135], a[36:39]
    ds_read_b64_tr_b16 v[72:73], v42 offset:0
    v_mfma_f32_16x16x32_bf16 a[40:43], v[116:119], v[136:139], a[40:43]
    ds_read_b128 v[100:103], v32 offset:4352
    v_mfma_f32_16x16x32_bf16 a[44:47], v[116:119], v[140:143], a[44:47]
    ds_read_b64_tr_b16 v[74:75], v42 offset:1024
    v_mfma_f32_16x16x32_bf16 a[48:51], v[116:119], v[144:147], a[48:51]
    ds_read_b128 v[104:107], v32 offset:6144
    v_mfma_f32_16x16x32_bf16 a[52:55], v[116:119], v[148:151], a[52:55]
    ds_read_b64_tr_b16 v[76:77], v43 offset:0
    v_mfma_f32_16x16x32_bf16 a[56:59], v[116:119], v[152:155], a[56:59]
    ds_read_b128 v[108:111], v32 offset:6400
    v_mfma_f32_16x16x32_bf16 a[60:63], v[116:119], v[156:159], a[60:63]
    ds_read_b64_tr_b16 v[78:79], v43 offset:1024
    v_mfma_f32_16x16x32_bf16 a[64:67], v[120:123], v[128:131], a[64:67]
    s_add_u32 s51, s51, 1
    s_cmp_eq_u32 s51, 6
    s_cselect_b32 s51, 0, s51
    s_mov_b32 s45, 24576
    s_cselect_b32 s45, -122880, s45
    v_mfma_f32_16x16x32_bf16 a[68:71], v[120:123], v[132:135], a[68:71]
    v_add_u32 v32, s45, v32
    v_mfma_f32_16x16x32_bf16 a[72:75], v[120:123], v[136:139], a[72:75]
    v_add_u32 v40, s45, v40
    v_mfma_f32_16x16x32_bf16 a[76:79], v[120:123], v[140:143], a[76:79]
    v_add_u32 v41, s45, v41
    v_mfma_f32_16x16x32_bf16 a[80:83], v[120:123], v[144:147], a[80:83]
    v_add_u32 v42, s45, v42
    v_mfma_f32_16x16x32_bf16 a[84:87], v[120:123], v[148:151], a[84:87]
    v_add_u32 v43, s45, v43
    v_mfma_f32_16x16x32_bf16 a[88:91], v[120:123], v[152:155], a[88:91]
    v_mfma_f32_16x16x32_bf16 a[92:95], v[120:123], v[156:159], a[92:95]
    v_mfma_f32_16x16x32_bf16 a[96:99], v[124:127], v[128:131], a[96:99]
    v_mfma_f32_16x16x32_bf16 a[100:103], v[124:127], v[132:135], a[100:103]
    v_mfma_f32_16x16x32_bf16 a[104:107], v[124:127], v[136:139], a[104:107]
    v_mfma_f32_16x16x32_bf16 a[108:111], v[124:127], v[140:143], a[108:111]
    v_mfma_f32_16x16x32_bf16 a[112:115], v[124:127], v[144:147], a[112:115]
    v_mfma_f32_16x16x32_bf16 a[116:119], v[124:127], v[148:151], a[116:119]
    v_mfma_f32_16x16x32_bf16 a[120:123], v[124:127], v[152:155], a[120:123]
    v_mfma_f32_16x16x32_bf16 a[124:127], v[124:127], v[156:159], a[124:127]
    s_waitcnt vmcnt(12) lgkmcnt(0)
    s_barrier
    v_mfma_f32_16x16x32_bf16 a[0:3], v[64:67], v[80:83], a[0:3]
    ds_read_b128 v[128:131], v32 offset:0
    v_mfma_f32_16x16x32_bf16 a[4:7], v[64:67], v[84:87], a[4:7]
    ds_read_b64_tr_b16 v[112:113], v40 offset:0
    v_mfma_f32_16x16x32_bf16 a[8:11], v[64:67], v[88:91], a[8:11]
    ds_read_b128 v[132:135], v32 offset:256
    v_mfma_f32_16x16x32_bf16 a[12:15], v[64:67], v[92:95], a[12:15]
    ds_read_b64_tr_b16 v[114:115], v40 offset:1024
    v_mfma_f32_16x16x32_bf16 a[16:19], v[64:67], v[96:99], a[16:19]
    ds_read_b128 v[136:139], v32 offset:2048
    v_mfma_f32_16x16x32_bf16 a[20:23], v[64:67], v[100:103], a[20:23]
    ds_read_b64_tr_b16 v[116:117], v41 offset:0
    v_mfma_f32_16x16x32_bf16 a[24:27], v[64:67], v[104:107], a[24:27]
    ds_read_b128 v[140:143], v32 offset:2304
    v_mfma_f32_16x16x32_bf16 a[28:31], v[64:67], v[108:111], a[28:31]
    ds_read_b64_tr_b16 v[118:119], v41 offset:1024
    v_mfma_f32_16x16x32_bf16 a[32:35], v[68:71], v[80:83], a[32:35]
    ds_read_b128 v[144:147], v32 offset:4096
    v_mfma_f32_16x16x32_bf16 a[36:39], v[68:71], v[84:87], a[36:39]
    ds_read_b64_tr_b16 v[120:121], v42 offset:0
    v_mfma_f32_16x16x32_bf16 a[40:43], v[68:71], v[88:91], a[40:43]
    ds_read_b128 v[148:151], v32 offset:4352
    v_mfma_f32_16x16x32_bf16 a[44:47], v[68:71], v[92:95], a[44:47]
    ds_read_b64_tr_b16 v[122:123], v42 offset:1024
    v_mfma_f32_16x16x32_bf16 a[48:51], v[68:71], v[96:99], a[48:51]
    ds_read_b128 v[152:155], v32 offset:6144
    v_mfma_f32_16x16x32_bf16 a[52:55], v[68:71], v[100:103], a[52:55]
    ds_read_b64_tr_b16 v[124:125], v43 offset:0
    v_mfma_f32_16x16x32_bf16 a[56:59], v[68:71], v[104:107], a[56:59]
    ds_read_b128 v[156:159], v32 offset:6400
    v_mfma_f32_16x16x32_bf16 a[60:63], v[68:71], v[108:111], a[60:63]
    ds_read_b64_tr_b16 v[126:127], v43 offset:1024
    v_mfma_f32_16x16x32_bf16 a[64:67], v[72:75], v[80:83], a[64:67]
    s_add_u32 s51, s51, 1
    s_cmp_eq_u32 s51, 6
    s_cselect_b32 s51, 0, s51
    s_mov_b32 s45, 24576
    s_cselect_b32 s45, -122880, s45
    v_mfma_f32_16x16x32_bf16 a[68:71], v[72:75], v[84:87], a[68:71]
    v_add_u32 v32, s45, v32
    v_mfma_f32_16x16x32_bf16 a[72:75], v[72:75], v[88:91], a[72:75]
    v_add_u32 v40, s45, v40
    v_mfma_f32_16x16x32_bf16 a[76:79], v[72:75], v[92:95], a[76:79]
    v_add_u32 v41, s45, v41
    v_mfma_f32_16x16x32_bf16 a[80:83], v[72:75], v[96:99], a[80:83]
    v_add_u32 v42, s45, v42
    v_mfma_f32_16x16x32_bf16 a[84:87], v[72:75], v[100:103], a[84:87]
    v_add_u32 v43, s45, v43
    v_mfma_f32_16x16x32_bf16 a[88:91], v[72:75], v[104:107], a[88:91]
    v_mfma_f32_16x16x32_bf16 a[92:95], v[72:75], v[108:111], a[92:95]
    v_mfma_f32_16x16x32_bf16 a[96:99], v[76:79], v[80:83], a[96:99]
    v_mfma_f32_16x16x32_bf16 a[100:103], v[76:79], v[84:87], a[100:103]
    v_mfma_f32_16x16x32_bf16 a[104:107], v[76:79], v[88:91], a[104:107]
    v_mfma_f32_16x16x32_bf16 a[108:111], v[76:79], v[92:95], a[108:111]
    v_mfma_f32_16x16x32_bf16 a[112:115], v[76:79], v[96:99], a[112:115]
    v_mfma_f32_16x16x32_bf16 a[116:119], v[76:79], v[100:103], a[116:119]
    v_mfma_f32_16x16x32_bf16 a[120:123], v[76:79], v[104:107], a[120:123]
    v_mfma_f32_16x16x32_bf16 a[124:127], v[76:79], v[108:111], a[124:127]
    s_waitcnt vmcnt(6) lgkmcnt(0)
    s_barrier
    v_mfma_f32_16x16x32_bf16 a[0:3], v[112:115], v[128:131], a[0:3]
    ds_read_b128 v[80:83], v32 offset:0
    v_mfma_f32_16x16x32_bf16 a[4:7], v[112:115], v[132:135], a[4:7]
    ds_read_b64_tr_b16 v[64:65], v40 offset:0
    v_mfma_f32_16x16x32_bf16 a[8:11], v[112:115], v[136:139], a[8:11]
    ds_read_b128 v[84:87], v32 offset:256
    v_mfma_f32_16x16x32_bf16 a[12:15], v[112:115], v[140:143], a[12:15]
    ds_read_b64_tr_b16 v[66:67], v40 offset:1024
    v_mfma_f32_16x16x32_bf16 a[16:19], v[112:115], v[144:147], a[16:19]
    ds_read_b128 v[88:91], v32 offset:2048
    v_mfma_f32_16x16x32_bf16 a[20:23], v[112:115], v[148:151], a[20:23]
    ds_read_b64_tr_b16 v[68:69], v41 offset:0
    v_mfma_f32_16x16x32_bf16 a[24:27], v[112:115], v[152:155], a[24:27]
    ds_read_b128 v[92:95], v32 offset:2304
    v_mfma_f32_16x16x32_bf16 a[28:31], v[112:115], v[156:159], a[28:31]
    ds_read_b64_tr_b16 v[70:71], v41 offset:1024
    v_mfma_f32_16x16x32_bf16 a[32:35], v[116:119], v[128:131], a[32:35]
    ds_read_b128 v[96:99], v32 offset:4096
    v_mfma_f32_16x16x32_bf16 a[36:39], v[116:119], v[132:135], a[36:39]
    ds_read_b64_tr_b16 v[72:73], v42 offset:0
    v_mfma_f32_16x16x32_bf16 a[40:43], v[116:119], v[136:139], a[40:43]
    ds_read_b128 v[100:103], v32 offset:4352
    v_mfma_f32_16x16x32_bf16 a[44:47], v[116:119], v[140:143], a[44:47]
    ds_read_b64_tr_b16 v[74:75], v42 offset:1024
    v_mfma_f32_16x16x32_bf16 a[48:51], v[116:119], v[144:147], a[48:51]
    ds_read_b128 v[104:107], v32 offset:6144
    v_mfma_f32_16x16x32_bf16 a[52:55], v[116:119], v[148:151], a[52:55]
    ds_read_b64_tr_b16 v[76:77], v43 offset:0
    v_mfma_f32_16x16x32_bf16 a[56:59], v[116:119], v[152:155], a[56:59]
    ds_read_b128 v[108:111], v32 offset:6400
    v_mfma_f32_16x16x32_bf16 a[60:63], v[116:119], v[156:159], a[60:63]
    ds_read_b64_tr_b16 v[78:79], v43 offset:1024
    v_mfma_f32_16x16x32_bf16 a[64:67], v[120:123], v[128:131], a[64:67]
    s_add_u32 s51, s51, 1
    s_cmp_eq_u32 s51, 6
    s_cselect_b32 s51, 0, s51
    s_mov_b32 s45, 24576
    s_cselect_b32 s45, -122880, s45
    v_mfma_f32_16x16x32_bf16 a[68:71], v[120:123], v[132:135], a[68:71]
    v_add_u32 v32, s45, v32
    v_mfma_f32_16x16x32_bf16 a[72:75], v[120:123], v[136:139], a[72:75]
    v_add_u32 v40, s45, v40
    v_mfma_f32_16x16x32_bf16 a[76:79], v[120:123], v[140:143], a[76:79]
    v_add_u32 v41, s45, v41
    v_mfma_f32_16x16x32_bf16 a[80:83], v[120:123], v[144:147], a[80:83]
    v_add_u32 v42, s45, v42
    v_mfma_f32_16x16x32_bf16 a[84:87], v[120:123], v[148:151], a[84:87]
    v_add_u32 v43, s45, v43
    v_mfma_f32_16x16x32_bf16 a[88:91], v[120:123], v[152:155], a[88:91]
    v_mfma_f32_16x16x32_bf16 a[92:95], v[120:123], v[156:159], a[92:95]
    v_mfma_f32_16x16x32_bf16 a[96:99], v[124:127], v[128:131], a[96:99]
    v_mfma_f32_16x16x32_bf16 a[100:103], v[124:127], v[132:135], a[100:103]
    v_mfma_f32_16x16x32_bf16 a[104:107], v[124:127], v[136:139], a[104:107]
    v_mfma_f32_16x16x32_bf16 a[108:111], v[124:127], v[140:143], a[108:111]
    v_mfma_f32_16x16x32_bf16 a[112:115], v[124:127], v[144:147], a[112:115]
    v_mfma_f32_16x16x32_bf16 a[116:119], v[124:127], v[148:151], a[116:119]
    v_mfma_f32_16x16x32_bf16 a[120:123], v[124:127], v[152:155], a[120:123]
    v_mfma_f32_16x16x32_bf16 a[124:127], v[124:127], v[156:159], a[124:127]
    s_waitcnt vmcnt(0) lgkmcnt(0)
    s_barrier
    v_mfma_f32_16x16x32_bf16 a[0:3], v[64:67], v[80:83], a[0:3]
    ds_read_b128 v[128:131], v32 offset:0
    v_mfma_f32_16x16x32_bf16 a[4:7], v[64:67], v[84:87], a[4:7]
    ds_read_b64_tr_b16 v[112:113], v40 offset:0
    v_mfma_f32_16x16x32_bf16 a[8:11], v[64:67], v[88:91], a[8:11]
    ds_read_b128 v[132:135], v32 offset:256
    v_mfma_f32_16x16x32_bf16 a[12:15], v[64:67], v[92:95], a[12:15]
    ds_read_b64_tr_b16 v[114:115], v40 offset:1024
    v_mfma_f32_16x16x32_bf16 a[16:19], v[64:67], v[96:99], a[16:19]
    ds_read_b128 v[136:139], v32 offset:2048
    v_mfma_f32_16x16x32_bf16 a[20:23], v[64:67], v[100:103], a[20:23]
    ds_read_b64_tr_b16 v[116:117], v41 offset:0
    v_mfma_f32_16x16x32_bf16 a[24:27], v[64:67], v[104:107], a[24:27]
    ds_read_b128 v[140:143], v32 offset:2304
    v_mfma_f32_16x16x32_bf16 a[28:31], v[64:67], v[108:111], a[28:31]
    ds_read_b64_tr_b16 v[118:119], v41 offset:1024
    v_mfma_f32_16x16x32_bf16 a[32:35], v[68:71], v[80:83], a[32:35]
    ds_read_b128 v[144:147], v32 offset:4096
    v_mfma_f32_16x16x32_bf16 a[36:39], v[68:71], v[84:87], a[36:39]
    ds_read_b64_tr_b16 v[120:121], v42 offset:0
    v_mfma_f32_16x16x32_bf16 a[40:43], v[68:71], v[88:91], a[40:43]
    ds_read_b128 v[148:151], v32 offset:4352
    v_mfma_f32_16x16x32_bf16 a[44:47], v[68:71], v[92:95], a[44:47]
    ds_read_b64_tr_b16 v[122:123], v42 offset:1024
    v_mfma_f32_16x16x32_bf16 a[48:51], v[68:71], v[96:99], a[48:51]
    ds_read_b128 v[152:155], v32 offset:6144
    v_mfma_f32_16x16x32_bf16 a[52:55], v[68:71], v[100:103], a[52:55]
    ds_read_b64_tr_b16 v[124:125], v43 offset:0
    v_mfma_f32_16x16x32_bf16 a[56:59], v[68:71], v[104:107], a[56:59]
    ds_read_b128 v[156:159], v32 offset:6400
    v_mfma_f32_16x16x32_bf16 a[60:63], v[68:71], v[108:111], a[60:63]
    ds_read_b64_tr_b16 v[126:127], v43 offset:1024
    v_mfma_f32_16x16x32_bf16 a[64:67], v[72:75], v[80:83], a[64:67]
    s_add_u32 s51, s51, 1
    s_cmp_eq_u32 s51, 6
    s_cselect_b32 s51, 0, s51
    s_mov_b32 s45, 24576
    s_cselect_b32 s45, -122880, s45
    v_mfma_f32_16x16x32_bf16 a[68:71], v[72:75], v[84:87], a[68:71]
    v_add_u32 v32, s45, v32
    v_mfma_f32_16x16x32_bf16 a[72:75], v[72:75], v[88:91], a[72:75]
    v_add_u32 v40, s45, v40
    v_mfma_f32_16x16x32_bf16 a[76:79], v[72:75], v[92:95], a[76:79]
    v_add_u32 v41, s45, v41
    v_mfma_f32_16x16x32_bf16 a[80:83], v[72:75], v[96:99], a[80:83]
    v_add_u32 v42, s45, v42
    v_mfma_f32_16x16x32_bf16 a[84:87], v[72:75], v[100:103], a[84:87]
    v_add_u32 v43, s45, v43
    v_mfma_f32_16x16x32_bf16 a[88:91], v[72:75], v[104:107], a[88:91]
    v_mfma_f32_16x16x32_bf16 a[92:95], v[72:75], v[108:111], a[92:95]
    v_mfma_f32_16x16x32_bf16 a[96:99], v[76:79], v[80:83], a[96:99]
    v_mfma_f32_16x16x32_bf16 a[100:103], v[76:79], v[84:87], a[100:103]
    v_mfma_f32_16x16x32_bf16 a[104:107], v[76:79], v[88:91], a[104:107]
    v_mfma_f32_16x16x32_bf16 a[108:111], v[76:79], v[92:95], a[108:111]
    v_mfma_f32_16x16x32_bf16 a[112:115], v[76:79], v[96:99], a[112:115]
    v_mfma_f32_16x16x32_bf16 a[116:119], v[76:79], v[100:103], a[116:119]
    v_mfma_f32_16x16x32_bf16 a[120:123], v[76:79], v[104:107], a[120:123]
    v_mfma_f32_16x16x32_bf16 a[124:127], v[76:79], v[108:111], a[124:127]
    s_waitcnt vmcnt(0) lgkmcnt(0)
    s_barrier
    v_mfma_f32_16x16x32_bf16 a[0:3], v[112:115], v[128:131], a[0:3]
    v_mfma_f32_16x16x32_bf16 a[4:7], v[112:115], v[132:135], a[4:7]
    v_mfma_f32_16x16x32_bf16 a[8:11], v[112:115], v[136:139], a[8:11]
    v_mfma_f32_16x16x32_bf16 a[12:15], v[112:115], v[140:143], a[12:15]
    v_mfma_f32_16x16x32_bf16 a[16:19], v[112:115], v[144:147], a[16:19]
    v_mfma_f32_16x16x32_bf16 a[20:23], v[112:115], v[148:151], a[20:23]
    v_mfma_f32_16x16x32_bf16 a[24:27], v[112:115], v[152:155], a[24:27]
    v_mfma_f32_16x16x32_bf16 a[28:31], v[112:115], v[156:159], a[28:31]
    v_mfma_f32_16x16x32_bf16 a[32:35], v[116:119], v[128:131], a[32:35]
    v_mfma_f32_16x16x32_bf16 a[36:39], v[116:119], v[132:135], a[36:39]
    v_mfma_f32_16x16x32_bf16 a[40:43], v[116:119], v[136:139], a[40:43]
    v_mfma_f32_16x16x32_bf16 a[44:47], v[116:119], v[140:143], a[44:47]
    v_mfma_f32_16x16x32_bf16 a[48:51], v[116:119], v[144:147], a[48:51]
    v_mfma_f32_16x16x32_bf16 a[52:55], v[116:119], v[148:151], a[52:55]
    v_mfma_f32_16x16x32_bf16 a[56:59], v[116:119], v[152:155], a[56:59]
    v_mfma_f32_16x16x32_bf16 a[60:63], v[116:119], v[156:159], a[60:63]
    v_mfma_f32_16x16x32_bf16 a[64:67], v[120:123], v[128:131], a[64:67]
    v_mfma_f32_16x16x32_bf16 a[68:71], v[120:123], v[132:135], a[68:71]
    v_mfma_f32_16x16x32_bf16 a[72:75], v[120:123], v[136:139], a[72:75]
    v_mfma_f32_16x16x32_bf16 a[76:79], v[120:123], v[140:143], a[76:79]
    v_mfma_f32_16x16x32_bf16 a[80:83], v[120:123], v[144:147], a[80:83]
    v_mfma_f32_16x16x32_bf16 a[84:87], v[120:123], v[148:151], a[84:87]
    v_mfma_f32_16x16x32_bf16 a[88:91], v[120:123], v[152:155], a[88:91]
    v_mfma_f32_16x16x32_bf16 a[92:95], v[120:123], v[156:159], a[92:95]
    v_mfma_f32_16x16x32_bf16 a[96:99], v[124:127], v[128:131], a[96:99]
    v_mfma_f32_16x16x32_bf16 a[100:103], v[124:127], v[132:135], a[100:103]
    v_mfma_f32_16x16x32_bf16 a[104:107], v[124:127], v[136:139], a[104:107]
    v_mfma_f32_16x16x32_bf16 a[108:111], v[124:127], v[140:143], a[108:111]
    v_mfma_f32_16x16x32_bf16 a[112:115], v[124:127], v[144:147], a[112:115]
    v_mfma_f32_16x16x32_bf16 a[116:119], v[124:127], v[148:151], a[116:119]
    v_mfma_f32_16x16x32_bf16 a[120:123], v[124:127], v[152:155], a[120:123]
    v_mfma_f32_16x16x32_bf16 a[124:127], v[124:127], v[156:159], a[124:127]
    s_nop 7
    s_setpc_b64 s[80:81]
Lw_att:
    s_lshl_b32 s53, s20, 9
    s_lshl_b32 s54, s22, 5
    s_add_u32 s53, s53, s54
    s_add_u32 s53, s53, 120061952
    s_mov_b32 s54, 0
    v_mov_b32 v2, 0
Lwf_qkv:
    buffer_load_dword v3, v2, s[8:11], s53 offen sc1
    s_waitcnt vmcnt(0)
    v_readfirstlane_b32 s55, v3
    s_and_b32 s55, s55, 65535
    s_cmp_eq_u32 s55, 4104
    s_cbranch_scc1 Lwd_qkv
    s_sleep 4
    s_add_u32 s54, s54, 1
    s_cmp_lt_u32 s54, 2000000
    s_cbranch_scc1 Lwf_qkv
    s_branch Lw_fail
Lwd_qkv:
    s_add_u32 s53, s53, 28
    s_mov_b32 s54, 0
    v_mov_b32 v2, 0
Lwf_qkw:
    buffer_load_dword v3, v2, s[8:11], s53 offen sc1
    s_waitcnt vmcnt(0)
    v_readfirstlane_b32 s55, v3
    s_and_b32 s55, s55, 65535
    s_cmp_eq_u32 s55, 4104
    s_cbranch_scc1 Lwd_qkw
    s_sleep 4
    s_add_u32 s54, s54, 1
    s_cmp_lt_u32 s54, 2000000
    s_cbranch_scc1 Lwf_qkw
    s_branch Lw_fail
Lwd_qkw:
    s_lshl_b32 s35, s46, 15
    v_and_b32 v2, 31, v1
    v_lshrrev_b32 v3, 5, v1
    v_lshlrev_b32 v4, 2, v3
    v_sub_u32 v4, v2, v4
    v_mov_b32 v5, 0xff800000
    v_cmp_gt_i32 vcc, 0, v4
    s_nop 1
    v_cndmask_b32 v160, 0, v5, vcc
    v_cmp_gt_i32 vcc, 1, v4
    s_nop 1
    v_cndmask_b32 v161, 0, v5, vcc
    v_cmp_gt_i32 vcc, 2, v4
    s_nop 1
    v_cndmask_b32 v162, 0, v5, vcc
    v_cmp_gt_i32 vcc, 3, v4
    s_nop 1
    v_cndmask_b32 v163, 0, v5, vcc
    v_cmp_gt_i32 vcc, 8, v4
    s_nop 1
    v_cndmask_b32 v164, 0, v5, vcc
    v_cmp_gt_i32 vcc, 9, v4
    s_nop 1
    v_cndmask_b32 v165, 0, v5, vcc
    v_cmp_gt_i32 vcc, 10, v4
    s_nop 1
    v_cndmask_b32 v166, 0, v5, vcc
    v_cmp_gt_i32 vcc, 11, v4
    s_nop 1
    v_cndmask_b32 v167, 0, v5, vcc
    v_cmp_gt_i32 vcc, 16, v4
    s_nop 1
    v_cndmask_b32 v168, 0, v5, vcc
    v_cmp_gt_i32 vcc, 17, v4
    s_nop 1
    v_cndmask_b32 v169, 0, v5, vcc
    v_cmp_gt_i32 vcc, 18, v4
    s_nop 1
    v_cndmask_b32 v170, 0, v5, vcc
    v_cmp_gt_i32 vcc, 19, v4
    s_nop 1
    v_cndmask_b32 v171, 0, v5, vcc
    v_cmp_gt_i32 vcc, 24, v4
    s_nop 1
    v_cndmask_b32 v172, 0, v5, vcc
    v_cmp_gt_i32 vcc, 25, v4
    s_nop 1
    v_cndmask_b32 v173, 0, v5, vcc
    v_cmp_gt_i32 vcc, 26, v4
    s_nop 1
    v_cndmask_b32 v174, 0, v5, vcc
    v_cmp_gt_i32 vcc, 27, v4
    s_nop 1
    v_cndmask_b32 v175, 0, v5, vcc
    v_lshlrev_b32 v10, 4, v1
    v_add_u32 v11, 4096, v10
    v_add_u32 v15, s35, v10
    v_and_b32 v2, 7, v1
    v_add_u32 v2, 8, v2
    v_lshlrev_b32 v12, 8, v3
    v_lshl_add_u32 v12, v2, 4, v12
    v_add_u32 v12, s35, v12
    v_bfe_u32 v4, v1, 4, 1
    v_bfe_u32 v5, v1, 1, 1
    v_lshl_add_u32 v4, v4, 1, v5
    v_bfe_u32 v5, v1, 2, 2
    v_lshl_add_u32 v5, v3, 2, v5
    v_lshlrev_b32 v5, 4, v5
    v_and_b32 v6, 1, v1
    v_lshl_add_u32 v5, v6, 3, v5
    v_lshl_add_u32 v13, v4, 9, v5
    v_add_u32 v13, s35, v13
    v_lshl_add_u32 v14, v4, 8, v5
    v_add_u32 v14, s35, v14
    s_lshl_b32 s56, s22, 3
    s_lshr_b32 s24, s46, 1
    s_add_u32 s56, s56, s24
    s_and_b32 s26, s46, 1
    s_lshl_b32 s24, s23, 1
    s_add_u32 s26, s26, s24
    s_lshl_b32 s24, s20, 2
    s_add_u32 s24, s24, s26
    s_lshl_b32 s24, s24, 13
    s_lshl_b32 s25, s56, 18
    s_add_u32 s24, s24, s25
    s_add_u32 s30, s24, 4194304
    s_add_u32 s31, s24, 20971520
    s_add_u32 s32, s24, 37748736
    s_add_u32 s34, s24, 71303168
    s_mul_i32 s24, s20, 2883584
    s_lshl_b32 s25, s26, 13
    s_add_u32 s24, s24, s25
    s_lshl_b32 s25, s56, 15
    s_add_u32 s24, s24, s25
    s_add_u32 s33, s24, 92274688
    s_mov_b32 s39, 0x80000
    s_cmp_lt_u32 s21, 14
    s_cbranch_scc1 Lw_on
    s_add_u32 s34, s24, 93061120
    s_mov_b32 s39, 0x10000
Lw_on:
    s_add_u32 s35, s35, 8192
    s_mov_b32 s36, 0x3e0293ee
    s_mov_b32 s38, 0
    s_add_u32 s56, s56, 1
    s_lshl_b32 s53, s20, 7
    s_add_u32 s53, s53, 120074240
    s_mov_b32 s54, 0
    v_mov_b32 v2, 0
Lwf_prog0:
    buffer_load_dword v3, v2, s[8:11], s53 offen sc1
    s_waitcnt vmcnt(0)
    v_readfirstlane_b32 s57, v3
    s_and_b32 s57, s57, 255
    s_cmp_ge_u32 s57, 0
    s_cbranch_scc1 Lwd_prog0
    s_sleep 4
    s_add_u32 s54, s54, 1
    s_cmp_lt_u32 s54, 2000000
    s_cbranch_scc1 Lwf_prog0
    s_branch Lw_fail
Lwd_prog0:
    s_cmp_ge_u32 s21, 14
    s_cbranch_scc1 Lw_nx
    s_mov_b32 s16, s60
    s_mov_b32 s17, s61
    s_mov_b32 s18, 0x400000
    s_mov_b32 s19, 0x20000
    s_lshr_b32 s49, s46, 1
    s_lshl_b32 s49, s49, 18
    s_lshl_b32 s50, s22, 19
    s_add_u32 s49, s49, s50
    s_and_b32 s50, s46, 1
    s_lshl_b32 s50, s50, 7
    s_add_u32 s49, s49, s50
    s_lshl_b32 s50, s20, 8
    s_add_u32 s49, s49, s50
    v_and_b32 v5, 15, v1
    v_lshlrev_b32 v5, 11, v5
    v_add_u32 v5, s49, v5
    v_bfe_u32 v6, v1, 4, 1
    v_lshl_add_u32 v6, v6, 5, v5
    v_lshrrev_b32 v7, 5, v1
    v_lshl_add_u32 v6, v7, 4, v6
    v_lshrrev_b32 v7, 4, v1
    v_lshl_add_u32 v7, v7, 3, v5
    s_lshl_b32 s49, s23, 17
    buffer_load_dwordx2 v[192:193], v7, s[16:19], s49 offen offset:0
    buffer_load_dwordx2 v[194:195], v7, s[16:19], s49 offen offset:32
    buffer_load_dwordx2 v[196:197], v7, s[16:19], s49 offen offset:64
    buffer_load_dwordx2 v[198:199], v7, s[16:19], s49 offen offset:96
    s_add_u32 s49, s49, 0x8000
    buffer_load_dwordx2 v[200:201], v7, s[16:19], s49 offen offset:0
    buffer_load_dwordx2 v[202:203], v7, s[16:19], s49 offen offset:32
    buffer_load_dwordx2 v[204:205], v7, s[16:19], s49 offen offset:64
    buffer_load_dwordx2 v[206:207], v7, s[16:19], s49 offen offset:96
    s_add_u32 s49, s49, 0x8000
    buffer_load_dwordx2 v[208:209], v7, s[16:19], s49 offen offset:0
    buffer_load_dwordx2 v[210:211], v7, s[16:19], s49 offen offset:32
    buffer_load_dwordx2 v[212:213], v7, s[16:19], s49 offen offset:64
    buffer_load_dwordx2 v[214:215], v7, s[16:19], s49 offen offset:96
    s_add_u32 s49, s49, 0x8000
    buffer_load_dwordx2 v[216:217], v7, s[16:19], s49 offen offset:0
    buffer_load_dwordx2 v[218:219], v7, s[16:19], s49 offen offset:32
    buffer_load_dwordx2 v[220:221], v7, s[16:19], s49 offen offset:64
    buffer_load_dwordx2 v[222:223], v7, s[16:19], s49 offen offset:96
    s_add_u32 s49, s49, 0x8000
    s_lshl_b32 s24, s28, 13
    s_add_u32 s24, s24, 115867648
    v_mov_b32 v4, -1
    v_mov_b32 v5, -1
    v_mov_b32 v6, -1
    v_mov_b32 v7, -1
    buffer_store_dwordx4 v[4:7], v10, s[8:11], s24 offen offset:0 sc1
    buffer_store_dwordx4 v[4:7], v10, s[8:11], s24 offen offset:1024 sc1
    buffer_store_dwordx4 v[4:7], v10, s[8:11], s24 offen offset:2048 sc1
    buffer_store_dwordx4 v[4:7], v10, s[8:11], s24 offen offset:3072 sc1
    buffer_store_dwordx4 v[4:7], v11, s[8:11], s24 offen offset:0 sc1
    buffer_store_dwordx4 v[4:7], v11, s[8:11], s24 offen offset:1024 sc1
    buffer_store_dwordx4 v[4:7], v11, s[8:11], s24 offen offset:2048 sc1
    buffer_store_dwordx4 v[4:7], v11, s[8:11], s24 offen offset:3072 sc1
Lw_nx:
    s_cmp_ge_u32 s57, s56
    s_cselect_b32 s58, s33, s31
    buffer_load_dwordx4 v[96:99], v10, s[8:11], s58 offen offset:0 sc1
    buffer_load_dwordx4 v[100:103], v10, s[8:11], s58 offen offset:1024 sc1
    buffer_load_dwordx4 v[104:107], v10, s[8:11], s58 offen offset:2048 sc1
    buffer_load_dwordx4 v[108:111], v10, s[8:11], s58 offen offset:3072 sc1
    buffer_load_dwordx4 v[112:115], v11, s[8:11], s58 offen offset:0 sc1
    buffer_load_dwordx4 v[116:119], v11, s[8:11], s58 offen offset:1024 sc1
    buffer_load_dwordx4 v[120:123], v11, s[8:11], s58 offen offset:2048 sc1
    buffer_load_dwordx4 v[124:127], v11, s[8:11], s58 offen offset:3072 sc1
    buffer_load_dwordx4 v[64:67], v10, s[8:11], s31 offen offset:0 sc1
    buffer_load_dwordx4 v[68:71], v10, s[8:11], s31 offen offset:1024 sc1
    buffer_load_dwordx4 v[72:75], v10, s[8:11], s31 offen offset:2048 sc1
    buffer_load_dwordx4 v[76:79], v10, s[8:11], s31 offen offset:3072 sc1
    buffer_load_dwordx4 v[80:83], v11, s[8:11], s31 offen offset:0 sc1
    buffer_load_dwordx4 v[84:87], v11, s[8:11], s31 offen offset:1024 sc1
    buffer_load_dwordx4 v[88:91], v11, s[8:11], s31 offen offset:2048 sc1
    buffer_load_dwordx4 v[92:95], v11, s[8:11], s31 offen offset:3072 sc1
    s_add_u32 m0, s35, 0
    s_nop 0
    buffer_load_dwordx4 v10, s[8:11], s32 offen offset:0 sc1 lds
    buffer_load_dwordx4 v10, s[8:11], s32 offen offset:1024 sc1 lds
    buffer_load_dwordx4 v10, s[8:11], s32 offen offset:2048 sc1 lds
    buffer_load_dwordx4 v10, s[8:11], s32 offen offset:3072 sc1 lds
    s_add_u32 m0, s35, 4096
    s_nop 0
    buffer_load_dwordx4 v11, s[8:11], s32 offen offset:0 sc1 lds
    buffer_load_dwordx4 v11, s[8:11], s32 offen offset:1024 sc1 lds
    buffer_load_dwordx4 v11, s[8:11], s32 offen offset:2048 sc1 lds
    buffer_load_dwordx4 v11, s[8:11], s32 offen offset:3072 sc1 lds
    s_waitcnt vmcnt(0)
    s_lshl_b32 s24, s28, 2
    s_add_u32 s24, s24, 120072192
    v_mov_b32 v2, 0
    v_mov_b32 v3, 1
    s_mov_b64 exec, 1
    buffer_store_dword v3, v2, s[8:11], s24 offen sc1
    s_mov_b64 exec, -1
Lw_at:
    s_cmp_eq_u32 s38, 1
    s_cbranch_scc1 Lw_q1
    s_cmp_eq_u32 s38, 2
    s_cbranch_scc1 Lw_q2
    v_accvgpr_read_b32 v32, a128
    v_accvgpr_read_b32 v33, a129
    v_accvgpr_read_b32 v34, a130
    v_accvgpr_read_b32 v35, a131
    v_accvgpr_read_b32 v36, a132
    v_accvgpr_read_b32 v37, a133
    v_accvgpr_read_b32 v38, a134
    v_accvgpr_read_b32 v39, a135
    v_accvgpr_read_b32 v40, a136
    v_accvgpr_read_b32 v41, a137
    v_accvgpr_read_b32 v42, a138
    v_accvgpr_read_b32 v43, a139
    v_accvgpr_read_b32 v44, a140
    v_accvgpr_read_b32 v45, a141
    v_accvgpr_read_b32 v46, a142
    v_accvgpr_read_b32 v47, a143
    v_accvgpr_read_b32 v48, a144
    v_accvgpr_read_b32 v49, a145
    v_accvgpr_read_b32 v50, a146
    v_accvgpr_read_b32 v51, a147
    v_accvgpr_read_b32 v52, a148
    v_accvgpr_read_b32 v53, a149
    v_accvgpr_read_b32 v54, a150
    v_accvgpr_read_b32 v55, a151
    v_accvgpr_read_b32 v56, a152
    v_accvgpr_read_b32 v57, a153
    v_accvgpr_read_b32 v58, a154
    v_accvgpr_read_b32 v59, a155
    v_accvgpr_read_b32 v60, a156
    v_accvgpr_read_b32 v61, a157
    v_accvgpr_read_b32 v62, a158
    v_accvgpr_read_b32 v63, a159
    s_branch Lw_q3
Lw_q1:
    v_accvgpr_read_b32 v32, a160
    v_accvgpr_read_b32 v33, a161
    v_accvgpr_read_b32 v34, a162
    v_accvgpr_read_b32 v35, a163
    v_accvgpr_read_b32 v36, a164
    v_accvgpr_read_b32 v37, a165
    v_accvgpr_read_b32 v38, a166
    v_accvgpr_read_b32 v39, a167
    v_accvgpr_read_b32 v40, a168
    v_accvgpr_read_b32 v41, a169
    v_accvgpr_read_b32 v42, a170
    v_accvgpr_read_b32 v43, a171
    v_accvgpr_read_b32 v44, a172
    v_accvgpr_read_b32 v45, a173
    v_accvgpr_read_b32 v46, a174
    v_accvgpr_read_b32 v47, a175
    v_accvgpr_read_b32 v48, a176
    v_accvgpr_read_b32 v49, a177
    v_accvgpr_read_b32 v50, a178
    v_accvgpr_read_b32 v51, a179
    v_accvgpr_read_b32 v52, a180
    v_accvgpr_read_b32 v53, a181
    v_accvgpr_read_b32 v54, a182
    v_accvgpr_read_b32 v55, a183
    v_accvgpr_read_b32 v56, a184
    v_accvgpr_read_b32 v57, a185
    v_accvgpr_read_b32 v58, a186
    v_accvgpr_read_b32 v59, a187
    v_accvgpr_read_b32 v60, a188
    v_accvgpr_read_b32 v61, a189
    v_accvgpr_read_b32 v62, a190
    v_accvgpr_read_b32 v63, a191
    s_branch Lw_q3
Lw_q2:
    v_accvgpr_read_b32 v32, a192
    v_accvgpr_read_b32 v33, a193
    v_accvgpr_read_b32 v34, a194
    v_accvgpr_read_b32 v35, a195
    v_accvgpr_read_b32 v36, a196
    v_accvgpr_read_b32 v37, a197
    v_accvgpr_read_b32 v38, a198
    v_accvgpr_read_b32 v39, a199
    v_accvgpr_read_b32 v40, a200
    v_accvgpr_read_b32 v41, a201
    v_accvgpr_read_b32 v42, a202
    v_accvgpr_read_b32 v43, a203
    v_accvgpr_read_b32 v44, a204
    v_accvgpr_read_b32 v45, a205
    v_accvgpr_read_b32 v46, a206
    v_accvgpr_read_b32 v47, a207
    v_accvgpr_read_b32 v48, a208
    v_accvgpr_read_b32 v49, a209
    v_accvgpr_read_b32 v50, a210
    v_accvgpr_read_b32 v51, a211
    v_accvgpr_read_b32 v52, a212
    v_accvgpr_read_b32 v53, a213
    v_accvgpr_read_b32 v54, a214
    v_accvgpr_read_b32 v55, a215
    v_accvgpr_read_b32 v56, a216
    v_accvgpr_read_b32 v57, a217
    v_accvgpr_read_b32 v58, a218
    v_accvgpr_read_b32 v59, a219
    v_accvgpr_read_b32 v60, a220
    v_accvgpr_read_b32 v61, a221
    v_accvgpr_read_b32 v62, a222
    v_accvgpr_read_b32 v63, a223
Lw_q3:
    s_mov_b32 s37, 0
    s_waitcnt vmcnt(8)
    v_mfma_f32_32x32x16_bf16 v[128:143], v[64:67], v[32:35], v[160:175]
    v_mfma_f32_32x32x16_bf16 v[128:143], v[68:71], v[36:39], v[128:143]
    v_mfma_f32_32x32x16_bf16 v[128:143], v[72:75], v[40:43], v[128:143]
    v_mfma_f32_32x32x16_bf16 v[128:143], v[76:79], v[44:47], v[128:143]
    v_mfma_f32_32x32x16_bf16 v[128:143], v[80:83], v[48:51], v[128:143]
    v_mfma_f32_32x32x16_bf16 v[128:143], v[84:87], v[52:55], v[128:143]
    v_mfma_f32_32x32x16_bf16 v[128:143], v[88:91], v[56:59], v[128:143]
    v_mfma_f32_32x32x16_bf16 v[128:143], v[92:95], v[60:63], v[128:143]
    s_cmp_ge_u32 s57, s56
    s_cbranch_scc1 Lw_rkw
    s_cmp_ge_u32 s21, 12
    s_cbranch_scc1 Lan_w
    s_mov_b32 s54, 0
    v_mov_b32 v2, 0
Lwf_progw:
    buffer_load_dword v3, v2, s[8:11], s53 offen sc1
    s_waitcnt vmcnt(0)
    v_readfirstlane_b32 s57, v3
    s_and_b32 s57, s57, 255
    s_cmp_ge_u32 s57, s56
    s_cbranch_scc1 Lwd_progw
    s_sleep 4
    s_add_u32 s54, s54, 1
    s_cmp_lt_u32 s54, 2000000
    s_cbranch_scc1 Lwf_progw
    s_branch Lw_fail
Lwd_progw:
    s_branch Lar_w
Lw_rkw:
Lam_w:
    v_max_u32 v2, v96, v97
    v_max3_u32 v2, v98, v99, v2
    v_max3_u32 v2, v100, v101, v2
    v_max3_u32 v2, v102, v103, v2
    v_max3_u32 v2, v104, v105, v2
    v_max3_u32 v2, v106, v107, v2
    v_max3_u32 v2, v108, v109, v2
    v_max3_u32 v2, v110, v111, v2
    v_max3_u32 v2, v112, v113, v2
    v_max3_u32 v2, v114, v115, v2
    v_max3_u32 v2, v116, v117, v2
    v_max3_u32 v2, v118, v119, v2
    v_max3_u32 v2, v120, v121, v2
    v_max3_u32 v2, v122, v123, v2
    v_max3_u32 v2, v124, v125, v2
    v_max3_u32 v2, v126, v127, v2
    v_cmp_eq_u32 vcc, -1, v2
    s_cbranch_vccz Lao_w
Lan_w:
    s_add_u32 s37, s37, 1
    s_cmp_ge_u32 s37, 4000000
    s_cbranch_scc1 Lw_fail
    s_mov_b64 exec, 1
    buffer_load_dword v2, v10, s[8:11], s33 offen sc1
    s_waitcnt vmcnt(0)
    v_cmp_eq_u32 vcc, -1, v2
    s_mov_b64 exec, -1
    s_cbranch_vccz Lar_w
    s_sleep 1
    s_branch Lan_w
Lar_w:
    buffer_load_dwordx4 v[96:99], v10, s[8:11], s33 offen offset:0 sc1
    buffer_load_dwordx4 v[100:103], v10, s[8:11], s33 offen offset:1024 sc1
    buffer_load_dwordx4 v[104:107], v10, s[8:11], s33 offen offset:2048 sc1
    buffer_load_dwordx4 v[108:111], v10, s[8:11], s33 offen offset:3072 sc1
    buffer_load_dwordx4 v[112:115], v11, s[8:11], s33 offen offset:0 sc1
    buffer_load_dwordx4 v[116:119], v11, s[8:11], s33 offen offset:1024 sc1
    buffer_load_dwordx4 v[120:123], v11, s[8:11], s33 offen offset:2048 sc1
    buffer_load_dwordx4 v[124:127], v11, s[8:11], s33 offen offset:3072 sc1
    s_waitcnt vmcnt(0)
    s_branch Lam_w
Lao_w:
    ds_write_b128 v15, v[96:99] offset:0
    ds_write_b128 v15, v[100:103] offset:1024
    ds_write_b128 v15, v[104:107] offset:2048
    ds_write_b128 v15, v[108:111] offset:3072
    ds_write_b128 v15, v[112:115] offset:4096
    ds_write_b128 v15, v[116:119] offset:5120
    ds_write_b128 v15, v[120:123] offset:6144
    ds_write_b128 v15, v[124:127] offset:7168
    s_waitcnt lgkmcnt(0)
    ds_read_b128 v[96:99], v12 offset:0
    ds_read_b128 v[100:103], v12 offset:512
    ds_read_b128 v[104:107], v12 offset:1024
    ds_read_b128 v[108:111], v12 offset:1536
    ds_read_b128 v[112:115], v12 offset:2048
    ds_read_b128 v[116:119], v12 offset:2560
    ds_read_b128 v[120:123], v12 offset:3072
    ds_read_b128 v[124:127], v12 offset:3584
    s_waitcnt lgkmcnt(7)
    v_mfma_f32_32x32x16_bf16 v[144:159], v[96:99], v[32:35], 0
    s_waitcnt lgkmcnt(6)
    v_mfma_f32_32x32x16_bf16 v[144:159], v[100:103], v[36:39], v[144:159]
    s_waitcnt lgkmcnt(5)
    v_mfma_f32_32x32x16_bf16 v[144:159], v[104:107], v[40:43], v[144:159]
    s_waitcnt lgkmcnt(4)
    v_mfma_f32_32x32x16_bf16 v[144:159], v[108:111], v[44:47], v[144:159]
    s_waitcnt lgkmcnt(3)
    v_mfma_f32_32x32x16_bf16 v[144:159], v[112:115], v[48:51], v[144:159]
    s_waitcnt lgkmcnt(2)
    v_mfma_f32_32x32x16_bf16 v[144:159], v[116:119], v[52:55], v[144:159]
    s_waitcnt lgkmcnt(1)
    v_mfma_f32_32x32x16_bf16 v[144:159], v[120:123], v[56:59], v[144:159]
    s_waitcnt lgkmcnt(0)
    v_mfma_f32_32x32x16_bf16 v[144:159], v[124:127], v[60:63], v[144:159]
    ds_read_b64_tr_b16 v[16:17], v13 offset:8192
    ds_read_b64_tr_b16 v[18:19], v13 offset:8320
    ds_read_b64_tr_b16 v[20:21], v13 offset:8448
    ds_read_b64_tr_b16 v[22:23], v13 offset:8576
    ds_read_b64_tr_b16 v[28:29], v13 offset:10240
    ds_read_b64_tr_b16 v[30:31], v13 offset:10368
    ds_read_b64_tr_b16 v[32:33], v13 offset:10496
    ds_read_b64_tr_b16 v[34:35], v13 offset:10624
    ds_read_b64_tr_b16 v[40:41], v13 offset:12288
    ds_read_b64_tr_b16 v[42:43], v13 offset:12416
    ds_read_b64_tr_b16 v[44:45], v13 offset:12544
    ds_read_b64_tr_b16 v[46:47], v13 offset:12672
    s_waitcnt lgkmcnt(3)
    ds_read_b64_tr_b16 v[52:53], v13 offset:14336
    ds_read_b64_tr_b16 v[54:55], v13 offset:14464
    ds_read_b64_tr_b16 v[56:57], v13 offset:14592
    ds_read_b64_tr_b16 v[58:59], v13 offset:14720
    ds_read_b64_tr_b16 v[24:25], v14 offset:4096
    ds_read_b64_tr_b16 v[26:27], v14 offset:4224
    ds_read_b64_tr_b16 v[36:37], v14 offset:5120
    ds_read_b64_tr_b16 v[38:39], v14 offset:5248
    ds_read_b64_tr_b16 v[48:49], v14 offset:6144
    ds_read_b64_tr_b16 v[50:51], v14 offset:6272
    ds_read_b64_tr_b16 v[60:61], v14 offset:7168
    ds_read_b64_tr_b16 v[62:63], v14 offset:7296
    s_add_u32 s30, s30, 0x80000
    s_add_u32 s31, s31, 0x80000
    s_add_u32 s32, s32, 0x80000
    s_add_u32 s33, s33, 65536
    s_xor_b32 s35, s35, 0x6000
    s_add_u32 s56, s56, 2
    s_cmp_ge_u32 s57, s56
    s_cselect_b32 s58, s33, s31
    v_xor_b32 v13, 0x2000, v13
    buffer_load_dwordx4 v[96:99], v10, s[8:11], s58 offen offset:0 sc1
    buffer_load_dwordx4 v[100:103], v10, s[8:11], s58 offen offset:1024 sc1
    buffer_load_dwordx4 v[104:107], v10, s[8:11], s58 offen offset:2048 sc1
    buffer_load_dwordx4 v[108:111], v10, s[8:11], s58 offen offset:3072 sc1
    v_max3_f32 v2, v128, v129, v130
    v_max3_f32 v3, v131, v132, v133
    v_max3_f32 v2, v134, v135, v2
    v_max3_f32 v3, v136, v137, v3
    v_max3_f32 v2, v138, v139, v2
    v_max3_f32 v3, v140, v141, v3
    v_max3_f32 v2, v142, v143, v2
    v_max3_f32 v3, v144, v145, v3
    v_max3_f32 v2, v146, v147, v2
    v_max_f32 v2, v2, v3
    v_mov_b32 v3, v2
    s_nop 1
    v_permlane32_swap_b32 v2, v3
    v_max_f32 v2, v2, v3
    v_mul_f32 v2, s36, v2
    v_fma_f32 v128, v128, s36, -v2
    v_fma_f32 v129, v129, s36, -v2
    v_fma_f32 v130, v130, s36, -v2
    v_fma_f32 v131, v131, s36, -v2
    v_fma_f32 v132, v132, s36, -v2
    v_fma_f32 v133, v133, s36, -v2
    v_fma_f32 v134, v134, s36, -v2
    v_fma_f32 v135, v135, s36, -v2
    v_fma_f32 v136, v136, s36, -v2
    v_fma_f32 v137, v137, s36, -v2
    v_fma_f32 v138, v138, s36, -v2
    v_fma_f32 v139, v139, s36, -v2
    v_fma_f32 v140, v140, s36, -v2
    v_fma_f32 v141, v141, s36, -v2
    v_fma_f32 v142, v142, s36, -v2
    v_fma_f32 v143, v143, s36, -v2
    v_fma_f32 v144, v144, s36, -v2
    v_fma_f32 v145, v145, s36, -v2
    v_fma_f32 v146, v146, s36, -v2
    v_fma_f32 v147, v147, s36, -v2
    v_exp_f32 v128, v128
    v_exp_f32 v129, v129
    buffer_load_dwordx4 v[112:115], v11, s[8:11], s58 offen offset:0 sc1
    v_exp_f32 v130, v130
    v_exp_f32 v131, v131
    buffer_load_dwordx4 v[116:119], v11, s[8:11], s58 offen offset:1024 sc1
    v_exp_f32 v132, v132
    v_exp_f32 v133, v133
    buffer_load_dwordx4 v[120:123], v11, s[8:11], s58 offen offset:2048 sc1
    v_exp_f32 v134, v134
    v_exp_f32 v135, v135
    buffer_load_dwordx4 v[124:127], v11, s[8:11], s58 offen offset:3072 sc1
    v_exp_f32 v136, v136
    v_exp_f32 v137, v137
    buffer_load_dwordx4 v[64:67], v10, s[8:11], s31 offen offset:0 sc1
    v_exp_f32 v138, v138
    v_exp_f32 v139, v139
    buffer_load_dwordx4 v[68:71], v10, s[8:11], s31 offen offset:1024 sc1
    v_exp_f32 v140, v140
    v_exp_f32 v141, v141
    buffer_load_dwordx4 v[72:75], v10, s[8:11], s31 offen offset:2048 sc1
    v_exp_f32 v142, v142
    v_exp_f32 v143, v143
    buffer_load_dwordx4 v[76:79], v10, s[8:11], s31 offen offset:3072 sc1
    v_exp_f32 v144, v144
    v_exp_f32 v145, v145
    v_exp_f32 v146, v146
    v_exp_f32 v147, v147
    v_cvt_pk_bf16_f32 v176, v128, v129
    v_cvt_pk_bf16_f32 v177, v130, v131
    v_cvt_pk_bf16_f32 v178, v132, v133
    v_cvt_pk_bf16_f32 v179, v134, v135
    v_cvt_pk_bf16_f32 v180, v136, v137
    v_cvt_pk_bf16_f32 v181, v138, v139
    v_cvt_pk_bf16_f32 v182, v140, v141
    v_cvt_pk_bf16_f32 v183, v142, v143
    v_cvt_pk_bf16_f32 v184, v144, v145
    v_cvt_pk_bf16_f32 v185, v146, v147
    v_cvt_pk_bf16_f32 v186, v144, v145
    v_cvt_pk_bf16_f32 v187, v146, v147
    v_add_f32 v2, v128, v129
    v_add_f32 v3, v130, v131
    v_add_f32 v2, v2, v132
    v_add_f32 v3, v3, v133
    v_add_f32 v2, v2, v134
    v_add_f32 v3, v3, v135
    v_add_f32 v2, v2, v136
    v_add_f32 v3, v3, v137
    v_add_f32 v2, v2, v138
    v_add_f32 v3, v3, v139
    v_add_f32 v2, v2, v140
    v_add_f32 v3, v3, v141
    v_add_f32 v2, v2, v142
    v_add_f32 v3, v3, v143
    v_add_f32 v2, v2, v144
    v_add_f32 v3, v3, v145
    v_add_f32 v2, v2, v146
    v_add_f32 v3, v3, v147
    v_add_f32 v2, v2, v3
    v_mov_b32 v3, v2
    s_nop 1
    v_permlane32_swap_b32 v2, v3
    v_add_f32 v2, v2, v3
    v_rcp_f32 v2, v2
    s_waitcnt lgkmcnt(0)
    v_mov_b32 v3, v2
    v_mfma_f32_32x32x16_bf16 v[224:239], v[16:19], v[176:179], 0
    buffer_load_dwordx4 v[80:83], v11, s[8:11], s31 offen offset:0 sc1
    v_mfma_f32_32x32x16_bf16 v[224:239], v[20:23], v[180:183], v[224:239]
    buffer_load_dwordx4 v[84:87], v11, s[8:11], s31 offen offset:1024 sc1
    v_mfma_f32_32x32x16_bf16 v[224:239], v[24:27], v[184:187], v[224:239]
    buffer_load_dwordx4 v[88:91], v11, s[8:11], s31 offen offset:2048 sc1
    v_mfma_f32_32x32x16_bf16 v[240:255], v[28:31], v[176:179], 0
    buffer_load_dwordx4 v[92:95], v11, s[8:11], s31 offen offset:3072 sc1
    v_mfma_f32_32x32x16_bf16 v[240:255], v[32:35], v[180:183], v[240:255]
    s_add_u32 m0, s35, 0
    s_nop 0
    buffer_load_dwordx4 v10, s[8:11], s32 offen offset:0 sc1 lds
    v_mfma_f32_32x32x16_bf16 v[240:255], v[36:39], v[184:187], v[240:255]
    buffer_load_dwordx4 v10, s[8:11], s32 offen offset:1024 sc1 lds
    v_mfma_f32_32x32x16_bf16 v[128:143], v[40:43], v[176:179], 0
    buffer_load_dwordx4 v10, s[8:11], s32 offen offset:2048 sc1 lds
    v_mfma_f32_32x32x16_bf16 v[128:143], v[44:47], v[180:183], v[128:143]
    buffer_load_dwordx4 v10, s[8:11], s32 offen offset:3072 sc1 lds
    v_mfma_f32_32x32x16_bf16 v[128:143], v[48:51], v[184:187], v[128:143]
    s_add_u32 m0, s35, 4096
    s_nop 0
    buffer_load_dwordx4 v11, s[8:11], s32 offen offset:0 sc1 lds
    v_mfma_f32_32x32x16_bf16 v[144:159], v[52:55], v[176:179], 0
    buffer_load_dwordx4 v11, s[8:11], s32 offen offset:1024 sc1 lds
    v_mfma_f32_32x32x16_bf16 v[144:159], v[56:59], v[180:183], v[144:159]
    buffer_load_dwordx4 v11, s[8:11], s32 offen offset:2048 sc1 lds
    v_mfma_f32_32x32x16_bf16 v[144:159], v[60:63], v[184:187], v[144:159]
    buffer_load_dwordx4 v11, s[8:11], s32 offen offset:3072 sc1 lds
    v_pk_mul_f32 v[224:225], v[224:225], v[2:3]
    v_pk_mul_f32 v[226:227], v[226:227], v[2:3]
    v_pk_mul_f32 v[228:229], v[228:229], v[2:3]
    v_pk_mul_f32 v[230:231], v[230:231], v[2:3]
    v_pk_mul_f32 v[232:233], v[232:233], v[2:3]
    v_pk_mul_f32 v[234:235], v[234:235], v[2:3]
    v_pk_mul_f32 v[236:237], v[236:237], v[2:3]
    v_pk_mul_f32 v[238:239], v[238:239], v[2:3]
    v_cvt_pk_bf16_f32 v16, v224, v225
    v_cvt_pk_bf16_f32 v17, v226, v227
    v_cvt_pk_bf16_f32 v18, v228, v229
    v_cvt_pk_bf16_f32 v19, v230, v231
    v_cvt_pk_bf16_f32 v20, v232, v233
    v_cvt_pk_bf16_f32 v21, v234, v235
    v_cvt_pk_bf16_f32 v22, v236, v237
    v_cvt_pk_bf16_f32 v23, v238, v239
    v_min_u32 v16, -2, v16
    v_min_u32 v17, -2, v17
    v_min_u32 v18, -2, v18
    v_min_u32 v19, -2, v19
    v_min_u32 v20, -2, v20
    v_min_u32 v21, -2, v21
    v_min_u32 v22, -2, v22
    v_min_u32 v23, -2, v23
    s_nop 0
    v_permlane32_swap_b32 v16, v18
    v_permlane32_swap_b32 v17, v19
    v_permlane32_swap_b32 v20, v22
    v_permlane32_swap_b32 v21, v23
    buffer_store_dwordx4 v[16:19], v10, s[8:11], s34 offen offset:0 sc1
    buffer_store_dwordx4 v[20:23], v10, s[8:11], s34 offen offset:1024 sc1
    v_pk_mul_f32 v[240:241], v[240:241], v[2:3]
    v_pk_mul_f32 v[242:243], v[242:243], v[2:3]
    v_pk_mul_f32 v[244:245], v[244:245], v[2:3]
    v_pk_mul_f32 v[246:247], v[246:247], v[2:3]
    v_pk_mul_f32 v[248:249], v[248:249], v[2:3]
    v_pk_mul_f32 v[250:251], v[250:251], v[2:3]
    v_pk_mul_f32 v[252:253], v[252:253], v[2:3]
    v_pk_mul_f32 v[254:255], v[254:255], v[2:3]
    v_cvt_pk_bf16_f32 v24, v240, v241
    v_cvt_pk_bf16_f32 v25, v242, v243
    v_cvt_pk_bf16_f32 v26, v244, v245
    v_cvt_pk_bf16_f32 v27, v246, v247
    v_cvt_pk_bf16_f32 v28, v248, v249
    v_cvt_pk_bf16_f32 v29, v250, v251
    v_cvt_pk_bf16_f32 v30, v252, v253
    v_cvt_pk_bf16_f32 v31, v254, v255
    v_min_u32 v24, -2, v24
    v_min_u32 v25, -2, v25
    v_min_u32 v26, -2, v26
    v_min_u32 v27, -2, v27
    v_min_u32 v28, -2, v28
    v_min_u32 v29, -2, v29
    v_min_u32 v30, -2, v30
    v_min_u32 v31, -2, v31
    s_nop 0
    v_permlane32_swap_b32 v24, v26
    v_permlane32_swap_b32 v25, v27
    v_permlane32_swap_b32 v28, v30
    v_permlane32_swap_b32 v29, v31
    buffer_store_dwordx4 v[24:27], v10, s[8:11], s34 offen offset:2048 sc1
    buffer_store_dwordx4 v[28:31], v10, s[8:11], s34 offen offset:3072 sc1
    v_pk_mul_f32 v[128:129], v[128:129], v[2:3]
    v_pk_mul_f32 v[130:131], v[130:131], v[2:3]
    v_pk_mul_f32 v[132:133], v[132:133], v[2:3]
    v_pk_mul_f32 v[134:135], v[134:135], v[2:3]
    v_pk_mul_f32 v[136:137], v[136:137], v[2:3]
    v_pk_mul_f32 v[138:139], v[138:139], v[2:3]
    v_pk_mul_f32 v[140:141], v[140:141], v[2:3]
    v_pk_mul_f32 v[142:143], v[142:143], v[2:3]
    v_cvt_pk_bf16_f32 v16, v128, v129
    v_cvt_pk_bf16_f32 v17, v130, v131
    v_cvt_pk_bf16_f32 v18, v132, v133
    v_cvt_pk_bf16_f32 v19, v134, v135
    v_cvt_pk_bf16_f32 v20, v136, v137
    v_cvt_pk_bf16_f32 v21, v138, v139
    v_cvt_pk_bf16_f32 v22, v140, v141
    v_cvt_pk_bf16_f32 v23, v142, v143
    v_min_u32 v16, -2, v16
    v_min_u32 v17, -2, v17
    v_min_u32 v18, -2, v18
    v_min_u32 v19, -2, v19
    v_min_u32 v20, -2, v20
    v_min_u32 v21, -2, v21
    v_min_u32 v22, -2, v22
    v_min_u32 v23, -2, v23
    s_nop 0
    v_permlane32_swap_b32 v16, v18
    v_permlane32_swap_b32 v17, v19
    v_permlane32_swap_b32 v20, v22
    v_permlane32_swap_b32 v21, v23
    buffer_store_dwordx4 v[16:19], v11, s[8:11], s34 offen offset:0 sc1
    buffer_store_dwordx4 v[20:23], v11, s[8:11], s34 offen offset:1024 sc1
    v_pk_mul_f32 v[144:145], v[144:145], v[2:3]
    v_pk_mul_f32 v[146:147], v[146:147], v[2:3]
    v_pk_mul_f32 v[148:149], v[148:149], v[2:3]
    v_pk_mul_f32 v[150:151], v[150:151], v[2:3]
    v_pk_mul_f32 v[152:153], v[152:153], v[2:3]
    v_pk_mul_f32 v[154:155], v[154:155], v[2:3]
    v_pk_mul_f32 v[156:157], v[156:157], v[2:3]
    v_pk_mul_f32 v[158:159], v[158:159], v[2:3]
    v_cvt_pk_bf16_f32 v24, v144, v145
    v_cvt_pk_bf16_f32 v25, v146, v147
    v_cvt_pk_bf16_f32 v26, v148, v149
    v_cvt_pk_bf16_f32 v27, v150, v151
    v_cvt_pk_bf16_f32 v28, v152, v153
    v_cvt_pk_bf16_f32 v29, v154, v155
    v_cvt_pk_bf16_f32 v30, v156, v157
    v_cvt_pk_bf16_f32 v31, v158, v159
    v_min_u32 v24, -2, v24
    v_min_u32 v25, -2, v25
    v_min_u32 v26, -2, v26
    v_min_u32 v27, -2, v27
    v_min_u32 v28, -2, v28
    v_min_u32 v29, -2, v29
    v_min_u32 v30, -2, v30
    v_min_u32 v31, -2, v31
    s_nop 0
    v_permlane32_swap_b32 v24, v26
    v_permlane32_swap_b32 v25, v27
    v_permlane32_swap_b32 v28, v30
    v_permlane32_swap_b32 v29, v31
    buffer_store_dwordx4 v[24:27], v11, s[8:11], s34 offen offset:2048 sc1
    buffer_store_dwordx4 v[28:31], v11, s[8:11], s34 offen offset:3072 sc1
    s_add_u32 s34, s34, s39
    s_add_u32 s38, s38, 1
    s_cmp_lt_u32 s38, 3
    s_cbranch_scc1 Lw_at
    v_accvgpr_read_b32 v32, a224
    v_accvgpr_read_b32 v33, a225
    v_accvgpr_read_b32 v34, a226
    v_accvgpr_read_b32 v35, a227
    v_accvgpr_read_b32 v36, a228
    v_accvgpr_read_b32 v37, a229
    v_accvgpr_read_b32 v38, a230
    v_accvgpr_read_b32 v39, a231
    v_accvgpr_read_b32 v40, a232
    v_accvgpr_read_b32 v41, a233
    v_accvgpr_read_b32 v42, a234
    v_accvgpr_read_b32 v43, a235
    v_accvgpr_read_b32 v44, a236
    v_accvgpr_read_b32 v45, a237
    v_accvgpr_read_b32 v46, a238
    v_accvgpr_read_b32 v47, a239
    v_accvgpr_read_b32 v48, a240
    v_accvgpr_read_b32 v49, a241
    v_accvgpr_read_b32 v50, a242
    v_accvgpr_read_b32 v51, a243
    v_accvgpr_read_b32 v52, a244
    v_accvgpr_read_b32 v53, a245
    v_accvgpr_read_b32 v54, a246
    v_accvgpr_read_b32 v55, a247
    v_accvgpr_read_b32 v56, a248
    v_accvgpr_read_b32 v57, a249
    v_accvgpr_read_b32 v58, a250
    v_accvgpr_read_b32 v59, a251
    v_accvgpr_read_b32 v60, a252
    v_accvgpr_read_b32 v61, a253
    v_accvgpr_read_b32 v62, a254
    v_accvgpr_read_b32 v63, a255
    s_mov_b32 s37, 0
    s_waitcnt vmcnt(8)
    v_mfma_f32_32x32x16_bf16 v[128:143], v[64:67], v[32:35], v[160:175]
    v_mfma_f32_32x32x16_bf16 v[128:143], v[68:71], v[36:39], v[128:143]
    v_mfma_f32_32x32x16_bf16 v[128:143], v[72:75], v[40:43], v[128:143]
    v_mfma_f32_32x32x16_bf16 v[128:143], v[76:79], v[44:47], v[128:143]
    v_mfma_f32_32x32x16_bf16 v[128:143], v[80:83], v[48:51], v[128:143]
    v_mfma_f32_32x32x16_bf16 v[128:143], v[84:87], v[52:55], v[128:143]
    v_mfma_f32_32x32x16_bf16 v[128:143], v[88:91], v[56:59], v[128:143]
    v_mfma_f32_32x32x16_bf16 v[128:143], v[92:95], v[60:63], v[128:143]
    s_cmp_ge_u32 s57, s56
    s_cbranch_scc1 Lw_rkz
    s_cmp_ge_u32 s21, 12
    s_cbranch_scc1 Lan_z
    s_mov_b32 s54, 0
    v_mov_b32 v2, 0
Lwf_progz:
    buffer_load_dword v3, v2, s[8:11], s53 offen sc1
    s_waitcnt vmcnt(0)
    v_readfirstlane_b32 s57, v3
    s_and_b32 s57, s57, 255
    s_cmp_ge_u32 s57, s56
    s_cbranch_scc1 Lwd_progz
    s_sleep 4
    s_add_u32 s54, s54, 1
    s_cmp_lt_u32 s54, 2000000
    s_cbranch_scc1 Lwf_progz
    s_branch Lw_fail
Lwd_progz:
    s_branch Lar_z
Lw_rkz:
Lam_z:
    v_max_u32 v2, v96, v97
    v_max3_u32 v2, v98, v99, v2
    v_max3_u32 v2, v100, v101, v2
    v_max3_u32 v2, v102, v103, v2
    v_max3_u32 v2, v104, v105, v2
    v_max3_u32 v2, v106, v107, v2
    v_max3_u32 v2, v108, v109, v2
    v_max3_u32 v2, v110, v111, v2
    v_max3_u32 v2, v112, v113, v2
    v_max3_u32 v2, v114, v115, v2
    v_max3_u32 v2, v116, v117, v2
    v_max3_u32 v2, v118, v119, v2
    v_max3_u32 v2, v120, v121, v2
    v_max3_u32 v2, v122, v123, v2
    v_max3_u32 v2, v124, v125, v2
    v_max3_u32 v2, v126, v127, v2
    v_cmp_eq_u32 vcc, -1, v2
    s_cbranch_vccz Lao_z
Lan_z:
    s_add_u32 s37, s37, 1
    s_cmp_ge_u32 s37, 4000000
    s_cbranch_scc1 Lw_fail
    s_mov_b64 exec, 1
    buffer_load_dword v2, v10, s[8:11], s33 offen sc1
    s_waitcnt vmcnt(0)
    v_cmp_eq_u32 vcc, -1, v2
    s_mov_b64 exec, -1
    s_cbranch_vccz Lar_z
    s_sleep 1
    s_branch Lan_z
Lar_z:
    buffer_load_dwordx4 v[96:99], v10, s[8:11], s33 offen offset:0 sc1
    buffer_load_dwordx4 v[100:103], v10, s[8:11], s33 offen offset:1024 sc1
    buffer_load_dwordx4 v[104:107], v10, s[8:11], s33 offen offset:2048 sc1
    buffer_load_dwordx4 v[108:111], v10, s[8:11], s33 offen offset:3072 sc1
    buffer_load_dwordx4 v[112:115], v11, s[8:11], s33 offen offset:0 sc1
    buffer_load_dwordx4 v[116:119], v11, s[8:11], s33 offen offset:1024 sc1
    buffer_load_dwordx4 v[120:123], v11, s[8:11], s33 offen offset:2048 sc1
    buffer_load_dwordx4 v[124:127], v11, s[8:11], s33 offen offset:3072 sc1
    s_waitcnt vmcnt(0)
    s_branch Lam_z
Lao_z:
    ds_write_b128 v15, v[96:99] offset:0
    ds_write_b128 v15, v[100:103] offset:1024
    ds_write_b128 v15, v[104:107] offset:2048
    ds_write_b128 v15, v[108:111] offset:3072
    ds_write_b128 v15, v[112:115] offset:4096
    ds_write_b128 v15, v[116:119] offset:5120
    ds_write_b128 v15, v[120:123] offset:6144
    ds_write_b128 v15, v[124:127] offset:7168
    s_waitcnt lgkmcnt(0)
    ds_read_b128 v[96:99], v12 offset:0
    ds_read_b128 v[100:103], v12 offset:512
    ds_read_b128 v[104:107], v12 offset:1024
    ds_read_b128 v[108:111], v12 offset:1536
    ds_read_b128 v[112:115], v12 offset:2048
    ds_read_b128 v[116:119], v12 offset:2560
    ds_read_b128 v[120:123], v12 offset:3072
    ds_read_b128 v[124:127], v12 offset:3584
    s_waitcnt lgkmcnt(7)
    v_mfma_f32_32x32x16_bf16 v[144:159], v[96:99], v[32:35], 0
    s_waitcnt lgkmcnt(6)
    v_mfma_f32_32x32x16_bf16 v[144:159], v[100:103], v[36:39], v[144:159]
    s_waitcnt lgkmcnt(5)
    v_mfma_f32_32x32x16_bf16 v[144:159], v[104:107], v[40:43], v[144:159]
    s_waitcnt lgkmcnt(4)
    v_mfma_f32_32x32x16_bf16 v[144:159], v[108:111], v[44:47], v[144:159]
    s_waitcnt lgkmcnt(3)
    v_mfma_f32_32x32x16_bf16 v[144:159], v[112:115], v[48:51], v[144:159]
    s_waitcnt lgkmcnt(2)
    v_mfma_f32_32x32x16_bf16 v[144:159], v[116:119], v[52:55], v[144:159]
    s_waitcnt lgkmcnt(1)
    v_mfma_f32_32x32x16_bf16 v[144:159], v[120:123], v[56:59], v[144:159]
    s_waitcnt lgkmcnt(0)
    v_mfma_f32_32x32x16_bf16 v[144:159], v[124:127], v[60:63], v[144:159]
    ds_read_b64_tr_b16 v[16:17], v13 offset:8192
    ds_read_b64_tr_b16 v[18:19], v13 offset:8320
    ds_read_b64_tr_b16 v[20:21], v13 offset:8448
    ds_read_b64_tr_b16 v[22:23], v13 offset:8576
    ds_read_b64_tr_b16 v[28:29], v13 offset:10240
    ds_read_b64_tr_b16 v[30:31], v13 offset:10368
    ds_read_b64_tr_b16 v[32:33], v13 offset:10496
    ds_read_b64_tr_b16 v[34:35], v13 offset:10624
    ds_read_b64_tr_b16 v[40:41], v13 offset:12288
    ds_read_b64_tr_b16 v[42:43], v13 offset:12416
    ds_read_b64_tr_b16 v[44:45], v13 offset:12544
    ds_read_b64_tr_b16 v[46:47], v13 offset:12672
    s_waitcnt lgkmcnt(3)
    ds_read_b64_tr_b16 v[52:53], v13 offset:14336
    ds_read_b64_tr_b16 v[54:55], v13 offset:14464
    ds_read_b64_tr_b16 v[56:57], v13 offset:14592
    ds_read_b64_tr_b16 v[58:59], v13 offset:14720
    ds_read_b64_tr_b16 v[24:25], v14 offset:4096
    ds_read_b64_tr_b16 v[26:27], v14 offset:4224
    ds_read_b64_tr_b16 v[36:37], v14 offset:5120
    ds_read_b64_tr_b16 v[38:39], v14 offset:5248
    ds_read_b64_tr_b16 v[48:49], v14 offset:6144
    ds_read_b64_tr_b16 v[50:51], v14 offset:6272
    ds_read_b64_tr_b16 v[60:61], v14 offset:7168
    ds_read_b64_tr_b16 v[62:63], v14 offset:7296
    v_max3_f32 v2, v128, v129, v130
    v_max3_f32 v3, v131, v132, v133
    v_max3_f32 v2, v134, v135, v2
    v_max3_f32 v3, v136, v137, v3
    v_max3_f32 v2, v138, v139, v2
    v_max3_f32 v3, v140, v141, v3
    v_max3_f32 v2, v142, v143, v2
    v_max3_f32 v3, v144, v145, v3
    v_max3_f32 v2, v146, v147, v2
    v_max_f32 v2, v2, v3
    v_mov_b32 v3, v2
    s_nop 1
    v_permlane32_swap_b32 v2, v3
    v_max_f32 v2, v2, v3
    v_mul_f32 v2, s36, v2
    v_fma_f32 v128, v128, s36, -v2
    v_fma_f32 v129, v129, s36, -v2
    v_fma_f32 v130, v130, s36, -v2
    v_fma_f32 v131, v131, s36, -v2
    v_fma_f32 v132, v132, s36, -v2
    v_fma_f32 v133, v133, s36, -v2
    v_fma_f32 v134, v134, s36, -v2
    v_fma_f32 v135, v135, s36, -v2
    v_fma_f32 v136, v136, s36, -v2
    v_fma_f32 v137, v137, s36, -v2
    v_fma_f32 v138, v138, s36, -v2
    v_fma_f32 v139, v139, s36, -v2
    v_fma_f32 v140, v140, s36, -v2
    v_fma_f32 v141, v141, s36, -v2
    v_fma_f32 v142, v142, s36, -v2
    v_fma_f32 v143, v143, s36, -v2
    v_fma_f32 v144, v144, s36, -v2
    v_fma_f32 v145, v145, s36, -v2
    v_fma_f32 v146, v146, s36, -v2
    v_fma_f32 v147, v147, s36, -v2
    v_exp_f32 v128, v128
    v_exp_f32 v129, v129
    v_exp_f32 v130, v130
    v_exp_f32 v131, v131
    v_exp_f32 v132, v132
    v_exp_f32 v133, v133
    v_exp_f32 v134, v134
    v_exp_f32 v135, v135
    v_exp_f32 v136, v136
    v_exp_f32 v137, v137
    v_exp_f32 v138, v138
    v_exp_f32 v139, v139
    v_exp_f32 v140, v140
    v_exp_f32 v141, v141
    v_exp_f32 v142, v142
    v_exp_f32 v143, v143
    v_exp_f32 v144, v144
    v_exp_f32 v145, v145
    v_exp_f32 v146, v146
    v_exp_f32 v147, v147
    v_cvt_pk_bf16_f32 v176, v128, v129
    v_cvt_pk_bf16_f32 v177, v130, v131
    v_cvt_pk_bf16_f32 v178, v132, v133
    v_cvt_pk_bf16_f32 v179, v134, v135
    v_cvt_pk_bf16_f32 v180, v136, v137
    v_cvt_pk_bf16_f32 v181, v138, v139
    v_cvt_pk_bf16_f32 v182, v140, v141
    v_cvt_pk_bf16_f32 v183, v142, v143
    v_cvt_pk_bf16_f32 v184, v144, v145
    v_cvt_pk_bf16_f32 v185, v146, v147
    v_cvt_pk_bf16_f32 v186, v144, v145
    v_cvt_pk_bf16_f32 v187, v146, v147
    v_add_f32 v2, v128, v129
    v_add_f32 v3, v130, v131
    v_add_f32 v2, v2, v132
    v_add_f32 v3, v3, v133
    v_add_f32 v2, v2, v134
    v_add_f32 v3, v3, v135
    v_add_f32 v2, v2, v136
    v_add_f32 v3, v3, v137
    v_add_f32 v2, v2, v138
    v_add_f32 v3, v3, v139
    v_add_f32 v2, v2, v140
    v_add_f32 v3, v3, v141
    v_add_f32 v2, v2, v142
    v_add_f32 v3, v3, v143
    v_add_f32 v2, v2, v144
    v_add_f32 v3, v3, v145
    v_add_f32 v2, v2, v146
    v_add_f32 v3, v3, v147
    v_add_f32 v2, v2, v3
    v_mov_b32 v3, v2
    s_nop 1
    v_permlane32_swap_b32 v2, v3
    v_add_f32 v2, v2, v3
    v_rcp_f32 v2, v2
    s_waitcnt lgkmcnt(0)
    v_mov_b32 v3, v2
    v_mfma_f32_32x32x16_bf16 v[224:239], v[16:19], v[176:179], 0
    v_mfma_f32_32x32x16_bf16 v[224:239], v[20:23], v[180:183], v[224:239]
    v_mfma_f32_32x32x16_bf16 v[224:239], v[24:27], v[184:187], v[224:239]
    v_mfma_f32_32x32x16_bf16 v[240:255], v[28:31], v[176:179], 0
    v_mfma_f32_32x32x16_bf16 v[240:255], v[32:35], v[180:183], v[240:255]
    v_mfma_f32_32x32x16_bf16 v[240:255], v[36:39], v[184:187], v[240:255]
    v_mfma_f32_32x32x16_bf16 v[128:143], v[40:43], v[176:179], 0
    v_mfma_f32_32x32x16_bf16 v[128:143], v[44:47], v[180:183], v[128:143]
    v_mfma_f32_32x32x16_bf16 v[128:143], v[48:51], v[184:187], v[128:143]
    v_mfma_f32_32x32x16_bf16 v[144:159], v[52:55], v[176:179], 0
    v_mfma_f32_32x32x16_bf16 v[144:159], v[56:59], v[180:183], v[144:159]
    v_mfma_f32_32x32x16_bf16 v[144:159], v[60:63], v[184:187], v[144:159]
    s_nop 2
    v_pk_mul_f32 v[224:225], v[224:225], v[2:3]
    v_pk_mul_f32 v[226:227], v[226:227], v[2:3]
    v_pk_mul_f32 v[228:229], v[228:229], v[2:3]
    v_pk_mul_f32 v[230:231], v[230:231], v[2:3]
    v_pk_mul_f32 v[232:233], v[232:233], v[2:3]
    v_pk_mul_f32 v[234:235], v[234:235], v[2:3]
    v_pk_mul_f32 v[236:237], v[236:237], v[2:3]
    v_pk_mul_f32 v[238:239], v[238:239], v[2:3]
    v_cvt_pk_bf16_f32 v16, v224, v225
    v_cvt_pk_bf16_f32 v17, v226, v227
    v_cvt_pk_bf16_f32 v18, v228, v229
    v_cvt_pk_bf16_f32 v19, v230, v231
    v_cvt_pk_bf16_f32 v20, v232, v233
    v_cvt_pk_bf16_f32 v21, v234, v235
    v_cvt_pk_bf16_f32 v22, v236, v237
    v_cvt_pk_bf16_f32 v23, v238, v239
    v_min_u32 v16, -2, v16
    v_min_u32 v17, -2, v17
    v_min_u32 v18, -2, v18
    v_min_u32 v19, -2, v19
    v_min_u32 v20, -2, v20
    v_min_u32 v21, -2, v21
    v_min_u32 v22, -2, v22
    v_min_u32 v23, -2, v23
    s_nop 0
    v_permlane32_swap_b32 v16, v18
    v_permlane32_swap_b32 v17, v19
    v_permlane32_swap_b32 v20, v22
    v_permlane32_swap_b32 v21, v23
    buffer_store_dwordx4 v[16:19], v10, s[8:11], s34 offen offset:0 sc1
    buffer_store_dwordx4 v[20:23], v10, s[8:11], s34 offen offset:1024 sc1
    v_pk_mul_f32 v[240:241], v[240:241], v[2:3]
    v_pk_mul_f32 v[242:243], v[242:243], v[2:3]
    v_pk_mul_f32 v[244:245], v[244:245], v[2:3]
    v_pk_mul_f32 v[246:247], v[246:247], v[2:3]
    v_pk_mul_f32 v[248:249], v[248:249], v[2:3]
    v_pk_mul_f32 v[250:251], v[250:251], v[2:3]
    v_pk_mul_f32 v[252:253], v[252:253], v[2:3]
    v_pk_mul_f32 v[254:255], v[254:255], v[2:3]
    v_cvt_pk_bf16_f32 v24, v240, v241
    v_cvt_pk_bf16_f32 v25, v242, v243
    v_cvt_pk_bf16_f32 v26, v244, v245
    v_cvt_pk_bf16_f32 v27, v246, v247
    v_cvt_pk_bf16_f32 v28, v248, v249
    v_cvt_pk_bf16_f32 v29, v250, v251
    v_cvt_pk_bf16_f32 v30, v252, v253
    v_cvt_pk_bf16_f32 v31, v254, v255
    v_min_u32 v24, -2, v24
    v_min_u32 v25, -2, v25
    v_min_u32 v26, -2, v26
    v_min_u32 v27, -2, v27
    v_min_u32 v28, -2, v28
    v_min_u32 v29, -2, v29
    v_min_u32 v30, -2, v30
    v_min_u32 v31, -2, v31
    s_nop 0
    v_permlane32_swap_b32 v24, v26
    v_permlane32_swap_b32 v25, v27
    v_permlane32_swap_b32 v28, v30
    v_permlane32_swap_b32 v29, v31
    buffer_store_dwordx4 v[24:27], v10, s[8:11], s34 offen offset:2048 sc1
    buffer_store_dwordx4 v[28:31], v10, s[8:11], s34 offen offset:3072 sc1
    v_pk_mul_f32 v[128:129], v[128:129], v[2:3]
    v_pk_mul_f32 v[130:131], v[130:131], v[2:3]
    v_pk_mul_f32 v[132:133], v[132:133], v[2:3]
    v_pk_mul_f32 v[134:135], v[134:135], v[2:3]
    v_pk_mul_f32 v[136:137], v[136:137], v[2:3]
    v_pk_mul_f32 v[138:139], v[138:139], v[2:3]
    v_pk_mul_f32 v[140:141], v[140:141], v[2:3]
    v_pk_mul_f32 v[142:143], v[142:143], v[2:3]
    v_cvt_pk_bf16_f32 v16, v128, v129
    v_cvt_pk_bf16_f32 v17, v130, v131
    v_cvt_pk_bf16_f32 v18, v132, v133
    v_cvt_pk_bf16_f32 v19, v134, v135
    v_cvt_pk_bf16_f32 v20, v136, v137
    v_cvt_pk_bf16_f32 v21, v138, v139
    v_cvt_pk_bf16_f32 v22, v140, v141
    v_cvt_pk_bf16_f32 v23, v142, v143
    v_min_u32 v16, -2, v16
    v_min_u32 v17, -2, v17
    v_min_u32 v18, -2, v18
    v_min_u32 v19, -2, v19
    v_min_u32 v20, -2, v20
    v_min_u32 v21, -2, v21
    v_min_u32 v22, -2, v22
    v_min_u32 v23, -2, v23
    s_nop 0
    v_permlane32_swap_b32 v16, v18
    v_permlane32_swap_b32 v17, v19
    v_permlane32_swap_b32 v20, v22
    v_permlane32_swap_b32 v21, v23
    buffer_store_dwordx4 v[16:19], v11, s[8:11], s34 offen offset:0 sc1
    buffer_store_dwordx4 v[20:23], v11, s[8:11], s34 offen offset:1024 sc1
    v_pk_mul_f32 v[144:145], v[144:145], v[2:3]
    v_pk_mul_f32 v[146:147], v[146:147], v[2:3]
    v_pk_mul_f32 v[148:149], v[148:149], v[2:3]
    v_pk_mul_f32 v[150:151], v[150:151], v[2:3]
    v_pk_mul_f32 v[152:153], v[152:153], v[2:3]
    v_pk_mul_f32 v[154:155], v[154:155], v[2:3]
    v_pk_mul_f32 v[156:157], v[156:157], v[2:3]
    v_pk_mul_f32 v[158:159], v[158:159], v[2:3]
    v_cvt_pk_bf16_f32 v24, v144, v145
    v_cvt_pk_bf16_f32 v25, v146, v147
    v_cvt_pk_bf16_f32 v26, v148, v149
    v_cvt_pk_bf16_f32 v27, v150, v151
    v_cvt_pk_bf16_f32 v28, v152, v153
    v_cvt_pk_bf16_f32 v29, v154, v155
    v_cvt_pk_bf16_f32 v30, v156, v157
    v_cvt_pk_bf16_f32 v31, v158, v159
    v_min_u32 v24, -2, v24
    v_min_u32 v25, -2, v25
    v_min_u32 v26, -2, v26
    v_min_u32 v27, -2, v27
    v_min_u32 v28, -2, v28
    v_min_u32 v29, -2, v29
    v_min_u32 v30, -2, v30
    v_min_u32 v31, -2, v31
    s_nop 0
    v_permlane32_swap_b32 v24, v26
    v_permlane32_swap_b32 v25, v27
    v_permlane32_swap_b32 v28, v30
    v_permlane32_swap_b32 v29, v31
    buffer_store_dwordx4 v[24:27], v11, s[8:11], s34 offen offset:2048 sc1
    buffer_store_dwordx4 v[28:31], v11, s[8:11], s34 offen offset:3072 sc1
    s_cmp_ge_u32 s21, 14
    s_cbranch_scc1 Lw_ar
    s_and_b32 s53, s21, 14
    s_lshr_b32 s54, s20, 2
    s_add_u32 s53, s53, s54
    s_lshl_b32 s53, s53, 7
    s_add_u32 s53, s53, 120070144
    s_mov_b32 s54, 1
    s_waitcnt vmcnt(0)
    s_barrier
    s_cmp_lg_u32 s46, 0
    s_cbranch_scc1 Lsg_o
    v_mov_b32 v2, 0
    v_mov_b32 v3, s54
    s_mov_b64 exec, 1
    buffer_atomic_add v3, v2, s[8:11], s53 offen sc1
    s_mov_b64 exec, -1
Lsg_o:
Lw_ar:
    s_setpc_b64 s[62:63]
Lw_spro:
    s_cmp_eq_u32 s37, 1
    s_cselect_b64 s[24:25], s[66:67], s[64:65]
    s_cmp_eq_u32 s37, 2
    s_cselect_b64 s[24:25], s[68:69], s[24:25]
    s_mov_b32 s12, s24
    s_mov_b32 s13, s25
    s_mov_b32 s14, 0x800000
    s_mov_b32 s15, 0x20000
    s_lshl_b32 s41, s38, 8
    s_lshl_b32 s40, s36, 18
    s_add_u32 s40, s40, 0
    s_mov_b32 s42, 65536
    s_mov_b32 s44, 4
    s_lshr_b32 s49, s46, 1
    s_lshl_b32 s49, s49, 13
    v_lshrrev_b32 v2, 4, v1
    v_and_b32 v3, 15, v1
    v_lshlrev_b32 v4, 9, v2
    v_lshl_add_u32 v4, v3, 4, v4
    v_add_u32 v16, s49, v4
    v_add_u32 v17, 0x10000, v16
    v_lshrrev_b32 v4, 2, v3
    v_lshl_add_u32 v6, v2, 3, v4
    v_lshlrev_b32 v6, 8, v6
    v_and_b32 v7, 3, v3
    v_lshl_add_u32 v6, v7, 3, v6
    v_and_b32 v7, 1, v2
    v_lshl_add_u32 v4, v7, 2, v4
    v_lshl_add_u32 v6, v4, 5, v6
    v_add_u32 v6, 16384, v6
    s_and_b32 s49, s46, 1
    s_lshl_b32 s49, s49, 7
    v_xor_b32 v6, s49, v6
    v_xor_b32 v24, 0, v6
    v_add_u32 v28, 0x10000, v24
    v_xor_b32 v25, 32, v6
    v_add_u32 v29, 0x10000, v25
    v_xor_b32 v26, 64, v6
    v_add_u32 v30, 0x10000, v26
    v_xor_b32 v27, 96, v6
    v_add_u32 v31, 0x10000, v27
    s_lshl_b32 s49, s46, 4
    v_lshlrev_b32 v4, 1, v2
    v_xor_b32 v3, v3, v4
    v_add_u32 v2, s49, v2
    v_lshlrev_b32 v2, 13, v2
    v_lshl_add_u32 v20, v3, 4, v2
    v_xor_b32 v2, 128, v20
    v_add_u32 v21, 31744, v20
    v_add_u32 v22, 63488, v2
    v_add_u32 v23, 95232, v2
    s_lshl_b32 s47, s46, 12
    s_add_u32 s48, s47, 16384
    s_mul_i32 s49, s46, s42
    v_lshl_add_u32 v18, v1, 4, s49
    s_add_u32 m0, s47, 0
    s_nop 0
    buffer_load_dwordx4 v18, s[8:11], s40 offen offset:0 sc1 lds
    buffer_load_dwordx4 v18, s[8:11], s40 offen offset:1024 sc1 lds
    buffer_load_dwordx4 v18, s[8:11], s40 offen offset:2048 sc1 lds
    buffer_load_dwordx4 v18, s[8:11], s40 offen offset:3072 sc1 lds
    s_add_u32 s40, s40, 4096
    s_add_u32 m0, s48, 0
    s_nop 0
    buffer_load_dwordx4 v20, s[12:15], s41 offen offset:0 lds
    buffer_load_dwordx4 v21, s[12:15], s41 offen offset:1024 lds
    buffer_load_dwordx4 v22, s[12:15], s41 offen offset:2048 lds
    buffer_load_dwordx4 v23, s[12:15], s41 offen offset:3072 lds
    s_add_u32 s41, s41, 524288
    s_add_u32 m0, s47, 32768
    s_nop 0
    buffer_load_dwordx4 v18, s[8:11], s40 offen offset:0 sc1 lds
    buffer_load_dwordx4 v18, s[8:11], s40 offen offset:1024 sc1 lds
    buffer_load_dwordx4 v18, s[8:11], s40 offen offset:2048 sc1 lds
    buffer_load_dwordx4 v18, s[8:11], s40 offen offset:3072 sc1 lds
    s_add_u32 s40, s40, 4096
    s_add_u32 m0, s48, 32768
    s_nop 0
    buffer_load_dwordx4 v20, s[12:15], s41 offen offset:0 lds
    buffer_load_dwordx4 v21, s[12:15], s41 offen offset:1024 lds
    buffer_load_dwordx4 v22, s[12:15], s41 offen offset:2048 lds
    buffer_load_dwordx4 v23, s[12:15], s41 offen offset:3072 lds
    s_add_u32 s41, s41, 524288
    s_add_u32 m0, s47, 65536
    s_nop 0
    buffer_load_dwordx4 v18, s[8:11], s40 offen offset:0 sc1 lds
    buffer_load_dwordx4 v18, s[8:11], s40 offen offset:1024 sc1 lds
    buffer_load_dwordx4 v18, s[8:11], s40 offen offset:2048 sc1 lds
    buffer_load_dwordx4 v18, s[8:11], s40 offen offset:3072 sc1 lds
    s_add_u32 s40, s40, 4096
    s_add_u32 m0, s48, 65536
    s_nop 0
    buffer_load_dwordx4 v20, s[12:15], s41 offen offset:0 lds
    buffer_load_dwordx4 v21, s[12:15], s41 offen offset:1024 lds
    buffer_load_dwordx4 v22, s[12:15], s41 offen offset:2048 lds
    buffer_load_dwordx4 v23, s[12:15], s41 offen offset:3072 lds
    s_add_u32 s41, s41, 524288
    s_add_u32 m0, s47, 98304
    s_nop 0
    buffer_load_dwordx4 v18, s[8:11], s40 offen offset:0 sc1 lds
    buffer_load_dwordx4 v18, s[8:11], s40 offen offset:1024 sc1 lds
    buffer_load_dwordx4 v18, s[8:11], s40 offen offset:2048 sc1 lds
    buffer_load_dwordx4 v18, s[8:11], s40 offen offset:3072 sc1 lds
    s_add_u32 s40, s40, 4096
    v_mov_b32 v128, 0
    v_mov_b32 v129, 0
    v_mov_b32 v130, 0
    v_mov_b32 v131, 0
    v_mov_b32 v132, 0
    v_mov_b32 v133, 0
    v_mov_b32 v134, 0
    v_mov_b32 v135, 0
    v_mov_b32 v136, 0
    v_mov_b32 v137, 0
    v_mov_b32 v138, 0
    v_mov_b32 v139, 0
    v_mov_b32 v140, 0
    v_mov_b32 v141, 0
    v_mov_b32 v142, 0
    v_mov_b32 v143, 0
    v_mov_b32 v144, 0
    v_mov_b32 v145, 0
    v_mov_b32 v146, 0
    v_mov_b32 v147, 0
    v_mov_b32 v148, 0
    v_mov_b32 v149, 0
    v_mov_b32 v150, 0
    v_mov_b32 v151, 0
    v_mov_b32 v152, 0
    v_mov_b32 v153, 0
    v_mov_b32 v154, 0
    v_mov_b32 v155, 0
    v_mov_b32 v156, 0
    v_mov_b32 v157, 0
    v_mov_b32 v158, 0
    v_mov_b32 v159, 0
    v_mov_b32 v160, 0
    v_mov_b32 v161, 0
    v_mov_b32 v162, 0
    v_mov_b32 v163, 0
    v_mov_b32 v164, 0
    v_mov_b32 v165, 0
    v_mov_b32 v166, 0
    v_mov_b32 v167, 0
    v_mov_b32 v168, 0
    v_mov_b32 v169, 0
    v_mov_b32 v170, 0
    v_mov_b32 v171, 0
    v_mov_b32 v172, 0
    v_mov_b32 v173, 0
    v_mov_b32 v174, 0
    v_mov_b32 v175, 0
    v_mov_b32 v176, 0
    v_mov_b32 v177, 0
    v_mov_b32 v178, 0
    v_mov_b32 v179, 0
    v_mov_b32 v180, 0
    v_mov_b32 v181, 0
    v_mov_b32 v182, 0
    v_mov_b32 v183, 0
    v_mov_b32 v184, 0
    v_mov_b32 v185, 0
    v_mov_b32 v186, 0
    v_mov_b32 v187, 0
    v_mov_b32 v188, 0
    v_mov_b32 v189, 0
    v_mov_b32 v190, 0
    v_mov_b32 v191, 0
    s_setpc_b64 s[62:63]
Lw_srun:
    s_waitcnt vmcnt(20)
    s_barrier
    ds_read_b128 v[80:83], v16 offset:0
    ds_read_b64_tr_b16 v[64:65], v24 offset:0
    ds_read_b64_tr_b16 v[66:67], v24 offset:1024
    ds_read_b128 v[84:87], v16 offset:256
    ds_read_b64_tr_b16 v[68:69], v25 offset:0
    ds_read_b64_tr_b16 v[70:71], v25 offset:1024
    ds_read_b128 v[88:91], v16 offset:4096
    ds_read_b64_tr_b16 v[72:73], v26 offset:0
    ds_read_b64_tr_b16 v[74:75], v26 offset:1024
    ds_read_b128 v[92:95], v16 offset:4352
    ds_read_b64_tr_b16 v[76:77], v27 offset:0
    ds_read_b64_tr_b16 v[78:79], v27 offset:1024
    s_waitcnt lgkmcnt(0)
    s_sub_u32 s44, s44, 1
Lh_loop_s:
    s_add_u32 m0, s48, 98304
    v_mfma_f32_16x16x32_bf16 v[128:131], v[64:67], v[80:83], v[128:131]
    ds_read_b128 v[112:115], v16 offset:2048
    ds_read_b64_tr_b16 v[96:97], v24 offset:8192
    v_mfma_f32_16x16x32_bf16 v[132:135], v[64:67], v[84:87], v[132:135]
    ds_read_b64_tr_b16 v[98:99], v24 offset:9216
    ds_read_b128 v[116:119], v16 offset:2304
    v_mfma_f32_16x16x32_bf16 v[136:139], v[64:67], v[88:91], v[136:139]
    ds_read_b64_tr_b16 v[100:101], v25 offset:8192
    ds_read_b64_tr_b16 v[102:103], v25 offset:9216
    v_mfma_f32_16x16x32_bf16 v[140:143], v[64:67], v[92:95], v[140:143]
    ds_read_b128 v[120:123], v16 offset:6144
    ds_read_b64_tr_b16 v[104:105], v26 offset:8192
    v_mfma_f32_16x16x32_bf16 v[144:147], v[68:71], v[80:83], v[144:147]
    ds_read_b64_tr_b16 v[106:107], v26 offset:9216
    ds_read_b128 v[124:127], v16 offset:6400
    v_mfma_f32_16x16x32_bf16 v[148:151], v[68:71], v[84:87], v[148:151]
    ds_read_b64_tr_b16 v[108:109], v27 offset:8192
    ds_read_b64_tr_b16 v[110:111], v27 offset:9216
    v_mfma_f32_16x16x32_bf16 v[152:155], v[68:71], v[88:91], v[152:155]
    buffer_load_dwordx4 v20, s[12:15], s41 offen offset:0 lds
    v_mfma_f32_16x16x32_bf16 v[156:159], v[68:71], v[92:95], v[156:159]
    v_mfma_f32_16x16x32_bf16 v[160:163], v[72:75], v[80:83], v[160:163]
    buffer_load_dwordx4 v21, s[12:15], s41 offen offset:1024 lds
    v_mfma_f32_16x16x32_bf16 v[164:167], v[72:75], v[84:87], v[164:167]
    v_mfma_f32_16x16x32_bf16 v[168:171], v[72:75], v[88:91], v[168:171]
    buffer_load_dwordx4 v22, s[12:15], s41 offen offset:2048 lds
    v_mfma_f32_16x16x32_bf16 v[172:175], v[72:75], v[92:95], v[172:175]
    v_mfma_f32_16x16x32_bf16 v[176:179], v[76:79], v[80:83], v[176:179]
    buffer_load_dwordx4 v23, s[12:15], s41 offen offset:3072 lds
    s_add_u32 s41, s41, 524288
    v_mfma_f32_16x16x32_bf16 v[180:183], v[76:79], v[84:87], v[180:183]
    v_mfma_f32_16x16x32_bf16 v[184:187], v[76:79], v[88:91], v[184:187]
    v_mfma_f32_16x16x32_bf16 v[188:191], v[76:79], v[92:95], v[188:191]
    s_waitcnt vmcnt(16) lgkmcnt(0)
    s_barrier
    s_add_u32 m0, s47, 0
    v_mfma_f32_16x16x32_bf16 v[128:131], v[96:99], v[112:115], v[128:131]
    ds_read_b128 v[80:83], v16 offset:32768
    ds_read_b64_tr_b16 v[64:65], v24 offset:32768
    v_mfma_f32_16x16x32_bf16 v[132:135], v[96:99], v[116:119], v[132:135]
    ds_read_b64_tr_b16 v[66:67], v24 offset:33792
    ds_read_b128 v[84:87], v16 offset:33024
    v_mfma_f32_16x16x32_bf16 v[136:139], v[96:99], v[120:123], v[136:139]
    ds_read_b64_tr_b16 v[68:69], v25 offset:32768
    ds_read_b64_tr_b16 v[70:71], v25 offset:33792
    v_mfma_f32_16x16x32_bf16 v[140:143], v[96:99], v[124:127], v[140:143]
    ds_read_b128 v[88:91], v16 offset:36864
    ds_read_b64_tr_b16 v[72:73], v26 offset:32768
    v_mfma_f32_16x16x32_bf16 v[144:147], v[100:103], v[112:115], v[144:147]
    ds_read_b64_tr_b16 v[74:75], v26 offset:33792
    ds_read_b128 v[92:95], v16 offset:37120
    v_mfma_f32_16x16x32_bf16 v[148:151], v[100:103], v[116:119], v[148:151]
    ds_read_b64_tr_b16 v[76:77], v27 offset:32768
    ds_read_b64_tr_b16 v[78:79], v27 offset:33792
    v_mfma_f32_16x16x32_bf16 v[152:155], v[100:103], v[120:123], v[152:155]
    buffer_load_dwordx4 v18, s[8:11], s40 offen offset:0 sc1 lds
    v_mfma_f32_16x16x32_bf16 v[156:159], v[100:103], v[124:127], v[156:159]
    v_mfma_f32_16x16x32_bf16 v[160:163], v[104:107], v[112:115], v[160:163]
    buffer_load_dwordx4 v18, s[8:11], s40 offen offset:1024 sc1 lds
    v_mfma_f32_16x16x32_bf16 v[164:167], v[104:107], v[116:119], v[164:167]
    v_mfma_f32_16x16x32_bf16 v[168:171], v[104:107], v[120:123], v[168:171]
    buffer_load_dwordx4 v18, s[8:11], s40 offen offset:2048 sc1 lds
    v_mfma_f32_16x16x32_bf16 v[172:175], v[104:107], v[124:127], v[172:175]
    v_mfma_f32_16x16x32_bf16 v[176:179], v[108:111], v[112:115], v[176:179]
    buffer_load_dwordx4 v18, s[8:11], s40 offen offset:3072 sc1 lds
    s_add_u32 s40, s40, 4096
    v_mfma_f32_16x16x32_bf16 v[180:183], v[108:111], v[116:119], v[180:183]
    v_mfma_f32_16x16x32_bf16 v[184:187], v[108:111], v[120:123], v[184:187]
    v_mfma_f32_16x16x32_bf16 v[188:191], v[108:111], v[124:127], v[188:191]
    s_waitcnt lgkmcnt(0)
    s_add_u32 m0, s48, 0
    v_mfma_f32_16x16x32_bf16 v[128:131], v[64:67], v[80:83], v[128:131]
    ds_read_b128 v[112:115], v16 offset:34816
    ds_read_b64_tr_b16 v[96:97], v24 offset:40960
    v_mfma_f32_16x16x32_bf16 v[132:135], v[64:67], v[84:87], v[132:135]
    ds_read_b64_tr_b16 v[98:99], v24 offset:41984
    ds_read_b128 v[116:119], v16 offset:35072
    v_mfma_f32_16x16x32_bf16 v[136:139], v[64:67], v[88:91], v[136:139]
    ds_read_b64_tr_b16 v[100:101], v25 offset:40960
    ds_read_b64_tr_b16 v[102:103], v25 offset:41984
    v_mfma_f32_16x16x32_bf16 v[140:143], v[64:67], v[92:95], v[140:143]
    ds_read_b128 v[120:123], v16 offset:38912
    ds_read_b64_tr_b16 v[104:105], v26 offset:40960
    v_mfma_f32_16x16x32_bf16 v[144:147], v[68:71], v[80:83], v[144:147]
    ds_read_b64_tr_b16 v[106:107], v26 offset:41984
    ds_read_b128 v[124:127], v16 offset:39168
    v_mfma_f32_16x16x32_bf16 v[148:151], v[68:71], v[84:87], v[148:151]
    ds_read_b64_tr_b16 v[108:109], v27 offset:40960
    ds_read_b64_tr_b16 v[110:111], v27 offset:41984
    v_mfma_f32_16x16x32_bf16 v[152:155], v[68:71], v[88:91], v[152:155]
    buffer_load_dwordx4 v20, s[12:15], s41 offen offset:0 lds
    v_mfma_f32_16x16x32_bf16 v[156:159], v[68:71], v[92:95], v[156:159]
    v_mfma_f32_16x16x32_bf16 v[160:163], v[72:75], v[80:83], v[160:163]
    buffer_load_dwordx4 v21, s[12:15], s41 offen offset:1024 lds
    v_mfma_f32_16x16x32_bf16 v[164:167], v[72:75], v[84:87], v[164:167]
    v_mfma_f32_16x16x32_bf16 v[168:171], v[72:75], v[88:91], v[168:171]
    buffer_load_dwordx4 v22, s[12:15], s41 offen offset:2048 lds
    v_mfma_f32_16x16x32_bf16 v[172:175], v[72:75], v[92:95], v[172:175]
    v_mfma_f32_16x16x32_bf16 v[176:179], v[76:79], v[80:83], v[176:179]
    buffer_load_dwordx4 v23, s[12:15], s41 offen offset:3072 lds
    s_add_u32 s41, s41, 524288
    v_mfma_f32_16x16x32_bf16 v[180:183], v[76:79], v[84:87], v[180:183]
    v_mfma_f32_16x16x32_bf16 v[184:187], v[76:79], v[88:91], v[184:187]
    v_mfma_f32_16x16x32_bf16 v[188:191], v[76:79], v[92:95], v[188:191]
    s_waitcnt vmcnt(16) lgkmcnt(0)
    s_barrier
    s_add_u32 m0, s47, 32768
    v_mfma_f32_16x16x32_bf16 v[128:131], v[96:99], v[112:115], v[128:131]
    ds_read_b128 v[80:83], v17 offset:0
    ds_read_b64_tr_b16 v[64:65], v28 offset:0
    v_mfma_f32_16x16x32_bf16 v[132:135], v[96:99], v[116:119], v[132:135]
    ds_read_b64_tr_b16 v[66:67], v28 offset:1024
    ds_read_b128 v[84:87], v17 offset:256
    v_mfma_f32_16x16x32_bf16 v[136:139], v[96:99], v[120:123], v[136:139]
    ds_read_b64_tr_b16 v[68:69], v29 offset:0
    ds_read_b64_tr_b16 v[70:71], v29 offset:1024
    v_mfma_f32_16x16x32_bf16 v[140:143], v[96:99], v[124:127], v[140:143]
    ds_read_b128 v[88:91], v17 offset:4096
    ds_read_b64_tr_b16 v[72:73], v30 offset:0
    v_mfma_f32_16x16x32_bf16 v[144:147], v[100:103], v[112:115], v[144:147]
    ds_read_b64_tr_b16 v[74:75], v30 offset:1024
    ds_read_b128 v[92:95], v17 offset:4352
    v_mfma_f32_16x16x32_bf16 v[148:151], v[100:103], v[116:119], v[148:151]
    ds_read_b64_tr_b16 v[76:77], v31 offset:0
    ds_read_b64_tr_b16 v[78:79], v31 offset:1024
    v_mfma_f32_16x16x32_bf16 v[152:155], v[100:103], v[120:123], v[152:155]
    buffer_load_dwordx4 v18, s[8:11], s40 offen offset:0 sc1 lds
    v_mfma_f32_16x16x32_bf16 v[156:159], v[100:103], v[124:127], v[156:159]
    v_mfma_f32_16x16x32_bf16 v[160:163], v[104:107], v[112:115], v[160:163]
    buffer_load_dwordx4 v18, s[8:11], s40 offen offset:1024 sc1 lds
    v_mfma_f32_16x16x32_bf16 v[164:167], v[104:107], v[116:119], v[164:167]
    v_mfma_f32_16x16x32_bf16 v[168:171], v[104:107], v[120:123], v[168:171]
    buffer_load_dwordx4 v18, s[8:11], s40 offen offset:2048 sc1 lds
    v_mfma_f32_16x16x32_bf16 v[172:175], v[104:107], v[124:127], v[172:175]
    v_mfma_f32_16x16x32_bf16 v[176:179], v[108:111], v[112:115], v[176:179]
    buffer_load_dwordx4 v18, s[8:11], s40 offen offset:3072 sc1 lds
    s_add_u32 s40, s40, 4096
    v_mfma_f32_16x16x32_bf16 v[180:183], v[108:111], v[116:119], v[180:183]
    v_mfma_f32_16x16x32_bf16 v[184:187], v[108:111], v[120:123], v[184:187]
    v_mfma_f32_16x16x32_bf16 v[188:191], v[108:111], v[124:127], v[188:191]
    s_waitcnt lgkmcnt(0)
    s_add_u32 m0, s48, 32768
    v_mfma_f32_16x16x32_bf16 v[128:131], v[64:67], v[80:83], v[128:131]
    ds_read_b128 v[112:115], v17 offset:2048
    ds_read_b64_tr_b16 v[96:97], v28 offset:8192
    v_mfma_f32_16x16x32_bf16 v[132:135], v[64:67], v[84:87], v[132:135]
    ds_read_b64_tr_b16 v[98:99], v28 offset:9216
    ds_read_b128 v[116:119], v17 offset:2304
    v_mfma_f32_16x16x32_bf16 v[136:139], v[64:67], v[88:91], v[136:139]
    ds_read_b64_tr_b16 v[100:101], v29 offset:8192
    ds_read_b64_tr_b16 v[102:103], v29 offset:9216
    v_mfma_f32_16x16x32_bf16 v[140:143], v[64:67], v[92:95], v[140:143]
    ds_read_b128 v[120:123], v17 offset:6144
    ds_read_b64_tr_b16 v[104:105], v30 offset:8192
    v_mfma_f32_16x16x32_bf16 v[144:147], v[68:71], v[80:83], v[144:147]
    ds_read_b64_tr_b16 v[106:107], v30 offset:9216
    ds_read_b128 v[124:127], v17 offset:6400
    v_mfma_f32_16x16x32_bf16 v[148:151], v[68:71], v[84:87], v[148:151]
    ds_read_b64_tr_b16 v[108:109], v31 offset:8192
    ds_read_b64_tr_b16 v[110:111], v31 offset:9216
    v_mfma_f32_16x16x32_bf16 v[152:155], v[68:71], v[88:91], v[152:155]
    buffer_load_dwordx4 v20, s[12:15], s41 offen offset:0 lds
    v_mfma_f32_16x16x32_bf16 v[156:159], v[68:71], v[92:95], v[156:159]
    v_mfma_f32_16x16x32_bf16 v[160:163], v[72:75], v[80:83], v[160:163]
    buffer_load_dwordx4 v21, s[12:15], s41 offen offset:1024 lds
    v_mfma_f32_16x16x32_bf16 v[164:167], v[72:75], v[84:87], v[164:167]
    v_mfma_f32_16x16x32_bf16 v[168:171], v[72:75], v[88:91], v[168:171]
    buffer_load_dwordx4 v22, s[12:15], s41 offen offset:2048 lds
    v_mfma_f32_16x16x32_bf16 v[172:175], v[72:75], v[92:95], v[172:175]
    v_mfma_f32_16x16x32_bf16 v[176:179], v[76:79], v[80:83], v[176:179]
    buffer_load_dwordx4 v23, s[12:15], s41 offen offset:3072 lds
    s_add_u32 s41, s41, 524288
    v_mfma_f32_16x16x32_bf16 v[180:183], v[76:79], v[84:87], v[180:183]
    v_mfma_f32_16x16x32_bf16 v[184:187], v[76:79], v[88:91], v[184:187]
    v_mfma_f32_16x16x32_bf16 v[188:191], v[76:79], v[92:95], v[188:191]
    s_waitcnt vmcnt(16) lgkmcnt(0)
    s_barrier
    s_add_u32 m0, s47, 65536
    v_mfma_f32_16x16x32_bf16 v[128:131], v[96:99], v[112:115], v[128:131]
    ds_read_b128 v[80:83], v17 offset:32768
    ds_read_b64_tr_b16 v[64:65], v28 offset:32768
    v_mfma_f32_16x16x32_bf16 v[132:135], v[96:99], v[116:119], v[132:135]
    ds_read_b64_tr_b16 v[66:67], v28 offset:33792
    ds_read_b128 v[84:87], v17 offset:33024
    v_mfma_f32_16x16x32_bf16 v[136:139], v[96:99], v[120:123], v[136:139]
    ds_read_b64_tr_b16 v[68:69], v29 offset:32768
    ds_read_b64_tr_b16 v[70:71], v29 offset:33792
    v_mfma_f32_16x16x32_bf16 v[140:143], v[96:99], v[124:127], v[140:143]
    ds_read_b128 v[88:91], v17 offset:36864
    ds_read_b64_tr_b16 v[72:73], v30 offset:32768
    v_mfma_f32_16x16x32_bf16 v[144:147], v[100:103], v[112:115], v[144:147]
    ds_read_b64_tr_b16 v[74:75], v30 offset:33792
    ds_read_b128 v[92:95], v17 offset:37120
    v_mfma_f32_16x16x32_bf16 v[148:151], v[100:103], v[116:119], v[148:151]
    ds_read_b64_tr_b16 v[76:77], v31 offset:32768
    ds_read_b64_tr_b16 v[78:79], v31 offset:33792
    v_mfma_f32_16x16x32_bf16 v[152:155], v[100:103], v[120:123], v[152:155]
    buffer_load_dwordx4 v18, s[8:11], s40 offen offset:0 sc1 lds
    v_mfma_f32_16x16x32_bf16 v[156:159], v[100:103], v[124:127], v[156:159]
    v_mfma_f32_16x16x32_bf16 v[160:163], v[104:107], v[112:115], v[160:163]
    buffer_load_dwordx4 v18, s[8:11], s40 offen offset:1024 sc1 lds
    v_mfma_f32_16x16x32_bf16 v[164:167], v[104:107], v[116:119], v[164:167]
    v_mfma_f32_16x16x32_bf16 v[168:171], v[104:107], v[120:123], v[168:171]
    buffer_load_dwordx4 v18, s[8:11], s40 offen offset:2048 sc1 lds
    v_mfma_f32_16x16x32_bf16 v[172:175], v[104:107], v[124:127], v[172:175]
    v_mfma_f32_16x16x32_bf16 v[176:179], v[108:111], v[112:115], v[176:179]
    buffer_load_dwordx4 v18, s[8:11], s40 offen offset:3072 sc1 lds
    s_add_u32 s40, s40, 4096
    v_mfma_f32_16x16x32_bf16 v[180:183], v[108:111], v[116:119], v[180:183]
    v_mfma_f32_16x16x32_bf16 v[184:187], v[108:111], v[120:123], v[184:187]
    v_mfma_f32_16x16x32_bf16 v[188:191], v[108:111], v[124:127], v[188:191]
    s_waitcnt lgkmcnt(0)
    s_add_u32 m0, s48, 65536
    v_mfma_f32_16x16x32_bf16 v[128:131], v[64:67], v[80:83], v[128:131]
    ds_read_b128 v[112:115], v17 offset:34816
    ds_read_b64_tr_b16 v[96:97], v28 offset:40960
    v_mfma_f32_16x16x32_bf16 v[132:135], v[64:67], v[84:87], v[132:135]
    ds_read_b64_tr_b16 v[98:99], v28 offset:41984
    ds_read_b128 v[116:119], v17 offset:35072
    v_mfma_f32_16x16x32_bf16 v[136:139], v[64:67], v[88:91], v[136:139]
    ds_read_b64_tr_b16 v[100:101], v29 offset:40960
    ds_read_b64_tr_b16 v[102:103], v29 offset:41984
    v_mfma_f32_16x16x32_bf16 v[140:143], v[64:67], v[92:95], v[140:143]
    ds_read_b128 v[120:123], v17 offset:38912
    ds_read_b64_tr_b16 v[104:105], v30 offset:40960
    v_mfma_f32_16x16x32_bf16 v[144:147], v[68:71], v[80:83], v[144:147]
    ds_read_b64_tr_b16 v[106:107], v30 offset:41984
    ds_read_b128 v[124:127], v17 offset:39168
    v_mfma_f32_16x16x32_bf16 v[148:151], v[68:71], v[84:87], v[148:151]
    ds_read_b64_tr_b16 v[108:109], v31 offset:40960
    ds_read_b64_tr_b16 v[110:111], v31 offset:41984
    v_mfma_f32_16x16x32_bf16 v[152:155], v[68:71], v[88:91], v[152:155]
    buffer_load_dwordx4 v20, s[12:15], s41 offen offset:0 lds
    v_mfma_f32_16x16x32_bf16 v[156:159], v[68:71], v[92:95], v[156:159]
    v_mfma_f32_16x16x32_bf16 v[160:163], v[72:75], v[80:83], v[160:163]
    buffer_load_dwordx4 v21, s[12:15], s41 offen offset:1024 lds
    v_mfma_f32_16x16x32_bf16 v[164:167], v[72:75], v[84:87], v[164:167]
    v_mfma_f32_16x16x32_bf16 v[168:171], v[72:75], v[88:91], v[168:171]
    buffer_load_dwordx4 v22, s[12:15], s41 offen offset:2048 lds
    v_mfma_f32_16x16x32_bf16 v[172:175], v[72:75], v[92:95], v[172:175]
    v_mfma_f32_16x16x32_bf16 v[176:179], v[76:79], v[80:83], v[176:179]
    buffer_load_dwordx4 v23, s[12:15], s41 offen offset:3072 lds
    s_add_u32 s41, s41, 524288
    v_mfma_f32_16x16x32_bf16 v[180:183], v[76:79], v[84:87], v[180:183]
    v_mfma_f32_16x16x32_bf16 v[184:187], v[76:79], v[88:91], v[184:187]
    v_mfma_f32_16x16x32_bf16 v[188:191], v[76:79], v[92:95], v[188:191]
    s_waitcnt vmcnt(16) lgkmcnt(0)
    s_barrier
    s_add_u32 m0, s47, 98304
    v_mfma_f32_16x16x32_bf16 v[128:131], v[96:99], v[112:115], v[128:131]
    ds_read_b128 v[80:83], v16 offset:0
    ds_read_b64_tr_b16 v[64:65], v24 offset:0
    v_mfma_f32_16x16x32_bf16 v[132:135], v[96:99], v[116:119], v[132:135]
    ds_read_b64_tr_b16 v[66:67], v24 offset:1024
    ds_read_b128 v[84:87], v16 offset:256
    v_mfma_f32_16x16x32_bf16 v[136:139], v[96:99], v[120:123], v[136:139]
    ds_read_b64_tr_b16 v[68:69], v25 offset:0
    ds_read_b64_tr_b16 v[70:71], v25 offset:1024
    v_mfma_f32_16x16x32_bf16 v[140:143], v[96:99], v[124:127], v[140:143]
    ds_read_b128 v[88:91], v16 offset:4096
    ds_read_b64_tr_b16 v[72:73], v26 offset:0
    v_mfma_f32_16x16x32_bf16 v[144:147], v[100:103], v[112:115], v[144:147]
    ds_read_b64_tr_b16 v[74:75], v26 offset:1024
    ds_read_b128 v[92:95], v16 offset:4352
    v_mfma_f32_16x16x32_bf16 v[148:151], v[100:103], v[116:119], v[148:151]
    ds_read_b64_tr_b16 v[76:77], v27 offset:0
    ds_read_b64_tr_b16 v[78:79], v27 offset:1024
    v_mfma_f32_16x16x32_bf16 v[152:155], v[100:103], v[120:123], v[152:155]
    buffer_load_dwordx4 v18, s[8:11], s40 offen offset:0 sc1 lds
    v_mfma_f32_16x16x32_bf16 v[156:159], v[100:103], v[124:127], v[156:159]
    v_mfma_f32_16x16x32_bf16 v[160:163], v[104:107], v[112:115], v[160:163]
    buffer_load_dwordx4 v18, s[8:11], s40 offen offset:1024 sc1 lds
    v_mfma_f32_16x16x32_bf16 v[164:167], v[104:107], v[116:119], v[164:167]
    v_mfma_f32_16x16x32_bf16 v[168:171], v[104:107], v[120:123], v[168:171]
    buffer_load_dwordx4 v18, s[8:11], s40 offen offset:2048 sc1 lds
    v_mfma_f32_16x16x32_bf16 v[172:175], v[104:107], v[124:127], v[172:175]
    v_mfma_f32_16x16x32_bf16 v[176:179], v[108:111], v[112:115], v[176:179]
    buffer_load_dwordx4 v18, s[8:11], s40 offen offset:3072 sc1 lds
    s_add_u32 s40, s40, 4096
    v_mfma_f32_16x16x32_bf16 v[180:183], v[108:111], v[116:119], v[180:183]
    v_mfma_f32_16x16x32_bf16 v[184:187], v[108:111], v[120:123], v[184:187]
    v_mfma_f32_16x16x32_bf16 v[188:191], v[108:111], v[124:127], v[188:191]
    s_waitcnt lgkmcnt(0)
    s_sub_u32 s44, s44, 1
    s_cmp_lg_u32 s44, 0
    s_cbranch_scc1 Lh_loop_s
    s_add_u32 m0, s48, 98304
    v_mfma_f32_16x16x32_bf16 v[128:131], v[64:67], v[80:83], v[128:131]
    ds_read_b128 v[112:115], v16 offset:2048
    ds_read_b64_tr_b16 v[96:97], v24 offset:8192
    v_mfma_f32_16x16x32_bf16 v[132:135], v[64:67], v[84:87], v[132:135]
    ds_read_b64_tr_b16 v[98:99], v24 offset:9216
    ds_read_b128 v[116:119], v16 offset:2304
    v_mfma_f32_16x16x32_bf16 v[136:139], v[64:67], v[88:91], v[136:139]
    ds_read_b64_tr_b16 v[100:101], v25 offset:8192
    ds_read_b64_tr_b16 v[102:103], v25 offset:9216
    v_mfma_f32_16x16x32_bf16 v[140:143], v[64:67], v[92:95], v[140:143]
    ds_read_b128 v[120:123], v16 offset:6144
    ds_read_b64_tr_b16 v[104:105], v26 offset:8192
    v_mfma_f32_16x16x32_bf16 v[144:147], v[68:71], v[80:83], v[144:147]
    ds_read_b64_tr_b16 v[106:107], v26 offset:9216
    ds_read_b128 v[124:127], v16 offset:6400
    v_mfma_f32_16x16x32_bf16 v[148:151], v[68:71], v[84:87], v[148:151]
    ds_read_b64_tr_b16 v[108:109], v27 offset:8192
    ds_read_b64_tr_b16 v[110:111], v27 offset:9216
    v_mfma_f32_16x16x32_bf16 v[152:155], v[68:71], v[88:91], v[152:155]
    buffer_load_dwordx4 v20, s[12:15], s41 offen offset:0 lds
    v_mfma_f32_16x16x32_bf16 v[156:159], v[68:71], v[92:95], v[156:159]
    v_mfma_f32_16x16x32_bf16 v[160:163], v[72:75], v[80:83], v[160:163]
    buffer_load_dwordx4 v21, s[12:15], s41 offen offset:1024 lds
    v_mfma_f32_16x16x32_bf16 v[164:167], v[72:75], v[84:87], v[164:167]
    v_mfma_f32_16x16x32_bf16 v[168:171], v[72:75], v[88:91], v[168:171]
    buffer_load_dwordx4 v22, s[12:15], s41 offen offset:2048 lds
    v_mfma_f32_16x16x32_bf16 v[172:175], v[72:75], v[92:95], v[172:175]
    v_mfma_f32_16x16x32_bf16 v[176:179], v[76:79], v[80:83], v[176:179]
    buffer_load_dwordx4 v23, s[12:15], s41 offen offset:3072 lds
    s_add_u32 s41, s41, 524288
    v_mfma_f32_16x16x32_bf16 v[180:183], v[76:79], v[84:87], v[180:183]
    v_mfma_f32_16x16x32_bf16 v[184:187], v[76:79], v[88:91], v[184:187]
    v_mfma_f32_16x16x32_bf16 v[188:191], v[76:79], v[92:95], v[188:191]
    s_waitcnt vmcnt(16) lgkmcnt(0)
    s_barrier
    v_mfma_f32_16x16x32_bf16 v[128:131], v[96:99], v[112:115], v[128:131]
    ds_read_b128 v[80:83], v16 offset:32768
    ds_read_b64_tr_b16 v[64:65], v24 offset:32768
    v_mfma_f32_16x16x32_bf16 v[132:135], v[96:99], v[116:119], v[132:135]
    ds_read_b64_tr_b16 v[66:67], v24 offset:33792
    ds_read_b128 v[84:87], v16 offset:33024
    v_mfma_f32_16x16x32_bf16 v[136:139], v[96:99], v[120:123], v[136:139]
    ds_read_b64_tr_b16 v[68:69], v25 offset:32768
    ds_read_b64_tr_b16 v[70:71], v25 offset:33792
    v_mfma_f32_16x16x32_bf16 v[140:143], v[96:99], v[124:127], v[140:143]
    ds_read_b128 v[88:91], v16 offset:36864
    ds_read_b64_tr_b16 v[72:73], v26 offset:32768
    v_mfma_f32_16x16x32_bf16 v[144:147], v[100:103], v[112:115], v[144:147]
    ds_read_b64_tr_b16 v[74:75], v26 offset:33792
    ds_read_b128 v[92:95], v16 offset:37120
    v_mfma_f32_16x16x32_bf16 v[148:151], v[100:103], v[116:119], v[148:151]
    ds_read_b64_tr_b16 v[76:77], v27 offset:32768
    ds_read_b64_tr_b16 v[78:79], v27 offset:33792
    v_mfma_f32_16x16x32_bf16 v[152:155], v[100:103], v[120:123], v[152:155]
    v_mfma_f32_16x16x32_bf16 v[156:159], v[100:103], v[124:127], v[156:159]
    v_mfma_f32_16x16x32_bf16 v[160:163], v[104:107], v[112:115], v[160:163]
    v_mfma_f32_16x16x32_bf16 v[164:167], v[104:107], v[116:119], v[164:167]
    v_mfma_f32_16x16x32_bf16 v[168:171], v[104:107], v[120:123], v[168:171]
    v_mfma_f32_16x16x32_bf16 v[172:175], v[104:107], v[124:127], v[172:175]
    v_mfma_f32_16x16x32_bf16 v[176:179], v[108:111], v[112:115], v[176:179]
    v_mfma_f32_16x16x32_bf16 v[180:183], v[108:111], v[116:119], v[180:183]
    v_mfma_f32_16x16x32_bf16 v[184:187], v[108:111], v[120:123], v[184:187]
    v_mfma_f32_16x16x32_bf16 v[188:191], v[108:111], v[124:127], v[188:191]
    s_waitcnt lgkmcnt(0)
    v_mfma_f32_16x16x32_bf16 v[128:131], v[64:67], v[80:83], v[128:131]
    ds_read_b128 v[112:115], v16 offset:34816
    ds_read_b64_tr_b16 v[96:97], v24 offset:40960
    v_mfma_f32_16x16x32_bf16 v[132:135], v[64:67], v[84:87], v[132:135]
    ds_read_b64_tr_b16 v[98:99], v24 offset:41984
    ds_read_b128 v[116:119], v16 offset:35072
    v_mfma_f32_16x16x32_bf16 v[136:139], v[64:67], v[88:91], v[136:139]
    ds_read_b64_tr_b16 v[100:101], v25 offset:40960
    ds_read_b64_tr_b16 v[102:103], v25 offset:41984
    v_mfma_f32_16x16x32_bf16 v[140:143], v[64:67], v[92:95], v[140:143]
    ds_read_b128 v[120:123], v16 offset:38912
    ds_read_b64_tr_b16 v[104:105], v26 offset:40960
    v_mfma_f32_16x16x32_bf16 v[144:147], v[68:71], v[80:83], v[144:147]
    ds_read_b64_tr_b16 v[106:107], v26 offset:41984
    ds_read_b128 v[124:127], v16 offset:39168
    v_mfma_f32_16x16x32_bf16 v[148:151], v[68:71], v[84:87], v[148:151]
    ds_read_b64_tr_b16 v[108:109], v27 offset:40960
    ds_read_b64_tr_b16 v[110:111], v27 offset:41984
    v_mfma_f32_16x16x32_bf16 v[152:155], v[68:71], v[88:91], v[152:155]
    v_mfma_f32_16x16x32_bf16 v[156:159], v[68:71], v[92:95], v[156:159]
    v_mfma_f32_16x16x32_bf16 v[160:163], v[72:75], v[80:83], v[160:163]
    v_mfma_f32_16x16x32_bf16 v[164:167], v[72:75], v[84:87], v[164:167]
    v_mfma_f32_16x16x32_bf16 v[168:171], v[72:75], v[88:91], v[168:171]
    v_mfma_f32_16x16x32_bf16 v[172:175], v[72:75], v[92:95], v[172:175]
    v_mfma_f32_16x16x32_bf16 v[176:179], v[76:79], v[80:83], v[176:179]
    v_mfma_f32_16x16x32_bf16 v[180:183], v[76:79], v[84:87], v[180:183]
    v_mfma_f32_16x16x32_bf16 v[184:187], v[76:79], v[88:91], v[184:187]
    v_mfma_f32_16x16x32_bf16 v[188:191], v[76:79], v[92:95], v[188:191]
    s_waitcnt vmcnt(8) lgkmcnt(0)
    s_barrier
    v_mfma_f32_16x16x32_bf16 v[128:131], v[96:99], v[112:115], v[128:131]
    ds_read_b128 v[80:83], v17 offset:0
    ds_read_b64_tr_b16 v[64:65], v28 offset:0
    v_mfma_f32_16x16x32_bf16 v[132:135], v[96:99], v[116:119], v[132:135]
    ds_read_b64_tr_b16 v[66:67], v28 offset:1024
    ds_read_b128 v[84:87], v17 offset:256
    v_mfma_f32_16x16x32_bf16 v[136:139], v[96:99], v[120:123], v[136:139]
    ds_read_b64_tr_b16 v[68:69], v29 offset:0
    ds_read_b64_tr_b16 v[70:71], v29 offset:1024
    v_mfma_f32_16x16x32_bf16 v[140:143], v[96:99], v[124:127], v[140:143]
    ds_read_b128 v[88:91], v17 offset:4096
    ds_read_b64_tr_b16 v[72:73], v30 offset:0
    v_mfma_f32_16x16x32_bf16 v[144:147], v[100:103], v[112:115], v[144:147]
    ds_read_b64_tr_b16 v[74:75], v30 offset:1024
    ds_read_b128 v[92:95], v17 offset:4352
    v_mfma_f32_16x16x32_bf16 v[148:151], v[100:103], v[116:119], v[148:151]
    ds_read_b64_tr_b16 v[76:77], v31 offset:0
    ds_read_b64_tr_b16 v[78:79], v31 offset:1024
    v_mfma_f32_16x16x32_bf16 v[152:155], v[100:103], v[120:123], v[152:155]
    v_mfma_f32_16x16x32_bf16 v[156:159], v[100:103], v[124:127], v[156:159]
    v_mfma_f32_16x16x32_bf16 v[160:163], v[104:107], v[112:115], v[160:163]
    v_mfma_f32_16x16x32_bf16 v[164:167], v[104:107], v[116:119], v[164:167]
    v_mfma_f32_16x16x32_bf16 v[168:171], v[104:107], v[120:123], v[168:171]
    v_mfma_f32_16x16x32_bf16 v[172:175], v[104:107], v[124:127], v[172:175]
    v_mfma_f32_16x16x32_bf16 v[176:179], v[108:111], v[112:115], v[176:179]
    v_mfma_f32_16x16x32_bf16 v[180:183], v[108:111], v[116:119], v[180:183]
    v_mfma_f32_16x16x32_bf16 v[184:187], v[108:111], v[120:123], v[184:187]
    v_mfma_f32_16x16x32_bf16 v[188:191], v[108:111], v[124:127], v[188:191]
    s_waitcnt lgkmcnt(0)
    v_mfma_f32_16x16x32_bf16 v[128:131], v[64:67], v[80:83], v[128:131]
    ds_read_b128 v[112:115], v17 offset:2048
    ds_read_b64_tr_b16 v[96:97], v28 offset:8192
    v_mfma_f32_16x16x32_bf16 v[132:135], v[64:67], v[84:87], v[132:135]
    ds_read_b64_tr_b16 v[98:99], v28 offset:9216
    ds_read_b128 v[116:119], v17 offset:2304
    v_mfma_f32_16x16x32_bf16 v[136:139], v[64:67], v[88:91], v[136:139]
    ds_read_b64_tr_b16 v[100:101], v29 offset:8192
    ds_read_b64_tr_b16 v[102:103], v29 offset:9216
    v_mfma_f32_16x16x32_bf16 v[140:143], v[64:67], v[92:95], v[140:143]
    ds_read_b128 v[120:123], v17 offset:6144
    ds_read_b64_tr_b16 v[104:105], v30 offset:8192
    v_mfma_f32_16x16x32_bf16 v[144:147], v[68:71], v[80:83], v[144:147]
    ds_read_b64_tr_b16 v[106:107], v30 offset:9216
    ds_read_b128 v[124:127], v17 offset:6400
    v_mfma_f32_16x16x32_bf16 v[148:151], v[68:71], v[84:87], v[148:151]
    ds_read_b64_tr_b16 v[108:109], v31 offset:8192
    ds_read_b64_tr_b16 v[110:111], v31 offset:9216
    v_mfma_f32_16x16x32_bf16 v[152:155], v[68:71], v[88:91], v[152:155]
    v_mfma_f32_16x16x32_bf16 v[156:159], v[68:71], v[92:95], v[156:159]
    v_mfma_f32_16x16x32_bf16 v[160:163], v[72:75], v[80:83], v[160:163]
    v_mfma_f32_16x16x32_bf16 v[164:167], v[72:75], v[84:87], v[164:167]
    v_mfma_f32_16x16x32_bf16 v[168:171], v[72:75], v[88:91], v[168:171]
    v_mfma_f32_16x16x32_bf16 v[172:175], v[72:75], v[92:95], v[172:175]
    v_mfma_f32_16x16x32_bf16 v[176:179], v[76:79], v[80:83], v[176:179]
    v_mfma_f32_16x16x32_bf16 v[180:183], v[76:79], v[84:87], v[180:183]
    v_mfma_f32_16x16x32_bf16 v[184:187], v[76:79], v[88:91], v[184:187]
    v_mfma_f32_16x16x32_bf16 v[188:191], v[76:79], v[92:95], v[188:191]
    s_waitcnt vmcnt(0) lgkmcnt(0)
    s_barrier
    v_mfma_f32_16x16x32_bf16 v[128:131], v[96:99], v[112:115], v[128:131]
    ds_read_b128 v[80:83], v17 offset:32768
    ds_read_b64_tr_b16 v[64:65], v28 offset:32768
    v_mfma_f32_16x16x32_bf16 v[132:135], v[96:99], v[116:119], v[132:135]
    ds_read_b64_tr_b16 v[66:67], v28 offset:33792
    ds_read_b128 v[84:87], v17 offset:33024
    v_mfma_f32_16x16x32_bf16 v[136:139], v[96:99], v[120:123], v[136:139]
    ds_read_b64_tr_b16 v[68:69], v29 offset:32768
    ds_read_b64_tr_b16 v[70:71], v29 offset:33792
    v_mfma_f32_16x16x32_bf16 v[140:143], v[96:99], v[124:127], v[140:143]
    ds_read_b128 v[88:91], v17 offset:36864
    ds_read_b64_tr_b16 v[72:73], v30 offset:32768
    v_mfma_f32_16x16x32_bf16 v[144:147], v[100:103], v[112:115], v[144:147]
    ds_read_b64_tr_b16 v[74:75], v30 offset:33792
    ds_read_b128 v[92:95], v17 offset:37120
    v_mfma_f32_16x16x32_bf16 v[148:151], v[100:103], v[116:119], v[148:151]
    ds_read_b64_tr_b16 v[76:77], v31 offset:32768
    ds_read_b64_tr_b16 v[78:79], v31 offset:33792
    v_mfma_f32_16x16x32_bf16 v[152:155], v[100:103], v[120:123], v[152:155]
    v_mfma_f32_16x16x32_bf16 v[156:159], v[100:103], v[124:127], v[156:159]
    v_mfma_f32_16x16x32_bf16 v[160:163], v[104:107], v[112:115], v[160:163]
    v_mfma_f32_16x16x32_bf16 v[164:167], v[104:107], v[116:119], v[164:167]
    v_mfma_f32_16x16x32_bf16 v[168:171], v[104:107], v[120:123], v[168:171]
    v_mfma_f32_16x16x32_bf16 v[172:175], v[104:107], v[124:127], v[172:175]
    v_mfma_f32_16x16x32_bf16 v[176:179], v[108:111], v[112:115], v[176:179]
    v_mfma_f32_16x16x32_bf16 v[180:183], v[108:111], v[116:119], v[180:183]
    v_mfma_f32_16x16x32_bf16 v[184:187], v[108:111], v[120:123], v[184:187]
    v_mfma_f32_16x16x32_bf16 v[188:191], v[108:111], v[124:127], v[188:191]
    s_waitcnt lgkmcnt(0)
    v_mfma_f32_16x16x32_bf16 v[128:131], v[64:67], v[80:83], v[128:131]
    ds_read_b128 v[112:115], v17 offset:34816
    ds_read_b64_tr_b16 v[96:97], v28 offset:40960
    v_mfma_f32_16x16x32_bf16 v[132:135], v[64:67], v[84:87], v[132:135]
    ds_read_b64_tr_b16 v[98:99], v28 offset:41984
    ds_read_b128 v[116:119], v17 offset:35072
    v_mfma_f32_16x16x32_bf16 v[136:139], v[64:67], v[88:91], v[136:139]
    ds_read_b64_tr_b16 v[100:101], v29 offset:40960
    ds_read_b64_tr_b16 v[102:103], v29 offset:41984
    v_mfma_f32_16x16x32_bf16 v[140:143], v[64:67], v[92:95], v[140:143]
    ds_read_b128 v[120:123], v17 offset:38912
    ds_read_b64_tr_b16 v[104:105], v30 offset:40960
    v_mfma_f32_16x16x32_bf16 v[144:147], v[68:71], v[80:83], v[144:147]
    ds_read_b64_tr_b16 v[106:107], v30 offset:41984
    ds_read_b128 v[124:127], v17 offset:39168
    v_mfma_f32_16x16x32_bf16 v[148:151], v[68:71], v[84:87], v[148:151]
    ds_read_b64_tr_b16 v[108:109], v31 offset:40960
    ds_read_b64_tr_b16 v[110:111], v31 offset:41984
    v_mfma_f32_16x16x32_bf16 v[152:155], v[68:71], v[88:91], v[152:155]
    v_mfma_f32_16x16x32_bf16 v[156:159], v[68:71], v[92:95], v[156:159]
    v_mfma_f32_16x16x32_bf16 v[160:163], v[72:75], v[80:83], v[160:163]
    v_mfma_f32_16x16x32_bf16 v[164:167], v[72:75], v[84:87], v[164:167]
    v_mfma_f32_16x16x32_bf16 v[168:171], v[72:75], v[88:91], v[168:171]
    v_mfma_f32_16x16x32_bf16 v[172:175], v[72:75], v[92:95], v[172:175]
    v_mfma_f32_16x16x32_bf16 v[176:179], v[76:79], v[80:83], v[176:179]
    v_mfma_f32_16x16x32_bf16 v[180:183], v[76:79], v[84:87], v[180:183]
    v_mfma_f32_16x16x32_bf16 v[184:187], v[76:79], v[88:91], v[184:187]
    v_mfma_f32_16x16x32_bf16 v[188:191], v[76:79], v[92:95], v[188:191]
    s_waitcnt vmcnt(0) lgkmcnt(0)
    s_barrier
    v_mfma_f32_16x16x32_bf16 v[128:131], v[96:99], v[112:115], v[128:131]
    v_mfma_f32_16x16x32_bf16 v[132:135], v[96:99], v[116:119], v[132:135]
    v_mfma_f32_16x16x32_bf16 v[136:139], v[96:99], v[120:123], v[136:139]
    v_mfma_f32_16x16x32_bf16 v[140:143], v[96:99], v[124:127], v[140:143]
    v_mfma_f32_16x16x32_bf16 v[144:147], v[100:103], v[112:115], v[144:147]
    v_mfma_f32_16x16x32_bf16 v[148:151], v[100:103], v[116:119], v[148:151]
    v_mfma_f32_16x16x32_bf16 v[152:155], v[100:103], v[120:123], v[152:155]
    v_mfma_f32_16x16x32_bf16 v[156:159], v[100:103], v[124:127], v[156:159]
    v_mfma_f32_16x16x32_bf16 v[160:163], v[104:107], v[112:115], v[160:163]
    v_mfma_f32_16x16x32_bf16 v[164:167], v[104:107], v[116:119], v[164:167]
    v_mfma_f32_16x16x32_bf16 v[168:171], v[104:107], v[120:123], v[168:171]
    v_mfma_f32_16x16x32_bf16 v[172:175], v[104:107], v[124:127], v[172:175]
    v_mfma_f32_16x16x32_bf16 v[176:179], v[108:111], v[112:115], v[176:179]
    v_mfma_f32_16x16x32_bf16 v[180:183], v[108:111], v[116:119], v[180:183]
    v_mfma_f32_16x16x32_bf16 v[184:187], v[108:111], v[120:123], v[184:187]
    v_mfma_f32_16x16x32_bf16 v[188:191], v[108:111], v[124:127], v[188:191]
    s_waitcnt lgkmcnt(0)
    s_cmp_lg_u32 s46, 0
    s_cbranch_scc1 Lld_x
    v_lshlrev_b32 v2, 2, v1
    s_mov_b32 s24, 0
    s_mov_b32 exec_lo, 0
    s_mov_b32 exec_hi, 2
Lln_x:
    buffer_load_dword v3, v2, s[4:7], 0 offen sc1
    s_waitcnt vmcnt(0)
    v_cmp_ne_u32 vcc, 16, v3
    s_cbranch_vccz Lld_x
    s_sleep 3
    s_add_u32 s24, s24, 1
    s_cmp_lt_u32 s24, 2000000
    s_cbranch_scc1 Lln_x
    s_mov_b64 exec, -1
    s_branch Lw_fail
Lld_x:
    s_mov_b64 exec, -1
    s_barrier
    s_lshl_b32 s53, s37, 24
    s_lshl_b32 s54, s36, 20
    s_add_u32 s53, s53, s54
    s_lshl_b32 s54, s38, 13
    s_add_u32 s53, s53, s54
    s_add_u32 s53, s53, 4194304
    s_lshr_b32 s49, s46, 1
    s_lshl_b32 s49, s49, 19
    s_and_b32 s50, s46, 1
    s_lshl_b32 s50, s50, 12
    s_add_u32 s49, s49, s50
    s_add_u32 s53, s53, s49
    s_nop 7
    v_lshlrev_b32 v6, 4, v1
    v_cvt_pk_bf16_f32 v64, v128, v129
    v_cvt_pk_bf16_f32 v65, v130, v131
    v_cvt_pk_bf16_f32 v66, v132, v133
    v_cvt_pk_bf16_f32 v67, v134, v135
    s_nop 0
    v_permlane16_swap_b32 v64, v66
    v_permlane16_swap_b32 v65, v67
    buffer_store_dwordx4 v[64:67], v6, s[8:11], s53 offen offset:0 sc1
    v_cvt_pk_bf16_f32 v68, v144, v145
    v_cvt_pk_bf16_f32 v69, v146, v147
    v_cvt_pk_bf16_f32 v70, v148, v149
    v_cvt_pk_bf16_f32 v71, v150, v151
    s_nop 0
    v_permlane16_swap_b32 v68, v70
    v_permlane16_swap_b32 v69, v71
    buffer_store_dwordx4 v[68:71], v6, s[8:11], s53 offen offset:1024 sc1
    v_cvt_pk_bf16_f32 v72, v160, v161
    v_cvt_pk_bf16_f32 v73, v162, v163
    v_cvt_pk_bf16_f32 v74, v164, v165
    v_cvt_pk_bf16_f32 v75, v166, v167
    s_nop 0
    v_permlane16_swap_b32 v72, v74
    v_permlane16_swap_b32 v73, v75
    buffer_store_dwordx4 v[72:75], v6, s[8:11], s53 offen offset:2048 sc1
    v_cvt_pk_bf16_f32 v76, v176, v177
    v_cvt_pk_bf16_f32 v77, v178, v179
    v_cvt_pk_bf16_f32 v78, v180, v181
    v_cvt_pk_bf16_f32 v79, v182, v183
    s_nop 0
    v_permlane16_swap_b32 v76, v78
    v_permlane16_swap_b32 v77, v79
    buffer_store_dwordx4 v[76:79], v6, s[8:11], s53 offen offset:3072 sc1
    s_add_u32 s53, s53, 0x40000
    v_cvt_pk_bf16_f32 v80, v136, v137
    v_cvt_pk_bf16_f32 v81, v138, v139
    v_cvt_pk_bf16_f32 v82, v140, v141
    v_cvt_pk_bf16_f32 v83, v142, v143
    s_nop 0
    v_permlane16_swap_b32 v80, v82
    v_permlane16_swap_b32 v81, v83
    buffer_store_dwordx4 v[80:83], v6, s[8:11], s53 offen offset:0 sc1
    v_cvt_pk_bf16_f32 v84, v152, v153
    v_cvt_pk_bf16_f32 v85, v154, v155
    v_cvt_pk_bf16_f32 v86, v156, v157
    v_cvt_pk_bf16_f32 v87, v158, v159
    s_nop 0
    v_permlane16_swap_b32 v84, v86
    v_permlane16_swap_b32 v85, v87
    buffer_store_dwordx4 v[84:87], v6, s[8:11], s53 offen offset:1024 sc1
    v_cvt_pk_bf16_f32 v88, v168, v169
    v_cvt_pk_bf16_f32 v89, v170, v171
    v_cvt_pk_bf16_f32 v90, v172, v173
    v_cvt_pk_bf16_f32 v91, v174, v175
    s_nop 0
    v_permlane16_swap_b32 v88, v90
    v_permlane16_swap_b32 v89, v91
    buffer_store_dwordx4 v[88:91], v6, s[8:11], s53 offen offset:2048 sc1
    v_cvt_pk_bf16_f32 v92, v184, v185
    v_cvt_pk_bf16_f32 v93, v186, v187
    v_cvt_pk_bf16_f32 v94, v188, v189
    v_cvt_pk_bf16_f32 v95, v190, v191
    s_nop 0
    v_permlane16_swap_b32 v92, v94
    v_permlane16_swap_b32 v93, v95
    buffer_store_dwordx4 v[92:95], v6, s[8:11], s53 offen offset:3072 sc1
    s_add_u32 s53, s53, 0x40000
    s_lshl_b32 s53, s20, 9
    s_lshl_b32 s54, s36, 4
    s_add_u32 s53, s53, s54
    s_add_u32 s92, s53, 120061952
    s_cmp_eq_u32 s37, 0
    s_cselect_b32 s93, 16, 1
    s_mov_b64 s[94:95], 15
    s_setpc_b64 s[62:63]
Lw_fail:
    s_mov_b32 s12, s84
    s_mov_b32 s13, s85
    s_mov_b32 s14, 0x100
    s_mov_b32 s15, 0x20000
    v_mov_b32 v2, 248
    v_mov_b32 v3, 0xbeef
    s_mov_b64 exec, 1
    buffer_store_dword v3, v2, s[12:15], 0 offen
    s_endpgm
Lcode1:
.section .rodata,"a"
.p2align 6
.amdhsa_kernel main_kernel
  .amdhsa_next_free_vgpr 512
  .amdhsa_next_free_sgpr 102
  .amdhsa_accum_offset 256
  .amdhsa_group_segment_fixed_size 0
  .amdhsa_kernarg_size 112
  .amdhsa_user_sgpr_count 2
  .amdhsa_user_sgpr_kernarg_segment_ptr 1
  .amdhsa_system_sgpr_workgroup_id_x 1
.end_amdhsa_kernel
```
